```python
import torch

def _softmax(x, axis=-1):
    return torch.softmax(x, dim=axis)
def _gelu(x):
    return torch.nn.functional.gelu(x, approximate="tanh")
def _silu(x):
    return torch.nn.functional.silu(x)
def _sigmoid(x):
    return torch.sigmoid(x)
def _layernorm(x, axis=-1, eps=1e-5):
    m = x.mean(dim=axis, keepdim=True)
    v = x.var(dim=axis, keepdim=True, unbiased=False)
    return (x - m) / torch.sqrt(v + eps)
def _scatter_add(tgt, idx, src, axis=0):
    return tgt.clone().index_add_(axis, idx, src)
def _segment_sum(src, seg, n):
    out = torch.zeros((n,) + src.shape[1:], dtype=src.dtype)
    return out.index_add_(0, seg, src)
def _pad(x, pw):
    flat = tuple(v for pair in reversed(pw) for v in pair)
    return torch.nn.functional.pad(x, flat)

kernel_name = 'concat_heads__gqa_block_cached__mha_block_cached__near_ridge'

def setup_inputs():

    _w = (lambda a: (lambda t: t.to(torch.bfloat16) if t.is_floating_point() else t)(torch.as_tensor(a)))
    def _A_setup():
        B, Sq, D = 32, 80, 448
        Hq, Hkv, Sk, Dh = 16, 8, 512, 256
        assert Hq % Hkv == 0, (Hq, Hkv)
        return {
            "x": _w((lambda *s: torch.randn(*s, dtype=torch.bfloat16) * 0.8)(B, Sq, D)),
            "k_cache": _w((lambda *s: torch.randn(*s, dtype=torch.bfloat16) * 0.8)(B, Hkv, Sk, Dh)),
            "v_cache": _w((lambda *s: torch.randn(*s, dtype=torch.bfloat16) * 0.05)(B, Hkv, Sk, Dh)),
            "wq": _w((lambda *s: torch.randn(*s, dtype=torch.bfloat16) * 0.8)(D, Hq * Dh) * (D ** -0.5)),
            "wo": _w((lambda *s: torch.randn(*s, dtype=torch.bfloat16) * 0.05)(Hq * Dh, D) * ((Hq * Dh) ** -0.5)),
        }
    _A_in = _A_setup()

    def _B_setup():
        B, Sq, D = 32, 80, 448
        H, Sk, Dh = 16, 512, 256
        return {
            "x": _w((lambda *s: torch.randn(*s, dtype=torch.bfloat16) * 0.8)(B, Sq, D)),
            "k_cache": _w((lambda *s: torch.randn(*s, dtype=torch.bfloat16) * 0.8)(B, H, Sk, Dh)),
            "v_cache": _w((lambda *s: torch.randn(*s, dtype=torch.bfloat16) * 0.05)(B, H, Sk, Dh)),
            "wq": _w((lambda *s: torch.randn(*s, dtype=torch.bfloat16) * 0.8)(D, H * Dh) * (D ** -0.5)),
            "wo": _w((lambda *s: torch.randn(*s, dtype=torch.bfloat16) * 0.05)(H * Dh, D) * ((H * Dh) ** -0.5)),
        }
    _B_in = _B_setup()

    return {
        "A_x": _A_in["x"],
        "A_k_cache": _A_in["k_cache"],
        "A_v_cache": _A_in["v_cache"],
        "A_wq": _A_in["wq"],
        "A_wo": _A_in["wo"],
        "B_x": _B_in["x"],
        "B_k_cache": _B_in["k_cache"],
        "B_v_cache": _B_in["v_cache"],
        "B_wq": _B_in["wq"],
        "B_wo": _B_in["wo"],
    }

def reference(A_x, A_k_cache, A_v_cache, A_wq, A_wo, B_x, B_k_cache, B_v_cache, B_wq, B_wo):
    def _A_ref(x, k_cache, v_cache, wq, wo):
        B, Sq, D = x.shape
        Hq, Dh = 16, 256
        Hkv = k_cache.shape[1]
        rep = Hq // Hkv
        q = (lambda x, *d: x.permute(*d))((x @ wq).reshape(B, Sq, Hq, Dh), 0, 2, 1, 3)
        k = (lambda x, n, axis: torch.repeat_interleave(x, n, dim=axis))(k_cache, rep, axis=1)
        v = (lambda x, n, axis: torch.repeat_interleave(x, n, dim=axis))(v_cache, rep, axis=1)
        scores = torch.einsum("bhqd,bhkd->bhqk", q, k) * (Dh ** -0.5)
        p = _softmax(scores, axis=-1)
        o = torch.einsum("bhqk,bhkd->bhqd", p, v)
        return (lambda x, *d: x.permute(*d))(o, 0, 2, 1, 3).reshape(B, Sq, Hq * Dh) @ wo

    def _B_ref(x, k_cache, v_cache, wq, wo):
        B, Sq, D = x.shape
        H, Dh = 16, 256
        q = (lambda x, *d: x.permute(*d))((x @ wq).reshape(B, Sq, H, Dh), 0, 2, 1, 3)
        scores = torch.einsum("bhqd,bhkd->bhqk", q, k_cache) * (Dh ** -0.5)
        p = _softmax(scores, axis=-1)
        o = torch.einsum("bhqk,bhkd->bhqd", p, v_cache)
        return (lambda x, *d: x.permute(*d))(o, 0, 2, 1, 3).reshape(B, Sq, H * Dh) @ wo

    a = _A_ref(A_x, A_k_cache, A_v_cache, A_wq, A_wo)
    b = _B_ref(B_x, B_k_cache, B_v_cache, B_wq, B_wo)
    return torch.concatenate([a, b], axis=-1)
```

```asm
; @launch grid=(256,1,1) block=(512,1,1) lds=163840
.amdgcn_target "amdgcn-amd-amdhsa--gfx950"
.text
.globl concat_heads__gqa_block_cached__mha_block_cached__near_ridge_kernel
.p2align 8
.type concat_heads__gqa_block_cached__mha_block_cached__near_ridge_kernel,@function
concat_heads__gqa_block_cached__mha_block_cached__near_ridge_kernel:
s_cmp_ge_u32 s2, 256
s_cbranch_scc1 L_exit
s_load_dwordx16 s[64:79], s[0:1], 0
s_load_dwordx8 s[80:87], s[0:1], 64
s_load_dwordx2 s[88:89], s[0:1], 96
v_lshrrev_b32 v1, 6, v0
v_and_b32 v235, 63, v0
v_readfirstlane_b32 s3, v1
v_and_b32 v1, 7, v235
v_lshrrev_b32 v2, 4, v235
v_lshlrev_b32 v3, 1, v2
v_xor_b32 v1, v1, v3
v_lshlrev_b32 v1, 4, v1
v_lshrrev_b32 v4, 3, v235
v_lshl_add_u32 v232, v4, 9, v1
v_mul_u32_u24 v5, 896, v4
v_add_u32 v234, v5, v1
v_and_b32 v5, 3, v4
v_lshrrev_b32 v6, 2, v4
v_lshl_add_u32 v5, v6, 3, v5
v_lshl_add_u32 v233, v5, 13, v1
s_lshl_b32 s4, s3, 13
s_add_u32 s4, s4, 81920
s_add_u32 s5, s4, 4096
s_lshr_b32 s14, s3, 2
s_and_b32 s15, s3, 3
s_lshl_b32 s13, s14, 15
v_bfe_u32 v5, v235, 2, 3
v_lshrrev_b32 v6, 1, v5
v_lshlrev_b32 v6, 1, v6
v_bfe_u32 v7, v235, 1, 1
v_xor_b32 v6, v6, v7
v_lshlrev_b32 v6, 4, v6
v_lshl_add_u32 v6, v5, 7, v6
v_and_b32 v8, 1, v235
v_lshl_add_u32 v6, v8, 3, v6
v_lshrrev_b32 v9, 5, v235
v_lshl_add_u32 v6, v9, 10, v6
v_add_u32 v236, s4, v6
v_xor_b32 v237, 32, v236
v_xor_b32 v238, 64, v236
v_xor_b32 v239, 96, v236
v_and_b32 v5, 15, v235
v_and_b32 v6, 6, v235
v_xor_b32 v6, v6, v2
v_lshlrev_b32 v6, 4, v6
v_lshl_add_u32 v6, v5, 7, v6
v_add_u32 v240, s4, v6
v_xor_b32 v241, 64, v240
v_xor_b32 v6, v5, v3
v_lshl_add_u32 v6, v2, 4, v6
v_lshlrev_b32 v242, 4, v6
v_add_u32 v243, 40960, v242
s_mul_i32 s8, s14, 40960
v_add_u32 v244, s8, v242
s_mul_i32 s12, s3, 10240
s_mov_b32 s6, 0x3db8aa3b
s_and_b32 s97, s2, 7
s_lshr_b32 s98, s2, 3
s_lshr_b32 s8, s98, 1
s_sub_u32 s9, s8, 7
s_cmp_ge_u32 s8, 7
s_cselect_b32 s8, s9, s8
s_sub_u32 s9, s8, 7
s_cmp_ge_u32 s8, 7
s_cselect_b32 s8, s9, s8
s_add_u32 s9, s8, 0
s_sub_u32 s10, s9, 7
s_cmp_ge_u32 s9, 7
s_cselect_b32 s9, s10, s9
s_lshl_b32 s90, s9, 19
s_add_u32 s9, s8, 1
s_sub_u32 s10, s9, 7
s_cmp_ge_u32 s9, 7
s_cselect_b32 s9, s10, s9
s_lshl_b32 s91, s9, 19
s_add_u32 s9, s8, 2
s_sub_u32 s10, s9, 7
s_cmp_ge_u32 s9, 7
s_cselect_b32 s9, s10, s9
s_lshl_b32 s92, s9, 19
s_add_u32 s9, s8, 3
s_sub_u32 s10, s9, 7
s_cmp_ge_u32 s9, 7
s_cselect_b32 s9, s10, s9
s_lshl_b32 s93, s9, 19
s_add_u32 s9, s8, 4
s_sub_u32 s10, s9, 7
s_cmp_ge_u32 s9, 7
s_cselect_b32 s9, s10, s9
s_lshl_b32 s94, s9, 19
s_add_u32 s9, s8, 5
s_sub_u32 s10, s9, 7
s_cmp_ge_u32 s9, 7
s_cselect_b32 s9, s10, s9
s_lshl_b32 s95, s9, 19
s_add_u32 s9, s8, 6
s_sub_u32 s10, s9, 7
s_cmp_ge_u32 s9, 7
s_cselect_b32 s9, s10, s9
s_lshl_b32 s96, s9, 19
s_add_u32 s9, s8, s3
s_sub_u32 s10, s9, 7
s_cmp_ge_u32 s9, 7
s_cselect_b32 s9, s10, s9
s_lshl_b32 s99, s9, 7
s_mul_i32 s7, s98, 14336
s_waitcnt lgkmcnt(0)
s_bitcmp1_b32 s98, 0
s_cselect_b64 s[8:9], s[74:75], s[64:65]
s_cselect_b64 s[74:75], s[64:65], s[74:75]
s_mov_b64 s[64:65], s[8:9]
s_cselect_b64 s[8:9], s[80:81], s[70:71]
s_cselect_b64 s[80:81], s[70:71], s[80:81]
s_mov_b64 s[70:71], s[8:9]
s_mul_i32 s8, s98, 71680
s_add_u32 s8, s8, s99
s_add_u32 s16, s64, s8
s_addc_u32 s17, s65, 0
s_sub_u32 s18, 2293760, s8
s_mov_b32 s19, 0x20000
s_cmp_eq_u32 s3, 7
s_cselect_b32 s18, 0, s18
s_lshl_b32 s9, s3, 7
s_lshl_b32 s8, s97, 10
s_add_u32 s8, s8, s9
s_add_u32 s20, s70, s8
s_addc_u32 s21, s71, 0
s_sub_u32 s22, 3670016, s8
s_mov_b32 s23, 0x20000
s_mul_i32 s8, s97, 458752
s_add_u32 s8, s8, s9
s_add_u32 s32, s72, s8
s_addc_u32 s33, s73, 0
s_sub_u32 s34, 3670016, s8
s_mov_b32 s35, 0x20000
s_cmp_eq_u32 s3, 7
s_cselect_b32 s34, 0, s34
s_lshl_b32 s10, s2, 18
s_lshl_b32 s8, s14, 13
s_add_u32 s10, s10, s8
s_lshl_b32 s8, s15, 15
s_add_u32 s8, s8, s10
s_add_u32 s24, s66, s8
s_addc_u32 s25, s67, 0
s_sub_u32 s26, 67108864, s8
s_mov_b32 s27, 0x20000
s_lshl_b32 s8, s15, 7
s_add_u32 s8, s8, s10
s_add_u32 s28, s68, s8
s_addc_u32 s29, s69, 0
s_sub_u32 s30, 67108864, s8
s_mov_b32 s31, 0x20000
s_add_u32 s8, s2, 0
s_mul_i32 s8, s8, 71680
s_add_u32 s8, s8, s12
s_add_u32 s36, s88, s8
s_addc_u32 s37, s89, 0
s_sub_u32 s38, 36700160, s8
s_mov_b32 s39, 0x20000
s_cmp_eq_u32 s3, 7
s_cselect_b32 s38, 0, s38
s_mul_i32 s8, s98, 71680
s_add_u32 s8, s8, s99
s_add_u32 s40, s74, s8
s_addc_u32 s41, s75, 0
s_sub_u32 s42, 2293760, s8
s_mov_b32 s43, 0x20000
s_cmp_eq_u32 s3, 7
s_cselect_b32 s42, 0, s42
s_lshl_b32 s9, s3, 7
s_lshl_b32 s8, s97, 10
s_add_u32 s8, s8, s9
s_add_u32 s44, s80, s8
s_addc_u32 s45, s81, 0
s_sub_u32 s46, 3670016, s8
s_mov_b32 s47, 0x20000
s_mul_i32 s8, s97, 458752
s_add_u32 s8, s8, s9
s_add_u32 s56, s82, s8
s_addc_u32 s57, s83, 0
s_sub_u32 s58, 3670016, s8
s_mov_b32 s59, 0x20000
s_cmp_eq_u32 s3, 7
s_cselect_b32 s58, 0, s58
s_lshl_b32 s10, s2, 19
s_lshl_b32 s8, s14, 18
s_add_u32 s10, s10, s8
s_lshl_b32 s8, s15, 15
s_add_u32 s8, s8, s10
s_add_u32 s48, s76, s8
s_addc_u32 s49, s77, 0
s_sub_u32 s50, 134217728, s8
s_mov_b32 s51, 0x20000
s_lshl_b32 s8, s15, 7
s_add_u32 s8, s8, s10
s_add_u32 s52, s78, s8
s_addc_u32 s53, s79, 0
s_sub_u32 s54, 134217728, s8
s_mov_b32 s55, 0x20000
s_add_u32 s8, s2, 256
s_mul_i32 s8, s8, 71680
s_add_u32 s8, s8, s12
s_add_u32 s60, s88, s8
s_addc_u32 s61, s89, 0
s_sub_u32 s62, 36700160, s8
s_mov_b32 s63, 0x20000
s_cmp_eq_u32 s3, 7
s_cselect_b32 s62, 0, s62
s_lshr_b32 s8, s98, 1
s_add_u32 s8, s8, s97
s_and_b32 s8, s8, 3
s_add_u32 s9, s8, 0
s_and_b32 s9, s9, 3
s_lshl_b32 s66, s9, 7
s_add_u32 s9, s8, 1
s_and_b32 s9, s9, 3
s_lshl_b32 s67, s9, 7
s_add_u32 s9, s8, 2
s_and_b32 s9, s9, 3
s_lshl_b32 s68, s9, 7
s_add_u32 s9, s8, 3
s_and_b32 s9, s9, 3
s_lshl_b32 s69, s9, 7
s_sub_u32 s9, s15, s8
s_and_b32 s9, s9, 3
s_mul_i32 s9, s9, 10240
s_mul_i32 s70, s14, 40960
s_add_u32 s70, s70, s9
s_lshr_b32 s8, s98, 1
s_add_u32 s9, s8, 0
s_and_b32 s9, s9, 7
s_mul_i32 s76, s9, 57344
s_add_u32 s9, s8, 1
s_and_b32 s9, s9, 7
s_mul_i32 s77, s9, 57344
s_add_u32 s9, s8, 2
s_and_b32 s9, s9, 7
s_mul_i32 s78, s9, 57344
s_add_u32 s9, s8, 3
s_and_b32 s9, s9, 7
s_mul_i32 s79, s9, 57344
s_add_u32 s9, s8, 4
s_and_b32 s9, s9, 7
s_mul_i32 s80, s9, 57344
s_add_u32 s9, s8, 5
s_and_b32 s9, s9, 7
s_mul_i32 s81, s9, 57344
s_add_u32 s9, s8, 6
s_and_b32 s9, s9, 7
s_mul_i32 s82, s9, 57344
s_add_u32 s9, s8, 7
s_and_b32 s9, s9, 7
s_mul_i32 s83, s9, 57344
s_sub_u32 s9, s3, s8
s_and_b32 s9, s9, 7
s_mul_i32 s71, s9, 10240
s_and_b32 s72, s98, 1
s_mov_b32 m0, s4
s_add_u32 s9, s90, 0
buffer_load_dwordx4 v233, s[20:23], s9 offen lds
s_add_u32 s8, s90, 130048
buffer_load_dwordx4 v233, s[20:23], s8 offen offset:1024 lds
s_mov_b32 m0, s4
s_add_u32 s9, s90, 30720
buffer_load_dwordx4 v233, s[20:23], s9 offen offset:2048 lds
s_add_u32 s8, s90, 160768
buffer_load_dwordx4 v233, s[20:23], s8 offen offset:3072 lds
s_barrier
s_cmp_ge_u32 s3, 4
s_cbranch_scc1 L_xa
v_lshrrev_b32 v251, 3, v235
v_bfe_u32 v252, v235, 2, 1
v_xor_b32 v251, v251, v252
v_mul_u32_u24 v251, 896, v251
v_and_b32 v252, 7, v235
v_lshl_add_u32 v251, v252, 4, v251
s_mov_b32 s9, 0
buffer_load_dwordx4 v[80:83], v251, s[16:19], s9 offen
s_mov_b32 s8, 7168
buffer_load_dwordx4 v[84:87], v251, s[16:19], s8 offen
s_mov_b32 s9, 14336
buffer_load_dwordx4 v[88:91], v251, s[16:19], s9 offen
s_mov_b32 s8, 21504
buffer_load_dwordx4 v[92:95], v251, s[16:19], s8 offen
s_mov_b32 s9, 28672
buffer_load_dwordx4 v[96:99], v251, s[16:19], s9 offen
s_mov_b32 s8, 35840
buffer_load_dwordx4 v[100:103], v251, s[16:19], s8 offen
s_mov_b32 s9, 43008
buffer_load_dwordx4 v[104:107], v251, s[16:19], s9 offen
s_mov_b32 s8, 50176
buffer_load_dwordx4 v[108:111], v251, s[16:19], s8 offen
s_mov_b32 s9, 57344
buffer_load_dwordx4 v[112:115], v251, s[16:19], s9 offen
s_mov_b32 s8, 64512
buffer_load_dwordx4 v[116:119], v251, s[16:19], s8 offen
L_xa:
s_mov_b32 m0, s5
s_add_u32 s9, s90, 262144
buffer_load_dwordx4 v233, s[20:23], s9 offen lds
s_add_u32 s8, s90, 392192
buffer_load_dwordx4 v233, s[20:23], s8 offen offset:1024 lds
s_mov_b32 m0, s5
s_add_u32 s9, s90, 292864
buffer_load_dwordx4 v233, s[20:23], s9 offen offset:2048 lds
s_add_u32 s8, s90, 422912
buffer_load_dwordx4 v233, s[20:23], s8 offen offset:3072 lds
v_lshrrev_b32 v251, 3, v235
v_bfe_u32 v252, v235, 2, 1
v_xor_b32 v251, v251, v252
v_and_b32 v253, 3, v235
v_lshl_add_u32 v251, v253, 4, v251
v_lshlrev_b32 v253, 1, v253
v_xor_b32 v251, v251, v253
v_lshlrev_b32 v251, 4, v251
v_mul_u32_u24 v252, 5120, v252
v_add3_u32 v251, v251, v252, s12
s_waitcnt vmcnt(6)
ds_read_b64_tr_b16 v[200:201], v236 offset:0
ds_read_b64_tr_b16 v[204:205], v237 offset:0
ds_read_b64_tr_b16 v[208:209], v238 offset:0
ds_read_b64_tr_b16 v[212:213], v239 offset:0
s_waitcnt vmcnt(4)
ds_read_b64_tr_b16 v[202:203], v236 offset:2048
ds_read_b64_tr_b16 v[206:207], v237 offset:2048
ds_read_b64_tr_b16 v[210:211], v238 offset:2048
ds_read_b64_tr_b16 v[214:215], v239 offset:2048
s_cmp_ge_u32 s3, 4
s_cbranch_scc1 L_xs
ds_write_b128 v251, v[80:83] offset:0
ds_write_b128 v251, v[84:87] offset:128
ds_write_b128 v251, v[88:91] offset:1024
ds_write_b128 v251, v[92:95] offset:1152
ds_write_b128 v251, v[96:99] offset:2048
ds_write_b128 v251, v[100:103] offset:2176
ds_write_b128 v251, v[104:107] offset:3072
ds_write_b128 v251, v[108:111] offset:3200
ds_write_b128 v251, v[112:115] offset:4096
ds_write_b128 v251, v[116:119] offset:4224
L_xs:
s_waitcnt lgkmcnt(0)
s_barrier
ds_read_b128 v[160:163], v242 offset:0
ds_read_b128 v[164:167], v242 offset:1024
ds_read_b128 v[168:171], v242 offset:2048
ds_read_b128 v[172:175], v242 offset:3072
ds_read_b128 v[176:179], v242 offset:4096
ds_read_b128 v[180:183], v242 offset:5120
ds_read_b128 v[184:187], v242 offset:6144
ds_read_b128 v[188:191], v242 offset:7168
ds_read_b128 v[192:195], v242 offset:8192
ds_read_b128 v[196:199], v242 offset:9216
s_mov_b32 m0, s4
s_add_u32 s9, s91, 0
buffer_load_dwordx4 v233, s[20:23], s9 offen lds
s_add_u32 s8, s91, 130048
buffer_load_dwordx4 v233, s[20:23], s8 offen offset:1024 lds
s_mov_b32 m0, s4
s_add_u32 s9, s91, 30720
buffer_load_dwordx4 v233, s[20:23], s9 offen offset:2048 lds
s_add_u32 s8, s91, 160768
buffer_load_dwordx4 v233, s[20:23], s8 offen offset:3072 lds
s_cmp_lt_u32 s3, 4
s_cbranch_scc1 L_xb
v_lshrrev_b32 v246, 3, v235
v_bfe_u32 v247, v235, 2, 1
v_xor_b32 v246, v246, v247
v_mul_u32_u24 v246, 896, v246
v_and_b32 v247, 7, v235
v_lshl_add_u32 v246, v247, 4, v246
s_mov_b32 s9, 0
buffer_load_dwordx4 v[80:83], v246, s[16:19], s9 offen
s_mov_b32 s8, 7168
buffer_load_dwordx4 v[84:87], v246, s[16:19], s8 offen
s_mov_b32 s9, 14336
buffer_load_dwordx4 v[88:91], v246, s[16:19], s9 offen
s_mov_b32 s8, 21504
buffer_load_dwordx4 v[92:95], v246, s[16:19], s8 offen
s_mov_b32 s9, 28672
buffer_load_dwordx4 v[96:99], v246, s[16:19], s9 offen
s_mov_b32 s8, 35840
buffer_load_dwordx4 v[100:103], v246, s[16:19], s8 offen
s_mov_b32 s9, 43008
buffer_load_dwordx4 v[104:107], v246, s[16:19], s9 offen
s_mov_b32 s8, 50176
buffer_load_dwordx4 v[108:111], v246, s[16:19], s8 offen
s_mov_b32 s9, 57344
buffer_load_dwordx4 v[112:115], v246, s[16:19], s9 offen
s_mov_b32 s8, 64512
buffer_load_dwordx4 v[116:119], v246, s[16:19], s8 offen
L_xb:
s_waitcnt lgkmcnt(9)
v_mfma_f32_16x16x32_bf16 v[0:3], v[200:203], v[160:163], 0
v_mfma_f32_16x16x32_bf16 v[20:23], v[204:207], v[160:163], 0
s_waitcnt vmcnt(6)
ds_read_b64_tr_b16 v[216:217], v236 offset:4096
ds_read_b64_tr_b16 v[220:221], v237 offset:4096
ds_read_b64_tr_b16 v[224:225], v238 offset:4096
ds_read_b64_tr_b16 v[228:229], v239 offset:4096
v_mfma_f32_16x16x32_bf16 v[40:43], v[208:211], v[160:163], 0
v_mfma_f32_16x16x32_bf16 v[60:63], v[212:215], v[160:163], 0
ds_read_b128 v[160:163], v242 offset:10240
s_waitcnt lgkmcnt(13)
v_mfma_f32_16x16x32_bf16 v[4:7], v[200:203], v[164:167], 0
v_mfma_f32_16x16x32_bf16 v[24:27], v[204:207], v[164:167], 0
v_mfma_f32_16x16x32_bf16 v[44:47], v[208:211], v[164:167], 0
s_waitcnt lgkmcnt(1)
s_mov_b32 m0, s5
s_add_u32 s9, s91, 262144
buffer_load_dwordx4 v233, s[20:23], s9 offen lds
s_add_u32 s8, s91, 392192
buffer_load_dwordx4 v233, s[20:23], s8 offen offset:1024 lds
v_mfma_f32_16x16x32_bf16 v[64:67], v[212:215], v[164:167], 0
ds_read_b128 v[164:167], v242 offset:11264
v_mfma_f32_16x16x32_bf16 v[8:11], v[200:203], v[168:171], 0
s_waitcnt vmcnt(6)
ds_read_b64_tr_b16 v[218:219], v236 offset:6144
ds_read_b64_tr_b16 v[222:223], v237 offset:6144
ds_read_b64_tr_b16 v[226:227], v238 offset:6144
ds_read_b64_tr_b16 v[230:231], v239 offset:6144
v_mfma_f32_16x16x32_bf16 v[28:31], v[204:207], v[168:171], 0
v_mfma_f32_16x16x32_bf16 v[48:51], v[208:211], v[168:171], 0
v_mfma_f32_16x16x32_bf16 v[68:71], v[212:215], v[168:171], 0
ds_read_b128 v[168:171], v242 offset:12288
v_mfma_f32_16x16x32_bf16 v[12:15], v[200:203], v[172:175], 0
v_mfma_f32_16x16x32_bf16 v[32:35], v[204:207], v[172:175], 0
s_waitcnt lgkmcnt(1)
s_mov_b32 m0, s5
s_add_u32 s9, s91, 292864
buffer_load_dwordx4 v233, s[20:23], s9 offen offset:2048 lds
s_add_u32 s8, s91, 422912
buffer_load_dwordx4 v233, s[20:23], s8 offen offset:3072 lds
v_mfma_f32_16x16x32_bf16 v[52:55], v[208:211], v[172:175], 0
v_mfma_f32_16x16x32_bf16 v[72:75], v[212:215], v[172:175], 0
ds_read_b128 v[172:175], v242 offset:13312
v_mfma_f32_16x16x32_bf16 v[16:19], v[200:203], v[176:179], 0
v_mfma_f32_16x16x32_bf16 v[36:39], v[204:207], v[176:179], 0
v_mfma_f32_16x16x32_bf16 v[56:59], v[208:211], v[176:179], 0
v_mfma_f32_16x16x32_bf16 v[76:79], v[212:215], v[176:179], 0
ds_read_b128 v[176:179], v242 offset:14336
v_mfma_f32_16x16x32_bf16 v[0:3], v[216:219], v[180:183], v[0:3]
v_mfma_f32_16x16x32_bf16 v[20:23], v[220:223], v[180:183], v[20:23]
s_waitcnt vmcnt(6)
ds_read_b64_tr_b16 v[200:201], v236 offset:0
ds_read_b64_tr_b16 v[204:205], v237 offset:0
ds_read_b64_tr_b16 v[208:209], v238 offset:0
ds_read_b64_tr_b16 v[212:213], v239 offset:0
v_mfma_f32_16x16x32_bf16 v[40:43], v[224:227], v[180:183], v[40:43]
v_mfma_f32_16x16x32_bf16 v[60:63], v[228:231], v[180:183], v[60:63]
ds_read_b128 v[180:183], v242 offset:15360
v_mfma_f32_16x16x32_bf16 v[4:7], v[216:219], v[184:187], v[4:7]
v_mfma_f32_16x16x32_bf16 v[24:27], v[220:223], v[184:187], v[24:27]
v_mfma_f32_16x16x32_bf16 v[44:47], v[224:227], v[184:187], v[44:47]
s_waitcnt lgkmcnt(1)
s_mov_b32 m0, s4
s_add_u32 s9, s92, 0
buffer_load_dwordx4 v233, s[20:23], s9 offen lds
s_add_u32 s8, s92, 130048
buffer_load_dwordx4 v233, s[20:23], s8 offen offset:1024 lds
v_mfma_f32_16x16x32_bf16 v[64:67], v[228:231], v[184:187], v[64:67]
ds_read_b128 v[184:187], v242 offset:16384
v_mfma_f32_16x16x32_bf16 v[8:11], v[216:219], v[188:191], v[8:11]
s_waitcnt vmcnt(6)
ds_read_b64_tr_b16 v[202:203], v236 offset:2048
ds_read_b64_tr_b16 v[206:207], v237 offset:2048
ds_read_b64_tr_b16 v[210:211], v238 offset:2048
ds_read_b64_tr_b16 v[214:215], v239 offset:2048
v_mfma_f32_16x16x32_bf16 v[28:31], v[220:223], v[188:191], v[28:31]
v_mfma_f32_16x16x32_bf16 v[48:51], v[224:227], v[188:191], v[48:51]
v_mfma_f32_16x16x32_bf16 v[68:71], v[228:231], v[188:191], v[68:71]
ds_read_b128 v[188:191], v242 offset:17408
v_mfma_f32_16x16x32_bf16 v[12:15], v[216:219], v[192:195], v[12:15]
v_mfma_f32_16x16x32_bf16 v[32:35], v[220:223], v[192:195], v[32:35]
s_waitcnt lgkmcnt(1)
s_mov_b32 m0, s4
s_add_u32 s9, s92, 30720
buffer_load_dwordx4 v233, s[20:23], s9 offen offset:2048 lds
s_add_u32 s8, s92, 160768
buffer_load_dwordx4 v233, s[20:23], s8 offen offset:3072 lds
v_mfma_f32_16x16x32_bf16 v[52:55], v[224:227], v[192:195], v[52:55]
v_mfma_f32_16x16x32_bf16 v[72:75], v[228:231], v[192:195], v[72:75]
ds_read_b128 v[192:195], v242 offset:18432
v_mfma_f32_16x16x32_bf16 v[16:19], v[216:219], v[196:199], v[16:19]
v_mfma_f32_16x16x32_bf16 v[36:39], v[220:223], v[196:199], v[36:39]
v_mfma_f32_16x16x32_bf16 v[56:59], v[224:227], v[196:199], v[56:59]
v_mfma_f32_16x16x32_bf16 v[76:79], v[228:231], v[196:199], v[76:79]
ds_read_b128 v[196:199], v242 offset:19456
v_mfma_f32_16x16x32_bf16 v[0:3], v[200:203], v[160:163], v[0:3]
v_mfma_f32_16x16x32_bf16 v[20:23], v[204:207], v[160:163], v[20:23]
s_waitcnt vmcnt(6)
ds_read_b64_tr_b16 v[216:217], v236 offset:4096
ds_read_b64_tr_b16 v[220:221], v237 offset:4096
ds_read_b64_tr_b16 v[224:225], v238 offset:4096
ds_read_b64_tr_b16 v[228:229], v239 offset:4096
v_mfma_f32_16x16x32_bf16 v[40:43], v[208:211], v[160:163], v[40:43]
v_mfma_f32_16x16x32_bf16 v[60:63], v[212:215], v[160:163], v[60:63]
ds_read_b128 v[160:163], v242 offset:20480
v_mfma_f32_16x16x32_bf16 v[4:7], v[200:203], v[164:167], v[4:7]
v_mfma_f32_16x16x32_bf16 v[24:27], v[204:207], v[164:167], v[24:27]
v_mfma_f32_16x16x32_bf16 v[44:47], v[208:211], v[164:167], v[44:47]
s_waitcnt lgkmcnt(1)
s_mov_b32 m0, s5
s_add_u32 s9, s92, 262144
buffer_load_dwordx4 v233, s[20:23], s9 offen lds
s_add_u32 s8, s92, 392192
buffer_load_dwordx4 v233, s[20:23], s8 offen offset:1024 lds
v_mfma_f32_16x16x32_bf16 v[64:67], v[212:215], v[164:167], v[64:67]
ds_read_b128 v[164:167], v242 offset:21504
v_mfma_f32_16x16x32_bf16 v[8:11], v[200:203], v[168:171], v[8:11]
s_waitcnt vmcnt(6)
ds_read_b64_tr_b16 v[218:219], v236 offset:6144
ds_read_b64_tr_b16 v[222:223], v237 offset:6144
ds_read_b64_tr_b16 v[226:227], v238 offset:6144
ds_read_b64_tr_b16 v[230:231], v239 offset:6144
v_mfma_f32_16x16x32_bf16 v[28:31], v[204:207], v[168:171], v[28:31]
v_mfma_f32_16x16x32_bf16 v[48:51], v[208:211], v[168:171], v[48:51]
v_mfma_f32_16x16x32_bf16 v[68:71], v[212:215], v[168:171], v[68:71]
ds_read_b128 v[168:171], v242 offset:22528
v_mfma_f32_16x16x32_bf16 v[12:15], v[200:203], v[172:175], v[12:15]
v_mfma_f32_16x16x32_bf16 v[32:35], v[204:207], v[172:175], v[32:35]
s_waitcnt lgkmcnt(1)
s_mov_b32 m0, s5
s_add_u32 s9, s92, 292864
buffer_load_dwordx4 v233, s[20:23], s9 offen offset:2048 lds
s_add_u32 s8, s92, 422912
buffer_load_dwordx4 v233, s[20:23], s8 offen offset:3072 lds
v_mfma_f32_16x16x32_bf16 v[52:55], v[208:211], v[172:175], v[52:55]
v_mfma_f32_16x16x32_bf16 v[72:75], v[212:215], v[172:175], v[72:75]
ds_read_b128 v[172:175], v242 offset:23552
v_mfma_f32_16x16x32_bf16 v[16:19], v[200:203], v[176:179], v[16:19]
v_mfma_f32_16x16x32_bf16 v[36:39], v[204:207], v[176:179], v[36:39]
v_mfma_f32_16x16x32_bf16 v[56:59], v[208:211], v[176:179], v[56:59]
v_mfma_f32_16x16x32_bf16 v[76:79], v[212:215], v[176:179], v[76:79]
ds_read_b128 v[176:179], v242 offset:24576
v_mfma_f32_16x16x32_bf16 v[0:3], v[216:219], v[180:183], v[0:3]
v_mfma_f32_16x16x32_bf16 v[20:23], v[220:223], v[180:183], v[20:23]
s_waitcnt vmcnt(6)
ds_read_b64_tr_b16 v[200:201], v236 offset:0
ds_read_b64_tr_b16 v[204:205], v237 offset:0
ds_read_b64_tr_b16 v[208:209], v238 offset:0
ds_read_b64_tr_b16 v[212:213], v239 offset:0
v_mfma_f32_16x16x32_bf16 v[40:43], v[224:227], v[180:183], v[40:43]
v_mfma_f32_16x16x32_bf16 v[60:63], v[228:231], v[180:183], v[60:63]
ds_read_b128 v[180:183], v242 offset:25600
v_mfma_f32_16x16x32_bf16 v[4:7], v[216:219], v[184:187], v[4:7]
v_mfma_f32_16x16x32_bf16 v[24:27], v[220:223], v[184:187], v[24:27]
v_mfma_f32_16x16x32_bf16 v[44:47], v[224:227], v[184:187], v[44:47]
s_waitcnt lgkmcnt(1)
s_mov_b32 m0, s4
s_add_u32 s9, s93, 0
buffer_load_dwordx4 v233, s[20:23], s9 offen lds
s_add_u32 s8, s93, 130048
buffer_load_dwordx4 v233, s[20:23], s8 offen offset:1024 lds
v_mfma_f32_16x16x32_bf16 v[64:67], v[228:231], v[184:187], v[64:67]
ds_read_b128 v[184:187], v242 offset:26624
v_mfma_f32_16x16x32_bf16 v[8:11], v[216:219], v[188:191], v[8:11]
s_waitcnt vmcnt(6)
ds_read_b64_tr_b16 v[202:203], v236 offset:2048
ds_read_b64_tr_b16 v[206:207], v237 offset:2048
ds_read_b64_tr_b16 v[210:211], v238 offset:2048
ds_read_b64_tr_b16 v[214:215], v239 offset:2048
v_mfma_f32_16x16x32_bf16 v[28:31], v[220:223], v[188:191], v[28:31]
v_mfma_f32_16x16x32_bf16 v[48:51], v[224:227], v[188:191], v[48:51]
s_cmp_lt_u32 s3, 4
s_cbranch_scc1 L_xt
ds_write_b128 v251, v[80:83] offset:0
ds_write_b128 v251, v[84:87] offset:128
ds_write_b128 v251, v[88:91] offset:1024
ds_write_b128 v251, v[92:95] offset:1152
ds_write_b128 v251, v[96:99] offset:2048
ds_write_b128 v251, v[100:103] offset:2176
ds_write_b128 v251, v[104:107] offset:3072
ds_write_b128 v251, v[108:111] offset:3200
ds_write_b128 v251, v[112:115] offset:4096
ds_write_b128 v251, v[116:119] offset:4224
L_xt:
v_mfma_f32_16x16x32_bf16 v[68:71], v[228:231], v[188:191], v[68:71]
ds_read_b128 v[188:191], v242 offset:27648
v_mfma_f32_16x16x32_bf16 v[12:15], v[216:219], v[192:195], v[12:15]
v_mfma_f32_16x16x32_bf16 v[32:35], v[220:223], v[192:195], v[32:35]
s_waitcnt lgkmcnt(1)
s_mov_b32 m0, s4
s_add_u32 s9, s93, 30720
buffer_load_dwordx4 v233, s[20:23], s9 offen offset:2048 lds
s_add_u32 s8, s93, 160768
buffer_load_dwordx4 v233, s[20:23], s8 offen offset:3072 lds
v_mfma_f32_16x16x32_bf16 v[52:55], v[224:227], v[192:195], v[52:55]
v_mfma_f32_16x16x32_bf16 v[72:75], v[228:231], v[192:195], v[72:75]
ds_read_b128 v[192:195], v242 offset:28672
v_mfma_f32_16x16x32_bf16 v[16:19], v[216:219], v[196:199], v[16:19]
v_mfma_f32_16x16x32_bf16 v[36:39], v[220:223], v[196:199], v[36:39]
v_mfma_f32_16x16x32_bf16 v[56:59], v[224:227], v[196:199], v[56:59]
v_mfma_f32_16x16x32_bf16 v[76:79], v[228:231], v[196:199], v[76:79]
ds_read_b128 v[196:199], v242 offset:29696
v_mfma_f32_16x16x32_bf16 v[0:3], v[200:203], v[160:163], v[0:3]
v_mfma_f32_16x16x32_bf16 v[20:23], v[204:207], v[160:163], v[20:23]
s_waitcnt vmcnt(6)
ds_read_b64_tr_b16 v[216:217], v236 offset:4096
ds_read_b64_tr_b16 v[220:221], v237 offset:4096
ds_read_b64_tr_b16 v[224:225], v238 offset:4096
ds_read_b64_tr_b16 v[228:229], v239 offset:4096
v_mfma_f32_16x16x32_bf16 v[40:43], v[208:211], v[160:163], v[40:43]
v_mfma_f32_16x16x32_bf16 v[60:63], v[212:215], v[160:163], v[60:63]
ds_read_b128 v[160:163], v242 offset:30720
v_mfma_f32_16x16x32_bf16 v[4:7], v[200:203], v[164:167], v[4:7]
v_mfma_f32_16x16x32_bf16 v[24:27], v[204:207], v[164:167], v[24:27]
v_mfma_f32_16x16x32_bf16 v[44:47], v[208:211], v[164:167], v[44:47]
s_waitcnt lgkmcnt(1)
s_mov_b32 m0, s5
s_add_u32 s9, s93, 262144
buffer_load_dwordx4 v233, s[20:23], s9 offen lds
s_add_u32 s8, s93, 392192
buffer_load_dwordx4 v233, s[20:23], s8 offen offset:1024 lds
v_mfma_f32_16x16x32_bf16 v[64:67], v[212:215], v[164:167], v[64:67]
ds_read_b128 v[164:167], v242 offset:31744
v_mfma_f32_16x16x32_bf16 v[8:11], v[200:203], v[168:171], v[8:11]
s_waitcnt vmcnt(6)
ds_read_b64_tr_b16 v[218:219], v236 offset:6144
ds_read_b64_tr_b16 v[222:223], v237 offset:6144
ds_read_b64_tr_b16 v[226:227], v238 offset:6144
ds_read_b64_tr_b16 v[230:231], v239 offset:6144
v_mfma_f32_16x16x32_bf16 v[28:31], v[204:207], v[168:171], v[28:31]
v_mfma_f32_16x16x32_bf16 v[48:51], v[208:211], v[168:171], v[48:51]
v_mfma_f32_16x16x32_bf16 v[68:71], v[212:215], v[168:171], v[68:71]
ds_read_b128 v[168:171], v242 offset:32768
v_mfma_f32_16x16x32_bf16 v[12:15], v[200:203], v[172:175], v[12:15]
v_mfma_f32_16x16x32_bf16 v[32:35], v[204:207], v[172:175], v[32:35]
s_waitcnt lgkmcnt(1)
s_mov_b32 m0, s5
s_add_u32 s9, s93, 292864
buffer_load_dwordx4 v233, s[20:23], s9 offen offset:2048 lds
s_add_u32 s8, s93, 422912
buffer_load_dwordx4 v233, s[20:23], s8 offen offset:3072 lds
v_mfma_f32_16x16x32_bf16 v[52:55], v[208:211], v[172:175], v[52:55]
v_mfma_f32_16x16x32_bf16 v[72:75], v[212:215], v[172:175], v[72:75]
ds_read_b128 v[172:175], v242 offset:33792
v_mfma_f32_16x16x32_bf16 v[16:19], v[200:203], v[176:179], v[16:19]
v_mfma_f32_16x16x32_bf16 v[36:39], v[204:207], v[176:179], v[36:39]
v_mfma_f32_16x16x32_bf16 v[56:59], v[208:211], v[176:179], v[56:59]
v_mfma_f32_16x16x32_bf16 v[76:79], v[212:215], v[176:179], v[76:79]
ds_read_b128 v[176:179], v242 offset:34816
v_mfma_f32_16x16x32_bf16 v[0:3], v[216:219], v[180:183], v[0:3]
v_mfma_f32_16x16x32_bf16 v[20:23], v[220:223], v[180:183], v[20:23]
s_waitcnt vmcnt(6)
ds_read_b64_tr_b16 v[200:201], v236 offset:0
ds_read_b64_tr_b16 v[204:205], v237 offset:0
ds_read_b64_tr_b16 v[208:209], v238 offset:0
ds_read_b64_tr_b16 v[212:213], v239 offset:0
v_mfma_f32_16x16x32_bf16 v[40:43], v[224:227], v[180:183], v[40:43]
v_mfma_f32_16x16x32_bf16 v[60:63], v[228:231], v[180:183], v[60:63]
ds_read_b128 v[180:183], v242 offset:35840
v_mfma_f32_16x16x32_bf16 v[4:7], v[216:219], v[184:187], v[4:7]
v_mfma_f32_16x16x32_bf16 v[24:27], v[220:223], v[184:187], v[24:27]
v_mfma_f32_16x16x32_bf16 v[44:47], v[224:227], v[184:187], v[44:47]
s_waitcnt lgkmcnt(1)
s_mov_b32 m0, s4
s_add_u32 s9, s94, 0
buffer_load_dwordx4 v233, s[20:23], s9 offen lds
s_add_u32 s8, s94, 130048
buffer_load_dwordx4 v233, s[20:23], s8 offen offset:1024 lds
v_mfma_f32_16x16x32_bf16 v[64:67], v[228:231], v[184:187], v[64:67]
ds_read_b128 v[184:187], v242 offset:36864
v_mfma_f32_16x16x32_bf16 v[8:11], v[216:219], v[188:191], v[8:11]
s_waitcnt vmcnt(6)
ds_read_b64_tr_b16 v[202:203], v236 offset:2048
ds_read_b64_tr_b16 v[206:207], v237 offset:2048
ds_read_b64_tr_b16 v[210:211], v238 offset:2048
ds_read_b64_tr_b16 v[214:215], v239 offset:2048
v_mfma_f32_16x16x32_bf16 v[28:31], v[220:223], v[188:191], v[28:31]
v_mfma_f32_16x16x32_bf16 v[48:51], v[224:227], v[188:191], v[48:51]
s_waitcnt lgkmcnt(0)
s_barrier
v_mfma_f32_16x16x32_bf16 v[68:71], v[228:231], v[188:191], v[68:71]
ds_read_b128 v[188:191], v242 offset:37888
v_mfma_f32_16x16x32_bf16 v[12:15], v[216:219], v[192:195], v[12:15]
v_mfma_f32_16x16x32_bf16 v[32:35], v[220:223], v[192:195], v[32:35]
s_mov_b32 m0, s4
s_add_u32 s9, s94, 30720
buffer_load_dwordx4 v233, s[20:23], s9 offen offset:2048 lds
s_add_u32 s8, s94, 160768
buffer_load_dwordx4 v233, s[20:23], s8 offen offset:3072 lds
v_mfma_f32_16x16x32_bf16 v[52:55], v[224:227], v[192:195], v[52:55]
v_mfma_f32_16x16x32_bf16 v[72:75], v[228:231], v[192:195], v[72:75]
ds_read_b128 v[192:195], v242 offset:38912
v_mfma_f32_16x16x32_bf16 v[16:19], v[216:219], v[196:199], v[16:19]
v_mfma_f32_16x16x32_bf16 v[36:39], v[220:223], v[196:199], v[36:39]
v_mfma_f32_16x16x32_bf16 v[56:59], v[224:227], v[196:199], v[56:59]
v_mfma_f32_16x16x32_bf16 v[76:79], v[228:231], v[196:199], v[76:79]
ds_read_b128 v[196:199], v242 offset:39936
v_mfma_f32_16x16x32_bf16 v[0:3], v[200:203], v[160:163], v[0:3]
v_mfma_f32_16x16x32_bf16 v[20:23], v[204:207], v[160:163], v[20:23]
s_waitcnt vmcnt(6)
ds_read_b64_tr_b16 v[216:217], v236 offset:4096
ds_read_b64_tr_b16 v[220:221], v237 offset:4096
ds_read_b64_tr_b16 v[224:225], v238 offset:4096
ds_read_b64_tr_b16 v[228:229], v239 offset:4096
v_mfma_f32_16x16x32_bf16 v[40:43], v[208:211], v[160:163], v[40:43]
v_mfma_f32_16x16x32_bf16 v[60:63], v[212:215], v[160:163], v[60:63]
ds_read_b128 v[160:163], v243 offset:0
v_mfma_f32_16x16x32_bf16 v[4:7], v[200:203], v[164:167], v[4:7]
v_mfma_f32_16x16x32_bf16 v[24:27], v[204:207], v[164:167], v[24:27]
v_mfma_f32_16x16x32_bf16 v[44:47], v[208:211], v[164:167], v[44:47]
s_waitcnt lgkmcnt(1)
s_mov_b32 m0, s5
s_add_u32 s9, s94, 262144
buffer_load_dwordx4 v233, s[20:23], s9 offen lds
s_add_u32 s8, s94, 392192
buffer_load_dwordx4 v233, s[20:23], s8 offen offset:1024 lds
v_mfma_f32_16x16x32_bf16 v[64:67], v[212:215], v[164:167], v[64:67]
ds_read_b128 v[164:167], v243 offset:1024
v_mfma_f32_16x16x32_bf16 v[8:11], v[200:203], v[168:171], v[8:11]
s_waitcnt vmcnt(6)
ds_read_b64_tr_b16 v[218:219], v236 offset:6144
ds_read_b64_tr_b16 v[222:223], v237 offset:6144
ds_read_b64_tr_b16 v[226:227], v238 offset:6144
ds_read_b64_tr_b16 v[230:231], v239 offset:6144
v_mfma_f32_16x16x32_bf16 v[28:31], v[204:207], v[168:171], v[28:31]
v_mfma_f32_16x16x32_bf16 v[48:51], v[208:211], v[168:171], v[48:51]
v_mfma_f32_16x16x32_bf16 v[68:71], v[212:215], v[168:171], v[68:71]
ds_read_b128 v[168:171], v243 offset:2048
v_mfma_f32_16x16x32_bf16 v[12:15], v[200:203], v[172:175], v[12:15]
v_mfma_f32_16x16x32_bf16 v[32:35], v[204:207], v[172:175], v[32:35]
s_waitcnt lgkmcnt(1)
s_mov_b32 m0, s5
s_add_u32 s9, s94, 292864
buffer_load_dwordx4 v233, s[20:23], s9 offen offset:2048 lds
s_add_u32 s8, s94, 422912
buffer_load_dwordx4 v233, s[20:23], s8 offen offset:3072 lds
v_mfma_f32_16x16x32_bf16 v[52:55], v[208:211], v[172:175], v[52:55]
v_mfma_f32_16x16x32_bf16 v[72:75], v[212:215], v[172:175], v[72:75]
ds_read_b128 v[172:175], v243 offset:3072
v_mfma_f32_16x16x32_bf16 v[16:19], v[200:203], v[176:179], v[16:19]
v_mfma_f32_16x16x32_bf16 v[36:39], v[204:207], v[176:179], v[36:39]
v_mfma_f32_16x16x32_bf16 v[56:59], v[208:211], v[176:179], v[56:59]
v_mfma_f32_16x16x32_bf16 v[76:79], v[212:215], v[176:179], v[76:79]
ds_read_b128 v[176:179], v243 offset:4096
v_mfma_f32_16x16x32_bf16 v[0:3], v[216:219], v[180:183], v[0:3]
v_mfma_f32_16x16x32_bf16 v[20:23], v[220:223], v[180:183], v[20:23]
s_waitcnt vmcnt(6)
ds_read_b64_tr_b16 v[200:201], v236 offset:0
ds_read_b64_tr_b16 v[204:205], v237 offset:0
ds_read_b64_tr_b16 v[208:209], v238 offset:0
ds_read_b64_tr_b16 v[212:213], v239 offset:0
v_mfma_f32_16x16x32_bf16 v[40:43], v[224:227], v[180:183], v[40:43]
v_mfma_f32_16x16x32_bf16 v[60:63], v[228:231], v[180:183], v[60:63]
ds_read_b128 v[180:183], v243 offset:5120
v_mfma_f32_16x16x32_bf16 v[4:7], v[216:219], v[184:187], v[4:7]
v_mfma_f32_16x16x32_bf16 v[24:27], v[220:223], v[184:187], v[24:27]
v_mfma_f32_16x16x32_bf16 v[44:47], v[224:227], v[184:187], v[44:47]
s_waitcnt lgkmcnt(1)
s_mov_b32 m0, s4
s_add_u32 s9, s95, 0
buffer_load_dwordx4 v233, s[20:23], s9 offen lds
s_add_u32 s8, s95, 130048
buffer_load_dwordx4 v233, s[20:23], s8 offen offset:1024 lds
v_mfma_f32_16x16x32_bf16 v[64:67], v[228:231], v[184:187], v[64:67]
ds_read_b128 v[184:187], v243 offset:6144
v_mfma_f32_16x16x32_bf16 v[8:11], v[216:219], v[188:191], v[8:11]
s_waitcnt vmcnt(6)
ds_read_b64_tr_b16 v[202:203], v236 offset:2048
ds_read_b64_tr_b16 v[206:207], v237 offset:2048
ds_read_b64_tr_b16 v[210:211], v238 offset:2048
ds_read_b64_tr_b16 v[214:215], v239 offset:2048
v_mfma_f32_16x16x32_bf16 v[28:31], v[220:223], v[188:191], v[28:31]
v_mfma_f32_16x16x32_bf16 v[48:51], v[224:227], v[188:191], v[48:51]
v_mfma_f32_16x16x32_bf16 v[68:71], v[228:231], v[188:191], v[68:71]
ds_read_b128 v[188:191], v243 offset:7168
v_mfma_f32_16x16x32_bf16 v[12:15], v[216:219], v[192:195], v[12:15]
v_mfma_f32_16x16x32_bf16 v[32:35], v[220:223], v[192:195], v[32:35]
s_waitcnt lgkmcnt(1)
s_mov_b32 m0, s4
s_add_u32 s9, s95, 30720
buffer_load_dwordx4 v233, s[20:23], s9 offen offset:2048 lds
s_add_u32 s8, s95, 160768
buffer_load_dwordx4 v233, s[20:23], s8 offen offset:3072 lds
v_mfma_f32_16x16x32_bf16 v[52:55], v[224:227], v[192:195], v[52:55]
v_mfma_f32_16x16x32_bf16 v[72:75], v[228:231], v[192:195], v[72:75]
ds_read_b128 v[192:195], v243 offset:8192
v_mfma_f32_16x16x32_bf16 v[16:19], v[216:219], v[196:199], v[16:19]
v_mfma_f32_16x16x32_bf16 v[36:39], v[220:223], v[196:199], v[36:39]
v_mfma_f32_16x16x32_bf16 v[56:59], v[224:227], v[196:199], v[56:59]
v_mfma_f32_16x16x32_bf16 v[76:79], v[228:231], v[196:199], v[76:79]
ds_read_b128 v[196:199], v243 offset:9216
v_mfma_f32_16x16x32_bf16 v[0:3], v[200:203], v[160:163], v[0:3]
v_mfma_f32_16x16x32_bf16 v[20:23], v[204:207], v[160:163], v[20:23]
s_waitcnt vmcnt(6)
ds_read_b64_tr_b16 v[216:217], v236 offset:4096
ds_read_b64_tr_b16 v[220:221], v237 offset:4096
ds_read_b64_tr_b16 v[224:225], v238 offset:4096
ds_read_b64_tr_b16 v[228:229], v239 offset:4096
v_mfma_f32_16x16x32_bf16 v[40:43], v[208:211], v[160:163], v[40:43]
v_mfma_f32_16x16x32_bf16 v[60:63], v[212:215], v[160:163], v[60:63]
ds_read_b128 v[160:163], v243 offset:10240
v_mfma_f32_16x16x32_bf16 v[4:7], v[200:203], v[164:167], v[4:7]
v_mfma_f32_16x16x32_bf16 v[24:27], v[204:207], v[164:167], v[24:27]
v_mfma_f32_16x16x32_bf16 v[44:47], v[208:211], v[164:167], v[44:47]
s_waitcnt lgkmcnt(1)
s_mov_b32 m0, s5
s_add_u32 s9, s95, 262144
buffer_load_dwordx4 v233, s[20:23], s9 offen lds
s_add_u32 s8, s95, 392192
buffer_load_dwordx4 v233, s[20:23], s8 offen offset:1024 lds
v_mfma_f32_16x16x32_bf16 v[64:67], v[212:215], v[164:167], v[64:67]
ds_read_b128 v[164:167], v243 offset:11264
v_mfma_f32_16x16x32_bf16 v[8:11], v[200:203], v[168:171], v[8:11]
s_waitcnt vmcnt(6)
ds_read_b64_tr_b16 v[218:219], v236 offset:6144
ds_read_b64_tr_b16 v[222:223], v237 offset:6144
ds_read_b64_tr_b16 v[226:227], v238 offset:6144
ds_read_b64_tr_b16 v[230:231], v239 offset:6144
v_mfma_f32_16x16x32_bf16 v[28:31], v[204:207], v[168:171], v[28:31]
v_mfma_f32_16x16x32_bf16 v[48:51], v[208:211], v[168:171], v[48:51]
v_mfma_f32_16x16x32_bf16 v[68:71], v[212:215], v[168:171], v[68:71]
ds_read_b128 v[168:171], v243 offset:12288
v_mfma_f32_16x16x32_bf16 v[12:15], v[200:203], v[172:175], v[12:15]
v_mfma_f32_16x16x32_bf16 v[32:35], v[204:207], v[172:175], v[32:35]
s_waitcnt lgkmcnt(1)
s_mov_b32 m0, s5
s_add_u32 s9, s95, 292864
buffer_load_dwordx4 v233, s[20:23], s9 offen offset:2048 lds
s_add_u32 s8, s95, 422912
buffer_load_dwordx4 v233, s[20:23], s8 offen offset:3072 lds
v_mfma_f32_16x16x32_bf16 v[52:55], v[208:211], v[172:175], v[52:55]
v_mfma_f32_16x16x32_bf16 v[72:75], v[212:215], v[172:175], v[72:75]
ds_read_b128 v[172:175], v243 offset:13312
v_mfma_f32_16x16x32_bf16 v[16:19], v[200:203], v[176:179], v[16:19]
v_mfma_f32_16x16x32_bf16 v[36:39], v[204:207], v[176:179], v[36:39]
v_mfma_f32_16x16x32_bf16 v[56:59], v[208:211], v[176:179], v[56:59]
v_mfma_f32_16x16x32_bf16 v[76:79], v[212:215], v[176:179], v[76:79]
ds_read_b128 v[176:179], v243 offset:14336
v_mfma_f32_16x16x32_bf16 v[0:3], v[216:219], v[180:183], v[0:3]
v_mfma_f32_16x16x32_bf16 v[20:23], v[220:223], v[180:183], v[20:23]
s_waitcnt vmcnt(6)
ds_read_b64_tr_b16 v[200:201], v236 offset:0
ds_read_b64_tr_b16 v[204:205], v237 offset:0
ds_read_b64_tr_b16 v[208:209], v238 offset:0
ds_read_b64_tr_b16 v[212:213], v239 offset:0
v_mfma_f32_16x16x32_bf16 v[40:43], v[224:227], v[180:183], v[40:43]
v_mfma_f32_16x16x32_bf16 v[60:63], v[228:231], v[180:183], v[60:63]
ds_read_b128 v[180:183], v243 offset:15360
v_mfma_f32_16x16x32_bf16 v[4:7], v[216:219], v[184:187], v[4:7]
v_mfma_f32_16x16x32_bf16 v[24:27], v[220:223], v[184:187], v[24:27]
v_mfma_f32_16x16x32_bf16 v[44:47], v[224:227], v[184:187], v[44:47]
s_waitcnt lgkmcnt(1)
s_mov_b32 m0, s4
s_add_u32 s9, s96, 0
buffer_load_dwordx4 v233, s[20:23], s9 offen lds
s_add_u32 s8, s96, 130048
buffer_load_dwordx4 v233, s[20:23], s8 offen offset:1024 lds
v_mfma_f32_16x16x32_bf16 v[64:67], v[228:231], v[184:187], v[64:67]
ds_read_b128 v[184:187], v243 offset:16384
v_mfma_f32_16x16x32_bf16 v[8:11], v[216:219], v[188:191], v[8:11]
s_waitcnt vmcnt(6)
ds_read_b64_tr_b16 v[202:203], v236 offset:2048
ds_read_b64_tr_b16 v[206:207], v237 offset:2048
ds_read_b64_tr_b16 v[210:211], v238 offset:2048
ds_read_b64_tr_b16 v[214:215], v239 offset:2048
v_mfma_f32_16x16x32_bf16 v[28:31], v[220:223], v[188:191], v[28:31]
v_mfma_f32_16x16x32_bf16 v[48:51], v[224:227], v[188:191], v[48:51]
v_mfma_f32_16x16x32_bf16 v[68:71], v[228:231], v[188:191], v[68:71]
ds_read_b128 v[188:191], v243 offset:17408
v_mfma_f32_16x16x32_bf16 v[12:15], v[216:219], v[192:195], v[12:15]
v_mfma_f32_16x16x32_bf16 v[32:35], v[220:223], v[192:195], v[32:35]
s_waitcnt lgkmcnt(1)
s_mov_b32 m0, s4
s_add_u32 s9, s96, 30720
buffer_load_dwordx4 v233, s[20:23], s9 offen offset:2048 lds
s_add_u32 s8, s96, 160768
buffer_load_dwordx4 v233, s[20:23], s8 offen offset:3072 lds
v_mfma_f32_16x16x32_bf16 v[52:55], v[224:227], v[192:195], v[52:55]
v_mfma_f32_16x16x32_bf16 v[72:75], v[228:231], v[192:195], v[72:75]
ds_read_b128 v[192:195], v243 offset:18432
v_mfma_f32_16x16x32_bf16 v[16:19], v[216:219], v[196:199], v[16:19]
v_mfma_f32_16x16x32_bf16 v[36:39], v[220:223], v[196:199], v[36:39]
v_mfma_f32_16x16x32_bf16 v[56:59], v[224:227], v[196:199], v[56:59]
v_mfma_f32_16x16x32_bf16 v[76:79], v[228:231], v[196:199], v[76:79]
ds_read_b128 v[196:199], v243 offset:19456
v_mfma_f32_16x16x32_bf16 v[0:3], v[200:203], v[160:163], v[0:3]
v_mfma_f32_16x16x32_bf16 v[20:23], v[204:207], v[160:163], v[20:23]
s_waitcnt vmcnt(6)
ds_read_b64_tr_b16 v[216:217], v236 offset:4096
ds_read_b64_tr_b16 v[220:221], v237 offset:4096
ds_read_b64_tr_b16 v[224:225], v238 offset:4096
ds_read_b64_tr_b16 v[228:229], v239 offset:4096
v_mfma_f32_16x16x32_bf16 v[40:43], v[208:211], v[160:163], v[40:43]
v_mfma_f32_16x16x32_bf16 v[60:63], v[212:215], v[160:163], v[60:63]
ds_read_b128 v[160:163], v243 offset:20480
v_mfma_f32_16x16x32_bf16 v[4:7], v[200:203], v[164:167], v[4:7]
v_mfma_f32_16x16x32_bf16 v[24:27], v[204:207], v[164:167], v[24:27]
v_mfma_f32_16x16x32_bf16 v[44:47], v[208:211], v[164:167], v[44:47]
s_waitcnt lgkmcnt(1)
s_mov_b32 m0, s5
s_add_u32 s9, s96, 262144
buffer_load_dwordx4 v233, s[20:23], s9 offen lds
s_add_u32 s8, s96, 392192
buffer_load_dwordx4 v233, s[20:23], s8 offen offset:1024 lds
v_mfma_f32_16x16x32_bf16 v[64:67], v[212:215], v[164:167], v[64:67]
ds_read_b128 v[164:167], v243 offset:21504
v_mfma_f32_16x16x32_bf16 v[8:11], v[200:203], v[168:171], v[8:11]
s_waitcnt vmcnt(6)
ds_read_b64_tr_b16 v[218:219], v236 offset:6144
ds_read_b64_tr_b16 v[222:223], v237 offset:6144
ds_read_b64_tr_b16 v[226:227], v238 offset:6144
ds_read_b64_tr_b16 v[230:231], v239 offset:6144
v_mfma_f32_16x16x32_bf16 v[28:31], v[204:207], v[168:171], v[28:31]
v_mfma_f32_16x16x32_bf16 v[48:51], v[208:211], v[168:171], v[48:51]
v_mfma_f32_16x16x32_bf16 v[68:71], v[212:215], v[168:171], v[68:71]
ds_read_b128 v[168:171], v243 offset:22528
v_mfma_f32_16x16x32_bf16 v[12:15], v[200:203], v[172:175], v[12:15]
v_mfma_f32_16x16x32_bf16 v[32:35], v[204:207], v[172:175], v[32:35]
s_waitcnt lgkmcnt(1)
s_mov_b32 m0, s5
s_add_u32 s9, s96, 292864
buffer_load_dwordx4 v233, s[20:23], s9 offen offset:2048 lds
s_add_u32 s8, s96, 422912
buffer_load_dwordx4 v233, s[20:23], s8 offen offset:3072 lds
v_mfma_f32_16x16x32_bf16 v[52:55], v[208:211], v[172:175], v[52:55]
v_mfma_f32_16x16x32_bf16 v[72:75], v[212:215], v[172:175], v[72:75]
ds_read_b128 v[172:175], v243 offset:23552
v_mfma_f32_16x16x32_bf16 v[16:19], v[200:203], v[176:179], v[16:19]
v_mfma_f32_16x16x32_bf16 v[36:39], v[204:207], v[176:179], v[36:39]
v_mfma_f32_16x16x32_bf16 v[56:59], v[208:211], v[176:179], v[56:59]
v_mfma_f32_16x16x32_bf16 v[76:79], v[212:215], v[176:179], v[76:79]
ds_read_b128 v[176:179], v243 offset:24576
v_mfma_f32_16x16x32_bf16 v[0:3], v[216:219], v[180:183], v[0:3]
v_lshrrev_b32 v246, 5, v235
v_add_u32 v246, 0, v246
v_lshlrev_b32 v247, 1, v246
v_and_b32 v248, 15, v235
v_xor_b32 v247, v248, v247
v_lshl_add_u32 v247, v246, 4, v247
v_lshlrev_b32 v247, 4, v247
v_bfe_u32 v248, v235, 4, 1
v_lshl_add_u32 v247, v248, 3, v247
v_add_u32 v251, s70, v247
v_lshrrev_b32 v246, 5, v235
v_add_u32 v246, 2, v246
v_lshlrev_b32 v247, 1, v246
v_and_b32 v248, 15, v235
v_xor_b32 v247, v248, v247
v_lshl_add_u32 v247, v246, 4, v247
v_lshlrev_b32 v247, 4, v247
v_bfe_u32 v248, v235, 4, 1
v_lshl_add_u32 v247, v248, 3, v247
v_add_u32 v252, s70, v247
v_mfma_f32_16x16x32_bf16 v[20:23], v[220:223], v[180:183], v[20:23]
s_waitcnt vmcnt(6)
ds_read_b64_tr_b16 v[200:201], v236 offset:0
ds_read_b64_tr_b16 v[204:205], v237 offset:0
ds_read_b64_tr_b16 v[208:209], v238 offset:0
ds_read_b64_tr_b16 v[212:213], v239 offset:0
v_mfma_f32_16x16x32_bf16 v[40:43], v[224:227], v[180:183], v[40:43]
v_mfma_f32_16x16x32_bf16 v[60:63], v[228:231], v[180:183], v[60:63]
ds_read_b128 v[180:183], v243 offset:25600
v_mfma_f32_16x16x32_bf16 v[4:7], v[216:219], v[184:187], v[4:7]
v_mfma_f32_16x16x32_bf16 v[24:27], v[220:223], v[184:187], v[24:27]
s_cmp_eq_u32 s72, 0
s_cbranch_scc1 L_other
v_mfma_f32_16x16x32_bf16 v[44:47], v[224:227], v[184:187], v[44:47]
s_waitcnt lgkmcnt(1)
s_mov_b32 m0, s4
s_add_u32 s9, s66, 0
buffer_load_dwordx4 v232, s[48:51], s9 offen nt lds
s_add_u32 s8, s66, 3072
buffer_load_dwordx4 v232, s[48:51], s8 offen offset:1024 nt lds
v_mfma_f32_16x16x32_bf16 v[64:67], v[228:231], v[184:187], v[64:67]
ds_read_b128 v[184:187], v243 offset:26624
v_mfma_f32_16x16x32_bf16 v[8:11], v[216:219], v[188:191], v[8:11]
s_waitcnt vmcnt(6)
ds_read_b64_tr_b16 v[202:203], v236 offset:2048
ds_read_b64_tr_b16 v[206:207], v237 offset:2048
ds_read_b64_tr_b16 v[210:211], v238 offset:2048
ds_read_b64_tr_b16 v[214:215], v239 offset:2048
v_mfma_f32_16x16x32_bf16 v[28:31], v[220:223], v[188:191], v[28:31]
v_mfma_f32_16x16x32_bf16 v[48:51], v[224:227], v[188:191], v[48:51]
v_mfma_f32_16x16x32_bf16 v[68:71], v[228:231], v[188:191], v[68:71]
ds_read_b128 v[188:191], v243 offset:27648
v_mfma_f32_16x16x32_bf16 v[12:15], v[216:219], v[192:195], v[12:15]
v_mfma_f32_16x16x32_bf16 v[32:35], v[220:223], v[192:195], v[32:35]
s_waitcnt lgkmcnt(1)
s_mov_b32 m0, s4
s_add_u32 s9, s66, 6144
buffer_load_dwordx4 v232, s[48:51], s9 offen offset:2048 nt lds
s_add_u32 s8, s66, 9216
buffer_load_dwordx4 v232, s[48:51], s8 offen offset:3072 nt lds
v_mfma_f32_16x16x32_bf16 v[52:55], v[224:227], v[192:195], v[52:55]
v_mfma_f32_16x16x32_bf16 v[72:75], v[228:231], v[192:195], v[72:75]
ds_read_b128 v[192:195], v243 offset:28672
v_mfma_f32_16x16x32_bf16 v[16:19], v[216:219], v[196:199], v[16:19]
v_mfma_f32_16x16x32_bf16 v[36:39], v[220:223], v[196:199], v[36:39]
v_mfma_f32_16x16x32_bf16 v[56:59], v[224:227], v[196:199], v[56:59]
v_mfma_f32_16x16x32_bf16 v[76:79], v[228:231], v[196:199], v[76:79]
ds_read_b128 v[196:199], v243 offset:29696
v_mfma_f32_16x16x32_bf16 v[0:3], v[200:203], v[160:163], v[0:3]
v_mfma_f32_16x16x32_bf16 v[20:23], v[204:207], v[160:163], v[20:23]
s_waitcnt vmcnt(6)
ds_read_b64_tr_b16 v[216:217], v236 offset:4096
ds_read_b64_tr_b16 v[220:221], v237 offset:4096
ds_read_b64_tr_b16 v[224:225], v238 offset:4096
ds_read_b64_tr_b16 v[228:229], v239 offset:4096
v_mfma_f32_16x16x32_bf16 v[40:43], v[208:211], v[160:163], v[40:43]
v_mfma_f32_16x16x32_bf16 v[60:63], v[212:215], v[160:163], v[60:63]
v_mfma_f32_16x16x32_bf16 v[4:7], v[200:203], v[164:167], v[4:7]
v_mfma_f32_16x16x32_bf16 v[24:27], v[204:207], v[164:167], v[24:27]
v_mfma_f32_16x16x32_bf16 v[44:47], v[208:211], v[164:167], v[44:47]
s_waitcnt lgkmcnt(0)
s_mov_b32 m0, s5
s_add_u32 s9, s66, 16384
buffer_load_dwordx4 v232, s[48:51], s9 offen nt lds
s_add_u32 s8, s66, 19456
buffer_load_dwordx4 v232, s[48:51], s8 offen offset:1024 nt lds
v_mfma_f32_16x16x32_bf16 v[64:67], v[212:215], v[164:167], v[64:67]
v_mfma_f32_16x16x32_bf16 v[8:11], v[200:203], v[168:171], v[8:11]
s_waitcnt vmcnt(6)
ds_read_b64_tr_b16 v[218:219], v236 offset:6144
ds_read_b64_tr_b16 v[222:223], v237 offset:6144
ds_read_b64_tr_b16 v[226:227], v238 offset:6144
ds_read_b64_tr_b16 v[230:231], v239 offset:6144
v_mfma_f32_16x16x32_bf16 v[28:31], v[204:207], v[168:171], v[28:31]
v_mfma_f32_16x16x32_bf16 v[48:51], v[208:211], v[168:171], v[48:51]
v_mfma_f32_16x16x32_bf16 v[68:71], v[212:215], v[168:171], v[68:71]
v_mfma_f32_16x16x32_bf16 v[12:15], v[200:203], v[172:175], v[12:15]
s_barrier
v_mfma_f32_16x16x32_bf16 v[32:35], v[204:207], v[172:175], v[32:35]
s_waitcnt lgkmcnt(0)
s_mov_b32 m0, s5
s_add_u32 s9, s66, 22528
buffer_load_dwordx4 v232, s[48:51], s9 offen offset:2048 nt lds
s_add_u32 s8, s66, 25600
buffer_load_dwordx4 v232, s[48:51], s8 offen offset:3072 nt lds
v_mfma_f32_16x16x32_bf16 v[52:55], v[208:211], v[172:175], v[52:55]
v_mfma_f32_16x16x32_bf16 v[72:75], v[212:215], v[172:175], v[72:75]
v_mfma_f32_16x16x32_bf16 v[16:19], v[200:203], v[176:179], v[16:19]
v_mfma_f32_16x16x32_bf16 v[36:39], v[204:207], v[176:179], v[36:39]
v_mfma_f32_16x16x32_bf16 v[56:59], v[208:211], v[176:179], v[56:59]
v_mfma_f32_16x16x32_bf16 v[76:79], v[212:215], v[176:179], v[76:79]
v_mfma_f32_16x16x32_bf16 v[0:3], v[216:219], v[180:183], v[0:3]
v_mfma_f32_16x16x32_bf16 v[20:23], v[220:223], v[180:183], v[20:23]
s_waitcnt vmcnt(6)
ds_read_b128 v[200:203], v240 offset:0
ds_read_b128 v[204:207], v241 offset:0
v_mfma_f32_16x16x32_bf16 v[40:43], v[224:227], v[180:183], v[40:43]
v_mfma_f32_16x16x32_bf16 v[60:63], v[228:231], v[180:183], v[60:63]
v_mfma_f32_16x16x32_bf16 v[4:7], v[216:219], v[184:187], v[4:7]
v_mfma_f32_16x16x32_bf16 v[24:27], v[220:223], v[184:187], v[24:27]
v_mfma_f32_16x16x32_bf16 v[44:47], v[224:227], v[184:187], v[44:47]
s_waitcnt lgkmcnt(0)
s_mov_b32 m0, s4
s_add_u32 s9, s67, 0
buffer_load_dwordx4 v232, s[48:51], s9 offen nt lds
s_add_u32 s8, s67, 3072
buffer_load_dwordx4 v232, s[48:51], s8 offen offset:1024 nt lds
v_mfma_f32_16x16x32_bf16 v[64:67], v[228:231], v[184:187], v[64:67]
v_mfma_f32_16x16x32_bf16 v[8:11], v[216:219], v[188:191], v[8:11]
s_waitcnt vmcnt(6)
ds_read_b128 v[208:211], v240 offset:2048
ds_read_b128 v[212:215], v241 offset:2048
v_mfma_f32_16x16x32_bf16 v[28:31], v[220:223], v[188:191], v[28:31]
v_mfma_f32_16x16x32_bf16 v[48:51], v[224:227], v[188:191], v[48:51]
v_mfma_f32_16x16x32_bf16 v[68:71], v[228:231], v[188:191], v[68:71]
v_mfma_f32_16x16x32_bf16 v[12:15], v[216:219], v[192:195], v[12:15]
v_cvt_pk_bf16_f32 v0, v0, v1
v_cvt_pk_bf16_f32 v1, v2, v3
ds_write_b64 v251, v[0:1] offset:0
v_cvt_pk_bf16_f32 v20, v20, v21
v_cvt_pk_bf16_f32 v21, v22, v23
ds_write_b64 v252, v[20:21] offset:0
v_cvt_pk_bf16_f32 v40, v40, v41
v_cvt_pk_bf16_f32 v41, v42, v43
ds_write_b64 v251, v[40:41] offset:5120
v_cvt_pk_bf16_f32 v60, v60, v61
v_cvt_pk_bf16_f32 v61, v62, v63
ds_write_b64 v252, v[60:61] offset:5120
v_mfma_f32_16x16x32_bf16 v[32:35], v[220:223], v[192:195], v[32:35]
s_waitcnt lgkmcnt(4)
s_mov_b32 m0, s4
s_add_u32 s9, s67, 6144
buffer_load_dwordx4 v232, s[48:51], s9 offen offset:2048 nt lds
s_add_u32 s8, s67, 9216
buffer_load_dwordx4 v232, s[48:51], s8 offen offset:3072 nt lds
v_mfma_f32_16x16x32_bf16 v[52:55], v[224:227], v[192:195], v[52:55]
v_mfma_f32_16x16x32_bf16 v[72:75], v[228:231], v[192:195], v[72:75]
v_mfma_f32_16x16x32_bf16 v[16:19], v[216:219], v[196:199], v[16:19]
v_cvt_pk_bf16_f32 v4, v4, v5
v_cvt_pk_bf16_f32 v5, v6, v7
ds_write_b64 v251, v[4:5] offset:1024
v_cvt_pk_bf16_f32 v24, v24, v25
v_cvt_pk_bf16_f32 v25, v26, v27
ds_write_b64 v252, v[24:25] offset:1024
v_cvt_pk_bf16_f32 v44, v44, v45
v_cvt_pk_bf16_f32 v45, v46, v47
ds_write_b64 v251, v[44:45] offset:6144
v_cvt_pk_bf16_f32 v64, v64, v65
v_cvt_pk_bf16_f32 v65, v66, v67
ds_write_b64 v252, v[64:65] offset:6144
v_mfma_f32_16x16x32_bf16 v[36:39], v[220:223], v[196:199], v[36:39]
v_mfma_f32_16x16x32_bf16 v[56:59], v[224:227], v[196:199], v[56:59]
v_mfma_f32_16x16x32_bf16 v[76:79], v[228:231], v[196:199], v[76:79]
s_nop 7
v_cvt_pk_bf16_f32 v8, v8, v9
v_cvt_pk_bf16_f32 v9, v10, v11
ds_write_b64 v251, v[8:9] offset:2048
v_cvt_pk_bf16_f32 v28, v28, v29
v_cvt_pk_bf16_f32 v29, v30, v31
ds_write_b64 v252, v[28:29] offset:2048
v_cvt_pk_bf16_f32 v48, v48, v49
v_cvt_pk_bf16_f32 v49, v50, v51
ds_write_b64 v251, v[48:49] offset:7168
v_cvt_pk_bf16_f32 v68, v68, v69
v_cvt_pk_bf16_f32 v69, v70, v71
ds_write_b64 v252, v[68:69] offset:7168
v_cvt_pk_bf16_f32 v12, v12, v13
v_cvt_pk_bf16_f32 v13, v14, v15
ds_write_b64 v251, v[12:13] offset:3072
v_cvt_pk_bf16_f32 v32, v32, v33
v_cvt_pk_bf16_f32 v33, v34, v35
ds_write_b64 v252, v[32:33] offset:3072
v_cvt_pk_bf16_f32 v52, v52, v53
v_cvt_pk_bf16_f32 v53, v54, v55
ds_write_b64 v251, v[52:53] offset:8192
v_cvt_pk_bf16_f32 v72, v72, v73
v_cvt_pk_bf16_f32 v73, v74, v75
ds_write_b64 v252, v[72:73] offset:8192
v_cvt_pk_bf16_f32 v16, v16, v17
v_cvt_pk_bf16_f32 v17, v18, v19
ds_write_b64 v251, v[16:17] offset:4096
v_cvt_pk_bf16_f32 v36, v36, v37
v_cvt_pk_bf16_f32 v37, v38, v39
ds_write_b64 v252, v[36:37] offset:4096
v_cvt_pk_bf16_f32 v56, v56, v57
v_cvt_pk_bf16_f32 v57, v58, v59
ds_write_b64 v251, v[56:57] offset:9216
v_cvt_pk_bf16_f32 v76, v76, v77
v_cvt_pk_bf16_f32 v77, v78, v79
ds_write_b64 v252, v[76:77] offset:9216
s_waitcnt lgkmcnt(0)
s_barrier
s_or_b32 s10, s3, s97
s_cmp_lg_u32 s10, 0
s_cbranch_scc1 L_rstBA
s_mul_i32 s10, s98, 4352
s_add_u32 s10, s10, 41943040
v_mov_b32 v253, s10
v_mov_b32 v254, 0
s_mov_b64 exec, 1
global_store_dword v253, v254, s[88:89] sc1
s_mov_b64 exec, -1
L_rstBA:
ds_read_b128 v[160:163], v244 offset:0
ds_read_b128 v[164:167], v244 offset:1024
ds_read_b128 v[168:171], v244 offset:2048
ds_read_b128 v[172:175], v244 offset:3072
ds_read_b128 v[176:179], v244 offset:4096
ds_read_b128 v[180:183], v244 offset:5120
ds_read_b128 v[184:187], v244 offset:6144
ds_read_b128 v[188:191], v244 offset:7168
ds_read_b128 v[192:195], v244 offset:8192
ds_read_b128 v[196:199], v244 offset:9216
s_waitcnt lgkmcnt(9)
v_mfma_f32_16x16x32_bf16 v[0:3], v[200:203], v[160:163], 0
v_mfma_f32_16x16x32_bf16 v[20:23], v[208:211], v[160:163], 0
s_waitcnt vmcnt(6)
ds_read_b128 v[216:219], v240 offset:4096
ds_read_b128 v[220:223], v241 offset:4096
s_waitcnt lgkmcnt(10)
v_mfma_f32_16x16x32_bf16 v[4:7], v[200:203], v[164:167], 0
v_mfma_f32_16x16x32_bf16 v[24:27], v[208:211], v[164:167], 0
s_waitcnt lgkmcnt(9)
v_mfma_f32_16x16x32_bf16 v[8:11], v[200:203], v[168:171], 0
v_mfma_f32_16x16x32_bf16 v[28:31], v[208:211], v[168:171], 0
s_waitcnt lgkmcnt(8)
v_mfma_f32_16x16x32_bf16 v[12:15], v[200:203], v[172:175], 0
s_waitcnt lgkmcnt(0)
s_mov_b32 m0, s5
s_add_u32 s9, s67, 16384
buffer_load_dwordx4 v232, s[48:51], s9 offen nt lds
s_add_u32 s8, s67, 19456
buffer_load_dwordx4 v232, s[48:51], s8 offen offset:1024 nt lds
v_mfma_f32_16x16x32_bf16 v[32:35], v[208:211], v[172:175], 0
v_mfma_f32_16x16x32_bf16 v[16:19], v[200:203], v[176:179], 0
s_waitcnt vmcnt(6)
ds_read_b128 v[224:227], v240 offset:6144
ds_read_b128 v[228:231], v241 offset:6144
v_mfma_f32_16x16x32_bf16 v[36:39], v[208:211], v[176:179], 0
v_mfma_f32_16x16x32_bf16 v[0:3], v[204:207], v[180:183], v[0:3]
v_mfma_f32_16x16x32_bf16 v[20:23], v[212:215], v[180:183], v[20:23]
v_mfma_f32_16x16x32_bf16 v[4:7], v[204:207], v[184:187], v[4:7]
v_mfma_f32_16x16x32_bf16 v[24:27], v[212:215], v[184:187], v[24:27]
s_waitcnt lgkmcnt(0)
s_mov_b32 m0, s5
s_add_u32 s9, s67, 22528
buffer_load_dwordx4 v232, s[48:51], s9 offen offset:2048 nt lds
s_add_u32 s8, s67, 25600
buffer_load_dwordx4 v232, s[48:51], s8 offen offset:3072 nt lds
v_mfma_f32_16x16x32_bf16 v[8:11], v[204:207], v[188:191], v[8:11]
v_mfma_f32_16x16x32_bf16 v[28:31], v[212:215], v[188:191], v[28:31]
v_mfma_f32_16x16x32_bf16 v[12:15], v[204:207], v[192:195], v[12:15]
v_mfma_f32_16x16x32_bf16 v[32:35], v[212:215], v[192:195], v[32:35]
v_mfma_f32_16x16x32_bf16 v[16:19], v[204:207], v[196:199], v[16:19]
v_mfma_f32_16x16x32_bf16 v[36:39], v[212:215], v[196:199], v[36:39]
v_mfma_f32_16x16x32_bf16 v[40:43], v[216:219], v[160:163], 0
v_mfma_f32_16x16x32_bf16 v[60:63], v[224:227], v[160:163], 0
ds_read_b128 v[160:163], v244 offset:10240
s_waitcnt vmcnt(6)
ds_read_b128 v[200:203], v240 offset:0
ds_read_b128 v[204:207], v241 offset:0
v_mfma_f32_16x16x32_bf16 v[44:47], v[216:219], v[164:167], 0
v_mfma_f32_16x16x32_bf16 v[64:67], v[224:227], v[164:167], 0
ds_read_b128 v[164:167], v244 offset:11264
v_mfma_f32_16x16x32_bf16 v[48:51], v[216:219], v[168:171], 0
v_mfma_f32_16x16x32_bf16 v[68:71], v[224:227], v[168:171], 0
ds_read_b128 v[168:171], v244 offset:12288
v_mfma_f32_16x16x32_bf16 v[52:55], v[216:219], v[172:175], 0
s_waitcnt lgkmcnt(2)
s_mov_b32 m0, s4
s_add_u32 s9, s68, 0
buffer_load_dwordx4 v232, s[48:51], s9 offen nt lds
s_add_u32 s8, s68, 3072
buffer_load_dwordx4 v232, s[48:51], s8 offen offset:1024 nt lds
v_mfma_f32_16x16x32_bf16 v[72:75], v[224:227], v[172:175], 0
ds_read_b128 v[172:175], v244 offset:13312
v_mfma_f32_16x16x32_bf16 v[56:59], v[216:219], v[176:179], 0
s_waitcnt vmcnt(6)
ds_read_b128 v[208:211], v240 offset:2048
ds_read_b128 v[212:215], v241 offset:2048
v_mfma_f32_16x16x32_bf16 v[76:79], v[224:227], v[176:179], 0
ds_read_b128 v[176:179], v244 offset:14336
v_mfma_f32_16x16x32_bf16 v[40:43], v[220:223], v[180:183], v[40:43]
v_mfma_f32_16x16x32_bf16 v[60:63], v[228:231], v[180:183], v[60:63]
ds_read_b128 v[180:183], v244 offset:15360
v_mfma_f32_16x16x32_bf16 v[44:47], v[220:223], v[184:187], v[44:47]
v_mfma_f32_16x16x32_bf16 v[64:67], v[228:231], v[184:187], v[64:67]
ds_read_b128 v[184:187], v244 offset:16384
s_waitcnt lgkmcnt(3)
s_mov_b32 m0, s4
s_add_u32 s9, s68, 6144
buffer_load_dwordx4 v232, s[48:51], s9 offen offset:2048 nt lds
s_add_u32 s8, s68, 9216
buffer_load_dwordx4 v232, s[48:51], s8 offen offset:3072 nt lds
v_mfma_f32_16x16x32_bf16 v[48:51], v[220:223], v[188:191], v[48:51]
v_mfma_f32_16x16x32_bf16 v[68:71], v[228:231], v[188:191], v[68:71]
ds_read_b128 v[188:191], v244 offset:17408
v_mfma_f32_16x16x32_bf16 v[52:55], v[220:223], v[192:195], v[52:55]
v_mfma_f32_16x16x32_bf16 v[72:75], v[228:231], v[192:195], v[72:75]
ds_read_b128 v[192:195], v244 offset:18432
v_mfma_f32_16x16x32_bf16 v[56:59], v[220:223], v[196:199], v[56:59]
v_mfma_f32_16x16x32_bf16 v[76:79], v[228:231], v[196:199], v[76:79]
ds_read_b128 v[196:199], v244 offset:19456
v_mfma_f32_16x16x32_bf16 v[0:3], v[200:203], v[160:163], v[0:3]
v_mfma_f32_16x16x32_bf16 v[20:23], v[208:211], v[160:163], v[20:23]
s_waitcnt vmcnt(6)
ds_read_b128 v[216:219], v240 offset:4096
ds_read_b128 v[220:223], v241 offset:4096
v_mfma_f32_16x16x32_bf16 v[4:7], v[200:203], v[164:167], v[4:7]
v_mfma_f32_16x16x32_bf16 v[24:27], v[208:211], v[164:167], v[24:27]
v_mfma_f32_16x16x32_bf16 v[8:11], v[200:203], v[168:171], v[8:11]
v_mfma_f32_16x16x32_bf16 v[28:31], v[208:211], v[168:171], v[28:31]
v_mfma_f32_16x16x32_bf16 v[12:15], v[200:203], v[172:175], v[12:15]
s_waitcnt lgkmcnt(0)
s_mov_b32 m0, s5
s_add_u32 s9, s68, 16384
buffer_load_dwordx4 v232, s[48:51], s9 offen nt lds
s_add_u32 s8, s68, 19456
buffer_load_dwordx4 v232, s[48:51], s8 offen offset:1024 nt lds
v_mfma_f32_16x16x32_bf16 v[32:35], v[208:211], v[172:175], v[32:35]
v_mfma_f32_16x16x32_bf16 v[16:19], v[200:203], v[176:179], v[16:19]
s_waitcnt vmcnt(6)
ds_read_b128 v[224:227], v240 offset:6144
ds_read_b128 v[228:231], v241 offset:6144
v_mfma_f32_16x16x32_bf16 v[36:39], v[208:211], v[176:179], v[36:39]
v_mfma_f32_16x16x32_bf16 v[0:3], v[204:207], v[180:183], v[0:3]
v_mfma_f32_16x16x32_bf16 v[20:23], v[212:215], v[180:183], v[20:23]
v_mfma_f32_16x16x32_bf16 v[4:7], v[204:207], v[184:187], v[4:7]
v_mfma_f32_16x16x32_bf16 v[24:27], v[212:215], v[184:187], v[24:27]
s_waitcnt lgkmcnt(0)
s_mov_b32 m0, s5
s_add_u32 s9, s68, 22528
buffer_load_dwordx4 v232, s[48:51], s9 offen offset:2048 nt lds
s_add_u32 s8, s68, 25600
buffer_load_dwordx4 v232, s[48:51], s8 offen offset:3072 nt lds
v_mfma_f32_16x16x32_bf16 v[8:11], v[204:207], v[188:191], v[8:11]
v_mfma_f32_16x16x32_bf16 v[28:31], v[212:215], v[188:191], v[28:31]
v_mfma_f32_16x16x32_bf16 v[12:15], v[204:207], v[192:195], v[12:15]
v_mfma_f32_16x16x32_bf16 v[32:35], v[212:215], v[192:195], v[32:35]
v_mfma_f32_16x16x32_bf16 v[16:19], v[204:207], v[196:199], v[16:19]
v_mfma_f32_16x16x32_bf16 v[36:39], v[212:215], v[196:199], v[36:39]
v_mfma_f32_16x16x32_bf16 v[40:43], v[216:219], v[160:163], v[40:43]
v_mfma_f32_16x16x32_bf16 v[60:63], v[224:227], v[160:163], v[60:63]
ds_read_b128 v[160:163], v244 offset:20480
s_waitcnt vmcnt(6)
ds_read_b128 v[200:203], v240 offset:0
ds_read_b128 v[204:207], v241 offset:0
v_mfma_f32_16x16x32_bf16 v[44:47], v[216:219], v[164:167], v[44:47]
v_mfma_f32_16x16x32_bf16 v[64:67], v[224:227], v[164:167], v[64:67]
ds_read_b128 v[164:167], v244 offset:21504
v_mfma_f32_16x16x32_bf16 v[48:51], v[216:219], v[168:171], v[48:51]
v_mfma_f32_16x16x32_bf16 v[68:71], v[224:227], v[168:171], v[68:71]
ds_read_b128 v[168:171], v244 offset:22528
v_mfma_f32_16x16x32_bf16 v[52:55], v[216:219], v[172:175], v[52:55]
s_waitcnt lgkmcnt(2)
s_mov_b32 m0, s4
s_add_u32 s9, s69, 0
buffer_load_dwordx4 v232, s[48:51], s9 offen nt lds
s_add_u32 s8, s69, 3072
buffer_load_dwordx4 v232, s[48:51], s8 offen offset:1024 nt lds
v_mfma_f32_16x16x32_bf16 v[72:75], v[224:227], v[172:175], v[72:75]
ds_read_b128 v[172:175], v244 offset:23552
v_mfma_f32_16x16x32_bf16 v[56:59], v[216:219], v[176:179], v[56:59]
s_waitcnt vmcnt(6)
ds_read_b128 v[208:211], v240 offset:2048
ds_read_b128 v[212:215], v241 offset:2048
v_mfma_f32_16x16x32_bf16 v[76:79], v[224:227], v[176:179], v[76:79]
ds_read_b128 v[176:179], v244 offset:24576
v_mfma_f32_16x16x32_bf16 v[40:43], v[220:223], v[180:183], v[40:43]
v_mfma_f32_16x16x32_bf16 v[60:63], v[228:231], v[180:183], v[60:63]
ds_read_b128 v[180:183], v244 offset:25600
v_mfma_f32_16x16x32_bf16 v[44:47], v[220:223], v[184:187], v[44:47]
v_mfma_f32_16x16x32_bf16 v[64:67], v[228:231], v[184:187], v[64:67]
ds_read_b128 v[184:187], v244 offset:26624
s_waitcnt lgkmcnt(3)
s_mov_b32 m0, s4
s_add_u32 s9, s69, 6144
buffer_load_dwordx4 v232, s[48:51], s9 offen offset:2048 nt lds
s_add_u32 s8, s69, 9216
buffer_load_dwordx4 v232, s[48:51], s8 offen offset:3072 nt lds
v_mfma_f32_16x16x32_bf16 v[48:51], v[220:223], v[188:191], v[48:51]
v_mfma_f32_16x16x32_bf16 v[68:71], v[228:231], v[188:191], v[68:71]
ds_read_b128 v[188:191], v244 offset:27648
v_mfma_f32_16x16x32_bf16 v[52:55], v[220:223], v[192:195], v[52:55]
v_mfma_f32_16x16x32_bf16 v[72:75], v[228:231], v[192:195], v[72:75]
ds_read_b128 v[192:195], v244 offset:28672
v_mfma_f32_16x16x32_bf16 v[56:59], v[220:223], v[196:199], v[56:59]
v_mfma_f32_16x16x32_bf16 v[76:79], v[228:231], v[196:199], v[76:79]
ds_read_b128 v[196:199], v244 offset:29696
v_mfma_f32_16x16x32_bf16 v[0:3], v[200:203], v[160:163], v[0:3]
v_mfma_f32_16x16x32_bf16 v[20:23], v[208:211], v[160:163], v[20:23]
s_waitcnt vmcnt(6)
ds_read_b128 v[216:219], v240 offset:4096
ds_read_b128 v[220:223], v241 offset:4096
v_mfma_f32_16x16x32_bf16 v[4:7], v[200:203], v[164:167], v[4:7]
v_mfma_f32_16x16x32_bf16 v[24:27], v[208:211], v[164:167], v[24:27]
v_mfma_f32_16x16x32_bf16 v[8:11], v[200:203], v[168:171], v[8:11]
v_mfma_f32_16x16x32_bf16 v[28:31], v[208:211], v[168:171], v[28:31]
v_mfma_f32_16x16x32_bf16 v[12:15], v[200:203], v[172:175], v[12:15]
s_waitcnt lgkmcnt(0)
s_mov_b32 m0, s5
s_add_u32 s9, s69, 16384
buffer_load_dwordx4 v232, s[48:51], s9 offen nt lds
s_add_u32 s8, s69, 19456
buffer_load_dwordx4 v232, s[48:51], s8 offen offset:1024 nt lds
v_mfma_f32_16x16x32_bf16 v[32:35], v[208:211], v[172:175], v[32:35]
v_mfma_f32_16x16x32_bf16 v[16:19], v[200:203], v[176:179], v[16:19]
s_waitcnt vmcnt(6)
ds_read_b128 v[224:227], v240 offset:6144
ds_read_b128 v[228:231], v241 offset:6144
v_mfma_f32_16x16x32_bf16 v[36:39], v[208:211], v[176:179], v[36:39]
v_mfma_f32_16x16x32_bf16 v[0:3], v[204:207], v[180:183], v[0:3]
v_mfma_f32_16x16x32_bf16 v[20:23], v[212:215], v[180:183], v[20:23]
v_mfma_f32_16x16x32_bf16 v[4:7], v[204:207], v[184:187], v[4:7]
v_mfma_f32_16x16x32_bf16 v[24:27], v[212:215], v[184:187], v[24:27]
s_waitcnt lgkmcnt(0)
s_mov_b32 m0, s5
s_add_u32 s9, s69, 22528
buffer_load_dwordx4 v232, s[48:51], s9 offen offset:2048 nt lds
s_add_u32 s8, s69, 25600
buffer_load_dwordx4 v232, s[48:51], s8 offen offset:3072 nt lds
v_mfma_f32_16x16x32_bf16 v[8:11], v[204:207], v[188:191], v[8:11]
v_mfma_f32_16x16x32_bf16 v[28:31], v[212:215], v[188:191], v[28:31]
v_mfma_f32_16x16x32_bf16 v[12:15], v[204:207], v[192:195], v[12:15]
v_mfma_f32_16x16x32_bf16 v[32:35], v[212:215], v[192:195], v[32:35]
v_mfma_f32_16x16x32_bf16 v[16:19], v[204:207], v[196:199], v[16:19]
v_mfma_f32_16x16x32_bf16 v[36:39], v[212:215], v[196:199], v[36:39]
v_mfma_f32_16x16x32_bf16 v[40:43], v[216:219], v[160:163], v[40:43]
v_mfma_f32_16x16x32_bf16 v[60:63], v[224:227], v[160:163], v[60:63]
ds_read_b128 v[160:163], v244 offset:30720
s_waitcnt vmcnt(6)
ds_read_b128 v[200:203], v240 offset:0
ds_read_b128 v[204:207], v241 offset:0
v_mfma_f32_16x16x32_bf16 v[44:47], v[216:219], v[164:167], v[44:47]
v_mfma_f32_16x16x32_bf16 v[64:67], v[224:227], v[164:167], v[64:67]
ds_read_b128 v[164:167], v244 offset:31744
v_mfma_f32_16x16x32_bf16 v[48:51], v[216:219], v[168:171], v[48:51]
v_mfma_f32_16x16x32_bf16 v[68:71], v[224:227], v[168:171], v[68:71]
ds_read_b128 v[168:171], v244 offset:32768
v_mfma_f32_16x16x32_bf16 v[52:55], v[216:219], v[172:175], v[52:55]
s_waitcnt lgkmcnt(2)
s_mov_b32 m0, s4
s_add_u32 s9, s66, 131072
buffer_load_dwordx4 v232, s[48:51], s9 offen nt lds
s_add_u32 s8, s66, 134144
buffer_load_dwordx4 v232, s[48:51], s8 offen offset:1024 nt lds
v_mfma_f32_16x16x32_bf16 v[72:75], v[224:227], v[172:175], v[72:75]
ds_read_b128 v[172:175], v244 offset:33792
v_mfma_f32_16x16x32_bf16 v[56:59], v[216:219], v[176:179], v[56:59]
s_waitcnt vmcnt(6)
ds_read_b128 v[208:211], v240 offset:2048
ds_read_b128 v[212:215], v241 offset:2048
v_mfma_f32_16x16x32_bf16 v[76:79], v[224:227], v[176:179], v[76:79]
ds_read_b128 v[176:179], v244 offset:34816
v_mfma_f32_16x16x32_bf16 v[40:43], v[220:223], v[180:183], v[40:43]
v_mfma_f32_16x16x32_bf16 v[60:63], v[228:231], v[180:183], v[60:63]
ds_read_b128 v[180:183], v244 offset:35840
v_mfma_f32_16x16x32_bf16 v[44:47], v[220:223], v[184:187], v[44:47]
v_mfma_f32_16x16x32_bf16 v[64:67], v[228:231], v[184:187], v[64:67]
ds_read_b128 v[184:187], v244 offset:36864
s_waitcnt lgkmcnt(3)
s_mov_b32 m0, s4
s_add_u32 s9, s66, 137216
buffer_load_dwordx4 v232, s[48:51], s9 offen offset:2048 nt lds
s_add_u32 s8, s66, 140288
buffer_load_dwordx4 v232, s[48:51], s8 offen offset:3072 nt lds
v_mfma_f32_16x16x32_bf16 v[48:51], v[220:223], v[188:191], v[48:51]
v_mfma_f32_16x16x32_bf16 v[68:71], v[228:231], v[188:191], v[68:71]
ds_read_b128 v[188:191], v244 offset:37888
v_mfma_f32_16x16x32_bf16 v[52:55], v[220:223], v[192:195], v[52:55]
v_mfma_f32_16x16x32_bf16 v[72:75], v[228:231], v[192:195], v[72:75]
ds_read_b128 v[192:195], v244 offset:38912
v_mfma_f32_16x16x32_bf16 v[56:59], v[220:223], v[196:199], v[56:59]
v_mfma_f32_16x16x32_bf16 v[76:79], v[228:231], v[196:199], v[76:79]
ds_read_b128 v[196:199], v244 offset:39936
v_mfma_f32_16x16x32_bf16 v[0:3], v[200:203], v[160:163], v[0:3]
v_mfma_f32_16x16x32_bf16 v[20:23], v[208:211], v[160:163], v[20:23]
s_waitcnt vmcnt(6)
ds_read_b128 v[216:219], v240 offset:4096
ds_read_b128 v[220:223], v241 offset:4096
v_mfma_f32_16x16x32_bf16 v[4:7], v[200:203], v[164:167], v[4:7]
v_mfma_f32_16x16x32_bf16 v[24:27], v[208:211], v[164:167], v[24:27]
v_mfma_f32_16x16x32_bf16 v[8:11], v[200:203], v[168:171], v[8:11]
v_mfma_f32_16x16x32_bf16 v[28:31], v[208:211], v[168:171], v[28:31]
v_mfma_f32_16x16x32_bf16 v[12:15], v[200:203], v[172:175], v[12:15]
s_waitcnt lgkmcnt(0)
s_mov_b32 m0, s5
s_add_u32 s9, s66, 147456
buffer_load_dwordx4 v232, s[48:51], s9 offen nt lds
s_add_u32 s8, s66, 150528
buffer_load_dwordx4 v232, s[48:51], s8 offen offset:1024 nt lds
v_mfma_f32_16x16x32_bf16 v[32:35], v[208:211], v[172:175], v[32:35]
v_mfma_f32_16x16x32_bf16 v[16:19], v[200:203], v[176:179], v[16:19]
s_waitcnt vmcnt(6)
ds_read_b128 v[224:227], v240 offset:6144
ds_read_b128 v[228:231], v241 offset:6144
v_mfma_f32_16x16x32_bf16 v[36:39], v[208:211], v[176:179], v[36:39]
v_mfma_f32_16x16x32_bf16 v[0:3], v[204:207], v[180:183], v[0:3]
v_mfma_f32_16x16x32_bf16 v[20:23], v[212:215], v[180:183], v[20:23]
v_mfma_f32_16x16x32_bf16 v[4:7], v[204:207], v[184:187], v[4:7]
v_mfma_f32_16x16x32_bf16 v[24:27], v[212:215], v[184:187], v[24:27]
s_waitcnt lgkmcnt(0)
s_mov_b32 m0, s5
s_add_u32 s9, s66, 153600
buffer_load_dwordx4 v232, s[48:51], s9 offen offset:2048 nt lds
s_add_u32 s8, s66, 156672
buffer_load_dwordx4 v232, s[48:51], s8 offen offset:3072 nt lds
v_mfma_f32_16x16x32_bf16 v[8:11], v[204:207], v[188:191], v[8:11]
v_mfma_f32_16x16x32_bf16 v[28:31], v[212:215], v[188:191], v[28:31]
v_mfma_f32_16x16x32_bf16 v[12:15], v[204:207], v[192:195], v[12:15]
v_mfma_f32_16x16x32_bf16 v[32:35], v[212:215], v[192:195], v[32:35]
v_mfma_f32_16x16x32_bf16 v[16:19], v[204:207], v[196:199], v[16:19]
v_mfma_f32_16x16x32_bf16 v[36:39], v[212:215], v[196:199], v[36:39]
v_mfma_f32_16x16x32_bf16 v[40:43], v[216:219], v[160:163], v[40:43]
v_mfma_f32_16x16x32_bf16 v[60:63], v[224:227], v[160:163], v[60:63]
ds_read_b128 v[160:163], v244 offset:0
s_waitcnt vmcnt(6)
ds_read_b128 v[200:203], v240 offset:0
ds_read_b128 v[204:207], v241 offset:0
v_mfma_f32_16x16x32_bf16 v[44:47], v[216:219], v[164:167], v[44:47]
v_mfma_f32_16x16x32_bf16 v[64:67], v[224:227], v[164:167], v[64:67]
ds_read_b128 v[164:167], v244 offset:1024
v_mfma_f32_16x16x32_bf16 v[48:51], v[216:219], v[168:171], v[48:51]
v_mfma_f32_16x16x32_bf16 v[68:71], v[224:227], v[168:171], v[68:71]
ds_read_b128 v[168:171], v244 offset:2048
v_mfma_f32_16x16x32_bf16 v[52:55], v[216:219], v[172:175], v[52:55]
s_waitcnt lgkmcnt(2)
s_mov_b32 m0, s4
s_add_u32 s9, s67, 131072
buffer_load_dwordx4 v232, s[48:51], s9 offen nt lds
s_add_u32 s8, s67, 134144
buffer_load_dwordx4 v232, s[48:51], s8 offen offset:1024 nt lds
v_mfma_f32_16x16x32_bf16 v[72:75], v[224:227], v[172:175], v[72:75]
ds_read_b128 v[172:175], v244 offset:3072
v_mfma_f32_16x16x32_bf16 v[56:59], v[216:219], v[176:179], v[56:59]
s_waitcnt vmcnt(6)
ds_read_b128 v[208:211], v240 offset:2048
ds_read_b128 v[212:215], v241 offset:2048
v_mfma_f32_16x16x32_bf16 v[76:79], v[224:227], v[176:179], v[76:79]
ds_read_b128 v[176:179], v244 offset:4096
v_mfma_f32_16x16x32_bf16 v[40:43], v[220:223], v[180:183], v[40:43]
v_mfma_f32_16x16x32_bf16 v[60:63], v[228:231], v[180:183], v[60:63]
ds_read_b128 v[180:183], v244 offset:5120
v_mfma_f32_16x16x32_bf16 v[44:47], v[220:223], v[184:187], v[44:47]
v_mfma_f32_16x16x32_bf16 v[64:67], v[228:231], v[184:187], v[64:67]
ds_read_b128 v[184:187], v244 offset:6144
s_waitcnt lgkmcnt(3)
s_mov_b32 m0, s4
s_add_u32 s9, s67, 137216
buffer_load_dwordx4 v232, s[48:51], s9 offen offset:2048 nt lds
s_add_u32 s8, s67, 140288
buffer_load_dwordx4 v232, s[48:51], s8 offen offset:3072 nt lds
v_mfma_f32_16x16x32_bf16 v[48:51], v[220:223], v[188:191], v[48:51]
v_mfma_f32_16x16x32_bf16 v[68:71], v[228:231], v[188:191], v[68:71]
ds_read_b128 v[188:191], v244 offset:7168
v_mfma_f32_16x16x32_bf16 v[52:55], v[220:223], v[192:195], v[52:55]
v_mfma_f32_16x16x32_bf16 v[72:75], v[228:231], v[192:195], v[72:75]
ds_read_b128 v[192:195], v244 offset:8192
v_mfma_f32_16x16x32_bf16 v[56:59], v[220:223], v[196:199], v[56:59]
v_mfma_f32_16x16x32_bf16 v[76:79], v[228:231], v[196:199], v[76:79]
ds_read_b128 v[196:199], v244 offset:9216
v_mfma_f32_16x16x32_bf16 v[80:83], v[200:203], v[160:163], 0
v_mfma_f32_16x16x32_bf16 v[100:103], v[208:211], v[160:163], 0
s_waitcnt vmcnt(6)
ds_read_b128 v[216:219], v240 offset:4096
ds_read_b128 v[220:223], v241 offset:4096
v_mfma_f32_16x16x32_bf16 v[84:87], v[200:203], v[164:167], 0
v_mfma_f32_16x16x32_bf16 v[104:107], v[208:211], v[164:167], 0
v_mfma_f32_16x16x32_bf16 v[88:91], v[200:203], v[168:171], 0
v_mfma_f32_16x16x32_bf16 v[108:111], v[208:211], v[168:171], 0
v_mfma_f32_16x16x32_bf16 v[92:95], v[200:203], v[172:175], 0
s_waitcnt lgkmcnt(0)
s_mov_b32 m0, s5
s_add_u32 s9, s67, 147456
buffer_load_dwordx4 v232, s[48:51], s9 offen nt lds
s_add_u32 s8, s67, 150528
buffer_load_dwordx4 v232, s[48:51], s8 offen offset:1024 nt lds
v_mfma_f32_16x16x32_bf16 v[112:115], v[208:211], v[172:175], 0
v_mfma_f32_16x16x32_bf16 v[96:99], v[200:203], v[176:179], 0
s_waitcnt vmcnt(6)
ds_read_b128 v[224:227], v240 offset:6144
ds_read_b128 v[228:231], v241 offset:6144
v_mfma_f32_16x16x32_bf16 v[116:119], v[208:211], v[176:179], 0
v_mfma_f32_16x16x32_bf16 v[80:83], v[204:207], v[180:183], v[80:83]
v_mfma_f32_16x16x32_bf16 v[100:103], v[212:215], v[180:183], v[100:103]
v_mfma_f32_16x16x32_bf16 v[84:87], v[204:207], v[184:187], v[84:87]
v_mfma_f32_16x16x32_bf16 v[104:107], v[212:215], v[184:187], v[104:107]
s_waitcnt lgkmcnt(0)
s_mov_b32 m0, s5
s_add_u32 s9, s67, 153600
buffer_load_dwordx4 v232, s[48:51], s9 offen offset:2048 nt lds
s_add_u32 s8, s67, 156672
buffer_load_dwordx4 v232, s[48:51], s8 offen offset:3072 nt lds
v_mfma_f32_16x16x32_bf16 v[88:91], v[204:207], v[188:191], v[88:91]
v_mfma_f32_16x16x32_bf16 v[108:111], v[212:215], v[188:191], v[108:111]
v_max_f32 v246, v0, v1
v_mfma_f32_16x16x32_bf16 v[92:95], v[204:207], v[192:195], v[92:95]
v_mfma_f32_16x16x32_bf16 v[112:115], v[212:215], v[192:195], v[112:115]
v_max_f32 v247, v4, v5
v_mfma_f32_16x16x32_bf16 v[96:99], v[204:207], v[196:199], v[96:99]
v_mfma_f32_16x16x32_bf16 v[116:119], v[212:215], v[196:199], v[116:119]
v_max_f32 v248, v8, v9
v_mfma_f32_16x16x32_bf16 v[120:123], v[216:219], v[160:163], 0
v_mfma_f32_16x16x32_bf16 v[140:143], v[224:227], v[160:163], 0
v_max_f32 v249, v12, v13
ds_read_b128 v[160:163], v244 offset:10240
s_waitcnt vmcnt(6)
ds_read_b128 v[200:203], v240 offset:0
ds_read_b128 v[204:207], v241 offset:0
v_mfma_f32_16x16x32_bf16 v[124:127], v[216:219], v[164:167], 0
v_mfma_f32_16x16x32_bf16 v[144:147], v[224:227], v[164:167], 0
v_max_f32 v250, v16, v17
ds_read_b128 v[164:167], v244 offset:11264
v_mfma_f32_16x16x32_bf16 v[128:131], v[216:219], v[168:171], 0
v_mfma_f32_16x16x32_bf16 v[148:151], v[224:227], v[168:171], 0
v_max3_f32 v246, v246, v2, v3
ds_read_b128 v[168:171], v244 offset:12288
v_mfma_f32_16x16x32_bf16 v[132:135], v[216:219], v[172:175], 0
s_waitcnt lgkmcnt(2)
s_mov_b32 m0, s4
s_add_u32 s9, s68, 131072
buffer_load_dwordx4 v232, s[48:51], s9 offen nt lds
s_add_u32 s8, s68, 134144
buffer_load_dwordx4 v232, s[48:51], s8 offen offset:1024 nt lds
v_mfma_f32_16x16x32_bf16 v[152:155], v[224:227], v[172:175], 0
v_max3_f32 v247, v247, v6, v7
ds_read_b128 v[172:175], v244 offset:13312
v_mfma_f32_16x16x32_bf16 v[136:139], v[216:219], v[176:179], 0
s_waitcnt vmcnt(6)
ds_read_b128 v[208:211], v240 offset:2048
ds_read_b128 v[212:215], v241 offset:2048
v_mfma_f32_16x16x32_bf16 v[156:159], v[224:227], v[176:179], 0
v_max3_f32 v248, v248, v10, v11
ds_read_b128 v[176:179], v244 offset:14336
v_mfma_f32_16x16x32_bf16 v[120:123], v[220:223], v[180:183], v[120:123]
v_mfma_f32_16x16x32_bf16 v[140:143], v[228:231], v[180:183], v[140:143]
v_max3_f32 v249, v249, v14, v15
ds_read_b128 v[180:183], v244 offset:15360
v_mfma_f32_16x16x32_bf16 v[124:127], v[220:223], v[184:187], v[124:127]
v_mfma_f32_16x16x32_bf16 v[144:147], v[228:231], v[184:187], v[144:147]
v_max3_f32 v250, v250, v18, v19
ds_read_b128 v[184:187], v244 offset:16384
s_waitcnt lgkmcnt(3)
s_mov_b32 m0, s4
s_add_u32 s9, s68, 137216
buffer_load_dwordx4 v232, s[48:51], s9 offen offset:2048 nt lds
s_add_u32 s8, s68, 140288
buffer_load_dwordx4 v232, s[48:51], s8 offen offset:3072 nt lds
v_mfma_f32_16x16x32_bf16 v[128:131], v[220:223], v[188:191], v[128:131]
v_mfma_f32_16x16x32_bf16 v[148:151], v[228:231], v[188:191], v[148:151]
v_max3_f32 v246, v246, v20, v21
ds_read_b128 v[188:191], v244 offset:17408
v_mfma_f32_16x16x32_bf16 v[132:135], v[220:223], v[192:195], v[132:135]
v_mfma_f32_16x16x32_bf16 v[152:155], v[228:231], v[192:195], v[152:155]
v_max3_f32 v247, v247, v24, v25
ds_read_b128 v[192:195], v244 offset:18432
v_mfma_f32_16x16x32_bf16 v[136:139], v[220:223], v[196:199], v[136:139]
v_mfma_f32_16x16x32_bf16 v[156:159], v[228:231], v[196:199], v[156:159]
v_max3_f32 v248, v248, v28, v29
ds_read_b128 v[196:199], v244 offset:19456
v_mfma_f32_16x16x32_bf16 v[80:83], v[200:203], v[160:163], v[80:83]
v_mfma_f32_16x16x32_bf16 v[100:103], v[208:211], v[160:163], v[100:103]
v_max3_f32 v249, v249, v32, v33
s_waitcnt vmcnt(6)
ds_read_b128 v[216:219], v240 offset:4096
ds_read_b128 v[220:223], v241 offset:4096
v_mfma_f32_16x16x32_bf16 v[84:87], v[200:203], v[164:167], v[84:87]
v_mfma_f32_16x16x32_bf16 v[104:107], v[208:211], v[164:167], v[104:107]
v_max3_f32 v250, v250, v36, v37
v_mfma_f32_16x16x32_bf16 v[88:91], v[200:203], v[168:171], v[88:91]
v_mfma_f32_16x16x32_bf16 v[108:111], v[208:211], v[168:171], v[108:111]
v_max3_f32 v246, v246, v22, v23
v_mfma_f32_16x16x32_bf16 v[92:95], v[200:203], v[172:175], v[92:95]
s_waitcnt lgkmcnt(0)
s_mov_b32 m0, s5
s_add_u32 s9, s68, 147456
buffer_load_dwordx4 v232, s[48:51], s9 offen nt lds
s_add_u32 s8, s68, 150528
buffer_load_dwordx4 v232, s[48:51], s8 offen offset:1024 nt lds
v_mfma_f32_16x16x32_bf16 v[112:115], v[208:211], v[172:175], v[112:115]
v_max3_f32 v247, v247, v26, v27
v_mfma_f32_16x16x32_bf16 v[96:99], v[200:203], v[176:179], v[96:99]
s_waitcnt vmcnt(6)
ds_read_b128 v[224:227], v240 offset:6144
ds_read_b128 v[228:231], v241 offset:6144
v_mfma_f32_16x16x32_bf16 v[116:119], v[208:211], v[176:179], v[116:119]
v_max3_f32 v248, v248, v30, v31
v_mfma_f32_16x16x32_bf16 v[80:83], v[204:207], v[180:183], v[80:83]
v_mfma_f32_16x16x32_bf16 v[100:103], v[212:215], v[180:183], v[100:103]
v_max3_f32 v249, v249, v34, v35
v_mfma_f32_16x16x32_bf16 v[84:87], v[204:207], v[184:187], v[84:87]
v_mfma_f32_16x16x32_bf16 v[104:107], v[212:215], v[184:187], v[104:107]
v_max3_f32 v250, v250, v38, v39
s_waitcnt lgkmcnt(0)
s_mov_b32 m0, s5
s_add_u32 s9, s68, 153600
buffer_load_dwordx4 v232, s[48:51], s9 offen offset:2048 nt lds
s_add_u32 s8, s68, 156672
buffer_load_dwordx4 v232, s[48:51], s8 offen offset:3072 nt lds
v_mfma_f32_16x16x32_bf16 v[88:91], v[204:207], v[188:191], v[88:91]
v_mfma_f32_16x16x32_bf16 v[108:111], v[212:215], v[188:191], v[108:111]
v_max3_f32 v246, v246, v40, v41
v_mfma_f32_16x16x32_bf16 v[92:95], v[204:207], v[192:195], v[92:95]
v_mfma_f32_16x16x32_bf16 v[112:115], v[212:215], v[192:195], v[112:115]
v_max3_f32 v247, v247, v44, v45
v_mfma_f32_16x16x32_bf16 v[96:99], v[204:207], v[196:199], v[96:99]
v_mfma_f32_16x16x32_bf16 v[116:119], v[212:215], v[196:199], v[116:119]
v_max3_f32 v248, v248, v48, v49
v_mfma_f32_16x16x32_bf16 v[120:123], v[216:219], v[160:163], v[120:123]
v_mfma_f32_16x16x32_bf16 v[140:143], v[224:227], v[160:163], v[140:143]
v_max3_f32 v249, v249, v52, v53
ds_read_b128 v[160:163], v244 offset:20480
s_waitcnt vmcnt(6)
ds_read_b128 v[200:203], v240 offset:0
ds_read_b128 v[204:207], v241 offset:0
v_mfma_f32_16x16x32_bf16 v[124:127], v[216:219], v[164:167], v[124:127]
v_mfma_f32_16x16x32_bf16 v[144:147], v[224:227], v[164:167], v[144:147]
v_max3_f32 v250, v250, v56, v57
ds_read_b128 v[164:167], v244 offset:21504
v_mfma_f32_16x16x32_bf16 v[128:131], v[216:219], v[168:171], v[128:131]
v_mfma_f32_16x16x32_bf16 v[148:151], v[224:227], v[168:171], v[148:151]
v_max3_f32 v246, v246, v42, v43
ds_read_b128 v[168:171], v244 offset:22528
v_mfma_f32_16x16x32_bf16 v[132:135], v[216:219], v[172:175], v[132:135]
s_waitcnt lgkmcnt(2)
s_mov_b32 m0, s4
s_add_u32 s9, s69, 131072
buffer_load_dwordx4 v232, s[48:51], s9 offen nt lds
s_add_u32 s8, s69, 134144
buffer_load_dwordx4 v232, s[48:51], s8 offen offset:1024 nt lds
v_mfma_f32_16x16x32_bf16 v[152:155], v[224:227], v[172:175], v[152:155]
v_max3_f32 v247, v247, v46, v47
ds_read_b128 v[172:175], v244 offset:23552
v_mfma_f32_16x16x32_bf16 v[136:139], v[216:219], v[176:179], v[136:139]
s_waitcnt vmcnt(6)
ds_read_b128 v[208:211], v240 offset:2048
ds_read_b128 v[212:215], v241 offset:2048
v_mfma_f32_16x16x32_bf16 v[156:159], v[224:227], v[176:179], v[156:159]
v_max3_f32 v248, v248, v50, v51
ds_read_b128 v[176:179], v244 offset:24576
v_mfma_f32_16x16x32_bf16 v[120:123], v[220:223], v[180:183], v[120:123]
v_mfma_f32_16x16x32_bf16 v[140:143], v[228:231], v[180:183], v[140:143]
v_max3_f32 v249, v249, v54, v55
ds_read_b128 v[180:183], v244 offset:25600
v_mfma_f32_16x16x32_bf16 v[124:127], v[220:223], v[184:187], v[124:127]
v_mfma_f32_16x16x32_bf16 v[144:147], v[228:231], v[184:187], v[144:147]
v_max3_f32 v250, v250, v58, v59
ds_read_b128 v[184:187], v244 offset:26624
s_waitcnt lgkmcnt(3)
s_mov_b32 m0, s4
s_add_u32 s9, s69, 137216
buffer_load_dwordx4 v232, s[48:51], s9 offen offset:2048 nt lds
s_add_u32 s8, s69, 140288
buffer_load_dwordx4 v232, s[48:51], s8 offen offset:3072 nt lds
v_mfma_f32_16x16x32_bf16 v[128:131], v[220:223], v[188:191], v[128:131]
v_mfma_f32_16x16x32_bf16 v[148:151], v[228:231], v[188:191], v[148:151]
v_max3_f32 v246, v246, v60, v61
ds_read_b128 v[188:191], v244 offset:27648
v_mfma_f32_16x16x32_bf16 v[132:135], v[220:223], v[192:195], v[132:135]
v_mfma_f32_16x16x32_bf16 v[152:155], v[228:231], v[192:195], v[152:155]
v_max3_f32 v247, v247, v64, v65
ds_read_b128 v[192:195], v244 offset:28672
v_mfma_f32_16x16x32_bf16 v[136:139], v[220:223], v[196:199], v[136:139]
v_mfma_f32_16x16x32_bf16 v[156:159], v[228:231], v[196:199], v[156:159]
v_max3_f32 v248, v248, v68, v69
ds_read_b128 v[196:199], v244 offset:29696
v_mfma_f32_16x16x32_bf16 v[80:83], v[200:203], v[160:163], v[80:83]
v_mfma_f32_16x16x32_bf16 v[100:103], v[208:211], v[160:163], v[100:103]
v_max3_f32 v249, v249, v72, v73
s_waitcnt vmcnt(6)
ds_read_b128 v[216:219], v240 offset:4096
ds_read_b128 v[220:223], v241 offset:4096
v_mfma_f32_16x16x32_bf16 v[84:87], v[200:203], v[164:167], v[84:87]
v_mfma_f32_16x16x32_bf16 v[104:107], v[208:211], v[164:167], v[104:107]
v_max3_f32 v250, v250, v76, v77
v_mfma_f32_16x16x32_bf16 v[88:91], v[200:203], v[168:171], v[88:91]
v_mfma_f32_16x16x32_bf16 v[108:111], v[208:211], v[168:171], v[108:111]
v_max3_f32 v246, v246, v62, v63
v_mfma_f32_16x16x32_bf16 v[92:95], v[200:203], v[172:175], v[92:95]
s_waitcnt lgkmcnt(0)
s_mov_b32 m0, s5
s_add_u32 s9, s69, 147456
buffer_load_dwordx4 v232, s[48:51], s9 offen nt lds
s_add_u32 s8, s69, 150528
buffer_load_dwordx4 v232, s[48:51], s8 offen offset:1024 nt lds
v_mfma_f32_16x16x32_bf16 v[112:115], v[208:211], v[172:175], v[112:115]
v_max3_f32 v247, v247, v66, v67
v_mfma_f32_16x16x32_bf16 v[96:99], v[200:203], v[176:179], v[96:99]
s_waitcnt vmcnt(6)
ds_read_b128 v[224:227], v240 offset:6144
ds_read_b128 v[228:231], v241 offset:6144
v_mfma_f32_16x16x32_bf16 v[116:119], v[208:211], v[176:179], v[116:119]
v_max3_f32 v248, v248, v70, v71
v_mfma_f32_16x16x32_bf16 v[80:83], v[204:207], v[180:183], v[80:83]
v_mfma_f32_16x16x32_bf16 v[100:103], v[212:215], v[180:183], v[100:103]
v_max3_f32 v249, v249, v74, v75
v_mfma_f32_16x16x32_bf16 v[84:87], v[204:207], v[184:187], v[84:87]
v_mfma_f32_16x16x32_bf16 v[104:107], v[212:215], v[184:187], v[104:107]
v_max3_f32 v250, v250, v78, v79
s_waitcnt lgkmcnt(0)
s_mov_b32 m0, s5
s_add_u32 s9, s69, 153600
buffer_load_dwordx4 v232, s[48:51], s9 offen offset:2048 nt lds
s_add_u32 s8, s69, 156672
buffer_load_dwordx4 v232, s[48:51], s8 offen offset:3072 nt lds
v_mfma_f32_16x16x32_bf16 v[88:91], v[204:207], v[188:191], v[88:91]
v_mfma_f32_16x16x32_bf16 v[108:111], v[212:215], v[188:191], v[108:111]
v_mfma_f32_16x16x32_bf16 v[92:95], v[204:207], v[192:195], v[92:95]
v_mfma_f32_16x16x32_bf16 v[112:115], v[212:215], v[192:195], v[112:115]
v_mfma_f32_16x16x32_bf16 v[96:99], v[204:207], v[196:199], v[96:99]
v_mfma_f32_16x16x32_bf16 v[116:119], v[212:215], v[196:199], v[116:119]
v_mfma_f32_16x16x32_bf16 v[120:123], v[216:219], v[160:163], v[120:123]
v_mfma_f32_16x16x32_bf16 v[140:143], v[224:227], v[160:163], v[140:143]
ds_read_b128 v[160:163], v244 offset:30720
s_waitcnt vmcnt(6)
ds_read_b128 v[200:203], v240 offset:0
ds_read_b128 v[204:207], v241 offset:0
v_mfma_f32_16x16x32_bf16 v[124:127], v[216:219], v[164:167], v[124:127]
v_mfma_f32_16x16x32_bf16 v[144:147], v[224:227], v[164:167], v[144:147]
ds_read_b128 v[164:167], v244 offset:31744
v_mfma_f32_16x16x32_bf16 v[128:131], v[216:219], v[168:171], v[128:131]
v_mfma_f32_16x16x32_bf16 v[148:151], v[224:227], v[168:171], v[148:151]
ds_read_b128 v[168:171], v244 offset:32768
v_mfma_f32_16x16x32_bf16 v[132:135], v[216:219], v[172:175], v[132:135]
s_waitcnt lgkmcnt(2)
s_mov_b32 m0, s4
s_mov_b32 s9, 0
buffer_load_dwordx4 v232, s[52:55], s9 offen nt lds
s_mov_b32 s8, 3072
buffer_load_dwordx4 v232, s[52:55], s8 offen offset:1024 nt lds
v_mfma_f32_16x16x32_bf16 v[152:155], v[224:227], v[172:175], v[152:155]
ds_read_b128 v[172:175], v244 offset:33792
v_mfma_f32_16x16x32_bf16 v[136:139], v[216:219], v[176:179], v[136:139]
s_waitcnt vmcnt(6)
ds_read_b128 v[208:211], v240 offset:2048
ds_read_b128 v[212:215], v241 offset:2048
v_mfma_f32_16x16x32_bf16 v[156:159], v[224:227], v[176:179], v[156:159]
ds_read_b128 v[176:179], v244 offset:34816
v_mfma_f32_16x16x32_bf16 v[120:123], v[220:223], v[180:183], v[120:123]
v_mfma_f32_16x16x32_bf16 v[140:143], v[228:231], v[180:183], v[140:143]
ds_read_b128 v[180:183], v244 offset:35840
v_mfma_f32_16x16x32_bf16 v[124:127], v[220:223], v[184:187], v[124:127]
v_mfma_f32_16x16x32_bf16 v[144:147], v[228:231], v[184:187], v[144:147]
ds_read_b128 v[184:187], v244 offset:36864
s_waitcnt lgkmcnt(3)
s_mov_b32 m0, s4
s_mov_b32 s9, 6144
buffer_load_dwordx4 v232, s[52:55], s9 offen offset:2048 nt lds
s_mov_b32 s8, 9216
buffer_load_dwordx4 v232, s[52:55], s8 offen offset:3072 nt lds
v_mfma_f32_16x16x32_bf16 v[128:131], v[220:223], v[188:191], v[128:131]
v_mfma_f32_16x16x32_bf16 v[148:151], v[228:231], v[188:191], v[148:151]
ds_read_b128 v[188:191], v244 offset:37888
v_mfma_f32_16x16x32_bf16 v[132:135], v[220:223], v[192:195], v[132:135]
v_mfma_f32_16x16x32_bf16 v[152:155], v[228:231], v[192:195], v[152:155]
ds_read_b128 v[192:195], v244 offset:38912
v_mfma_f32_16x16x32_bf16 v[136:139], v[220:223], v[196:199], v[136:139]
v_mfma_f32_16x16x32_bf16 v[156:159], v[228:231], v[196:199], v[156:159]
ds_read_b128 v[196:199], v244 offset:39936
v_mfma_f32_16x16x32_bf16 v[80:83], v[200:203], v[160:163], v[80:83]
v_mfma_f32_16x16x32_bf16 v[100:103], v[208:211], v[160:163], v[100:103]
s_waitcnt vmcnt(6)
ds_read_b128 v[216:219], v240 offset:4096
ds_read_b128 v[220:223], v241 offset:4096
v_mfma_f32_16x16x32_bf16 v[84:87], v[200:203], v[164:167], v[84:87]
v_mfma_f32_16x16x32_bf16 v[104:107], v[208:211], v[164:167], v[104:107]
v_mfma_f32_16x16x32_bf16 v[88:91], v[200:203], v[168:171], v[88:91]
v_mfma_f32_16x16x32_bf16 v[108:111], v[208:211], v[168:171], v[108:111]
v_mfma_f32_16x16x32_bf16 v[92:95], v[200:203], v[172:175], v[92:95]
s_waitcnt lgkmcnt(0)
s_mov_b32 m0, s5
s_mov_b32 s9, 16384
buffer_load_dwordx4 v232, s[52:55], s9 offen nt lds
s_mov_b32 s8, 19456
buffer_load_dwordx4 v232, s[52:55], s8 offen offset:1024 nt lds
v_mfma_f32_16x16x32_bf16 v[112:115], v[208:211], v[172:175], v[112:115]
v_mfma_f32_16x16x32_bf16 v[96:99], v[200:203], v[176:179], v[96:99]
s_waitcnt vmcnt(6)
ds_read_b128 v[224:227], v240 offset:6144
ds_read_b128 v[228:231], v241 offset:6144
v_mfma_f32_16x16x32_bf16 v[116:119], v[208:211], v[176:179], v[116:119]
v_mfma_f32_16x16x32_bf16 v[80:83], v[204:207], v[180:183], v[80:83]
v_mfma_f32_16x16x32_bf16 v[100:103], v[212:215], v[180:183], v[100:103]
v_mfma_f32_16x16x32_bf16 v[84:87], v[204:207], v[184:187], v[84:87]
v_mfma_f32_16x16x32_bf16 v[104:107], v[212:215], v[184:187], v[104:107]
s_waitcnt lgkmcnt(0)
s_mov_b32 m0, s5
s_mov_b32 s9, 22528
buffer_load_dwordx4 v232, s[52:55], s9 offen offset:2048 nt lds
s_mov_b32 s8, 25600
buffer_load_dwordx4 v232, s[52:55], s8 offen offset:3072 nt lds
v_mfma_f32_16x16x32_bf16 v[88:91], v[204:207], v[188:191], v[88:91]
v_mfma_f32_16x16x32_bf16 v[108:111], v[212:215], v[188:191], v[108:111]
v_mfma_f32_16x16x32_bf16 v[92:95], v[204:207], v[192:195], v[92:95]
v_mfma_f32_16x16x32_bf16 v[112:115], v[212:215], v[192:195], v[112:115]
v_mfma_f32_16x16x32_bf16 v[96:99], v[204:207], v[196:199], v[96:99]
v_mfma_f32_16x16x32_bf16 v[116:119], v[212:215], v[196:199], v[116:119]
v_mfma_f32_16x16x32_bf16 v[120:123], v[216:219], v[160:163], v[120:123]
v_mfma_f32_16x16x32_bf16 v[140:143], v[224:227], v[160:163], v[140:143]
s_waitcnt vmcnt(6)
ds_read_b64_tr_b16 v[200:201], v236 offset:0
ds_read_b64_tr_b16 v[204:205], v237 offset:0
ds_read_b64_tr_b16 v[208:209], v238 offset:0
ds_read_b64_tr_b16 v[212:213], v239 offset:0
v_mfma_f32_16x16x32_bf16 v[124:127], v[216:219], v[164:167], v[124:127]
v_mfma_f32_16x16x32_bf16 v[144:147], v[224:227], v[164:167], v[144:147]
v_mfma_f32_16x16x32_bf16 v[128:131], v[216:219], v[168:171], v[128:131]
v_mfma_f32_16x16x32_bf16 v[148:151], v[224:227], v[168:171], v[148:151]
v_mfma_f32_16x16x32_bf16 v[132:135], v[216:219], v[172:175], v[132:135]
s_waitcnt lgkmcnt(0)
s_mov_b32 m0, s4
s_mov_b32 s9, 32768
buffer_load_dwordx4 v232, s[52:55], s9 offen nt lds
s_mov_b32 s8, 35840
buffer_load_dwordx4 v232, s[52:55], s8 offen offset:1024 nt lds
v_mfma_f32_16x16x32_bf16 v[152:155], v[224:227], v[172:175], v[152:155]
v_mfma_f32_16x16x32_bf16 v[136:139], v[216:219], v[176:179], v[136:139]
s_waitcnt vmcnt(6)
ds_read_b64_tr_b16 v[202:203], v236 offset:2048
ds_read_b64_tr_b16 v[206:207], v237 offset:2048
ds_read_b64_tr_b16 v[210:211], v238 offset:2048
ds_read_b64_tr_b16 v[214:215], v239 offset:2048
v_mfma_f32_16x16x32_bf16 v[156:159], v[224:227], v[176:179], v[156:159]
v_mfma_f32_16x16x32_bf16 v[120:123], v[220:223], v[180:183], v[120:123]
v_mfma_f32_16x16x32_bf16 v[140:143], v[228:231], v[180:183], v[140:143]
v_mfma_f32_16x16x32_bf16 v[124:127], v[220:223], v[184:187], v[124:127]
v_mfma_f32_16x16x32_bf16 v[144:147], v[228:231], v[184:187], v[144:147]
s_waitcnt lgkmcnt(0)
s_mov_b32 m0, s4
s_mov_b32 s9, 38912
buffer_load_dwordx4 v232, s[52:55], s9 offen offset:2048 nt lds
s_mov_b32 s8, 41984
buffer_load_dwordx4 v232, s[52:55], s8 offen offset:3072 nt lds
v_mfma_f32_16x16x32_bf16 v[128:131], v[220:223], v[188:191], v[128:131]
v_mfma_f32_16x16x32_bf16 v[148:151], v[228:231], v[188:191], v[148:151]
v_mfma_f32_16x16x32_bf16 v[132:135], v[220:223], v[192:195], v[132:135]
v_mfma_f32_16x16x32_bf16 v[152:155], v[228:231], v[192:195], v[152:155]
v_mfma_f32_16x16x32_bf16 v[136:139], v[220:223], v[196:199], v[136:139]
v_mfma_f32_16x16x32_bf16 v[156:159], v[228:231], v[196:199], v[156:159]
s_nop 7
v_max3_f32 v246, v246, v80, v81
v_max3_f32 v247, v247, v84, v85
v_max3_f32 v248, v248, v88, v89
v_max3_f32 v249, v249, v92, v93
v_max3_f32 v250, v250, v96, v97
v_max3_f32 v246, v246, v82, v83
v_max3_f32 v247, v247, v86, v87
v_max3_f32 v248, v248, v90, v91
v_max3_f32 v249, v249, v94, v95
v_max3_f32 v250, v250, v98, v99
v_max3_f32 v246, v246, v100, v101
v_max3_f32 v247, v247, v104, v105
v_max3_f32 v248, v248, v108, v109
v_max3_f32 v249, v249, v112, v113
v_max3_f32 v250, v250, v116, v117
v_max3_f32 v246, v246, v102, v103
v_max3_f32 v247, v247, v106, v107
v_max3_f32 v248, v248, v110, v111
v_max3_f32 v249, v249, v114, v115
v_max3_f32 v250, v250, v118, v119
v_max3_f32 v246, v246, v120, v121
v_max3_f32 v247, v247, v124, v125
v_max3_f32 v248, v248, v128, v129
v_max3_f32 v249, v249, v132, v133
v_max3_f32 v250, v250, v136, v137
v_max3_f32 v246, v246, v122, v123
v_max3_f32 v247, v247, v126, v127
v_max3_f32 v248, v248, v130, v131
v_max3_f32 v249, v249, v134, v135
v_max3_f32 v250, v250, v138, v139
v_max3_f32 v246, v246, v140, v141
v_max3_f32 v247, v247, v144, v145
v_max3_f32 v248, v248, v148, v149
v_max3_f32 v249, v249, v152, v153
v_max3_f32 v250, v250, v156, v157
v_max3_f32 v246, v246, v142, v143
v_max3_f32 v247, v247, v146, v147
v_max3_f32 v248, v248, v150, v151
v_max3_f32 v249, v249, v154, v155
v_max3_f32 v250, v250, v158, v159
v_lshlrev_b32 v217, 4, v235
s_lshl_b32 s10, s14, 11
s_lshl_b32 s11, s15, 2
s_add_u32 s10, s10, s11
s_add_u32 s10, s10, 147456
v_add_u32 v217, s10, v217
v_mov_b32 v216, v250
s_nop 1
v_permlane32_swap_b32 v246, v248
v_permlane32_swap_b32 v247, v249
v_permlane32_swap_b32 v250, v216
v_max_f32 v246, v246, v248
v_max_f32 v247, v247, v249
v_max_f32 v250, v250, v216
v_mov_b32 v216, v250
s_nop 1
v_permlane16_swap_b32 v246, v247
v_permlane16_swap_b32 v250, v216
v_max_f32 v246, v246, v247
v_max_f32 v250, v250, v216
ds_write_b32 v217, v246 offset:0
ds_write_b32 v217, v250 offset:1024
s_waitcnt lgkmcnt(0)
s_barrier
v_and_b32 v217, 15, v235
v_lshlrev_b32 v217, 4, v217
s_lshl_b32 s10, s14, 11
s_add_u32 s10, s10, 147456
v_add_u32 v217, s10, v217
ds_read_b128 v[160:163], v217 offset:0
ds_read_b128 v[164:167], v217 offset:256
ds_read_b128 v[168:171], v217 offset:512
ds_read_b128 v[172:175], v217 offset:768
ds_read_b128 v[176:179], v217 offset:1024
s_waitcnt lgkmcnt(4)
v_max_f32 v246, v160, v161
v_max3_f32 v246, v246, v162, v163
s_waitcnt lgkmcnt(3)
v_max_f32 v247, v164, v165
v_max3_f32 v247, v247, v166, v167
s_waitcnt lgkmcnt(2)
v_max_f32 v248, v168, v169
v_max3_f32 v248, v248, v170, v171
s_waitcnt lgkmcnt(1)
v_max_f32 v249, v172, v173
v_max3_f32 v249, v249, v174, v175
s_waitcnt lgkmcnt(0)
v_max_f32 v250, v176, v177
v_max3_f32 v250, v250, v178, v179
v_mul_f32 v246, s6, v246
v_mul_f32 v247, s6, v247
v_mul_f32 v248, s6, v248
v_mul_f32 v249, s6, v249
v_mul_f32 v250, s6, v250
v_add_u32 v197, s12, v242
v_pk_fma_f32 v[0:1], v[0:1], s[6:7], v[246:247] op_sel:[0,0,0] op_sel_hi:[1,0,0] neg_lo:[0,0,1] neg_hi:[0,0,1]
v_pk_fma_f32 v[2:3], v[2:3], s[6:7], v[246:247] op_sel:[0,0,0] op_sel_hi:[1,0,0] neg_lo:[0,0,1] neg_hi:[0,0,1]
v_pk_fma_f32 v[20:21], v[20:21], s[6:7], v[246:247] op_sel:[0,0,0] op_sel_hi:[1,0,0] neg_lo:[0,0,1] neg_hi:[0,0,1]
v_pk_fma_f32 v[22:23], v[22:23], s[6:7], v[246:247] op_sel:[0,0,0] op_sel_hi:[1,0,0] neg_lo:[0,0,1] neg_hi:[0,0,1]
v_exp_f32 v0, v0
v_exp_f32 v1, v1
v_exp_f32 v2, v2
v_exp_f32 v3, v3
v_exp_f32 v20, v20
v_exp_f32 v21, v21
v_exp_f32 v22, v22
v_exp_f32 v23, v23
v_pk_add_f32 v[220:221], v[0:1], v[2:3]
v_pk_add_f32 v[222:223], v[20:21], v[22:23]
v_cvt_pk_bf16_f32 v0, v0, v1
v_cvt_pk_bf16_f32 v1, v2, v3
v_cvt_pk_bf16_f32 v2, v20, v21
v_cvt_pk_bf16_f32 v3, v22, v23
v_pk_add_f32 v[220:221], v[220:221], v[222:223]
v_add_f32 v192, v220, v221
ds_write_b128 v197, v[0:3] offset:0
v_pk_fma_f32 v[4:5], v[4:5], s[6:7], v[246:247] op_sel:[0,0,1] op_sel_hi:[1,0,1] neg_lo:[0,0,1] neg_hi:[0,0,1]
v_pk_fma_f32 v[6:7], v[6:7], s[6:7], v[246:247] op_sel:[0,0,1] op_sel_hi:[1,0,1] neg_lo:[0,0,1] neg_hi:[0,0,1]
v_pk_fma_f32 v[24:25], v[24:25], s[6:7], v[246:247] op_sel:[0,0,1] op_sel_hi:[1,0,1] neg_lo:[0,0,1] neg_hi:[0,0,1]
v_pk_fma_f32 v[26:27], v[26:27], s[6:7], v[246:247] op_sel:[0,0,1] op_sel_hi:[1,0,1] neg_lo:[0,0,1] neg_hi:[0,0,1]
v_exp_f32 v4, v4
v_exp_f32 v5, v5
v_exp_f32 v6, v6
v_exp_f32 v7, v7
v_exp_f32 v24, v24
v_exp_f32 v25, v25
v_exp_f32 v26, v26
v_exp_f32 v27, v27
v_pk_add_f32 v[224:225], v[4:5], v[6:7]
v_pk_add_f32 v[226:227], v[24:25], v[26:27]
v_cvt_pk_bf16_f32 v4, v4, v5
v_cvt_pk_bf16_f32 v5, v6, v7
v_cvt_pk_bf16_f32 v6, v24, v25
v_cvt_pk_bf16_f32 v7, v26, v27
v_pk_add_f32 v[224:225], v[224:225], v[226:227]
v_add_f32 v193, v224, v225
ds_write_b128 v197, v[4:7] offset:1024
v_pk_fma_f32 v[8:9], v[8:9], s[6:7], v[248:249] op_sel:[0,0,0] op_sel_hi:[1,0,0] neg_lo:[0,0,1] neg_hi:[0,0,1]
v_pk_fma_f32 v[10:11], v[10:11], s[6:7], v[248:249] op_sel:[0,0,0] op_sel_hi:[1,0,0] neg_lo:[0,0,1] neg_hi:[0,0,1]
v_pk_fma_f32 v[28:29], v[28:29], s[6:7], v[248:249] op_sel:[0,0,0] op_sel_hi:[1,0,0] neg_lo:[0,0,1] neg_hi:[0,0,1]
v_pk_fma_f32 v[30:31], v[30:31], s[6:7], v[248:249] op_sel:[0,0,0] op_sel_hi:[1,0,0] neg_lo:[0,0,1] neg_hi:[0,0,1]
v_exp_f32 v8, v8
v_exp_f32 v9, v9
v_exp_f32 v10, v10
v_exp_f32 v11, v11
v_exp_f32 v28, v28
v_exp_f32 v29, v29
v_exp_f32 v30, v30
v_exp_f32 v31, v31
v_pk_add_f32 v[220:221], v[8:9], v[10:11]
v_pk_add_f32 v[222:223], v[28:29], v[30:31]
v_cvt_pk_bf16_f32 v8, v8, v9
v_cvt_pk_bf16_f32 v9, v10, v11
v_cvt_pk_bf16_f32 v10, v28, v29
v_cvt_pk_bf16_f32 v11, v30, v31
v_pk_add_f32 v[220:221], v[220:221], v[222:223]
v_add_f32 v194, v220, v221
ds_write_b128 v197, v[8:11] offset:2048
v_pk_fma_f32 v[12:13], v[12:13], s[6:7], v[248:249] op_sel:[0,0,1] op_sel_hi:[1,0,1] neg_lo:[0,0,1] neg_hi:[0,0,1]
v_pk_fma_f32 v[14:15], v[14:15], s[6:7], v[248:249] op_sel:[0,0,1] op_sel_hi:[1,0,1] neg_lo:[0,0,1] neg_hi:[0,0,1]
v_pk_fma_f32 v[32:33], v[32:33], s[6:7], v[248:249] op_sel:[0,0,1] op_sel_hi:[1,0,1] neg_lo:[0,0,1] neg_hi:[0,0,1]
v_pk_fma_f32 v[34:35], v[34:35], s[6:7], v[248:249] op_sel:[0,0,1] op_sel_hi:[1,0,1] neg_lo:[0,0,1] neg_hi:[0,0,1]
v_exp_f32 v12, v12
v_exp_f32 v13, v13
v_exp_f32 v14, v14
v_exp_f32 v15, v15
v_exp_f32 v32, v32
v_exp_f32 v33, v33
v_exp_f32 v34, v34
v_exp_f32 v35, v35
v_pk_add_f32 v[224:225], v[12:13], v[14:15]
v_pk_add_f32 v[226:227], v[32:33], v[34:35]
v_cvt_pk_bf16_f32 v12, v12, v13
v_cvt_pk_bf16_f32 v13, v14, v15
v_cvt_pk_bf16_f32 v14, v32, v33
v_cvt_pk_bf16_f32 v15, v34, v35
v_pk_add_f32 v[224:225], v[224:225], v[226:227]
v_add_f32 v195, v224, v225
ds_write_b128 v197, v[12:15] offset:3072
v_pk_fma_f32 v[16:17], v[16:17], s[6:7], v[250:251] op_sel:[0,0,0] op_sel_hi:[1,0,0] neg_lo:[0,0,1] neg_hi:[0,0,1]
v_pk_fma_f32 v[18:19], v[18:19], s[6:7], v[250:251] op_sel:[0,0,0] op_sel_hi:[1,0,0] neg_lo:[0,0,1] neg_hi:[0,0,1]
v_pk_fma_f32 v[36:37], v[36:37], s[6:7], v[250:251] op_sel:[0,0,0] op_sel_hi:[1,0,0] neg_lo:[0,0,1] neg_hi:[0,0,1]
v_pk_fma_f32 v[38:39], v[38:39], s[6:7], v[250:251] op_sel:[0,0,0] op_sel_hi:[1,0,0] neg_lo:[0,0,1] neg_hi:[0,0,1]
v_exp_f32 v16, v16
v_exp_f32 v17, v17
v_exp_f32 v18, v18
v_exp_f32 v19, v19
v_exp_f32 v36, v36
v_exp_f32 v37, v37
v_exp_f32 v38, v38
v_exp_f32 v39, v39
v_pk_add_f32 v[220:221], v[16:17], v[18:19]
v_pk_add_f32 v[222:223], v[36:37], v[38:39]
v_cvt_pk_bf16_f32 v16, v16, v17
v_cvt_pk_bf16_f32 v17, v18, v19
v_cvt_pk_bf16_f32 v18, v36, v37
v_cvt_pk_bf16_f32 v19, v38, v39
v_pk_add_f32 v[220:221], v[220:221], v[222:223]
v_add_f32 v196, v220, v221
ds_write_b128 v197, v[16:19] offset:4096
v_pk_fma_f32 v[40:41], v[40:41], s[6:7], v[246:247] op_sel:[0,0,0] op_sel_hi:[1,0,0] neg_lo:[0,0,1] neg_hi:[0,0,1]
v_pk_fma_f32 v[42:43], v[42:43], s[6:7], v[246:247] op_sel:[0,0,0] op_sel_hi:[1,0,0] neg_lo:[0,0,1] neg_hi:[0,0,1]
v_pk_fma_f32 v[60:61], v[60:61], s[6:7], v[246:247] op_sel:[0,0,0] op_sel_hi:[1,0,0] neg_lo:[0,0,1] neg_hi:[0,0,1]
v_pk_fma_f32 v[62:63], v[62:63], s[6:7], v[246:247] op_sel:[0,0,0] op_sel_hi:[1,0,0] neg_lo:[0,0,1] neg_hi:[0,0,1]
v_exp_f32 v40, v40
v_exp_f32 v41, v41
v_exp_f32 v42, v42
v_exp_f32 v43, v43
v_exp_f32 v60, v60
v_exp_f32 v61, v61
v_exp_f32 v62, v62
v_exp_f32 v63, v63
v_pk_add_f32 v[224:225], v[40:41], v[42:43]
v_pk_add_f32 v[226:227], v[60:61], v[62:63]
v_cvt_pk_bf16_f32 v40, v40, v41
v_cvt_pk_bf16_f32 v41, v42, v43
v_cvt_pk_bf16_f32 v42, v60, v61
v_cvt_pk_bf16_f32 v43, v62, v63
v_pk_add_f32 v[224:225], v[224:225], v[226:227]
v_add_f32 v192, v192, v224
v_add_f32 v192, v192, v225
ds_write_b128 v197, v[40:43] offset:5120
v_pk_fma_f32 v[44:45], v[44:45], s[6:7], v[246:247] op_sel:[0,0,1] op_sel_hi:[1,0,1] neg_lo:[0,0,1] neg_hi:[0,0,1]
v_pk_fma_f32 v[46:47], v[46:47], s[6:7], v[246:247] op_sel:[0,0,1] op_sel_hi:[1,0,1] neg_lo:[0,0,1] neg_hi:[0,0,1]
v_pk_fma_f32 v[64:65], v[64:65], s[6:7], v[246:247] op_sel:[0,0,1] op_sel_hi:[1,0,1] neg_lo:[0,0,1] neg_hi:[0,0,1]
v_pk_fma_f32 v[66:67], v[66:67], s[6:7], v[246:247] op_sel:[0,0,1] op_sel_hi:[1,0,1] neg_lo:[0,0,1] neg_hi:[0,0,1]
v_exp_f32 v44, v44
v_exp_f32 v45, v45
v_exp_f32 v46, v46
v_exp_f32 v47, v47
v_exp_f32 v64, v64
v_exp_f32 v65, v65
v_exp_f32 v66, v66
v_exp_f32 v67, v67
v_pk_add_f32 v[220:221], v[44:45], v[46:47]
v_pk_add_f32 v[222:223], v[64:65], v[66:67]
v_cvt_pk_bf16_f32 v44, v44, v45
v_cvt_pk_bf16_f32 v45, v46, v47
v_cvt_pk_bf16_f32 v46, v64, v65
v_cvt_pk_bf16_f32 v47, v66, v67
v_pk_add_f32 v[220:221], v[220:221], v[222:223]
v_add_f32 v193, v193, v220
v_add_f32 v193, v193, v221
ds_write_b128 v197, v[44:47] offset:6144
v_pk_fma_f32 v[48:49], v[48:49], s[6:7], v[248:249] op_sel:[0,0,0] op_sel_hi:[1,0,0] neg_lo:[0,0,1] neg_hi:[0,0,1]
v_pk_fma_f32 v[50:51], v[50:51], s[6:7], v[248:249] op_sel:[0,0,0] op_sel_hi:[1,0,0] neg_lo:[0,0,1] neg_hi:[0,0,1]
v_pk_fma_f32 v[68:69], v[68:69], s[6:7], v[248:249] op_sel:[0,0,0] op_sel_hi:[1,0,0] neg_lo:[0,0,1] neg_hi:[0,0,1]
v_pk_fma_f32 v[70:71], v[70:71], s[6:7], v[248:249] op_sel:[0,0,0] op_sel_hi:[1,0,0] neg_lo:[0,0,1] neg_hi:[0,0,1]
v_exp_f32 v48, v48
v_exp_f32 v49, v49
v_exp_f32 v50, v50
v_exp_f32 v51, v51
v_exp_f32 v68, v68
v_exp_f32 v69, v69
v_exp_f32 v70, v70
v_exp_f32 v71, v71
v_pk_add_f32 v[224:225], v[48:49], v[50:51]
v_pk_add_f32 v[226:227], v[68:69], v[70:71]
v_cvt_pk_bf16_f32 v48, v48, v49
v_cvt_pk_bf16_f32 v49, v50, v51
v_cvt_pk_bf16_f32 v50, v68, v69
v_cvt_pk_bf16_f32 v51, v70, v71
v_pk_add_f32 v[224:225], v[224:225], v[226:227]
v_add_f32 v194, v194, v224
v_add_f32 v194, v194, v225
ds_write_b128 v197, v[48:51] offset:7168
v_pk_fma_f32 v[52:53], v[52:53], s[6:7], v[248:249] op_sel:[0,0,1] op_sel_hi:[1,0,1] neg_lo:[0,0,1] neg_hi:[0,0,1]
v_pk_fma_f32 v[54:55], v[54:55], s[6:7], v[248:249] op_sel:[0,0,1] op_sel_hi:[1,0,1] neg_lo:[0,0,1] neg_hi:[0,0,1]
v_pk_fma_f32 v[72:73], v[72:73], s[6:7], v[248:249] op_sel:[0,0,1] op_sel_hi:[1,0,1] neg_lo:[0,0,1] neg_hi:[0,0,1]
v_pk_fma_f32 v[74:75], v[74:75], s[6:7], v[248:249] op_sel:[0,0,1] op_sel_hi:[1,0,1] neg_lo:[0,0,1] neg_hi:[0,0,1]
v_exp_f32 v52, v52
v_exp_f32 v53, v53
v_exp_f32 v54, v54
v_exp_f32 v55, v55
v_exp_f32 v72, v72
v_exp_f32 v73, v73
v_exp_f32 v74, v74
v_exp_f32 v75, v75
v_pk_add_f32 v[220:221], v[52:53], v[54:55]
v_pk_add_f32 v[222:223], v[72:73], v[74:75]
v_cvt_pk_bf16_f32 v52, v52, v53
v_cvt_pk_bf16_f32 v53, v54, v55
v_cvt_pk_bf16_f32 v54, v72, v73
v_cvt_pk_bf16_f32 v55, v74, v75
v_pk_add_f32 v[220:221], v[220:221], v[222:223]
v_add_f32 v195, v195, v220
v_add_f32 v195, v195, v221
ds_write_b128 v197, v[52:55] offset:8192
v_pk_fma_f32 v[56:57], v[56:57], s[6:7], v[250:251] op_sel:[0,0,0] op_sel_hi:[1,0,0] neg_lo:[0,0,1] neg_hi:[0,0,1]
v_pk_fma_f32 v[58:59], v[58:59], s[6:7], v[250:251] op_sel:[0,0,0] op_sel_hi:[1,0,0] neg_lo:[0,0,1] neg_hi:[0,0,1]
v_pk_fma_f32 v[76:77], v[76:77], s[6:7], v[250:251] op_sel:[0,0,0] op_sel_hi:[1,0,0] neg_lo:[0,0,1] neg_hi:[0,0,1]
v_pk_fma_f32 v[78:79], v[78:79], s[6:7], v[250:251] op_sel:[0,0,0] op_sel_hi:[1,0,0] neg_lo:[0,0,1] neg_hi:[0,0,1]
v_exp_f32 v56, v56
v_exp_f32 v57, v57
v_exp_f32 v58, v58
v_exp_f32 v59, v59
v_exp_f32 v76, v76
v_exp_f32 v77, v77
v_exp_f32 v78, v78
v_exp_f32 v79, v79
v_pk_add_f32 v[224:225], v[56:57], v[58:59]
v_pk_add_f32 v[226:227], v[76:77], v[78:79]
v_cvt_pk_bf16_f32 v56, v56, v57
v_cvt_pk_bf16_f32 v57, v58, v59
v_cvt_pk_bf16_f32 v58, v76, v77
v_cvt_pk_bf16_f32 v59, v78, v79
v_pk_add_f32 v[224:225], v[224:225], v[226:227]
v_add_f32 v196, v196, v224
v_add_f32 v196, v196, v225
ds_write_b128 v197, v[56:59] offset:9216
v_pk_fma_f32 v[80:81], v[80:81], s[6:7], v[246:247] op_sel:[0,0,0] op_sel_hi:[1,0,0] neg_lo:[0,0,1] neg_hi:[0,0,1]
v_pk_fma_f32 v[82:83], v[82:83], s[6:7], v[246:247] op_sel:[0,0,0] op_sel_hi:[1,0,0] neg_lo:[0,0,1] neg_hi:[0,0,1]
v_pk_fma_f32 v[100:101], v[100:101], s[6:7], v[246:247] op_sel:[0,0,0] op_sel_hi:[1,0,0] neg_lo:[0,0,1] neg_hi:[0,0,1]
v_pk_fma_f32 v[102:103], v[102:103], s[6:7], v[246:247] op_sel:[0,0,0] op_sel_hi:[1,0,0] neg_lo:[0,0,1] neg_hi:[0,0,1]
v_exp_f32 v80, v80
v_exp_f32 v81, v81
v_exp_f32 v82, v82
v_exp_f32 v83, v83
v_exp_f32 v100, v100
v_exp_f32 v101, v101
v_exp_f32 v102, v102
v_exp_f32 v103, v103
v_pk_add_f32 v[220:221], v[80:81], v[82:83]
v_pk_add_f32 v[222:223], v[100:101], v[102:103]
v_cvt_pk_bf16_f32 v80, v80, v81
v_cvt_pk_bf16_f32 v81, v82, v83
v_cvt_pk_bf16_f32 v82, v100, v101
v_cvt_pk_bf16_f32 v83, v102, v103
v_pk_add_f32 v[220:221], v[220:221], v[222:223]
v_add_f32 v192, v192, v220
v_add_f32 v192, v192, v221
s_waitcnt lgkmcnt(0)
s_barrier
ds_read_b128 v[160:163], v244 offset:0
ds_read_b128 v[164:167], v244 offset:1024
ds_read_b128 v[168:171], v244 offset:2048
ds_read_b128 v[172:175], v244 offset:3072
ds_read_b128 v[176:179], v244 offset:4096
ds_read_b128 v[180:183], v244 offset:5120
ds_read_b128 v[184:187], v244 offset:6144
ds_read_b128 v[188:191], v244 offset:7168
s_waitcnt lgkmcnt(7)
v_mfma_f32_16x16x32_bf16 v[0:3], v[200:203], v[160:163], 0
v_mfma_f32_16x16x32_bf16 v[20:23], v[204:207], v[160:163], 0
s_waitcnt vmcnt(6)
ds_read_b64_tr_b16 v[216:217], v236 offset:4096
ds_read_b64_tr_b16 v[220:221], v237 offset:4096
ds_read_b64_tr_b16 v[224:225], v238 offset:4096
ds_read_b64_tr_b16 v[228:229], v239 offset:4096
v_mfma_f32_16x16x32_bf16 v[40:43], v[208:211], v[160:163], 0
v_fma_f32 v84, v84, s6, -v247
v_fma_f32 v85, v85, s6, -v247
v_mfma_f32_16x16x32_bf16 v[60:63], v[212:215], v[160:163], 0
v_fma_f32 v86, v86, s6, -v247
v_fma_f32 v87, v87, s6, -v247
ds_read_b128 v[160:163], v244 offset:8192
s_waitcnt lgkmcnt(11)
v_mfma_f32_16x16x32_bf16 v[4:7], v[200:203], v[164:167], 0
v_fma_f32 v104, v104, s6, -v247
v_fma_f32 v105, v105, s6, -v247
v_mfma_f32_16x16x32_bf16 v[24:27], v[204:207], v[164:167], 0
v_fma_f32 v106, v106, s6, -v247
v_fma_f32 v107, v107, s6, -v247
v_mfma_f32_16x16x32_bf16 v[44:47], v[208:211], v[164:167], 0
v_exp_f32 v84, v84
v_exp_f32 v85, v85
s_waitcnt lgkmcnt(1)
s_mov_b32 m0, s5
s_mov_b32 s9, 49152
buffer_load_dwordx4 v232, s[52:55], s9 offen nt lds
s_mov_b32 s8, 52224
buffer_load_dwordx4 v232, s[52:55], s8 offen offset:1024 nt lds
v_mfma_f32_16x16x32_bf16 v[64:67], v[212:215], v[164:167], 0
v_exp_f32 v86, v86
v_exp_f32 v87, v87
ds_read_b128 v[164:167], v244 offset:9216
v_mfma_f32_16x16x32_bf16 v[8:11], v[200:203], v[168:171], 0
v_exp_f32 v104, v104
v_exp_f32 v105, v105
s_waitcnt vmcnt(6)
ds_read_b64_tr_b16 v[218:219], v236 offset:6144
ds_read_b64_tr_b16 v[222:223], v237 offset:6144
ds_read_b64_tr_b16 v[226:227], v238 offset:6144
ds_read_b64_tr_b16 v[230:231], v239 offset:6144
v_mfma_f32_16x16x32_bf16 v[28:31], v[204:207], v[168:171], 0
v_exp_f32 v106, v106
v_mfma_f32_16x16x32_bf16 v[48:51], v[208:211], v[168:171], 0
v_exp_f32 v107, v107
v_pk_add_f32 v[100:101], v[84:85], v[86:87]
v_mfma_f32_16x16x32_bf16 v[68:71], v[212:215], v[168:171], 0
v_pk_add_f32 v[102:103], v[104:105], v[106:107]
v_cvt_pk_bf16_f32 v84, v84, v85
ds_read_b128 v[168:171], v244 offset:10240
v_mfma_f32_16x16x32_bf16 v[12:15], v[200:203], v[172:175], 0
v_cvt_pk_bf16_f32 v85, v86, v87
v_cvt_pk_bf16_f32 v86, v104, v105
v_mfma_f32_16x16x32_bf16 v[32:35], v[204:207], v[172:175], 0
v_cvt_pk_bf16_f32 v87, v106, v107
v_pk_add_f32 v[100:101], v[100:101], v[102:103]
s_waitcnt lgkmcnt(1)
s_mov_b32 m0, s5
s_mov_b32 s9, 55296
buffer_load_dwordx4 v232, s[52:55], s9 offen offset:2048 nt lds
s_mov_b32 s8, 58368
buffer_load_dwordx4 v232, s[52:55], s8 offen offset:3072 nt lds
v_mfma_f32_16x16x32_bf16 v[52:55], v[208:211], v[172:175], 0
v_add_f32 v193, v193, v100
v_add_f32 v193, v193, v101
v_mfma_f32_16x16x32_bf16 v[72:75], v[212:215], v[172:175], 0
v_fma_f32 v88, v88, s6, -v248
v_fma_f32 v89, v89, s6, -v248
ds_read_b128 v[172:175], v244 offset:11264
v_mfma_f32_16x16x32_bf16 v[16:19], v[200:203], v[176:179], 0
v_fma_f32 v90, v90, s6, -v248
v_fma_f32 v91, v91, s6, -v248
v_mfma_f32_16x16x32_bf16 v[36:39], v[204:207], v[176:179], 0
v_fma_f32 v108, v108, s6, -v248
v_mfma_f32_16x16x32_bf16 v[56:59], v[208:211], v[176:179], 0
v_fma_f32 v109, v109, s6, -v248
v_fma_f32 v110, v110, s6, -v248
v_mfma_f32_16x16x32_bf16 v[76:79], v[212:215], v[176:179], 0
v_fma_f32 v111, v111, s6, -v248
v_exp_f32 v88, v88
ds_read_b128 v[176:179], v244 offset:12288
v_mfma_f32_16x16x32_bf16 v[0:3], v[216:219], v[180:183], v[0:3]
v_exp_f32 v89, v89
v_exp_f32 v90, v90
v_mfma_f32_16x16x32_bf16 v[20:23], v[220:223], v[180:183], v[20:23]
v_exp_f32 v91, v91
v_exp_f32 v108, v108
s_waitcnt vmcnt(6)
ds_read_b64_tr_b16 v[200:201], v236 offset:0
ds_read_b64_tr_b16 v[204:205], v237 offset:0
ds_read_b64_tr_b16 v[208:209], v238 offset:0
ds_read_b64_tr_b16 v[212:213], v239 offset:0
v_mfma_f32_16x16x32_bf16 v[40:43], v[224:227], v[180:183], v[40:43]
v_exp_f32 v109, v109
v_exp_f32 v110, v110
v_mfma_f32_16x16x32_bf16 v[60:63], v[228:231], v[180:183], v[60:63]
v_exp_f32 v111, v111
v_pk_add_f32 v[100:101], v[88:89], v[90:91]
ds_read_b128 v[180:183], v244 offset:13312
v_mfma_f32_16x16x32_bf16 v[4:7], v[216:219], v[184:187], v[4:7]
v_pk_add_f32 v[102:103], v[108:109], v[110:111]
v_cvt_pk_bf16_f32 v88, v88, v89
v_mfma_f32_16x16x32_bf16 v[24:27], v[220:223], v[184:187], v[24:27]
v_cvt_pk_bf16_f32 v89, v90, v91
v_mfma_f32_16x16x32_bf16 v[44:47], v[224:227], v[184:187], v[44:47]
v_cvt_pk_bf16_f32 v90, v108, v109
v_cvt_pk_bf16_f32 v91, v110, v111
s_waitcnt lgkmcnt(1)
s_mov_b32 m0, s4
s_mov_b32 s9, 65536
buffer_load_dwordx4 v232, s[52:55], s9 offen nt lds
s_mov_b32 s8, 68608
buffer_load_dwordx4 v232, s[52:55], s8 offen offset:1024 nt lds
v_mfma_f32_16x16x32_bf16 v[64:67], v[228:231], v[184:187], v[64:67]
v_pk_add_f32 v[100:101], v[100:101], v[102:103]
v_add_f32 v194, v194, v100
ds_read_b128 v[184:187], v244 offset:14336
v_mfma_f32_16x16x32_bf16 v[8:11], v[216:219], v[188:191], v[8:11]
v_add_f32 v194, v194, v101
v_fma_f32 v92, v92, s6, -v249
s_waitcnt vmcnt(6)
ds_read_b64_tr_b16 v[202:203], v236 offset:2048
ds_read_b64_tr_b16 v[206:207], v237 offset:2048
ds_read_b64_tr_b16 v[210:211], v238 offset:2048
ds_read_b64_tr_b16 v[214:215], v239 offset:2048
v_mfma_f32_16x16x32_bf16 v[28:31], v[220:223], v[188:191], v[28:31]
v_fma_f32 v93, v93, s6, -v249
v_fma_f32 v94, v94, s6, -v249
v_mfma_f32_16x16x32_bf16 v[48:51], v[224:227], v[188:191], v[48:51]
v_fma_f32 v95, v95, s6, -v249
v_fma_f32 v112, v112, s6, -v249
v_mfma_f32_16x16x32_bf16 v[68:71], v[228:231], v[188:191], v[68:71]
v_fma_f32 v113, v113, s6, -v249
v_fma_f32 v114, v114, s6, -v249
ds_read_b128 v[188:191], v244 offset:15360
v_mfma_f32_16x16x32_bf16 v[12:15], v[216:219], v[160:163], v[12:15]
v_fma_f32 v115, v115, s6, -v249
v_exp_f32 v92, v92
v_mfma_f32_16x16x32_bf16 v[32:35], v[220:223], v[160:163], v[32:35]
v_exp_f32 v93, v93
s_waitcnt lgkmcnt(1)
s_mov_b32 m0, s4
s_mov_b32 s9, 71680
buffer_load_dwordx4 v232, s[52:55], s9 offen offset:2048 nt lds
s_mov_b32 s8, 74752
buffer_load_dwordx4 v232, s[52:55], s8 offen offset:3072 nt lds
v_mfma_f32_16x16x32_bf16 v[52:55], v[224:227], v[160:163], v[52:55]
v_exp_f32 v94, v94
v_exp_f32 v95, v95
v_mfma_f32_16x16x32_bf16 v[72:75], v[228:231], v[160:163], v[72:75]
v_exp_f32 v112, v112
v_exp_f32 v113, v113
ds_read_b128 v[160:163], v244 offset:16384
v_mfma_f32_16x16x32_bf16 v[16:19], v[216:219], v[164:167], v[16:19]
v_exp_f32 v114, v114
v_exp_f32 v115, v115
v_mfma_f32_16x16x32_bf16 v[36:39], v[220:223], v[164:167], v[36:39]
v_pk_add_f32 v[100:101], v[92:93], v[94:95]
v_pk_add_f32 v[102:103], v[112:113], v[114:115]
v_mfma_f32_16x16x32_bf16 v[56:59], v[224:227], v[164:167], v[56:59]
v_cvt_pk_bf16_f32 v92, v92, v93
v_cvt_pk_bf16_f32 v93, v94, v95
v_mfma_f32_16x16x32_bf16 v[76:79], v[228:231], v[164:167], v[76:79]
v_cvt_pk_bf16_f32 v94, v112, v113
v_cvt_pk_bf16_f32 v95, v114, v115
ds_read_b128 v[164:167], v244 offset:17408
v_mfma_f32_16x16x32_bf16 v[0:3], v[200:203], v[168:171], v[0:3]
v_pk_add_f32 v[100:101], v[100:101], v[102:103]
v_add_f32 v195, v195, v100
v_mfma_f32_16x16x32_bf16 v[20:23], v[204:207], v[168:171], v[20:23]
v_add_f32 v195, v195, v101
s_waitcnt vmcnt(6)
ds_read_b64_tr_b16 v[216:217], v236 offset:4096
ds_read_b64_tr_b16 v[220:221], v237 offset:4096
ds_read_b64_tr_b16 v[224:225], v238 offset:4096
ds_read_b64_tr_b16 v[228:229], v239 offset:4096
v_mfma_f32_16x16x32_bf16 v[40:43], v[208:211], v[168:171], v[40:43]
v_fma_f32 v96, v96, s6, -v250
v_fma_f32 v97, v97, s6, -v250
v_mfma_f32_16x16x32_bf16 v[60:63], v[212:215], v[168:171], v[60:63]
v_fma_f32 v98, v98, s6, -v250
v_fma_f32 v99, v99, s6, -v250
ds_read_b128 v[168:171], v244 offset:18432
v_mfma_f32_16x16x32_bf16 v[4:7], v[200:203], v[172:175], v[4:7]
v_fma_f32 v116, v116, s6, -v250
v_fma_f32 v117, v117, s6, -v250
v_mfma_f32_16x16x32_bf16 v[24:27], v[204:207], v[172:175], v[24:27]
v_fma_f32 v118, v118, s6, -v250
v_fma_f32 v119, v119, s6, -v250
v_mfma_f32_16x16x32_bf16 v[44:47], v[208:211], v[172:175], v[44:47]
v_exp_f32 v96, v96
v_exp_f32 v97, v97
s_waitcnt lgkmcnt(1)
s_mov_b32 m0, s5
s_mov_b32 s9, 81920
buffer_load_dwordx4 v232, s[52:55], s9 offen nt lds
s_mov_b32 s8, 84992
buffer_load_dwordx4 v232, s[52:55], s8 offen offset:1024 nt lds
v_mfma_f32_16x16x32_bf16 v[64:67], v[212:215], v[172:175], v[64:67]
v_exp_f32 v98, v98
v_exp_f32 v99, v99
ds_read_b128 v[172:175], v244 offset:19456
v_mfma_f32_16x16x32_bf16 v[8:11], v[200:203], v[176:179], v[8:11]
v_exp_f32 v116, v116
v_exp_f32 v117, v117
s_waitcnt vmcnt(6)
ds_read_b64_tr_b16 v[218:219], v236 offset:6144
ds_read_b64_tr_b16 v[222:223], v237 offset:6144
ds_read_b64_tr_b16 v[226:227], v238 offset:6144
ds_read_b64_tr_b16 v[230:231], v239 offset:6144
v_mfma_f32_16x16x32_bf16 v[28:31], v[204:207], v[176:179], v[28:31]
v_exp_f32 v118, v118
v_mfma_f32_16x16x32_bf16 v[48:51], v[208:211], v[176:179], v[48:51]
v_exp_f32 v119, v119
v_pk_add_f32 v[100:101], v[96:97], v[98:99]
v_mfma_f32_16x16x32_bf16 v[68:71], v[212:215], v[176:179], v[68:71]
v_pk_add_f32 v[102:103], v[116:117], v[118:119]
v_cvt_pk_bf16_f32 v96, v96, v97
ds_read_b128 v[176:179], v244 offset:20480
v_mfma_f32_16x16x32_bf16 v[12:15], v[200:203], v[180:183], v[12:15]
v_cvt_pk_bf16_f32 v97, v98, v99
v_cvt_pk_bf16_f32 v98, v116, v117
v_mfma_f32_16x16x32_bf16 v[32:35], v[204:207], v[180:183], v[32:35]
v_cvt_pk_bf16_f32 v99, v118, v119
v_pk_add_f32 v[100:101], v[100:101], v[102:103]
s_waitcnt lgkmcnt(1)
s_mov_b32 m0, s5
s_mov_b32 s9, 88064
buffer_load_dwordx4 v232, s[52:55], s9 offen offset:2048 nt lds
s_mov_b32 s8, 91136
buffer_load_dwordx4 v232, s[52:55], s8 offen offset:3072 nt lds
v_mfma_f32_16x16x32_bf16 v[52:55], v[208:211], v[180:183], v[52:55]
v_add_f32 v196, v196, v100
v_add_f32 v196, v196, v101
v_mfma_f32_16x16x32_bf16 v[72:75], v[212:215], v[180:183], v[72:75]
v_fma_f32 v120, v120, s6, -v246
v_fma_f32 v121, v121, s6, -v246
ds_read_b128 v[180:183], v244 offset:21504
v_mfma_f32_16x16x32_bf16 v[16:19], v[200:203], v[184:187], v[16:19]
v_fma_f32 v122, v122, s6, -v246
v_fma_f32 v123, v123, s6, -v246
v_mfma_f32_16x16x32_bf16 v[36:39], v[204:207], v[184:187], v[36:39]
v_fma_f32 v140, v140, s6, -v246
v_mfma_f32_16x16x32_bf16 v[56:59], v[208:211], v[184:187], v[56:59]
v_fma_f32 v141, v141, s6, -v246
v_fma_f32 v142, v142, s6, -v246
v_mfma_f32_16x16x32_bf16 v[76:79], v[212:215], v[184:187], v[76:79]
v_fma_f32 v143, v143, s6, -v246
v_exp_f32 v120, v120
ds_read_b128 v[184:187], v244 offset:22528
v_mfma_f32_16x16x32_bf16 v[0:3], v[216:219], v[188:191], v[0:3]
v_exp_f32 v121, v121
v_exp_f32 v122, v122
v_mfma_f32_16x16x32_bf16 v[20:23], v[220:223], v[188:191], v[20:23]
v_exp_f32 v123, v123
v_exp_f32 v140, v140
s_waitcnt vmcnt(6)
ds_read_b64_tr_b16 v[200:201], v236 offset:0
ds_read_b64_tr_b16 v[204:205], v237 offset:0
ds_read_b64_tr_b16 v[208:209], v238 offset:0
ds_read_b64_tr_b16 v[212:213], v239 offset:0
v_mfma_f32_16x16x32_bf16 v[40:43], v[224:227], v[188:191], v[40:43]
v_exp_f32 v141, v141
v_exp_f32 v142, v142
v_mfma_f32_16x16x32_bf16 v[60:63], v[228:231], v[188:191], v[60:63]
v_exp_f32 v143, v143
v_pk_add_f32 v[100:101], v[120:121], v[122:123]
ds_read_b128 v[188:191], v244 offset:23552
v_mfma_f32_16x16x32_bf16 v[4:7], v[216:219], v[160:163], v[4:7]
v_pk_add_f32 v[102:103], v[140:141], v[142:143]
v_cvt_pk_bf16_f32 v120, v120, v121
v_mfma_f32_16x16x32_bf16 v[24:27], v[220:223], v[160:163], v[24:27]
v_cvt_pk_bf16_f32 v121, v122, v123
v_mfma_f32_16x16x32_bf16 v[44:47], v[224:227], v[160:163], v[44:47]
v_cvt_pk_bf16_f32 v122, v140, v141
v_cvt_pk_bf16_f32 v123, v142, v143
s_waitcnt lgkmcnt(1)
s_mov_b32 m0, s4
s_mov_b32 s9, 98304
buffer_load_dwordx4 v232, s[52:55], s9 offen nt lds
s_mov_b32 s8, 101376
buffer_load_dwordx4 v232, s[52:55], s8 offen offset:1024 nt lds
v_mfma_f32_16x16x32_bf16 v[64:67], v[228:231], v[160:163], v[64:67]
v_pk_add_f32 v[100:101], v[100:101], v[102:103]
v_add_f32 v192, v192, v100
ds_read_b128 v[160:163], v244 offset:24576
v_mfma_f32_16x16x32_bf16 v[8:11], v[216:219], v[164:167], v[8:11]
v_add_f32 v192, v192, v101
v_fma_f32 v124, v124, s6, -v247
s_waitcnt vmcnt(6)
ds_read_b64_tr_b16 v[202:203], v236 offset:2048
ds_read_b64_tr_b16 v[206:207], v237 offset:2048
ds_read_b64_tr_b16 v[210:211], v238 offset:2048
ds_read_b64_tr_b16 v[214:215], v239 offset:2048
v_mfma_f32_16x16x32_bf16 v[28:31], v[220:223], v[164:167], v[28:31]
v_fma_f32 v125, v125, s6, -v247
v_fma_f32 v126, v126, s6, -v247
v_mfma_f32_16x16x32_bf16 v[48:51], v[224:227], v[164:167], v[48:51]
v_fma_f32 v127, v127, s6, -v247
v_fma_f32 v144, v144, s6, -v247
v_mfma_f32_16x16x32_bf16 v[68:71], v[228:231], v[164:167], v[68:71]
v_fma_f32 v145, v145, s6, -v247
v_fma_f32 v146, v146, s6, -v247
ds_read_b128 v[164:167], v244 offset:25600
v_mfma_f32_16x16x32_bf16 v[12:15], v[216:219], v[168:171], v[12:15]
v_fma_f32 v147, v147, s6, -v247
v_exp_f32 v124, v124
v_mfma_f32_16x16x32_bf16 v[32:35], v[220:223], v[168:171], v[32:35]
v_exp_f32 v125, v125
s_waitcnt lgkmcnt(1)
s_mov_b32 m0, s4
s_mov_b32 s9, 104448
buffer_load_dwordx4 v232, s[52:55], s9 offen offset:2048 nt lds
s_mov_b32 s8, 107520
buffer_load_dwordx4 v232, s[52:55], s8 offen offset:3072 nt lds
v_mfma_f32_16x16x32_bf16 v[52:55], v[224:227], v[168:171], v[52:55]
v_exp_f32 v126, v126
v_exp_f32 v127, v127
v_mfma_f32_16x16x32_bf16 v[72:75], v[228:231], v[168:171], v[72:75]
v_exp_f32 v144, v144
v_exp_f32 v145, v145
ds_read_b128 v[168:171], v244 offset:26624
v_mfma_f32_16x16x32_bf16 v[16:19], v[216:219], v[172:175], v[16:19]
v_exp_f32 v146, v146
v_exp_f32 v147, v147
v_mfma_f32_16x16x32_bf16 v[36:39], v[220:223], v[172:175], v[36:39]
v_pk_add_f32 v[100:101], v[124:125], v[126:127]
v_pk_add_f32 v[102:103], v[144:145], v[146:147]
v_mfma_f32_16x16x32_bf16 v[56:59], v[224:227], v[172:175], v[56:59]
v_cvt_pk_bf16_f32 v124, v124, v125
v_cvt_pk_bf16_f32 v125, v126, v127
v_mfma_f32_16x16x32_bf16 v[76:79], v[228:231], v[172:175], v[76:79]
v_cvt_pk_bf16_f32 v126, v144, v145
v_cvt_pk_bf16_f32 v127, v146, v147
ds_read_b128 v[172:175], v244 offset:27648
v_mfma_f32_16x16x32_bf16 v[0:3], v[200:203], v[176:179], v[0:3]
v_pk_add_f32 v[100:101], v[100:101], v[102:103]
v_add_f32 v193, v193, v100
v_mfma_f32_16x16x32_bf16 v[20:23], v[204:207], v[176:179], v[20:23]
v_add_f32 v193, v193, v101
s_waitcnt vmcnt(6)
ds_read_b64_tr_b16 v[216:217], v236 offset:4096
ds_read_b64_tr_b16 v[220:221], v237 offset:4096
ds_read_b64_tr_b16 v[224:225], v238 offset:4096
ds_read_b64_tr_b16 v[228:229], v239 offset:4096
v_mfma_f32_16x16x32_bf16 v[40:43], v[208:211], v[176:179], v[40:43]
v_fma_f32 v128, v128, s6, -v248
v_fma_f32 v129, v129, s6, -v248
v_mfma_f32_16x16x32_bf16 v[60:63], v[212:215], v[176:179], v[60:63]
v_fma_f32 v130, v130, s6, -v248
v_fma_f32 v131, v131, s6, -v248
ds_read_b128 v[176:179], v244 offset:28672
v_mfma_f32_16x16x32_bf16 v[4:7], v[200:203], v[180:183], v[4:7]
v_fma_f32 v148, v148, s6, -v248
v_fma_f32 v149, v149, s6, -v248
v_mfma_f32_16x16x32_bf16 v[24:27], v[204:207], v[180:183], v[24:27]
v_fma_f32 v150, v150, s6, -v248
v_fma_f32 v151, v151, s6, -v248
v_mfma_f32_16x16x32_bf16 v[44:47], v[208:211], v[180:183], v[44:47]
v_exp_f32 v128, v128
v_exp_f32 v129, v129
s_waitcnt lgkmcnt(1)
s_mov_b32 m0, s5
s_mov_b32 s9, 114688
buffer_load_dwordx4 v232, s[52:55], s9 offen nt lds
s_mov_b32 s8, 117760
buffer_load_dwordx4 v232, s[52:55], s8 offen offset:1024 nt lds
v_mfma_f32_16x16x32_bf16 v[64:67], v[212:215], v[180:183], v[64:67]
v_exp_f32 v130, v130
v_exp_f32 v131, v131
ds_read_b128 v[180:183], v244 offset:29696
v_mfma_f32_16x16x32_bf16 v[8:11], v[200:203], v[184:187], v[8:11]
v_exp_f32 v148, v148
v_exp_f32 v149, v149
s_waitcnt vmcnt(6)
ds_read_b64_tr_b16 v[218:219], v236 offset:6144
ds_read_b64_tr_b16 v[222:223], v237 offset:6144
ds_read_b64_tr_b16 v[226:227], v238 offset:6144
ds_read_b64_tr_b16 v[230:231], v239 offset:6144
v_mfma_f32_16x16x32_bf16 v[28:31], v[204:207], v[184:187], v[28:31]
v_exp_f32 v150, v150
v_mfma_f32_16x16x32_bf16 v[48:51], v[208:211], v[184:187], v[48:51]
v_exp_f32 v151, v151
v_pk_add_f32 v[100:101], v[128:129], v[130:131]
v_mfma_f32_16x16x32_bf16 v[68:71], v[212:215], v[184:187], v[68:71]
v_pk_add_f32 v[102:103], v[148:149], v[150:151]
v_cvt_pk_bf16_f32 v128, v128, v129
ds_read_b128 v[184:187], v244 offset:30720
v_mfma_f32_16x16x32_bf16 v[12:15], v[200:203], v[188:191], v[12:15]
v_cvt_pk_bf16_f32 v129, v130, v131
v_cvt_pk_bf16_f32 v130, v148, v149
v_mfma_f32_16x16x32_bf16 v[32:35], v[204:207], v[188:191], v[32:35]
v_cvt_pk_bf16_f32 v131, v150, v151
v_pk_add_f32 v[100:101], v[100:101], v[102:103]
s_waitcnt lgkmcnt(1)
s_mov_b32 m0, s5
s_mov_b32 s9, 120832
buffer_load_dwordx4 v232, s[52:55], s9 offen offset:2048 nt lds
s_mov_b32 s8, 123904
buffer_load_dwordx4 v232, s[52:55], s8 offen offset:3072 nt lds
v_mfma_f32_16x16x32_bf16 v[52:55], v[208:211], v[188:191], v[52:55]
v_add_f32 v194, v194, v100
v_add_f32 v194, v194, v101
v_mfma_f32_16x16x32_bf16 v[72:75], v[212:215], v[188:191], v[72:75]
v_fma_f32 v132, v132, s6, -v249
v_fma_f32 v133, v133, s6, -v249
ds_read_b128 v[188:191], v244 offset:31744
v_mfma_f32_16x16x32_bf16 v[16:19], v[200:203], v[160:163], v[16:19]
v_fma_f32 v134, v134, s6, -v249
v_fma_f32 v135, v135, s6, -v249
v_mfma_f32_16x16x32_bf16 v[36:39], v[204:207], v[160:163], v[36:39]
v_fma_f32 v152, v152, s6, -v249
v_mfma_f32_16x16x32_bf16 v[56:59], v[208:211], v[160:163], v[56:59]
v_fma_f32 v153, v153, s6, -v249
v_fma_f32 v154, v154, s6, -v249
v_mfma_f32_16x16x32_bf16 v[76:79], v[212:215], v[160:163], v[76:79]
v_fma_f32 v155, v155, s6, -v249
v_exp_f32 v132, v132
ds_read_b128 v[160:163], v244 offset:32768
v_mfma_f32_16x16x32_bf16 v[0:3], v[216:219], v[164:167], v[0:3]
v_exp_f32 v133, v133
v_exp_f32 v134, v134
v_mfma_f32_16x16x32_bf16 v[20:23], v[220:223], v[164:167], v[20:23]
v_exp_f32 v135, v135
v_exp_f32 v152, v152
s_waitcnt vmcnt(6)
ds_read_b64_tr_b16 v[200:201], v236 offset:0
ds_read_b64_tr_b16 v[204:205], v237 offset:0
ds_read_b64_tr_b16 v[208:209], v238 offset:0
ds_read_b64_tr_b16 v[212:213], v239 offset:0
v_mfma_f32_16x16x32_bf16 v[40:43], v[224:227], v[164:167], v[40:43]
v_exp_f32 v153, v153
v_exp_f32 v154, v154
v_mfma_f32_16x16x32_bf16 v[60:63], v[228:231], v[164:167], v[60:63]
v_exp_f32 v155, v155
v_pk_add_f32 v[100:101], v[132:133], v[134:135]
ds_read_b128 v[164:167], v244 offset:33792
v_mfma_f32_16x16x32_bf16 v[4:7], v[216:219], v[168:171], v[4:7]
v_pk_add_f32 v[102:103], v[152:153], v[154:155]
v_cvt_pk_bf16_f32 v132, v132, v133
v_mfma_f32_16x16x32_bf16 v[24:27], v[220:223], v[168:171], v[24:27]
v_cvt_pk_bf16_f32 v133, v134, v135
v_mfma_f32_16x16x32_bf16 v[44:47], v[224:227], v[168:171], v[44:47]
v_cvt_pk_bf16_f32 v134, v152, v153
v_cvt_pk_bf16_f32 v135, v154, v155
s_waitcnt lgkmcnt(1)
s_mov_b32 m0, s4
s_mov_b32 s9, 131072
buffer_load_dwordx4 v232, s[52:55], s9 offen nt lds
s_mov_b32 s8, 134144
buffer_load_dwordx4 v232, s[52:55], s8 offen offset:1024 nt lds
v_mfma_f32_16x16x32_bf16 v[64:67], v[228:231], v[168:171], v[64:67]
v_pk_add_f32 v[100:101], v[100:101], v[102:103]
v_add_f32 v195, v195, v100
ds_read_b128 v[168:171], v244 offset:34816
v_mfma_f32_16x16x32_bf16 v[8:11], v[216:219], v[172:175], v[8:11]
v_add_f32 v195, v195, v101
v_fma_f32 v136, v136, s6, -v250
s_waitcnt vmcnt(6)
ds_read_b64_tr_b16 v[202:203], v236 offset:2048
ds_read_b64_tr_b16 v[206:207], v237 offset:2048
ds_read_b64_tr_b16 v[210:211], v238 offset:2048
ds_read_b64_tr_b16 v[214:215], v239 offset:2048
v_mfma_f32_16x16x32_bf16 v[28:31], v[220:223], v[172:175], v[28:31]
v_fma_f32 v137, v137, s6, -v250
v_fma_f32 v138, v138, s6, -v250
v_mfma_f32_16x16x32_bf16 v[48:51], v[224:227], v[172:175], v[48:51]
v_fma_f32 v139, v139, s6, -v250
v_fma_f32 v156, v156, s6, -v250
v_mfma_f32_16x16x32_bf16 v[68:71], v[228:231], v[172:175], v[68:71]
v_fma_f32 v157, v157, s6, -v250
v_fma_f32 v158, v158, s6, -v250
ds_read_b128 v[172:175], v244 offset:35840
v_mfma_f32_16x16x32_bf16 v[12:15], v[216:219], v[176:179], v[12:15]
v_fma_f32 v159, v159, s6, -v250
v_exp_f32 v136, v136
v_mfma_f32_16x16x32_bf16 v[32:35], v[220:223], v[176:179], v[32:35]
v_exp_f32 v137, v137
s_waitcnt lgkmcnt(1)
s_mov_b32 m0, s4
s_mov_b32 s9, 137216
buffer_load_dwordx4 v232, s[52:55], s9 offen offset:2048 nt lds
s_mov_b32 s8, 140288
buffer_load_dwordx4 v232, s[52:55], s8 offen offset:3072 nt lds
v_mfma_f32_16x16x32_bf16 v[52:55], v[224:227], v[176:179], v[52:55]
v_exp_f32 v138, v138
v_exp_f32 v139, v139
v_mfma_f32_16x16x32_bf16 v[72:75], v[228:231], v[176:179], v[72:75]
v_exp_f32 v156, v156
v_exp_f32 v157, v157
ds_read_b128 v[176:179], v244 offset:36864
v_mfma_f32_16x16x32_bf16 v[16:19], v[216:219], v[180:183], v[16:19]
v_exp_f32 v158, v158
v_exp_f32 v159, v159
v_mfma_f32_16x16x32_bf16 v[36:39], v[220:223], v[180:183], v[36:39]
v_pk_add_f32 v[100:101], v[136:137], v[138:139]
v_pk_add_f32 v[102:103], v[156:157], v[158:159]
v_mfma_f32_16x16x32_bf16 v[56:59], v[224:227], v[180:183], v[56:59]
v_cvt_pk_bf16_f32 v136, v136, v137
v_cvt_pk_bf16_f32 v137, v138, v139
v_mfma_f32_16x16x32_bf16 v[76:79], v[228:231], v[180:183], v[76:79]
v_cvt_pk_bf16_f32 v138, v156, v157
v_cvt_pk_bf16_f32 v139, v158, v159
ds_read_b128 v[180:183], v244 offset:37888
v_mfma_f32_16x16x32_bf16 v[0:3], v[200:203], v[184:187], v[0:3]
v_pk_add_f32 v[100:101], v[100:101], v[102:103]
v_add_f32 v196, v196, v100
v_mfma_f32_16x16x32_bf16 v[20:23], v[204:207], v[184:187], v[20:23]
v_add_f32 v196, v196, v101
s_waitcnt vmcnt(6)
ds_read_b64_tr_b16 v[216:217], v236 offset:4096
ds_read_b64_tr_b16 v[220:221], v237 offset:4096
ds_read_b64_tr_b16 v[224:225], v238 offset:4096
ds_read_b64_tr_b16 v[228:229], v239 offset:4096
v_mfma_f32_16x16x32_bf16 v[40:43], v[208:211], v[184:187], v[40:43]
v_mfma_f32_16x16x32_bf16 v[60:63], v[212:215], v[184:187], v[60:63]
ds_read_b128 v[184:187], v244 offset:38912
v_mfma_f32_16x16x32_bf16 v[4:7], v[200:203], v[188:191], v[4:7]
v_lshlrev_b32 v199, 4, v235
s_lshl_b32 s10, s14, 11
s_lshl_b32 s11, s15, 2
s_add_u32 s10, s10, s11
s_add_u32 s10, s10, 151552
v_add_u32 v199, s10, v199
v_mov_b32 v198, v196
s_nop 1
v_permlane32_swap_b32 v192, v194
v_permlane32_swap_b32 v193, v195
v_permlane32_swap_b32 v196, v198
v_add_f32 v192, v192, v194
v_add_f32 v193, v193, v195
v_add_f32 v196, v196, v198
v_mov_b32 v198, v196
s_nop 1
v_permlane16_swap_b32 v192, v193
v_permlane16_swap_b32 v196, v198
v_add_f32 v192, v192, v193
v_add_f32 v196, v196, v198
ds_write_b32 v199, v192 offset:0
ds_write_b32 v199, v196 offset:1024
v_mfma_f32_16x16x32_bf16 v[24:27], v[204:207], v[188:191], v[24:27]
v_mfma_f32_16x16x32_bf16 v[44:47], v[208:211], v[188:191], v[44:47]
s_waitcnt lgkmcnt(3)
s_mov_b32 m0, s5
s_mov_b32 s9, 147456
buffer_load_dwordx4 v232, s[52:55], s9 offen nt lds
s_mov_b32 s8, 150528
buffer_load_dwordx4 v232, s[52:55], s8 offen offset:1024 nt lds
v_mfma_f32_16x16x32_bf16 v[64:67], v[212:215], v[188:191], v[64:67]
ds_read_b128 v[188:191], v244 offset:39936
v_mfma_f32_16x16x32_bf16 v[8:11], v[200:203], v[160:163], v[8:11]
s_waitcnt vmcnt(6)
ds_read_b64_tr_b16 v[218:219], v236 offset:6144
ds_read_b64_tr_b16 v[222:223], v237 offset:6144
ds_read_b64_tr_b16 v[226:227], v238 offset:6144
ds_read_b64_tr_b16 v[230:231], v239 offset:6144
v_mfma_f32_16x16x32_bf16 v[28:31], v[204:207], v[160:163], v[28:31]
v_mfma_f32_16x16x32_bf16 v[48:51], v[208:211], v[160:163], v[48:51]
v_mfma_f32_16x16x32_bf16 v[68:71], v[212:215], v[160:163], v[68:71]
v_mfma_f32_16x16x32_bf16 v[12:15], v[200:203], v[164:167], v[12:15]
v_mfma_f32_16x16x32_bf16 v[32:35], v[204:207], v[164:167], v[32:35]
s_waitcnt lgkmcnt(0)
s_mov_b32 m0, s5
s_mov_b32 s9, 153600
buffer_load_dwordx4 v232, s[52:55], s9 offen offset:2048 nt lds
s_mov_b32 s8, 156672
buffer_load_dwordx4 v232, s[52:55], s8 offen offset:3072 nt lds
v_mfma_f32_16x16x32_bf16 v[52:55], v[208:211], v[164:167], v[52:55]
v_mfma_f32_16x16x32_bf16 v[72:75], v[212:215], v[164:167], v[72:75]
v_mfma_f32_16x16x32_bf16 v[16:19], v[200:203], v[168:171], v[16:19]
s_barrier
ds_write_b128 v197, v[80:83] offset:0
v_mfma_f32_16x16x32_bf16 v[36:39], v[204:207], v[168:171], v[36:39]
ds_write_b128 v197, v[84:87] offset:1024
v_mfma_f32_16x16x32_bf16 v[56:59], v[208:211], v[168:171], v[56:59]
ds_write_b128 v197, v[88:91] offset:2048
v_mfma_f32_16x16x32_bf16 v[76:79], v[212:215], v[168:171], v[76:79]
ds_write_b128 v197, v[92:95] offset:3072
v_mfma_f32_16x16x32_bf16 v[0:3], v[216:219], v[172:175], v[0:3]
ds_write_b128 v197, v[96:99] offset:4096
v_mfma_f32_16x16x32_bf16 v[20:23], v[220:223], v[172:175], v[20:23]
ds_write_b128 v197, v[120:123] offset:5120
s_waitcnt vmcnt(6)
ds_read_b64_tr_b16 v[200:201], v236 offset:0
ds_read_b64_tr_b16 v[204:205], v237 offset:0
ds_read_b64_tr_b16 v[208:209], v238 offset:0
ds_read_b64_tr_b16 v[212:213], v239 offset:0
v_mfma_f32_16x16x32_bf16 v[40:43], v[224:227], v[172:175], v[40:43]
ds_write_b128 v197, v[124:127] offset:6144
v_mfma_f32_16x16x32_bf16 v[60:63], v[228:231], v[172:175], v[60:63]
ds_write_b128 v197, v[128:131] offset:7168
v_mfma_f32_16x16x32_bf16 v[4:7], v[216:219], v[176:179], v[4:7]
ds_write_b128 v197, v[132:135] offset:8192
v_mfma_f32_16x16x32_bf16 v[24:27], v[220:223], v[176:179], v[24:27]
ds_write_b128 v197, v[136:139] offset:9216
v_mfma_f32_16x16x32_bf16 v[44:47], v[224:227], v[176:179], v[44:47]
s_waitcnt lgkmcnt(4)
s_mov_b32 m0, s4
s_mov_b32 s9, 163840
buffer_load_dwordx4 v232, s[52:55], s9 offen nt lds
s_mov_b32 s8, 166912
buffer_load_dwordx4 v232, s[52:55], s8 offen offset:1024 nt lds
v_mfma_f32_16x16x32_bf16 v[64:67], v[228:231], v[176:179], v[64:67]
v_mfma_f32_16x16x32_bf16 v[8:11], v[216:219], v[180:183], v[8:11]
s_waitcnt vmcnt(6)
ds_read_b64_tr_b16 v[202:203], v236 offset:2048
ds_read_b64_tr_b16 v[206:207], v237 offset:2048
ds_read_b64_tr_b16 v[210:211], v238 offset:2048
ds_read_b64_tr_b16 v[214:215], v239 offset:2048
v_mfma_f32_16x16x32_bf16 v[28:31], v[220:223], v[180:183], v[28:31]
v_mfma_f32_16x16x32_bf16 v[48:51], v[224:227], v[180:183], v[48:51]
v_mfma_f32_16x16x32_bf16 v[68:71], v[228:231], v[180:183], v[68:71]
v_mfma_f32_16x16x32_bf16 v[12:15], v[216:219], v[184:187], v[12:15]
v_mfma_f32_16x16x32_bf16 v[32:35], v[220:223], v[184:187], v[32:35]
s_waitcnt lgkmcnt(0)
s_mov_b32 m0, s4
s_mov_b32 s9, 169984
buffer_load_dwordx4 v232, s[52:55], s9 offen offset:2048 nt lds
s_mov_b32 s8, 173056
buffer_load_dwordx4 v232, s[52:55], s8 offen offset:3072 nt lds
v_mfma_f32_16x16x32_bf16 v[52:55], v[224:227], v[184:187], v[52:55]
v_mfma_f32_16x16x32_bf16 v[72:75], v[228:231], v[184:187], v[72:75]
v_mfma_f32_16x16x32_bf16 v[16:19], v[216:219], v[188:191], v[16:19]
v_mfma_f32_16x16x32_bf16 v[36:39], v[220:223], v[188:191], v[36:39]
v_mfma_f32_16x16x32_bf16 v[56:59], v[224:227], v[188:191], v[56:59]
s_barrier
ds_read_b128 v[160:163], v244 offset:0
ds_read_b128 v[164:167], v244 offset:1024
ds_read_b128 v[168:171], v244 offset:2048
v_mfma_f32_16x16x32_bf16 v[76:79], v[228:231], v[188:191], v[76:79]
ds_read_b128 v[172:175], v244 offset:3072
ds_read_b128 v[176:179], v244 offset:4096
ds_read_b128 v[180:183], v244 offset:5120
s_waitcnt lgkmcnt(5)
v_mfma_f32_16x16x32_bf16 v[0:3], v[200:203], v[160:163], v[0:3]
ds_read_b128 v[184:187], v244 offset:6144
ds_read_b128 v[188:191], v244 offset:7168
v_mfma_f32_16x16x32_bf16 v[20:23], v[204:207], v[160:163], v[20:23]
s_waitcnt vmcnt(6)
ds_read_b64_tr_b16 v[216:217], v236 offset:4096
ds_read_b64_tr_b16 v[220:221], v237 offset:4096
ds_read_b64_tr_b16 v[224:225], v238 offset:4096
ds_read_b64_tr_b16 v[228:229], v239 offset:4096
v_mfma_f32_16x16x32_bf16 v[40:43], v[208:211], v[160:163], v[40:43]
v_mfma_f32_16x16x32_bf16 v[60:63], v[212:215], v[160:163], v[60:63]
ds_read_b128 v[160:163], v244 offset:8192
s_waitcnt lgkmcnt(11)
v_mfma_f32_16x16x32_bf16 v[4:7], v[200:203], v[164:167], v[4:7]
v_mfma_f32_16x16x32_bf16 v[24:27], v[204:207], v[164:167], v[24:27]
v_mfma_f32_16x16x32_bf16 v[44:47], v[208:211], v[164:167], v[44:47]
s_waitcnt lgkmcnt(1)
s_mov_b32 m0, s5
s_mov_b32 s9, 180224
buffer_load_dwordx4 v232, s[52:55], s9 offen nt lds
s_mov_b32 s8, 183296
buffer_load_dwordx4 v232, s[52:55], s8 offen offset:1024 nt lds
v_mfma_f32_16x16x32_bf16 v[64:67], v[212:215], v[164:167], v[64:67]
ds_read_b128 v[164:167], v244 offset:9216
v_mfma_f32_16x16x32_bf16 v[8:11], v[200:203], v[168:171], v[8:11]
s_waitcnt vmcnt(6)
ds_read_b64_tr_b16 v[218:219], v236 offset:6144
ds_read_b64_tr_b16 v[222:223], v237 offset:6144
ds_read_b64_tr_b16 v[226:227], v238 offset:6144
ds_read_b64_tr_b16 v[230:231], v239 offset:6144
v_mfma_f32_16x16x32_bf16 v[28:31], v[204:207], v[168:171], v[28:31]
v_mfma_f32_16x16x32_bf16 v[48:51], v[208:211], v[168:171], v[48:51]
v_mfma_f32_16x16x32_bf16 v[68:71], v[212:215], v[168:171], v[68:71]
ds_read_b128 v[168:171], v244 offset:10240
v_mfma_f32_16x16x32_bf16 v[12:15], v[200:203], v[172:175], v[12:15]
v_mfma_f32_16x16x32_bf16 v[32:35], v[204:207], v[172:175], v[32:35]
s_waitcnt lgkmcnt(1)
s_mov_b32 m0, s5
s_mov_b32 s9, 186368
buffer_load_dwordx4 v232, s[52:55], s9 offen offset:2048 nt lds
s_mov_b32 s8, 189440
buffer_load_dwordx4 v232, s[52:55], s8 offen offset:3072 nt lds
v_mfma_f32_16x16x32_bf16 v[52:55], v[208:211], v[172:175], v[52:55]
v_mfma_f32_16x16x32_bf16 v[72:75], v[212:215], v[172:175], v[72:75]
ds_read_b128 v[172:175], v244 offset:11264
v_mfma_f32_16x16x32_bf16 v[16:19], v[200:203], v[176:179], v[16:19]
v_mfma_f32_16x16x32_bf16 v[36:39], v[204:207], v[176:179], v[36:39]
v_mfma_f32_16x16x32_bf16 v[56:59], v[208:211], v[176:179], v[56:59]
v_mfma_f32_16x16x32_bf16 v[76:79], v[212:215], v[176:179], v[76:79]
ds_read_b128 v[176:179], v244 offset:12288
v_mfma_f32_16x16x32_bf16 v[0:3], v[216:219], v[180:183], v[0:3]
v_mfma_f32_16x16x32_bf16 v[20:23], v[220:223], v[180:183], v[20:23]
s_waitcnt vmcnt(6)
ds_read_b64_tr_b16 v[200:201], v236 offset:0
ds_read_b64_tr_b16 v[204:205], v237 offset:0
ds_read_b64_tr_b16 v[208:209], v238 offset:0
ds_read_b64_tr_b16 v[212:213], v239 offset:0
v_mfma_f32_16x16x32_bf16 v[40:43], v[224:227], v[180:183], v[40:43]
v_mfma_f32_16x16x32_bf16 v[60:63], v[228:231], v[180:183], v[60:63]
ds_read_b128 v[180:183], v244 offset:13312
v_mfma_f32_16x16x32_bf16 v[4:7], v[216:219], v[184:187], v[4:7]
v_mfma_f32_16x16x32_bf16 v[24:27], v[220:223], v[184:187], v[24:27]
v_mfma_f32_16x16x32_bf16 v[44:47], v[224:227], v[184:187], v[44:47]
s_waitcnt lgkmcnt(1)
s_mov_b32 m0, s4
s_mov_b32 s9, 196608
buffer_load_dwordx4 v232, s[52:55], s9 offen nt lds
s_mov_b32 s8, 199680
buffer_load_dwordx4 v232, s[52:55], s8 offen offset:1024 nt lds
v_mfma_f32_16x16x32_bf16 v[64:67], v[228:231], v[184:187], v[64:67]
ds_read_b128 v[184:187], v244 offset:14336
v_mfma_f32_16x16x32_bf16 v[8:11], v[216:219], v[188:191], v[8:11]
s_waitcnt vmcnt(6)
ds_read_b64_tr_b16 v[202:203], v236 offset:2048
ds_read_b64_tr_b16 v[206:207], v237 offset:2048
ds_read_b64_tr_b16 v[210:211], v238 offset:2048
ds_read_b64_tr_b16 v[214:215], v239 offset:2048
v_mfma_f32_16x16x32_bf16 v[28:31], v[220:223], v[188:191], v[28:31]
v_mfma_f32_16x16x32_bf16 v[48:51], v[224:227], v[188:191], v[48:51]
v_mfma_f32_16x16x32_bf16 v[68:71], v[228:231], v[188:191], v[68:71]
ds_read_b128 v[188:191], v244 offset:15360
v_mfma_f32_16x16x32_bf16 v[12:15], v[216:219], v[160:163], v[12:15]
v_mfma_f32_16x16x32_bf16 v[32:35], v[220:223], v[160:163], v[32:35]
s_waitcnt lgkmcnt(1)
s_mov_b32 m0, s4
s_mov_b32 s9, 202752
buffer_load_dwordx4 v232, s[52:55], s9 offen offset:2048 nt lds
s_mov_b32 s8, 205824
buffer_load_dwordx4 v232, s[52:55], s8 offen offset:3072 nt lds
v_mfma_f32_16x16x32_bf16 v[52:55], v[224:227], v[160:163], v[52:55]
v_mfma_f32_16x16x32_bf16 v[72:75], v[228:231], v[160:163], v[72:75]
ds_read_b128 v[160:163], v244 offset:16384
v_mfma_f32_16x16x32_bf16 v[16:19], v[216:219], v[164:167], v[16:19]
v_mfma_f32_16x16x32_bf16 v[36:39], v[220:223], v[164:167], v[36:39]
v_mfma_f32_16x16x32_bf16 v[56:59], v[224:227], v[164:167], v[56:59]
v_mfma_f32_16x16x32_bf16 v[76:79], v[228:231], v[164:167], v[76:79]
ds_read_b128 v[164:167], v244 offset:17408
v_mfma_f32_16x16x32_bf16 v[0:3], v[200:203], v[168:171], v[0:3]
v_mfma_f32_16x16x32_bf16 v[20:23], v[204:207], v[168:171], v[20:23]
s_waitcnt vmcnt(6)
ds_read_b64_tr_b16 v[216:217], v236 offset:4096
ds_read_b64_tr_b16 v[220:221], v237 offset:4096
ds_read_b64_tr_b16 v[224:225], v238 offset:4096
ds_read_b64_tr_b16 v[228:229], v239 offset:4096
v_mfma_f32_16x16x32_bf16 v[40:43], v[208:211], v[168:171], v[40:43]
v_mfma_f32_16x16x32_bf16 v[60:63], v[212:215], v[168:171], v[60:63]
ds_read_b128 v[168:171], v244 offset:18432
v_mfma_f32_16x16x32_bf16 v[4:7], v[200:203], v[172:175], v[4:7]
v_mfma_f32_16x16x32_bf16 v[24:27], v[204:207], v[172:175], v[24:27]
v_mfma_f32_16x16x32_bf16 v[44:47], v[208:211], v[172:175], v[44:47]
s_waitcnt lgkmcnt(1)
s_mov_b32 m0, s5
s_mov_b32 s9, 212992
buffer_load_dwordx4 v232, s[52:55], s9 offen nt lds
s_mov_b32 s8, 216064
buffer_load_dwordx4 v232, s[52:55], s8 offen offset:1024 nt lds
v_mfma_f32_16x16x32_bf16 v[64:67], v[212:215], v[172:175], v[64:67]
ds_read_b128 v[172:175], v244 offset:19456
v_mfma_f32_16x16x32_bf16 v[8:11], v[200:203], v[176:179], v[8:11]
s_waitcnt vmcnt(6)
ds_read_b64_tr_b16 v[218:219], v236 offset:6144
ds_read_b64_tr_b16 v[222:223], v237 offset:6144
ds_read_b64_tr_b16 v[226:227], v238 offset:6144
ds_read_b64_tr_b16 v[230:231], v239 offset:6144
v_mfma_f32_16x16x32_bf16 v[28:31], v[204:207], v[176:179], v[28:31]
v_mfma_f32_16x16x32_bf16 v[48:51], v[208:211], v[176:179], v[48:51]
v_mfma_f32_16x16x32_bf16 v[68:71], v[212:215], v[176:179], v[68:71]
ds_read_b128 v[176:179], v244 offset:20480
v_mfma_f32_16x16x32_bf16 v[12:15], v[200:203], v[180:183], v[12:15]
v_mfma_f32_16x16x32_bf16 v[32:35], v[204:207], v[180:183], v[32:35]
s_waitcnt lgkmcnt(1)
s_mov_b32 m0, s5
s_mov_b32 s9, 219136
buffer_load_dwordx4 v232, s[52:55], s9 offen offset:2048 nt lds
s_mov_b32 s8, 222208
buffer_load_dwordx4 v232, s[52:55], s8 offen offset:3072 nt lds
v_mfma_f32_16x16x32_bf16 v[52:55], v[208:211], v[180:183], v[52:55]
v_mfma_f32_16x16x32_bf16 v[72:75], v[212:215], v[180:183], v[72:75]
ds_read_b128 v[180:183], v244 offset:21504
v_mfma_f32_16x16x32_bf16 v[16:19], v[200:203], v[184:187], v[16:19]
v_mfma_f32_16x16x32_bf16 v[36:39], v[204:207], v[184:187], v[36:39]
v_mfma_f32_16x16x32_bf16 v[56:59], v[208:211], v[184:187], v[56:59]
v_mfma_f32_16x16x32_bf16 v[76:79], v[212:215], v[184:187], v[76:79]
ds_read_b128 v[184:187], v244 offset:22528
v_mfma_f32_16x16x32_bf16 v[0:3], v[216:219], v[188:191], v[0:3]
v_and_b32 v253, 15, v235
v_lshlrev_b32 v253, 4, v253
s_lshl_b32 s10, s14, 11
s_add_u32 s10, s10, 151552
v_add_u32 v253, s10, v253
ds_read_b128 v[140:143], v253 offset:0
ds_read_b128 v[144:147], v253 offset:256
ds_read_b128 v[148:151], v253 offset:512
ds_read_b128 v[152:155], v253 offset:768
ds_read_b128 v[156:159], v253 offset:1024
s_waitcnt lgkmcnt(4)
v_pk_add_f32 v[140:141], v[140:141], v[142:143]
v_add_f32 v246, v140, v141
s_waitcnt lgkmcnt(3)
v_pk_add_f32 v[144:145], v[144:145], v[146:147]
v_add_f32 v247, v144, v145
s_waitcnt lgkmcnt(2)
v_pk_add_f32 v[148:149], v[148:149], v[150:151]
v_add_f32 v248, v148, v149
s_waitcnt lgkmcnt(1)
v_pk_add_f32 v[152:153], v[152:153], v[154:155]
v_add_f32 v249, v152, v153
s_waitcnt lgkmcnt(0)
v_pk_add_f32 v[156:157], v[156:157], v[158:159]
v_add_f32 v250, v156, v157
v_rcp_f32 v246, v246
v_rcp_f32 v247, v247
v_rcp_f32 v248, v248
v_rcp_f32 v249, v249
v_rcp_f32 v250, v250
v_mfma_f32_16x16x32_bf16 v[20:23], v[220:223], v[188:191], v[20:23]
s_waitcnt vmcnt(6)
ds_read_b64_tr_b16 v[200:201], v236 offset:0
ds_read_b64_tr_b16 v[204:205], v237 offset:0
ds_read_b64_tr_b16 v[208:209], v238 offset:0
ds_read_b64_tr_b16 v[212:213], v239 offset:0
v_mfma_f32_16x16x32_bf16 v[40:43], v[224:227], v[188:191], v[40:43]
v_mfma_f32_16x16x32_bf16 v[60:63], v[228:231], v[188:191], v[60:63]
ds_read_b128 v[188:191], v244 offset:23552
v_mfma_f32_16x16x32_bf16 v[4:7], v[216:219], v[160:163], v[4:7]
v_mfma_f32_16x16x32_bf16 v[24:27], v[220:223], v[160:163], v[24:27]
v_mfma_f32_16x16x32_bf16 v[44:47], v[224:227], v[160:163], v[44:47]
s_waitcnt lgkmcnt(1)
s_mov_b32 m0, s4
s_mov_b32 s9, 229376
buffer_load_dwordx4 v232, s[52:55], s9 offen nt lds
s_mov_b32 s8, 232448
buffer_load_dwordx4 v232, s[52:55], s8 offen offset:1024 nt lds
v_mfma_f32_16x16x32_bf16 v[64:67], v[228:231], v[160:163], v[64:67]
ds_read_b128 v[160:163], v244 offset:24576
v_mfma_f32_16x16x32_bf16 v[8:11], v[216:219], v[164:167], v[8:11]
s_waitcnt vmcnt(6)
ds_read_b64_tr_b16 v[202:203], v236 offset:2048
ds_read_b64_tr_b16 v[206:207], v237 offset:2048
ds_read_b64_tr_b16 v[210:211], v238 offset:2048
ds_read_b64_tr_b16 v[214:215], v239 offset:2048
v_mfma_f32_16x16x32_bf16 v[28:31], v[220:223], v[164:167], v[28:31]
v_mfma_f32_16x16x32_bf16 v[48:51], v[224:227], v[164:167], v[48:51]
v_mfma_f32_16x16x32_bf16 v[68:71], v[228:231], v[164:167], v[68:71]
ds_read_b128 v[164:167], v244 offset:25600
v_mfma_f32_16x16x32_bf16 v[12:15], v[216:219], v[168:171], v[12:15]
v_mfma_f32_16x16x32_bf16 v[32:35], v[220:223], v[168:171], v[32:35]
s_waitcnt lgkmcnt(1)
s_mov_b32 m0, s4
s_mov_b32 s9, 235520
buffer_load_dwordx4 v232, s[52:55], s9 offen offset:2048 nt lds
s_mov_b32 s8, 238592
buffer_load_dwordx4 v232, s[52:55], s8 offen offset:3072 nt lds
v_mfma_f32_16x16x32_bf16 v[52:55], v[224:227], v[168:171], v[52:55]
v_mfma_f32_16x16x32_bf16 v[72:75], v[228:231], v[168:171], v[72:75]
ds_read_b128 v[168:171], v244 offset:26624
v_mfma_f32_16x16x32_bf16 v[16:19], v[216:219], v[172:175], v[16:19]
v_mfma_f32_16x16x32_bf16 v[36:39], v[220:223], v[172:175], v[36:39]
v_mfma_f32_16x16x32_bf16 v[56:59], v[224:227], v[172:175], v[56:59]
v_mfma_f32_16x16x32_bf16 v[76:79], v[228:231], v[172:175], v[76:79]
ds_read_b128 v[172:175], v244 offset:27648
v_mfma_f32_16x16x32_bf16 v[0:3], v[200:203], v[176:179], v[0:3]
v_mfma_f32_16x16x32_bf16 v[20:23], v[204:207], v[176:179], v[20:23]
s_waitcnt vmcnt(6)
ds_read_b64_tr_b16 v[216:217], v236 offset:4096
ds_read_b64_tr_b16 v[220:221], v237 offset:4096
ds_read_b64_tr_b16 v[224:225], v238 offset:4096
ds_read_b64_tr_b16 v[228:229], v239 offset:4096
v_mfma_f32_16x16x32_bf16 v[40:43], v[208:211], v[176:179], v[40:43]
v_mfma_f32_16x16x32_bf16 v[60:63], v[212:215], v[176:179], v[60:63]
ds_read_b128 v[176:179], v244 offset:28672
v_mfma_f32_16x16x32_bf16 v[4:7], v[200:203], v[180:183], v[4:7]
v_mfma_f32_16x16x32_bf16 v[24:27], v[204:207], v[180:183], v[24:27]
v_mfma_f32_16x16x32_bf16 v[44:47], v[208:211], v[180:183], v[44:47]
s_waitcnt lgkmcnt(1)
s_mov_b32 m0, s5
s_mov_b32 s9, 245760
buffer_load_dwordx4 v232, s[52:55], s9 offen nt lds
s_mov_b32 s8, 248832
buffer_load_dwordx4 v232, s[52:55], s8 offen offset:1024 nt lds
v_mfma_f32_16x16x32_bf16 v[64:67], v[212:215], v[180:183], v[64:67]
ds_read_b128 v[180:183], v244 offset:29696
v_mfma_f32_16x16x32_bf16 v[8:11], v[200:203], v[184:187], v[8:11]
s_waitcnt vmcnt(6)
ds_read_b64_tr_b16 v[218:219], v236 offset:6144
ds_read_b64_tr_b16 v[222:223], v237 offset:6144
ds_read_b64_tr_b16 v[226:227], v238 offset:6144
ds_read_b64_tr_b16 v[230:231], v239 offset:6144
v_mfma_f32_16x16x32_bf16 v[28:31], v[204:207], v[184:187], v[28:31]
v_mfma_f32_16x16x32_bf16 v[48:51], v[208:211], v[184:187], v[48:51]
v_mfma_f32_16x16x32_bf16 v[68:71], v[212:215], v[184:187], v[68:71]
ds_read_b128 v[184:187], v244 offset:30720
v_mfma_f32_16x16x32_bf16 v[12:15], v[200:203], v[188:191], v[12:15]
v_mfma_f32_16x16x32_bf16 v[32:35], v[204:207], v[188:191], v[32:35]
s_waitcnt lgkmcnt(1)
s_mov_b32 m0, s5
s_mov_b32 s9, 251904
buffer_load_dwordx4 v232, s[52:55], s9 offen offset:2048 nt lds
s_mov_b32 s8, 254976
buffer_load_dwordx4 v232, s[52:55], s8 offen offset:3072 nt lds
v_mfma_f32_16x16x32_bf16 v[52:55], v[208:211], v[188:191], v[52:55]
v_mfma_f32_16x16x32_bf16 v[72:75], v[212:215], v[188:191], v[72:75]
ds_read_b128 v[188:191], v244 offset:31744
v_mfma_f32_16x16x32_bf16 v[16:19], v[200:203], v[160:163], v[16:19]
v_mfma_f32_16x16x32_bf16 v[36:39], v[204:207], v[160:163], v[36:39]
v_mfma_f32_16x16x32_bf16 v[56:59], v[208:211], v[160:163], v[56:59]
v_mfma_f32_16x16x32_bf16 v[76:79], v[212:215], v[160:163], v[76:79]
ds_read_b128 v[160:163], v244 offset:32768
v_mfma_f32_16x16x32_bf16 v[0:3], v[216:219], v[164:167], v[0:3]
v_mfma_f32_16x16x32_bf16 v[20:23], v[220:223], v[164:167], v[20:23]
s_waitcnt vmcnt(6)
ds_read_b64_tr_b16 v[200:201], v236 offset:0
ds_read_b64_tr_b16 v[204:205], v237 offset:0
ds_read_b64_tr_b16 v[208:209], v238 offset:0
ds_read_b64_tr_b16 v[212:213], v239 offset:0
v_mfma_f32_16x16x32_bf16 v[40:43], v[224:227], v[164:167], v[40:43]
v_mfma_f32_16x16x32_bf16 v[60:63], v[228:231], v[164:167], v[60:63]
ds_read_b128 v[164:167], v244 offset:33792
v_mfma_f32_16x16x32_bf16 v[4:7], v[216:219], v[168:171], v[4:7]
v_mfma_f32_16x16x32_bf16 v[24:27], v[220:223], v[168:171], v[24:27]
v_mfma_f32_16x16x32_bf16 v[44:47], v[224:227], v[168:171], v[44:47]
s_waitcnt lgkmcnt(1)
s_mov_b32 m0, s4
s_add_u32 s9, s76, 0
buffer_load_dwordx4 v234, s[56:59], s9 offen lds
s_add_u32 s8, s76, 6144
buffer_load_dwordx4 v234, s[56:59], s8 offen offset:1024 lds
v_mfma_f32_16x16x32_bf16 v[64:67], v[228:231], v[168:171], v[64:67]
ds_read_b128 v[168:171], v244 offset:34816
v_mfma_f32_16x16x32_bf16 v[8:11], v[216:219], v[172:175], v[8:11]
s_waitcnt vmcnt(6)
ds_read_b64_tr_b16 v[202:203], v236 offset:2048
ds_read_b64_tr_b16 v[206:207], v237 offset:2048
ds_read_b64_tr_b16 v[210:211], v238 offset:2048
ds_read_b64_tr_b16 v[214:215], v239 offset:2048
v_mfma_f32_16x16x32_bf16 v[28:31], v[220:223], v[172:175], v[28:31]
v_mfma_f32_16x16x32_bf16 v[48:51], v[224:227], v[172:175], v[48:51]
v_mfma_f32_16x16x32_bf16 v[68:71], v[228:231], v[172:175], v[68:71]
ds_read_b128 v[172:175], v244 offset:35840
v_mfma_f32_16x16x32_bf16 v[12:15], v[216:219], v[176:179], v[12:15]
v_mfma_f32_16x16x32_bf16 v[32:35], v[220:223], v[176:179], v[32:35]
s_waitcnt lgkmcnt(1)
s_mov_b32 m0, s4
s_add_u32 s9, s76, 12288
buffer_load_dwordx4 v234, s[56:59], s9 offen offset:2048 lds
s_add_u32 s8, s76, 18432
buffer_load_dwordx4 v234, s[56:59], s8 offen offset:3072 lds
v_mfma_f32_16x16x32_bf16 v[52:55], v[224:227], v[176:179], v[52:55]
v_mfma_f32_16x16x32_bf16 v[72:75], v[228:231], v[176:179], v[72:75]
ds_read_b128 v[176:179], v244 offset:36864
v_mfma_f32_16x16x32_bf16 v[16:19], v[216:219], v[180:183], v[16:19]
v_mfma_f32_16x16x32_bf16 v[36:39], v[220:223], v[180:183], v[36:39]
v_mfma_f32_16x16x32_bf16 v[56:59], v[224:227], v[180:183], v[56:59]
v_mfma_f32_16x16x32_bf16 v[76:79], v[228:231], v[180:183], v[76:79]
ds_read_b128 v[180:183], v244 offset:37888
v_mfma_f32_16x16x32_bf16 v[0:3], v[200:203], v[184:187], v[0:3]
v_mfma_f32_16x16x32_bf16 v[20:23], v[204:207], v[184:187], v[20:23]
s_waitcnt vmcnt(6)
ds_read_b64_tr_b16 v[216:217], v236 offset:4096
ds_read_b64_tr_b16 v[220:221], v237 offset:4096
ds_read_b64_tr_b16 v[224:225], v238 offset:4096
ds_read_b64_tr_b16 v[228:229], v239 offset:4096
v_mfma_f32_16x16x32_bf16 v[40:43], v[208:211], v[184:187], v[40:43]
v_mfma_f32_16x16x32_bf16 v[60:63], v[212:215], v[184:187], v[60:63]
ds_read_b128 v[184:187], v244 offset:38912
v_mfma_f32_16x16x32_bf16 v[4:7], v[200:203], v[188:191], v[4:7]
v_mfma_f32_16x16x32_bf16 v[24:27], v[204:207], v[188:191], v[24:27]
v_mfma_f32_16x16x32_bf16 v[44:47], v[208:211], v[188:191], v[44:47]
s_waitcnt lgkmcnt(1)
s_mov_b32 m0, s5
s_add_u32 s9, s76, 28672
buffer_load_dwordx4 v234, s[56:59], s9 offen lds
s_add_u32 s8, s76, 34816
buffer_load_dwordx4 v234, s[56:59], s8 offen offset:1024 lds
v_mfma_f32_16x16x32_bf16 v[64:67], v[212:215], v[188:191], v[64:67]
ds_read_b128 v[188:191], v244 offset:39936
v_mfma_f32_16x16x32_bf16 v[8:11], v[200:203], v[160:163], v[8:11]
s_waitcnt vmcnt(6)
ds_read_b64_tr_b16 v[218:219], v236 offset:6144
ds_read_b64_tr_b16 v[222:223], v237 offset:6144
ds_read_b64_tr_b16 v[226:227], v238 offset:6144
ds_read_b64_tr_b16 v[230:231], v239 offset:6144
v_mfma_f32_16x16x32_bf16 v[28:31], v[204:207], v[160:163], v[28:31]
v_mfma_f32_16x16x32_bf16 v[48:51], v[208:211], v[160:163], v[48:51]
v_mfma_f32_16x16x32_bf16 v[68:71], v[212:215], v[160:163], v[68:71]
v_mfma_f32_16x16x32_bf16 v[12:15], v[200:203], v[164:167], v[12:15]
v_mfma_f32_16x16x32_bf16 v[32:35], v[204:207], v[164:167], v[32:35]
s_waitcnt lgkmcnt(0)
s_mov_b32 m0, s5
s_add_u32 s9, s76, 40960
buffer_load_dwordx4 v234, s[56:59], s9 offen offset:2048 lds
s_add_u32 s8, s76, 47104
buffer_load_dwordx4 v234, s[56:59], s8 offen offset:3072 lds
v_mfma_f32_16x16x32_bf16 v[52:55], v[208:211], v[164:167], v[52:55]
v_mfma_f32_16x16x32_bf16 v[72:75], v[212:215], v[164:167], v[72:75]
v_mfma_f32_16x16x32_bf16 v[16:19], v[200:203], v[168:171], v[16:19]
s_barrier
v_mfma_f32_16x16x32_bf16 v[36:39], v[204:207], v[168:171], v[36:39]
v_mfma_f32_16x16x32_bf16 v[56:59], v[208:211], v[168:171], v[56:59]
v_mfma_f32_16x16x32_bf16 v[76:79], v[212:215], v[168:171], v[76:79]
v_mfma_f32_16x16x32_bf16 v[0:3], v[216:219], v[172:175], v[0:3]
v_mfma_f32_16x16x32_bf16 v[20:23], v[220:223], v[172:175], v[20:23]
s_waitcnt vmcnt(6)
ds_read_b64_tr_b16 v[200:201], v236 offset:0
ds_read_b64_tr_b16 v[204:205], v237 offset:0
ds_read_b64_tr_b16 v[208:209], v238 offset:0
ds_read_b64_tr_b16 v[212:213], v239 offset:0
v_mfma_f32_16x16x32_bf16 v[40:43], v[224:227], v[172:175], v[40:43]
v_mfma_f32_16x16x32_bf16 v[60:63], v[228:231], v[172:175], v[60:63]
v_mfma_f32_16x16x32_bf16 v[4:7], v[216:219], v[176:179], v[4:7]
v_mfma_f32_16x16x32_bf16 v[24:27], v[220:223], v[176:179], v[24:27]
v_mfma_f32_16x16x32_bf16 v[44:47], v[224:227], v[176:179], v[44:47]
s_waitcnt lgkmcnt(0)
s_mov_b32 m0, s4
s_add_u32 s9, s77, 0
buffer_load_dwordx4 v234, s[56:59], s9 offen lds
s_add_u32 s8, s77, 6144
buffer_load_dwordx4 v234, s[56:59], s8 offen offset:1024 lds
v_mfma_f32_16x16x32_bf16 v[64:67], v[228:231], v[176:179], v[64:67]
v_mfma_f32_16x16x32_bf16 v[8:11], v[216:219], v[180:183], v[8:11]
s_waitcnt vmcnt(6)
ds_read_b64_tr_b16 v[202:203], v236 offset:2048
ds_read_b64_tr_b16 v[206:207], v237 offset:2048
ds_read_b64_tr_b16 v[210:211], v238 offset:2048
ds_read_b64_tr_b16 v[214:215], v239 offset:2048
v_mfma_f32_16x16x32_bf16 v[28:31], v[220:223], v[180:183], v[28:31]
v_mfma_f32_16x16x32_bf16 v[48:51], v[224:227], v[180:183], v[48:51]
v_mfma_f32_16x16x32_bf16 v[68:71], v[228:231], v[180:183], v[68:71]
v_mfma_f32_16x16x32_bf16 v[12:15], v[216:219], v[184:187], v[12:15]
v_mfma_f32_16x16x32_bf16 v[32:35], v[220:223], v[184:187], v[32:35]
s_waitcnt lgkmcnt(0)
s_mov_b32 m0, s4
s_add_u32 s9, s77, 12288
buffer_load_dwordx4 v234, s[56:59], s9 offen offset:2048 lds
s_add_u32 s8, s77, 18432
buffer_load_dwordx4 v234, s[56:59], s8 offen offset:3072 lds
v_mfma_f32_16x16x32_bf16 v[52:55], v[224:227], v[184:187], v[52:55]
v_mfma_f32_16x16x32_bf16 v[72:75], v[228:231], v[184:187], v[72:75]
v_mfma_f32_16x16x32_bf16 v[16:19], v[216:219], v[188:191], v[16:19]
v_mfma_f32_16x16x32_bf16 v[36:39], v[220:223], v[188:191], v[36:39]
v_mfma_f32_16x16x32_bf16 v[56:59], v[224:227], v[188:191], v[56:59]
v_mfma_f32_16x16x32_bf16 v[76:79], v[228:231], v[188:191], v[76:79]
s_nop 7
v_add_u32 v252, s71, v242
v_mul_f32 v0, v0, v246
v_mul_f32 v1, v1, v246
v_mul_f32 v2, v2, v246
v_mul_f32 v3, v3, v246
v_mul_f32 v20, v20, v246
v_mul_f32 v21, v21, v246
v_mul_f32 v22, v22, v246
v_mul_f32 v23, v23, v246
v_cvt_pk_bf16_f32 v0, v0, v1
v_cvt_pk_bf16_f32 v1, v2, v3
v_cvt_pk_bf16_f32 v2, v20, v21
v_cvt_pk_bf16_f32 v3, v22, v23
ds_write_b128 v252, v[0:3] offset:0
v_mul_f32 v40, v40, v246
v_mul_f32 v41, v41, v246
v_mul_f32 v42, v42, v246
v_mul_f32 v43, v43, v246
v_mul_f32 v60, v60, v246
v_mul_f32 v61, v61, v246
v_mul_f32 v62, v62, v246
v_mul_f32 v63, v63, v246
v_cvt_pk_bf16_f32 v40, v40, v41
v_cvt_pk_bf16_f32 v41, v42, v43
v_cvt_pk_bf16_f32 v42, v60, v61
v_cvt_pk_bf16_f32 v43, v62, v63
ds_write_b128 v252, v[40:43] offset:5120
v_mul_f32 v4, v4, v247
v_mul_f32 v5, v5, v247
v_mul_f32 v6, v6, v247
v_mul_f32 v7, v7, v247
v_mul_f32 v24, v24, v247
v_mul_f32 v25, v25, v247
v_mul_f32 v26, v26, v247
v_mul_f32 v27, v27, v247
v_cvt_pk_bf16_f32 v4, v4, v5
v_cvt_pk_bf16_f32 v5, v6, v7
v_cvt_pk_bf16_f32 v6, v24, v25
v_cvt_pk_bf16_f32 v7, v26, v27
ds_write_b128 v252, v[4:7] offset:1024
v_mul_f32 v44, v44, v247
v_mul_f32 v45, v45, v247
v_mul_f32 v46, v46, v247
v_mul_f32 v47, v47, v247
v_mul_f32 v64, v64, v247
v_mul_f32 v65, v65, v247
v_mul_f32 v66, v66, v247
v_mul_f32 v67, v67, v247
v_cvt_pk_bf16_f32 v44, v44, v45
v_cvt_pk_bf16_f32 v45, v46, v47
v_cvt_pk_bf16_f32 v46, v64, v65
v_cvt_pk_bf16_f32 v47, v66, v67
ds_write_b128 v252, v[44:47] offset:6144
v_mul_f32 v8, v8, v248
v_mul_f32 v9, v9, v248
v_mul_f32 v10, v10, v248
v_mul_f32 v11, v11, v248
v_mul_f32 v28, v28, v248
v_mul_f32 v29, v29, v248
v_mul_f32 v30, v30, v248
v_mul_f32 v31, v31, v248
v_cvt_pk_bf16_f32 v8, v8, v9
v_cvt_pk_bf16_f32 v9, v10, v11
v_cvt_pk_bf16_f32 v10, v28, v29
v_cvt_pk_bf16_f32 v11, v30, v31
ds_write_b128 v252, v[8:11] offset:2048
v_mul_f32 v48, v48, v248
v_mul_f32 v49, v49, v248
v_mul_f32 v50, v50, v248
v_mul_f32 v51, v51, v248
v_mul_f32 v68, v68, v248
v_mul_f32 v69, v69, v248
v_mul_f32 v70, v70, v248
v_mul_f32 v71, v71, v248
v_cvt_pk_bf16_f32 v48, v48, v49
v_cvt_pk_bf16_f32 v49, v50, v51
v_cvt_pk_bf16_f32 v50, v68, v69
v_cvt_pk_bf16_f32 v51, v70, v71
ds_write_b128 v252, v[48:51] offset:7168
v_mul_f32 v12, v12, v249
v_mul_f32 v13, v13, v249
v_mul_f32 v14, v14, v249
v_mul_f32 v15, v15, v249
v_mul_f32 v32, v32, v249
v_mul_f32 v33, v33, v249
v_mul_f32 v34, v34, v249
v_mul_f32 v35, v35, v249
v_cvt_pk_bf16_f32 v12, v12, v13
v_cvt_pk_bf16_f32 v13, v14, v15
v_cvt_pk_bf16_f32 v14, v32, v33
v_cvt_pk_bf16_f32 v15, v34, v35
ds_write_b128 v252, v[12:15] offset:3072
v_mul_f32 v52, v52, v249
v_mul_f32 v53, v53, v249
v_mul_f32 v54, v54, v249
v_mul_f32 v55, v55, v249
v_mul_f32 v72, v72, v249
v_mul_f32 v73, v73, v249
v_mul_f32 v74, v74, v249
v_mul_f32 v75, v75, v249
v_cvt_pk_bf16_f32 v52, v52, v53
v_cvt_pk_bf16_f32 v53, v54, v55
v_cvt_pk_bf16_f32 v54, v72, v73
v_cvt_pk_bf16_f32 v55, v74, v75
ds_write_b128 v252, v[52:55] offset:8192
v_mul_f32 v16, v16, v250
v_mul_f32 v17, v17, v250
v_mul_f32 v18, v18, v250
v_mul_f32 v19, v19, v250
v_mul_f32 v36, v36, v250
v_mul_f32 v37, v37, v250
v_mul_f32 v38, v38, v250
v_mul_f32 v39, v39, v250
v_cvt_pk_bf16_f32 v16, v16, v17
v_cvt_pk_bf16_f32 v17, v18, v19
v_cvt_pk_bf16_f32 v18, v36, v37
v_cvt_pk_bf16_f32 v19, v38, v39
ds_write_b128 v252, v[16:19] offset:4096
v_mul_f32 v56, v56, v250
v_mul_f32 v57, v57, v250
v_mul_f32 v58, v58, v250
v_mul_f32 v59, v59, v250
v_mul_f32 v76, v76, v250
v_mul_f32 v77, v77, v250
v_mul_f32 v78, v78, v250
v_mul_f32 v79, v79, v250
v_cvt_pk_bf16_f32 v56, v56, v57
v_cvt_pk_bf16_f32 v57, v58, v59
v_cvt_pk_bf16_f32 v58, v76, v77
v_cvt_pk_bf16_f32 v59, v78, v79
ds_write_b128 v252, v[56:59] offset:9216
s_waitcnt lgkmcnt(0)
s_barrier
ds_read_b128 v[160:163], v242 offset:0
ds_read_b128 v[164:167], v242 offset:1024
ds_read_b128 v[168:171], v242 offset:2048
ds_read_b128 v[172:175], v242 offset:3072
ds_read_b128 v[176:179], v242 offset:4096
ds_read_b128 v[180:183], v242 offset:5120
ds_read_b128 v[184:187], v242 offset:6144
ds_read_b128 v[188:191], v242 offset:7168
ds_read_b128 v[192:195], v242 offset:8192
ds_read_b128 v[196:199], v242 offset:9216
s_waitcnt lgkmcnt(9)
v_mfma_f32_16x16x32_bf16 v[0:3], v[200:203], v[160:163], 0
v_mfma_f32_16x16x32_bf16 v[20:23], v[204:207], v[160:163], 0
s_waitcnt vmcnt(6)
ds_read_b64_tr_b16 v[216:217], v236 offset:4096
ds_read_b64_tr_b16 v[220:221], v237 offset:4096
ds_read_b64_tr_b16 v[224:225], v238 offset:4096
ds_read_b64_tr_b16 v[228:229], v239 offset:4096
v_mfma_f32_16x16x32_bf16 v[40:43], v[208:211], v[160:163], 0
v_mfma_f32_16x16x32_bf16 v[60:63], v[212:215], v[160:163], 0
ds_read_b128 v[160:163], v242 offset:10240
s_waitcnt lgkmcnt(13)
v_mfma_f32_16x16x32_bf16 v[4:7], v[200:203], v[164:167], 0
v_mfma_f32_16x16x32_bf16 v[24:27], v[204:207], v[164:167], 0
v_mfma_f32_16x16x32_bf16 v[44:47], v[208:211], v[164:167], 0
s_waitcnt lgkmcnt(1)
s_mov_b32 m0, s5
s_add_u32 s9, s77, 28672
buffer_load_dwordx4 v234, s[56:59], s9 offen lds
s_add_u32 s8, s77, 34816
buffer_load_dwordx4 v234, s[56:59], s8 offen offset:1024 lds
v_mfma_f32_16x16x32_bf16 v[64:67], v[212:215], v[164:167], 0
ds_read_b128 v[164:167], v242 offset:11264
v_mfma_f32_16x16x32_bf16 v[8:11], v[200:203], v[168:171], 0
s_waitcnt vmcnt(6)
ds_read_b64_tr_b16 v[218:219], v236 offset:6144
ds_read_b64_tr_b16 v[222:223], v237 offset:6144
ds_read_b64_tr_b16 v[226:227], v238 offset:6144
ds_read_b64_tr_b16 v[230:231], v239 offset:6144
v_mfma_f32_16x16x32_bf16 v[28:31], v[204:207], v[168:171], 0
v_mfma_f32_16x16x32_bf16 v[48:51], v[208:211], v[168:171], 0
v_mfma_f32_16x16x32_bf16 v[68:71], v[212:215], v[168:171], 0
ds_read_b128 v[168:171], v242 offset:12288
v_mfma_f32_16x16x32_bf16 v[12:15], v[200:203], v[172:175], 0
v_mfma_f32_16x16x32_bf16 v[32:35], v[204:207], v[172:175], 0
s_waitcnt lgkmcnt(1)
s_mov_b32 m0, s5
s_add_u32 s9, s77, 40960
buffer_load_dwordx4 v234, s[56:59], s9 offen offset:2048 lds
s_add_u32 s8, s77, 47104
buffer_load_dwordx4 v234, s[56:59], s8 offen offset:3072 lds
v_mfma_f32_16x16x32_bf16 v[52:55], v[208:211], v[172:175], 0
v_mfma_f32_16x16x32_bf16 v[72:75], v[212:215], v[172:175], 0
v_lshrrev_b32 v251, 3, v235
v_bfe_u32 v252, v235, 2, 1
v_xor_b32 v251, v251, v252
v_mul_u32_u24 v251, 896, v251
v_and_b32 v252, 7, v235
v_lshl_add_u32 v251, v252, 4, v251
s_mov_b32 s9, 0
buffer_load_dwordx4 v[80:83], v251, s[40:43], s9 offen
s_mov_b32 s8, 7168
buffer_load_dwordx4 v[84:87], v251, s[40:43], s8 offen
ds_read_b128 v[172:175], v242 offset:13312
v_mfma_f32_16x16x32_bf16 v[16:19], v[200:203], v[176:179], 0
v_mfma_f32_16x16x32_bf16 v[36:39], v[204:207], v[176:179], 0
v_mfma_f32_16x16x32_bf16 v[56:59], v[208:211], v[176:179], 0
v_mfma_f32_16x16x32_bf16 v[76:79], v[212:215], v[176:179], 0
ds_read_b128 v[176:179], v242 offset:14336
v_mfma_f32_16x16x32_bf16 v[0:3], v[216:219], v[180:183], v[0:3]
v_mfma_f32_16x16x32_bf16 v[20:23], v[220:223], v[180:183], v[20:23]
s_waitcnt vmcnt(8)
ds_read_b64_tr_b16 v[200:201], v236 offset:0
ds_read_b64_tr_b16 v[204:205], v237 offset:0
ds_read_b64_tr_b16 v[208:209], v238 offset:0
ds_read_b64_tr_b16 v[212:213], v239 offset:0
v_mfma_f32_16x16x32_bf16 v[40:43], v[224:227], v[180:183], v[40:43]
v_mfma_f32_16x16x32_bf16 v[60:63], v[228:231], v[180:183], v[60:63]
ds_read_b128 v[180:183], v242 offset:15360
v_mfma_f32_16x16x32_bf16 v[4:7], v[216:219], v[184:187], v[4:7]
v_mfma_f32_16x16x32_bf16 v[24:27], v[220:223], v[184:187], v[24:27]
v_mfma_f32_16x16x32_bf16 v[44:47], v[224:227], v[184:187], v[44:47]
s_waitcnt lgkmcnt(1)
s_mov_b32 m0, s4
s_add_u32 s9, s78, 0
buffer_load_dwordx4 v234, s[56:59], s9 offen lds
s_add_u32 s8, s78, 6144
buffer_load_dwordx4 v234, s[56:59], s8 offen offset:1024 lds
v_mfma_f32_16x16x32_bf16 v[64:67], v[228:231], v[184:187], v[64:67]
ds_read_b128 v[184:187], v242 offset:16384
v_mfma_f32_16x16x32_bf16 v[8:11], v[216:219], v[188:191], v[8:11]
s_waitcnt vmcnt(8)
ds_read_b64_tr_b16 v[202:203], v236 offset:2048
ds_read_b64_tr_b16 v[206:207], v237 offset:2048
ds_read_b64_tr_b16 v[210:211], v238 offset:2048
ds_read_b64_tr_b16 v[214:215], v239 offset:2048
v_mfma_f32_16x16x32_bf16 v[28:31], v[220:223], v[188:191], v[28:31]
v_mfma_f32_16x16x32_bf16 v[48:51], v[224:227], v[188:191], v[48:51]
v_mfma_f32_16x16x32_bf16 v[68:71], v[228:231], v[188:191], v[68:71]
ds_read_b128 v[188:191], v242 offset:17408
v_mfma_f32_16x16x32_bf16 v[12:15], v[216:219], v[192:195], v[12:15]
v_mfma_f32_16x16x32_bf16 v[32:35], v[220:223], v[192:195], v[32:35]
s_waitcnt lgkmcnt(1)
s_mov_b32 m0, s4
s_add_u32 s9, s78, 12288
buffer_load_dwordx4 v234, s[56:59], s9 offen offset:2048 lds
s_add_u32 s8, s78, 18432
buffer_load_dwordx4 v234, s[56:59], s8 offen offset:3072 lds
v_mfma_f32_16x16x32_bf16 v[52:55], v[224:227], v[192:195], v[52:55]
v_mfma_f32_16x16x32_bf16 v[72:75], v[228:231], v[192:195], v[72:75]
ds_read_b128 v[192:195], v242 offset:18432
v_mfma_f32_16x16x32_bf16 v[16:19], v[216:219], v[196:199], v[16:19]
v_mfma_f32_16x16x32_bf16 v[36:39], v[220:223], v[196:199], v[36:39]
v_mfma_f32_16x16x32_bf16 v[56:59], v[224:227], v[196:199], v[56:59]
v_mfma_f32_16x16x32_bf16 v[76:79], v[228:231], v[196:199], v[76:79]
ds_read_b128 v[196:199], v242 offset:19456
v_mfma_f32_16x16x32_bf16 v[0:3], v[200:203], v[160:163], v[0:3]
v_mfma_f32_16x16x32_bf16 v[20:23], v[204:207], v[160:163], v[20:23]
s_waitcnt vmcnt(8)
ds_read_b64_tr_b16 v[216:217], v236 offset:4096
ds_read_b64_tr_b16 v[220:221], v237 offset:4096
ds_read_b64_tr_b16 v[224:225], v238 offset:4096
ds_read_b64_tr_b16 v[228:229], v239 offset:4096
v_mfma_f32_16x16x32_bf16 v[40:43], v[208:211], v[160:163], v[40:43]
v_mfma_f32_16x16x32_bf16 v[60:63], v[212:215], v[160:163], v[60:63]
ds_read_b128 v[160:163], v242 offset:20480
v_mfma_f32_16x16x32_bf16 v[4:7], v[200:203], v[164:167], v[4:7]
v_mfma_f32_16x16x32_bf16 v[24:27], v[204:207], v[164:167], v[24:27]
v_mfma_f32_16x16x32_bf16 v[44:47], v[208:211], v[164:167], v[44:47]
s_waitcnt lgkmcnt(1)
s_mov_b32 m0, s5
s_add_u32 s9, s78, 28672
buffer_load_dwordx4 v234, s[56:59], s9 offen lds
s_add_u32 s8, s78, 34816
buffer_load_dwordx4 v234, s[56:59], s8 offen offset:1024 lds
v_mfma_f32_16x16x32_bf16 v[64:67], v[212:215], v[164:167], v[64:67]
ds_read_b128 v[164:167], v242 offset:21504
v_mfma_f32_16x16x32_bf16 v[8:11], v[200:203], v[168:171], v[8:11]
s_waitcnt vmcnt(8)
ds_read_b64_tr_b16 v[218:219], v236 offset:6144
ds_read_b64_tr_b16 v[222:223], v237 offset:6144
ds_read_b64_tr_b16 v[226:227], v238 offset:6144
ds_read_b64_tr_b16 v[230:231], v239 offset:6144
v_mfma_f32_16x16x32_bf16 v[28:31], v[204:207], v[168:171], v[28:31]
v_mfma_f32_16x16x32_bf16 v[48:51], v[208:211], v[168:171], v[48:51]
v_mfma_f32_16x16x32_bf16 v[68:71], v[212:215], v[168:171], v[68:71]
ds_read_b128 v[168:171], v242 offset:22528
v_mfma_f32_16x16x32_bf16 v[12:15], v[200:203], v[172:175], v[12:15]
v_mfma_f32_16x16x32_bf16 v[32:35], v[204:207], v[172:175], v[32:35]
s_waitcnt lgkmcnt(1)
s_mov_b32 m0, s5
s_add_u32 s9, s78, 40960
buffer_load_dwordx4 v234, s[56:59], s9 offen offset:2048 lds
s_add_u32 s8, s78, 47104
buffer_load_dwordx4 v234, s[56:59], s8 offen offset:3072 lds
v_mfma_f32_16x16x32_bf16 v[52:55], v[208:211], v[172:175], v[52:55]
v_mfma_f32_16x16x32_bf16 v[72:75], v[212:215], v[172:175], v[72:75]
v_lshrrev_b32 v251, 3, v235
v_bfe_u32 v252, v235, 2, 1
v_xor_b32 v251, v251, v252
v_mul_u32_u24 v251, 896, v251
v_and_b32 v252, 7, v235
v_lshl_add_u32 v251, v252, 4, v251
s_mov_b32 s9, 14336
buffer_load_dwordx4 v[88:91], v251, s[40:43], s9 offen
s_mov_b32 s8, 21504
buffer_load_dwordx4 v[92:95], v251, s[40:43], s8 offen
ds_read_b128 v[172:175], v242 offset:23552
v_mfma_f32_16x16x32_bf16 v[16:19], v[200:203], v[176:179], v[16:19]
v_mfma_f32_16x16x32_bf16 v[36:39], v[204:207], v[176:179], v[36:39]
v_mfma_f32_16x16x32_bf16 v[56:59], v[208:211], v[176:179], v[56:59]
v_mfma_f32_16x16x32_bf16 v[76:79], v[212:215], v[176:179], v[76:79]
ds_read_b128 v[176:179], v242 offset:24576
v_mfma_f32_16x16x32_bf16 v[0:3], v[216:219], v[180:183], v[0:3]
v_mfma_f32_16x16x32_bf16 v[20:23], v[220:223], v[180:183], v[20:23]
s_waitcnt vmcnt(8)
ds_read_b64_tr_b16 v[200:201], v236 offset:0
ds_read_b64_tr_b16 v[204:205], v237 offset:0
ds_read_b64_tr_b16 v[208:209], v238 offset:0
ds_read_b64_tr_b16 v[212:213], v239 offset:0
v_mfma_f32_16x16x32_bf16 v[40:43], v[224:227], v[180:183], v[40:43]
v_mfma_f32_16x16x32_bf16 v[60:63], v[228:231], v[180:183], v[60:63]
ds_read_b128 v[180:183], v242 offset:25600
v_mfma_f32_16x16x32_bf16 v[4:7], v[216:219], v[184:187], v[4:7]
v_mfma_f32_16x16x32_bf16 v[24:27], v[220:223], v[184:187], v[24:27]
v_mfma_f32_16x16x32_bf16 v[44:47], v[224:227], v[184:187], v[44:47]
s_waitcnt lgkmcnt(1)
s_mov_b32 m0, s4
s_add_u32 s9, s79, 0
buffer_load_dwordx4 v234, s[56:59], s9 offen lds
s_add_u32 s8, s79, 6144
buffer_load_dwordx4 v234, s[56:59], s8 offen offset:1024 lds
v_mfma_f32_16x16x32_bf16 v[64:67], v[228:231], v[184:187], v[64:67]
ds_read_b128 v[184:187], v242 offset:26624
v_mfma_f32_16x16x32_bf16 v[8:11], v[216:219], v[188:191], v[8:11]
s_waitcnt vmcnt(8)
ds_read_b64_tr_b16 v[202:203], v236 offset:2048
ds_read_b64_tr_b16 v[206:207], v237 offset:2048
ds_read_b64_tr_b16 v[210:211], v238 offset:2048
ds_read_b64_tr_b16 v[214:215], v239 offset:2048
v_mfma_f32_16x16x32_bf16 v[28:31], v[220:223], v[188:191], v[28:31]
v_mfma_f32_16x16x32_bf16 v[48:51], v[224:227], v[188:191], v[48:51]
v_mfma_f32_16x16x32_bf16 v[68:71], v[228:231], v[188:191], v[68:71]
ds_read_b128 v[188:191], v242 offset:27648
v_mfma_f32_16x16x32_bf16 v[12:15], v[216:219], v[192:195], v[12:15]
v_mfma_f32_16x16x32_bf16 v[32:35], v[220:223], v[192:195], v[32:35]
s_waitcnt lgkmcnt(1)
s_mov_b32 m0, s4
s_add_u32 s9, s79, 12288
buffer_load_dwordx4 v234, s[56:59], s9 offen offset:2048 lds
s_add_u32 s8, s79, 18432
buffer_load_dwordx4 v234, s[56:59], s8 offen offset:3072 lds
v_mfma_f32_16x16x32_bf16 v[52:55], v[224:227], v[192:195], v[52:55]
v_mfma_f32_16x16x32_bf16 v[72:75], v[228:231], v[192:195], v[72:75]
ds_read_b128 v[192:195], v242 offset:28672
v_mfma_f32_16x16x32_bf16 v[16:19], v[216:219], v[196:199], v[16:19]
v_mfma_f32_16x16x32_bf16 v[36:39], v[220:223], v[196:199], v[36:39]
v_mfma_f32_16x16x32_bf16 v[56:59], v[224:227], v[196:199], v[56:59]
v_mfma_f32_16x16x32_bf16 v[76:79], v[228:231], v[196:199], v[76:79]
ds_read_b128 v[196:199], v242 offset:29696
v_mfma_f32_16x16x32_bf16 v[0:3], v[200:203], v[160:163], v[0:3]
v_mfma_f32_16x16x32_bf16 v[20:23], v[204:207], v[160:163], v[20:23]
s_waitcnt vmcnt(8)
ds_read_b64_tr_b16 v[216:217], v236 offset:4096
ds_read_b64_tr_b16 v[220:221], v237 offset:4096
ds_read_b64_tr_b16 v[224:225], v238 offset:4096
ds_read_b64_tr_b16 v[228:229], v239 offset:4096
v_mfma_f32_16x16x32_bf16 v[40:43], v[208:211], v[160:163], v[40:43]
v_mfma_f32_16x16x32_bf16 v[60:63], v[212:215], v[160:163], v[60:63]
ds_read_b128 v[160:163], v242 offset:30720
v_mfma_f32_16x16x32_bf16 v[4:7], v[200:203], v[164:167], v[4:7]
v_mfma_f32_16x16x32_bf16 v[24:27], v[204:207], v[164:167], v[24:27]
v_mfma_f32_16x16x32_bf16 v[44:47], v[208:211], v[164:167], v[44:47]
s_waitcnt lgkmcnt(1)
s_mov_b32 m0, s5
s_add_u32 s9, s79, 28672
buffer_load_dwordx4 v234, s[56:59], s9 offen lds
s_add_u32 s8, s79, 34816
buffer_load_dwordx4 v234, s[56:59], s8 offen offset:1024 lds
v_mfma_f32_16x16x32_bf16 v[64:67], v[212:215], v[164:167], v[64:67]
ds_read_b128 v[164:167], v242 offset:31744
v_mfma_f32_16x16x32_bf16 v[8:11], v[200:203], v[168:171], v[8:11]
s_waitcnt vmcnt(8)
ds_read_b64_tr_b16 v[218:219], v236 offset:6144
ds_read_b64_tr_b16 v[222:223], v237 offset:6144
ds_read_b64_tr_b16 v[226:227], v238 offset:6144
ds_read_b64_tr_b16 v[230:231], v239 offset:6144
v_mfma_f32_16x16x32_bf16 v[28:31], v[204:207], v[168:171], v[28:31]
v_mfma_f32_16x16x32_bf16 v[48:51], v[208:211], v[168:171], v[48:51]
v_mfma_f32_16x16x32_bf16 v[68:71], v[212:215], v[168:171], v[68:71]
ds_read_b128 v[168:171], v242 offset:32768
v_mfma_f32_16x16x32_bf16 v[12:15], v[200:203], v[172:175], v[12:15]
v_mfma_f32_16x16x32_bf16 v[32:35], v[204:207], v[172:175], v[32:35]
s_waitcnt lgkmcnt(1)
s_mov_b32 m0, s5
s_add_u32 s9, s79, 40960
buffer_load_dwordx4 v234, s[56:59], s9 offen offset:2048 lds
s_add_u32 s8, s79, 47104
buffer_load_dwordx4 v234, s[56:59], s8 offen offset:3072 lds
v_mfma_f32_16x16x32_bf16 v[52:55], v[208:211], v[172:175], v[52:55]
v_mfma_f32_16x16x32_bf16 v[72:75], v[212:215], v[172:175], v[72:75]
v_lshrrev_b32 v251, 3, v235
v_bfe_u32 v252, v235, 2, 1
v_xor_b32 v251, v251, v252
v_mul_u32_u24 v251, 896, v251
v_and_b32 v252, 7, v235
v_lshl_add_u32 v251, v252, 4, v251
s_mov_b32 s9, 28672
buffer_load_dwordx4 v[96:99], v251, s[40:43], s9 offen
s_mov_b32 s8, 35840
buffer_load_dwordx4 v[100:103], v251, s[40:43], s8 offen
ds_read_b128 v[172:175], v242 offset:33792
v_mfma_f32_16x16x32_bf16 v[16:19], v[200:203], v[176:179], v[16:19]
v_mfma_f32_16x16x32_bf16 v[36:39], v[204:207], v[176:179], v[36:39]
v_mfma_f32_16x16x32_bf16 v[56:59], v[208:211], v[176:179], v[56:59]
v_mfma_f32_16x16x32_bf16 v[76:79], v[212:215], v[176:179], v[76:79]
ds_read_b128 v[176:179], v242 offset:34816
v_mfma_f32_16x16x32_bf16 v[0:3], v[216:219], v[180:183], v[0:3]
v_mfma_f32_16x16x32_bf16 v[20:23], v[220:223], v[180:183], v[20:23]
s_waitcnt vmcnt(8)
ds_read_b64_tr_b16 v[200:201], v236 offset:0
ds_read_b64_tr_b16 v[204:205], v237 offset:0
ds_read_b64_tr_b16 v[208:209], v238 offset:0
ds_read_b64_tr_b16 v[212:213], v239 offset:0
v_mfma_f32_16x16x32_bf16 v[40:43], v[224:227], v[180:183], v[40:43]
v_mfma_f32_16x16x32_bf16 v[60:63], v[228:231], v[180:183], v[60:63]
ds_read_b128 v[180:183], v242 offset:35840
v_mfma_f32_16x16x32_bf16 v[4:7], v[216:219], v[184:187], v[4:7]
v_mfma_f32_16x16x32_bf16 v[24:27], v[220:223], v[184:187], v[24:27]
v_mfma_f32_16x16x32_bf16 v[44:47], v[224:227], v[184:187], v[44:47]
s_waitcnt lgkmcnt(1)
s_mov_b32 m0, s4
s_add_u32 s9, s80, 0
buffer_load_dwordx4 v234, s[56:59], s9 offen lds
s_add_u32 s8, s80, 6144
buffer_load_dwordx4 v234, s[56:59], s8 offen offset:1024 lds
v_mfma_f32_16x16x32_bf16 v[64:67], v[228:231], v[184:187], v[64:67]
ds_read_b128 v[184:187], v242 offset:36864
v_mfma_f32_16x16x32_bf16 v[8:11], v[216:219], v[188:191], v[8:11]
s_waitcnt vmcnt(8)
ds_read_b64_tr_b16 v[202:203], v236 offset:2048
ds_read_b64_tr_b16 v[206:207], v237 offset:2048
ds_read_b64_tr_b16 v[210:211], v238 offset:2048
ds_read_b64_tr_b16 v[214:215], v239 offset:2048
v_mfma_f32_16x16x32_bf16 v[28:31], v[220:223], v[188:191], v[28:31]
v_mfma_f32_16x16x32_bf16 v[48:51], v[224:227], v[188:191], v[48:51]
v_mfma_f32_16x16x32_bf16 v[68:71], v[228:231], v[188:191], v[68:71]
ds_read_b128 v[188:191], v242 offset:37888
v_mfma_f32_16x16x32_bf16 v[12:15], v[216:219], v[192:195], v[12:15]
v_mfma_f32_16x16x32_bf16 v[32:35], v[220:223], v[192:195], v[32:35]
s_waitcnt lgkmcnt(1)
s_mov_b32 m0, s4
s_add_u32 s9, s80, 12288
buffer_load_dwordx4 v234, s[56:59], s9 offen offset:2048 lds
s_add_u32 s8, s80, 18432
buffer_load_dwordx4 v234, s[56:59], s8 offen offset:3072 lds
v_mfma_f32_16x16x32_bf16 v[52:55], v[224:227], v[192:195], v[52:55]
v_mfma_f32_16x16x32_bf16 v[72:75], v[228:231], v[192:195], v[72:75]
ds_read_b128 v[192:195], v242 offset:38912
v_mfma_f32_16x16x32_bf16 v[16:19], v[216:219], v[196:199], v[16:19]
v_mfma_f32_16x16x32_bf16 v[36:39], v[220:223], v[196:199], v[36:39]
v_mfma_f32_16x16x32_bf16 v[56:59], v[224:227], v[196:199], v[56:59]
v_mfma_f32_16x16x32_bf16 v[76:79], v[228:231], v[196:199], v[76:79]
ds_read_b128 v[196:199], v242 offset:39936
v_mfma_f32_16x16x32_bf16 v[0:3], v[200:203], v[160:163], v[0:3]
v_mfma_f32_16x16x32_bf16 v[20:23], v[204:207], v[160:163], v[20:23]
s_waitcnt vmcnt(8)
ds_read_b64_tr_b16 v[216:217], v236 offset:4096
ds_read_b64_tr_b16 v[220:221], v237 offset:4096
ds_read_b64_tr_b16 v[224:225], v238 offset:4096
ds_read_b64_tr_b16 v[228:229], v239 offset:4096
v_mfma_f32_16x16x32_bf16 v[40:43], v[208:211], v[160:163], v[40:43]
v_mfma_f32_16x16x32_bf16 v[60:63], v[212:215], v[160:163], v[60:63]
ds_read_b128 v[160:163], v243 offset:0
v_mfma_f32_16x16x32_bf16 v[4:7], v[200:203], v[164:167], v[4:7]
v_mfma_f32_16x16x32_bf16 v[24:27], v[204:207], v[164:167], v[24:27]
v_mfma_f32_16x16x32_bf16 v[44:47], v[208:211], v[164:167], v[44:47]
s_waitcnt lgkmcnt(1)
s_mov_b32 m0, s5
s_add_u32 s9, s80, 28672
buffer_load_dwordx4 v234, s[56:59], s9 offen lds
s_add_u32 s8, s80, 34816
buffer_load_dwordx4 v234, s[56:59], s8 offen offset:1024 lds
v_mfma_f32_16x16x32_bf16 v[64:67], v[212:215], v[164:167], v[64:67]
ds_read_b128 v[164:167], v243 offset:1024
v_mfma_f32_16x16x32_bf16 v[8:11], v[200:203], v[168:171], v[8:11]
s_waitcnt vmcnt(8)
ds_read_b64_tr_b16 v[218:219], v236 offset:6144
ds_read_b64_tr_b16 v[222:223], v237 offset:6144
ds_read_b64_tr_b16 v[226:227], v238 offset:6144
ds_read_b64_tr_b16 v[230:231], v239 offset:6144
v_mfma_f32_16x16x32_bf16 v[28:31], v[204:207], v[168:171], v[28:31]
v_mfma_f32_16x16x32_bf16 v[48:51], v[208:211], v[168:171], v[48:51]
v_mfma_f32_16x16x32_bf16 v[68:71], v[212:215], v[168:171], v[68:71]
ds_read_b128 v[168:171], v243 offset:2048
v_mfma_f32_16x16x32_bf16 v[12:15], v[200:203], v[172:175], v[12:15]
v_mfma_f32_16x16x32_bf16 v[32:35], v[204:207], v[172:175], v[32:35]
s_waitcnt lgkmcnt(1)
s_mov_b32 m0, s5
s_add_u32 s9, s80, 40960
buffer_load_dwordx4 v234, s[56:59], s9 offen offset:2048 lds
s_add_u32 s8, s80, 47104
buffer_load_dwordx4 v234, s[56:59], s8 offen offset:3072 lds
v_mfma_f32_16x16x32_bf16 v[52:55], v[208:211], v[172:175], v[52:55]
v_mfma_f32_16x16x32_bf16 v[72:75], v[212:215], v[172:175], v[72:75]
v_lshrrev_b32 v251, 3, v235
v_bfe_u32 v252, v235, 2, 1
v_xor_b32 v251, v251, v252
v_mul_u32_u24 v251, 896, v251
v_and_b32 v252, 7, v235
v_lshl_add_u32 v251, v252, 4, v251
s_mov_b32 s9, 43008
buffer_load_dwordx4 v[104:107], v251, s[40:43], s9 offen
s_mov_b32 s8, 50176
buffer_load_dwordx4 v[108:111], v251, s[40:43], s8 offen
ds_read_b128 v[172:175], v243 offset:3072
v_mfma_f32_16x16x32_bf16 v[16:19], v[200:203], v[176:179], v[16:19]
v_mfma_f32_16x16x32_bf16 v[36:39], v[204:207], v[176:179], v[36:39]
v_mfma_f32_16x16x32_bf16 v[56:59], v[208:211], v[176:179], v[56:59]
v_mfma_f32_16x16x32_bf16 v[76:79], v[212:215], v[176:179], v[76:79]
ds_read_b128 v[176:179], v243 offset:4096
v_mfma_f32_16x16x32_bf16 v[0:3], v[216:219], v[180:183], v[0:3]
v_mfma_f32_16x16x32_bf16 v[20:23], v[220:223], v[180:183], v[20:23]
s_waitcnt vmcnt(8)
ds_read_b64_tr_b16 v[200:201], v236 offset:0
ds_read_b64_tr_b16 v[204:205], v237 offset:0
ds_read_b64_tr_b16 v[208:209], v238 offset:0
ds_read_b64_tr_b16 v[212:213], v239 offset:0
v_mfma_f32_16x16x32_bf16 v[40:43], v[224:227], v[180:183], v[40:43]
v_mfma_f32_16x16x32_bf16 v[60:63], v[228:231], v[180:183], v[60:63]
ds_read_b128 v[180:183], v243 offset:5120
v_mfma_f32_16x16x32_bf16 v[4:7], v[216:219], v[184:187], v[4:7]
v_mfma_f32_16x16x32_bf16 v[24:27], v[220:223], v[184:187], v[24:27]
v_mfma_f32_16x16x32_bf16 v[44:47], v[224:227], v[184:187], v[44:47]
s_waitcnt lgkmcnt(1)
s_mov_b32 m0, s4
s_add_u32 s9, s81, 0
buffer_load_dwordx4 v234, s[56:59], s9 offen lds
s_add_u32 s8, s81, 6144
buffer_load_dwordx4 v234, s[56:59], s8 offen offset:1024 lds
v_mfma_f32_16x16x32_bf16 v[64:67], v[228:231], v[184:187], v[64:67]
ds_read_b128 v[184:187], v243 offset:6144
v_mfma_f32_16x16x32_bf16 v[8:11], v[216:219], v[188:191], v[8:11]
s_waitcnt vmcnt(8)
ds_read_b64_tr_b16 v[202:203], v236 offset:2048
ds_read_b64_tr_b16 v[206:207], v237 offset:2048
ds_read_b64_tr_b16 v[210:211], v238 offset:2048
ds_read_b64_tr_b16 v[214:215], v239 offset:2048
v_mfma_f32_16x16x32_bf16 v[28:31], v[220:223], v[188:191], v[28:31]
v_mfma_f32_16x16x32_bf16 v[48:51], v[224:227], v[188:191], v[48:51]
v_mfma_f32_16x16x32_bf16 v[68:71], v[228:231], v[188:191], v[68:71]
ds_read_b128 v[188:191], v243 offset:7168
v_mfma_f32_16x16x32_bf16 v[12:15], v[216:219], v[192:195], v[12:15]
v_mfma_f32_16x16x32_bf16 v[32:35], v[220:223], v[192:195], v[32:35]
s_waitcnt lgkmcnt(1)
s_mov_b32 m0, s4
s_add_u32 s9, s81, 12288
buffer_load_dwordx4 v234, s[56:59], s9 offen offset:2048 lds
s_add_u32 s8, s81, 18432
buffer_load_dwordx4 v234, s[56:59], s8 offen offset:3072 lds
v_mfma_f32_16x16x32_bf16 v[52:55], v[224:227], v[192:195], v[52:55]
v_mfma_f32_16x16x32_bf16 v[72:75], v[228:231], v[192:195], v[72:75]
ds_read_b128 v[192:195], v243 offset:8192
v_mfma_f32_16x16x32_bf16 v[16:19], v[216:219], v[196:199], v[16:19]
v_mfma_f32_16x16x32_bf16 v[36:39], v[220:223], v[196:199], v[36:39]
v_mfma_f32_16x16x32_bf16 v[56:59], v[224:227], v[196:199], v[56:59]
v_mfma_f32_16x16x32_bf16 v[76:79], v[228:231], v[196:199], v[76:79]
ds_read_b128 v[196:199], v243 offset:9216
v_mfma_f32_16x16x32_bf16 v[0:3], v[200:203], v[160:163], v[0:3]
v_mfma_f32_16x16x32_bf16 v[20:23], v[204:207], v[160:163], v[20:23]
s_waitcnt vmcnt(8)
ds_read_b64_tr_b16 v[216:217], v236 offset:4096
ds_read_b64_tr_b16 v[220:221], v237 offset:4096
ds_read_b64_tr_b16 v[224:225], v238 offset:4096
ds_read_b64_tr_b16 v[228:229], v239 offset:4096
v_mfma_f32_16x16x32_bf16 v[40:43], v[208:211], v[160:163], v[40:43]
v_mfma_f32_16x16x32_bf16 v[60:63], v[212:215], v[160:163], v[60:63]
ds_read_b128 v[160:163], v243 offset:10240
v_mfma_f32_16x16x32_bf16 v[4:7], v[200:203], v[164:167], v[4:7]
v_mfma_f32_16x16x32_bf16 v[24:27], v[204:207], v[164:167], v[24:27]
v_mfma_f32_16x16x32_bf16 v[44:47], v[208:211], v[164:167], v[44:47]
s_waitcnt lgkmcnt(1)
s_mov_b32 m0, s5
s_add_u32 s9, s81, 28672
buffer_load_dwordx4 v234, s[56:59], s9 offen lds
s_add_u32 s8, s81, 34816
buffer_load_dwordx4 v234, s[56:59], s8 offen offset:1024 lds
v_mfma_f32_16x16x32_bf16 v[64:67], v[212:215], v[164:167], v[64:67]
ds_read_b128 v[164:167], v243 offset:11264
v_mfma_f32_16x16x32_bf16 v[8:11], v[200:203], v[168:171], v[8:11]
s_waitcnt vmcnt(8)
ds_read_b64_tr_b16 v[218:219], v236 offset:6144
ds_read_b64_tr_b16 v[222:223], v237 offset:6144
ds_read_b64_tr_b16 v[226:227], v238 offset:6144
ds_read_b64_tr_b16 v[230:231], v239 offset:6144
v_mfma_f32_16x16x32_bf16 v[28:31], v[204:207], v[168:171], v[28:31]
v_mfma_f32_16x16x32_bf16 v[48:51], v[208:211], v[168:171], v[48:51]
v_mfma_f32_16x16x32_bf16 v[68:71], v[212:215], v[168:171], v[68:71]
ds_read_b128 v[168:171], v243 offset:12288
v_mfma_f32_16x16x32_bf16 v[12:15], v[200:203], v[172:175], v[12:15]
v_mfma_f32_16x16x32_bf16 v[32:35], v[204:207], v[172:175], v[32:35]
s_waitcnt lgkmcnt(1)
s_mov_b32 m0, s5
s_add_u32 s9, s81, 40960
buffer_load_dwordx4 v234, s[56:59], s9 offen offset:2048 lds
s_add_u32 s8, s81, 47104
buffer_load_dwordx4 v234, s[56:59], s8 offen offset:3072 lds
v_mfma_f32_16x16x32_bf16 v[52:55], v[208:211], v[172:175], v[52:55]
v_mfma_f32_16x16x32_bf16 v[72:75], v[212:215], v[172:175], v[72:75]
v_lshrrev_b32 v251, 3, v235
v_bfe_u32 v252, v235, 2, 1
v_xor_b32 v251, v251, v252
v_mul_u32_u24 v251, 896, v251
v_and_b32 v252, 7, v235
v_lshl_add_u32 v251, v252, 4, v251
s_mov_b32 s9, 57344
buffer_load_dwordx4 v[112:115], v251, s[40:43], s9 offen
s_mov_b32 s8, 64512
buffer_load_dwordx4 v[116:119], v251, s[40:43], s8 offen
ds_read_b128 v[172:175], v243 offset:13312
v_mfma_f32_16x16x32_bf16 v[16:19], v[200:203], v[176:179], v[16:19]
v_mfma_f32_16x16x32_bf16 v[36:39], v[204:207], v[176:179], v[36:39]
v_mfma_f32_16x16x32_bf16 v[56:59], v[208:211], v[176:179], v[56:59]
v_mfma_f32_16x16x32_bf16 v[76:79], v[212:215], v[176:179], v[76:79]
ds_read_b128 v[176:179], v243 offset:14336
v_mfma_f32_16x16x32_bf16 v[0:3], v[216:219], v[180:183], v[0:3]
v_mfma_f32_16x16x32_bf16 v[20:23], v[220:223], v[180:183], v[20:23]
s_waitcnt vmcnt(8)
ds_read_b64_tr_b16 v[200:201], v236 offset:0
ds_read_b64_tr_b16 v[204:205], v237 offset:0
ds_read_b64_tr_b16 v[208:209], v238 offset:0
ds_read_b64_tr_b16 v[212:213], v239 offset:0
v_mfma_f32_16x16x32_bf16 v[40:43], v[224:227], v[180:183], v[40:43]
v_mfma_f32_16x16x32_bf16 v[60:63], v[228:231], v[180:183], v[60:63]
ds_read_b128 v[180:183], v243 offset:15360
v_mfma_f32_16x16x32_bf16 v[4:7], v[216:219], v[184:187], v[4:7]
v_mfma_f32_16x16x32_bf16 v[24:27], v[220:223], v[184:187], v[24:27]
v_mfma_f32_16x16x32_bf16 v[44:47], v[224:227], v[184:187], v[44:47]
s_waitcnt lgkmcnt(1)
s_mov_b32 m0, s4
s_add_u32 s9, s82, 0
buffer_load_dwordx4 v234, s[56:59], s9 offen lds
s_add_u32 s8, s82, 6144
buffer_load_dwordx4 v234, s[56:59], s8 offen offset:1024 lds
v_mfma_f32_16x16x32_bf16 v[64:67], v[228:231], v[184:187], v[64:67]
ds_read_b128 v[184:187], v243 offset:16384
v_mfma_f32_16x16x32_bf16 v[8:11], v[216:219], v[188:191], v[8:11]
s_waitcnt vmcnt(8)
ds_read_b64_tr_b16 v[202:203], v236 offset:2048
ds_read_b64_tr_b16 v[206:207], v237 offset:2048
ds_read_b64_tr_b16 v[210:211], v238 offset:2048
ds_read_b64_tr_b16 v[214:215], v239 offset:2048
v_mfma_f32_16x16x32_bf16 v[28:31], v[220:223], v[188:191], v[28:31]
v_mfma_f32_16x16x32_bf16 v[48:51], v[224:227], v[188:191], v[48:51]
v_mfma_f32_16x16x32_bf16 v[68:71], v[228:231], v[188:191], v[68:71]
ds_read_b128 v[188:191], v243 offset:17408
v_mfma_f32_16x16x32_bf16 v[12:15], v[216:219], v[192:195], v[12:15]
v_mfma_f32_16x16x32_bf16 v[32:35], v[220:223], v[192:195], v[32:35]
s_waitcnt lgkmcnt(1)
s_mov_b32 m0, s4
s_add_u32 s9, s82, 12288
buffer_load_dwordx4 v234, s[56:59], s9 offen offset:2048 lds
s_add_u32 s8, s82, 18432
buffer_load_dwordx4 v234, s[56:59], s8 offen offset:3072 lds
v_mfma_f32_16x16x32_bf16 v[52:55], v[224:227], v[192:195], v[52:55]
v_mfma_f32_16x16x32_bf16 v[72:75], v[228:231], v[192:195], v[72:75]
ds_read_b128 v[192:195], v243 offset:18432
v_mfma_f32_16x16x32_bf16 v[16:19], v[216:219], v[196:199], v[16:19]
v_mfma_f32_16x16x32_bf16 v[36:39], v[220:223], v[196:199], v[36:39]
v_mfma_f32_16x16x32_bf16 v[56:59], v[224:227], v[196:199], v[56:59]
v_mfma_f32_16x16x32_bf16 v[76:79], v[228:231], v[196:199], v[76:79]
ds_read_b128 v[196:199], v243 offset:19456
v_mfma_f32_16x16x32_bf16 v[0:3], v[200:203], v[160:163], v[0:3]
v_mfma_f32_16x16x32_bf16 v[20:23], v[204:207], v[160:163], v[20:23]
s_waitcnt vmcnt(8)
ds_read_b64_tr_b16 v[216:217], v236 offset:4096
ds_read_b64_tr_b16 v[220:221], v237 offset:4096
ds_read_b64_tr_b16 v[224:225], v238 offset:4096
ds_read_b64_tr_b16 v[228:229], v239 offset:4096
v_mfma_f32_16x16x32_bf16 v[40:43], v[208:211], v[160:163], v[40:43]
v_mfma_f32_16x16x32_bf16 v[60:63], v[212:215], v[160:163], v[60:63]
ds_read_b128 v[160:163], v243 offset:20480
v_mfma_f32_16x16x32_bf16 v[4:7], v[200:203], v[164:167], v[4:7]
v_mfma_f32_16x16x32_bf16 v[24:27], v[204:207], v[164:167], v[24:27]
v_mfma_f32_16x16x32_bf16 v[44:47], v[208:211], v[164:167], v[44:47]
s_waitcnt lgkmcnt(1)
s_mov_b32 m0, s5
s_add_u32 s9, s82, 28672
buffer_load_dwordx4 v234, s[56:59], s9 offen lds
s_add_u32 s8, s82, 34816
buffer_load_dwordx4 v234, s[56:59], s8 offen offset:1024 lds
v_mfma_f32_16x16x32_bf16 v[64:67], v[212:215], v[164:167], v[64:67]
ds_read_b128 v[164:167], v243 offset:21504
v_mfma_f32_16x16x32_bf16 v[8:11], v[200:203], v[168:171], v[8:11]
s_waitcnt vmcnt(8)
ds_read_b64_tr_b16 v[218:219], v236 offset:6144
ds_read_b64_tr_b16 v[222:223], v237 offset:6144
ds_read_b64_tr_b16 v[226:227], v238 offset:6144
ds_read_b64_tr_b16 v[230:231], v239 offset:6144
v_mfma_f32_16x16x32_bf16 v[28:31], v[204:207], v[168:171], v[28:31]
v_mfma_f32_16x16x32_bf16 v[48:51], v[208:211], v[168:171], v[48:51]
v_mfma_f32_16x16x32_bf16 v[68:71], v[212:215], v[168:171], v[68:71]
ds_read_b128 v[168:171], v243 offset:22528
v_mfma_f32_16x16x32_bf16 v[12:15], v[200:203], v[172:175], v[12:15]
v_mfma_f32_16x16x32_bf16 v[32:35], v[204:207], v[172:175], v[32:35]
s_waitcnt lgkmcnt(1)
s_mov_b32 m0, s5
s_add_u32 s9, s82, 40960
buffer_load_dwordx4 v234, s[56:59], s9 offen offset:2048 lds
s_add_u32 s8, s82, 47104
buffer_load_dwordx4 v234, s[56:59], s8 offen offset:3072 lds
v_mfma_f32_16x16x32_bf16 v[52:55], v[208:211], v[172:175], v[52:55]
v_mfma_f32_16x16x32_bf16 v[72:75], v[212:215], v[172:175], v[72:75]
ds_read_b128 v[172:175], v243 offset:23552
v_mfma_f32_16x16x32_bf16 v[16:19], v[200:203], v[176:179], v[16:19]
v_mfma_f32_16x16x32_bf16 v[36:39], v[204:207], v[176:179], v[36:39]
v_mfma_f32_16x16x32_bf16 v[56:59], v[208:211], v[176:179], v[56:59]
v_mfma_f32_16x16x32_bf16 v[76:79], v[212:215], v[176:179], v[76:79]
ds_read_b128 v[176:179], v243 offset:24576
v_mfma_f32_16x16x32_bf16 v[0:3], v[216:219], v[180:183], v[0:3]
v_mfma_f32_16x16x32_bf16 v[20:23], v[220:223], v[180:183], v[20:23]
s_waitcnt vmcnt(6)
ds_read_b64_tr_b16 v[200:201], v236 offset:0
ds_read_b64_tr_b16 v[204:205], v237 offset:0
ds_read_b64_tr_b16 v[208:209], v238 offset:0
ds_read_b64_tr_b16 v[212:213], v239 offset:0
v_mfma_f32_16x16x32_bf16 v[40:43], v[224:227], v[180:183], v[40:43]
v_mfma_f32_16x16x32_bf16 v[60:63], v[228:231], v[180:183], v[60:63]
ds_read_b128 v[180:183], v243 offset:25600
v_mfma_f32_16x16x32_bf16 v[4:7], v[216:219], v[184:187], v[4:7]
v_mfma_f32_16x16x32_bf16 v[24:27], v[220:223], v[184:187], v[24:27]
v_mfma_f32_16x16x32_bf16 v[44:47], v[224:227], v[184:187], v[44:47]
s_waitcnt lgkmcnt(1)
s_mov_b32 m0, s4
s_add_u32 s9, s83, 0
buffer_load_dwordx4 v234, s[56:59], s9 offen lds
s_add_u32 s8, s83, 6144
buffer_load_dwordx4 v234, s[56:59], s8 offen offset:1024 lds
v_mfma_f32_16x16x32_bf16 v[64:67], v[228:231], v[184:187], v[64:67]
ds_read_b128 v[184:187], v243 offset:26624
v_mfma_f32_16x16x32_bf16 v[8:11], v[216:219], v[188:191], v[8:11]
s_waitcnt vmcnt(6)
ds_read_b64_tr_b16 v[202:203], v236 offset:2048
ds_read_b64_tr_b16 v[206:207], v237 offset:2048
ds_read_b64_tr_b16 v[210:211], v238 offset:2048
ds_read_b64_tr_b16 v[214:215], v239 offset:2048
v_mfma_f32_16x16x32_bf16 v[28:31], v[220:223], v[188:191], v[28:31]
v_mfma_f32_16x16x32_bf16 v[48:51], v[224:227], v[188:191], v[48:51]
v_mfma_f32_16x16x32_bf16 v[68:71], v[228:231], v[188:191], v[68:71]
ds_read_b128 v[188:191], v243 offset:27648
v_mfma_f32_16x16x32_bf16 v[12:15], v[216:219], v[192:195], v[12:15]
v_mfma_f32_16x16x32_bf16 v[32:35], v[220:223], v[192:195], v[32:35]
s_waitcnt lgkmcnt(1)
s_mov_b32 m0, s4
s_add_u32 s9, s83, 12288
buffer_load_dwordx4 v234, s[56:59], s9 offen offset:2048 lds
s_add_u32 s8, s83, 18432
buffer_load_dwordx4 v234, s[56:59], s8 offen offset:3072 lds
v_mfma_f32_16x16x32_bf16 v[52:55], v[224:227], v[192:195], v[52:55]
v_mfma_f32_16x16x32_bf16 v[72:75], v[228:231], v[192:195], v[72:75]
ds_read_b128 v[192:195], v243 offset:28672
v_mfma_f32_16x16x32_bf16 v[16:19], v[216:219], v[196:199], v[16:19]
v_mfma_f32_16x16x32_bf16 v[36:39], v[220:223], v[196:199], v[36:39]
v_mfma_f32_16x16x32_bf16 v[56:59], v[224:227], v[196:199], v[56:59]
v_mfma_f32_16x16x32_bf16 v[76:79], v[228:231], v[196:199], v[76:79]
ds_read_b128 v[196:199], v243 offset:29696
v_mfma_f32_16x16x32_bf16 v[0:3], v[200:203], v[160:163], v[0:3]
v_mfma_f32_16x16x32_bf16 v[20:23], v[204:207], v[160:163], v[20:23]
s_waitcnt vmcnt(6)
ds_read_b64_tr_b16 v[216:217], v236 offset:4096
ds_read_b64_tr_b16 v[220:221], v237 offset:4096
ds_read_b64_tr_b16 v[224:225], v238 offset:4096
ds_read_b64_tr_b16 v[228:229], v239 offset:4096
v_mfma_f32_16x16x32_bf16 v[40:43], v[208:211], v[160:163], v[40:43]
v_mfma_f32_16x16x32_bf16 v[60:63], v[212:215], v[160:163], v[60:63]
ds_read_b128 v[160:163], v243 offset:30720
v_mfma_f32_16x16x32_bf16 v[4:7], v[200:203], v[164:167], v[4:7]
v_mfma_f32_16x16x32_bf16 v[24:27], v[204:207], v[164:167], v[24:27]
v_mfma_f32_16x16x32_bf16 v[44:47], v[208:211], v[164:167], v[44:47]
s_waitcnt lgkmcnt(1)
s_mov_b32 m0, s5
s_add_u32 s9, s83, 28672
buffer_load_dwordx4 v234, s[56:59], s9 offen lds
s_add_u32 s8, s83, 34816
buffer_load_dwordx4 v234, s[56:59], s8 offen offset:1024 lds
v_mfma_f32_16x16x32_bf16 v[64:67], v[212:215], v[164:167], v[64:67]
ds_read_b128 v[164:167], v243 offset:31744
v_mfma_f32_16x16x32_bf16 v[8:11], v[200:203], v[168:171], v[8:11]
s_waitcnt vmcnt(6)
ds_read_b64_tr_b16 v[218:219], v236 offset:6144
ds_read_b64_tr_b16 v[222:223], v237 offset:6144
ds_read_b64_tr_b16 v[226:227], v238 offset:6144
ds_read_b64_tr_b16 v[230:231], v239 offset:6144
v_mfma_f32_16x16x32_bf16 v[28:31], v[204:207], v[168:171], v[28:31]
v_mfma_f32_16x16x32_bf16 v[48:51], v[208:211], v[168:171], v[48:51]
v_mfma_f32_16x16x32_bf16 v[68:71], v[212:215], v[168:171], v[68:71]
ds_read_b128 v[168:171], v243 offset:32768
v_mfma_f32_16x16x32_bf16 v[12:15], v[200:203], v[172:175], v[12:15]
v_mfma_f32_16x16x32_bf16 v[32:35], v[204:207], v[172:175], v[32:35]
s_waitcnt lgkmcnt(1)
s_mov_b32 m0, s5
s_add_u32 s9, s83, 40960
buffer_load_dwordx4 v234, s[56:59], s9 offen offset:2048 lds
s_add_u32 s8, s83, 47104
buffer_load_dwordx4 v234, s[56:59], s8 offen offset:3072 lds
v_mfma_f32_16x16x32_bf16 v[52:55], v[208:211], v[172:175], v[52:55]
v_mfma_f32_16x16x32_bf16 v[72:75], v[212:215], v[172:175], v[72:75]
ds_read_b128 v[172:175], v243 offset:33792
v_mfma_f32_16x16x32_bf16 v[16:19], v[200:203], v[176:179], v[16:19]
v_mfma_f32_16x16x32_bf16 v[36:39], v[204:207], v[176:179], v[36:39]
v_mfma_f32_16x16x32_bf16 v[56:59], v[208:211], v[176:179], v[56:59]
v_mfma_f32_16x16x32_bf16 v[76:79], v[212:215], v[176:179], v[76:79]
ds_read_b128 v[176:179], v243 offset:34816
v_mfma_f32_16x16x32_bf16 v[0:3], v[216:219], v[180:183], v[0:3]
v_lshrrev_b32 v251, 3, v235
v_bfe_u32 v252, v235, 2, 1
v_xor_b32 v251, v251, v252
v_and_b32 v253, 3, v235
v_lshl_add_u32 v251, v253, 4, v251
v_lshlrev_b32 v253, 1, v253
v_xor_b32 v251, v251, v253
v_lshlrev_b32 v251, 4, v251
v_mul_u32_u24 v252, 5120, v252
v_add3_u32 v251, v251, v252, s12
v_mfma_f32_16x16x32_bf16 v[20:23], v[220:223], v[180:183], v[20:23]
s_waitcnt vmcnt(6)
ds_read_b64_tr_b16 v[200:201], v236 offset:0
ds_read_b64_tr_b16 v[204:205], v237 offset:0
ds_read_b64_tr_b16 v[208:209], v238 offset:0
ds_read_b64_tr_b16 v[212:213], v239 offset:0
v_mfma_f32_16x16x32_bf16 v[40:43], v[224:227], v[180:183], v[40:43]
v_mfma_f32_16x16x32_bf16 v[60:63], v[228:231], v[180:183], v[60:63]
ds_read_b128 v[180:183], v243 offset:35840
v_mfma_f32_16x16x32_bf16 v[4:7], v[216:219], v[184:187], v[4:7]
v_mfma_f32_16x16x32_bf16 v[24:27], v[220:223], v[184:187], v[24:27]
v_mfma_f32_16x16x32_bf16 v[44:47], v[224:227], v[184:187], v[44:47]
s_waitcnt lgkmcnt(1)
s_mov_b32 m0, s4
s_add_u32 s9, s90, 0
buffer_load_dwordx4 v233, s[44:47], s9 offen lds
s_add_u32 s8, s90, 130048
buffer_load_dwordx4 v233, s[44:47], s8 offen offset:1024 lds
v_mfma_f32_16x16x32_bf16 v[64:67], v[228:231], v[184:187], v[64:67]
ds_read_b128 v[184:187], v243 offset:36864
v_mfma_f32_16x16x32_bf16 v[8:11], v[216:219], v[188:191], v[8:11]
s_waitcnt vmcnt(6)
ds_read_b64_tr_b16 v[202:203], v236 offset:2048
ds_read_b64_tr_b16 v[206:207], v237 offset:2048
ds_read_b64_tr_b16 v[210:211], v238 offset:2048
ds_read_b64_tr_b16 v[214:215], v239 offset:2048
v_mfma_f32_16x16x32_bf16 v[28:31], v[220:223], v[188:191], v[28:31]
v_mfma_f32_16x16x32_bf16 v[48:51], v[224:227], v[188:191], v[48:51]
v_mfma_f32_16x16x32_bf16 v[68:71], v[228:231], v[188:191], v[68:71]
ds_read_b128 v[188:191], v243 offset:37888
v_mfma_f32_16x16x32_bf16 v[12:15], v[216:219], v[192:195], v[12:15]
v_mfma_f32_16x16x32_bf16 v[32:35], v[220:223], v[192:195], v[32:35]
s_waitcnt lgkmcnt(1)
s_mov_b32 m0, s4
s_add_u32 s9, s90, 30720
buffer_load_dwordx4 v233, s[44:47], s9 offen offset:2048 lds
s_add_u32 s8, s90, 160768
buffer_load_dwordx4 v233, s[44:47], s8 offen offset:3072 lds
v_mfma_f32_16x16x32_bf16 v[52:55], v[224:227], v[192:195], v[52:55]
v_mfma_f32_16x16x32_bf16 v[72:75], v[228:231], v[192:195], v[72:75]
ds_read_b128 v[192:195], v243 offset:38912
v_mfma_f32_16x16x32_bf16 v[16:19], v[216:219], v[196:199], v[16:19]
v_mfma_f32_16x16x32_bf16 v[36:39], v[220:223], v[196:199], v[36:39]
v_mfma_f32_16x16x32_bf16 v[56:59], v[224:227], v[196:199], v[56:59]
v_mfma_f32_16x16x32_bf16 v[76:79], v[228:231], v[196:199], v[76:79]
ds_read_b128 v[196:199], v243 offset:39936
v_mfma_f32_16x16x32_bf16 v[0:3], v[200:203], v[160:163], v[0:3]
v_mfma_f32_16x16x32_bf16 v[20:23], v[204:207], v[160:163], v[20:23]
s_waitcnt vmcnt(6)
ds_read_b64_tr_b16 v[216:217], v236 offset:4096
ds_read_b64_tr_b16 v[220:221], v237 offset:4096
ds_read_b64_tr_b16 v[224:225], v238 offset:4096
ds_read_b64_tr_b16 v[228:229], v239 offset:4096
v_mfma_f32_16x16x32_bf16 v[40:43], v[208:211], v[160:163], v[40:43]
v_mfma_f32_16x16x32_bf16 v[60:63], v[212:215], v[160:163], v[60:63]
v_mfma_f32_16x16x32_bf16 v[4:7], v[200:203], v[164:167], v[4:7]
v_mfma_f32_16x16x32_bf16 v[24:27], v[204:207], v[164:167], v[24:27]
v_mfma_f32_16x16x32_bf16 v[44:47], v[208:211], v[164:167], v[44:47]
s_waitcnt lgkmcnt(0)
s_mov_b32 m0, s5
s_add_u32 s9, s90, 262144
buffer_load_dwordx4 v233, s[44:47], s9 offen lds
s_add_u32 s8, s90, 392192
buffer_load_dwordx4 v233, s[44:47], s8 offen offset:1024 lds
v_mfma_f32_16x16x32_bf16 v[64:67], v[212:215], v[164:167], v[64:67]
v_mfma_f32_16x16x32_bf16 v[8:11], v[200:203], v[168:171], v[8:11]
s_waitcnt vmcnt(6)
ds_read_b64_tr_b16 v[218:219], v236 offset:6144
ds_read_b64_tr_b16 v[222:223], v237 offset:6144
ds_read_b64_tr_b16 v[226:227], v238 offset:6144
ds_read_b64_tr_b16 v[230:231], v239 offset:6144
v_mfma_f32_16x16x32_bf16 v[28:31], v[204:207], v[168:171], v[28:31]
v_mfma_f32_16x16x32_bf16 v[48:51], v[208:211], v[168:171], v[48:51]
s_barrier
ds_write_b128 v251, v[80:83] offset:0
v_mfma_f32_16x16x32_bf16 v[68:71], v[212:215], v[168:171], v[68:71]
ds_write_b128 v251, v[84:87] offset:128
v_mfma_f32_16x16x32_bf16 v[12:15], v[200:203], v[172:175], v[12:15]
ds_write_b128 v251, v[88:91] offset:1024
v_mfma_f32_16x16x32_bf16 v[32:35], v[204:207], v[172:175], v[32:35]
ds_write_b128 v251, v[92:95] offset:1152
s_waitcnt lgkmcnt(4)
s_mov_b32 m0, s5
s_add_u32 s9, s90, 292864
buffer_load_dwordx4 v233, s[44:47], s9 offen offset:2048 lds
s_add_u32 s8, s90, 422912
buffer_load_dwordx4 v233, s[44:47], s8 offen offset:3072 lds
v_mfma_f32_16x16x32_bf16 v[52:55], v[208:211], v[172:175], v[52:55]
ds_write_b128 v251, v[96:99] offset:2048
v_mfma_f32_16x16x32_bf16 v[72:75], v[212:215], v[172:175], v[72:75]
ds_write_b128 v251, v[100:103] offset:2176
v_mfma_f32_16x16x32_bf16 v[16:19], v[200:203], v[176:179], v[16:19]
ds_write_b128 v251, v[104:107] offset:3072
v_mfma_f32_16x16x32_bf16 v[36:39], v[204:207], v[176:179], v[36:39]
ds_write_b128 v251, v[108:111] offset:3200
v_mfma_f32_16x16x32_bf16 v[56:59], v[208:211], v[176:179], v[56:59]
ds_write_b128 v251, v[112:115] offset:4096
v_mfma_f32_16x16x32_bf16 v[76:79], v[212:215], v[176:179], v[76:79]
ds_write_b128 v251, v[116:119] offset:4224
v_mfma_f32_16x16x32_bf16 v[0:3], v[216:219], v[180:183], v[0:3]
v_mfma_f32_16x16x32_bf16 v[20:23], v[220:223], v[180:183], v[20:23]
s_waitcnt vmcnt(6)
ds_read_b64_tr_b16 v[200:201], v236 offset:0
ds_read_b64_tr_b16 v[204:205], v237 offset:0
ds_read_b64_tr_b16 v[208:209], v238 offset:0
ds_read_b64_tr_b16 v[212:213], v239 offset:0
v_mfma_f32_16x16x32_bf16 v[40:43], v[224:227], v[180:183], v[40:43]
v_mfma_f32_16x16x32_bf16 v[60:63], v[228:231], v[180:183], v[60:63]
v_mfma_f32_16x16x32_bf16 v[4:7], v[216:219], v[184:187], v[4:7]
v_mfma_f32_16x16x32_bf16 v[24:27], v[220:223], v[184:187], v[24:27]
v_mfma_f32_16x16x32_bf16 v[44:47], v[224:227], v[184:187], v[44:47]
s_waitcnt lgkmcnt(0)
s_mov_b32 m0, s4
s_add_u32 s9, s91, 0
buffer_load_dwordx4 v233, s[44:47], s9 offen lds
s_add_u32 s8, s91, 130048
buffer_load_dwordx4 v233, s[44:47], s8 offen offset:1024 lds
v_mfma_f32_16x16x32_bf16 v[64:67], v[228:231], v[184:187], v[64:67]
v_mfma_f32_16x16x32_bf16 v[8:11], v[216:219], v[188:191], v[8:11]
s_waitcnt vmcnt(6)
ds_read_b64_tr_b16 v[202:203], v236 offset:2048
ds_read_b64_tr_b16 v[206:207], v237 offset:2048
ds_read_b64_tr_b16 v[210:211], v238 offset:2048
ds_read_b64_tr_b16 v[214:215], v239 offset:2048
v_mfma_f32_16x16x32_bf16 v[28:31], v[220:223], v[188:191], v[28:31]
v_mfma_f32_16x16x32_bf16 v[48:51], v[224:227], v[188:191], v[48:51]
v_mfma_f32_16x16x32_bf16 v[68:71], v[228:231], v[188:191], v[68:71]
v_mfma_f32_16x16x32_bf16 v[12:15], v[216:219], v[192:195], v[12:15]
v_mfma_f32_16x16x32_bf16 v[32:35], v[220:223], v[192:195], v[32:35]
s_waitcnt lgkmcnt(0)
s_mov_b32 m0, s4
s_add_u32 s9, s91, 30720
buffer_load_dwordx4 v233, s[44:47], s9 offen offset:2048 lds
s_add_u32 s8, s91, 160768
buffer_load_dwordx4 v233, s[44:47], s8 offen offset:3072 lds
v_mfma_f32_16x16x32_bf16 v[52:55], v[224:227], v[192:195], v[52:55]
v_mfma_f32_16x16x32_bf16 v[72:75], v[228:231], v[192:195], v[72:75]
v_mfma_f32_16x16x32_bf16 v[16:19], v[216:219], v[196:199], v[16:19]
v_mfma_f32_16x16x32_bf16 v[36:39], v[220:223], v[196:199], v[36:39]
v_mfma_f32_16x16x32_bf16 v[56:59], v[224:227], v[196:199], v[56:59]
v_mfma_f32_16x16x32_bf16 v[76:79], v[228:231], v[196:199], v[76:79]
s_nop 7
s_waitcnt lgkmcnt(0)
s_barrier
ds_read_b128 v[160:163], v242 offset:0
ds_read_b128 v[164:167], v242 offset:1024
ds_read_b128 v[168:171], v242 offset:2048
ds_read_b128 v[172:175], v242 offset:3072
ds_read_b128 v[176:179], v242 offset:4096
ds_read_b128 v[180:183], v242 offset:5120
ds_read_b128 v[184:187], v242 offset:6144
ds_read_b128 v[188:191], v242 offset:7168
ds_read_b128 v[192:195], v242 offset:8192
ds_read_b128 v[196:199], v242 offset:9216
v_lshlrev_b32 v254, 4, v235
v_cvt_pk_bf16_f32 v0, v0, v1
v_cvt_pk_bf16_f32 v1, v2, v3
v_cvt_pk_bf16_f32 v2, v20, v21
v_cvt_pk_bf16_f32 v3, v22, v23
s_mov_b32 s9, 0
buffer_store_dwordx4 v[0:3], v254, s[60:63], s9 offen sc1
v_cvt_pk_bf16_f32 v4, v4, v5
v_cvt_pk_bf16_f32 v5, v6, v7
v_cvt_pk_bf16_f32 v6, v24, v25
v_cvt_pk_bf16_f32 v7, v26, v27
s_mov_b32 s8, 1024
buffer_store_dwordx4 v[4:7], v254, s[60:63], s8 offen sc1
v_cvt_pk_bf16_f32 v8, v8, v9
v_cvt_pk_bf16_f32 v9, v10, v11
v_cvt_pk_bf16_f32 v10, v28, v29
v_cvt_pk_bf16_f32 v11, v30, v31
s_mov_b32 s9, 2048
buffer_store_dwordx4 v[8:11], v254, s[60:63], s9 offen sc1
v_cvt_pk_bf16_f32 v12, v12, v13
v_cvt_pk_bf16_f32 v13, v14, v15
v_cvt_pk_bf16_f32 v14, v32, v33
v_cvt_pk_bf16_f32 v15, v34, v35
s_mov_b32 s8, 3072
buffer_store_dwordx4 v[12:15], v254, s[60:63], s8 offen sc1
v_cvt_pk_bf16_f32 v16, v16, v17
v_cvt_pk_bf16_f32 v17, v18, v19
v_cvt_pk_bf16_f32 v18, v36, v37
v_cvt_pk_bf16_f32 v19, v38, v39
s_mov_b32 s9, 4096
buffer_store_dwordx4 v[16:19], v254, s[60:63], s9 offen sc1
v_cvt_pk_bf16_f32 v40, v40, v41
v_cvt_pk_bf16_f32 v41, v42, v43
v_cvt_pk_bf16_f32 v42, v60, v61
v_cvt_pk_bf16_f32 v43, v62, v63
s_mov_b32 s8, 5120
buffer_store_dwordx4 v[40:43], v254, s[60:63], s8 offen sc1
v_cvt_pk_bf16_f32 v44, v44, v45
v_cvt_pk_bf16_f32 v45, v46, v47
v_cvt_pk_bf16_f32 v46, v64, v65
v_cvt_pk_bf16_f32 v47, v66, v67
s_mov_b32 s9, 6144
buffer_store_dwordx4 v[44:47], v254, s[60:63], s9 offen sc1
v_cvt_pk_bf16_f32 v48, v48, v49
v_cvt_pk_bf16_f32 v49, v50, v51
v_cvt_pk_bf16_f32 v50, v68, v69
v_cvt_pk_bf16_f32 v51, v70, v71
s_mov_b32 s8, 7168
buffer_store_dwordx4 v[48:51], v254, s[60:63], s8 offen sc1
v_cvt_pk_bf16_f32 v52, v52, v53
v_cvt_pk_bf16_f32 v53, v54, v55
v_cvt_pk_bf16_f32 v54, v72, v73
v_cvt_pk_bf16_f32 v55, v74, v75
s_mov_b32 s9, 8192
buffer_store_dwordx4 v[52:55], v254, s[60:63], s9 offen sc1
v_cvt_pk_bf16_f32 v56, v56, v57
v_cvt_pk_bf16_f32 v57, v58, v59
v_cvt_pk_bf16_f32 v58, v76, v77
v_cvt_pk_bf16_f32 v59, v78, v79
s_mov_b32 s8, 9216
buffer_store_dwordx4 v[56:59], v254, s[60:63], s8 offen sc1
s_nop 1
s_waitcnt lgkmcnt(9)
v_mfma_f32_16x16x32_bf16 v[0:3], v[200:203], v[160:163], 0
v_mfma_f32_16x16x32_bf16 v[20:23], v[204:207], v[160:163], 0
s_waitcnt vmcnt(16)
ds_read_b64_tr_b16 v[216:217], v236 offset:4096
ds_read_b64_tr_b16 v[220:221], v237 offset:4096
ds_read_b64_tr_b16 v[224:225], v238 offset:4096
ds_read_b64_tr_b16 v[228:229], v239 offset:4096
v_mfma_f32_16x16x32_bf16 v[40:43], v[208:211], v[160:163], 0
v_mfma_f32_16x16x32_bf16 v[60:63], v[212:215], v[160:163], 0
ds_read_b128 v[160:163], v242 offset:10240
s_waitcnt lgkmcnt(13)
v_mfma_f32_16x16x32_bf16 v[4:7], v[200:203], v[164:167], 0
v_mfma_f32_16x16x32_bf16 v[24:27], v[204:207], v[164:167], 0
v_mfma_f32_16x16x32_bf16 v[44:47], v[208:211], v[164:167], 0
s_waitcnt lgkmcnt(1)
s_mov_b32 m0, s5
s_add_u32 s9, s91, 262144
buffer_load_dwordx4 v233, s[44:47], s9 offen lds
s_add_u32 s8, s91, 392192
buffer_load_dwordx4 v233, s[44:47], s8 offen offset:1024 lds
v_mfma_f32_16x16x32_bf16 v[64:67], v[212:215], v[164:167], 0
ds_read_b128 v[164:167], v242 offset:11264
v_mfma_f32_16x16x32_bf16 v[8:11], v[200:203], v[168:171], 0
s_waitcnt vmcnt(16)
ds_read_b64_tr_b16 v[218:219], v236 offset:6144
ds_read_b64_tr_b16 v[222:223], v237 offset:6144
ds_read_b64_tr_b16 v[226:227], v238 offset:6144
ds_read_b64_tr_b16 v[230:231], v239 offset:6144
v_mfma_f32_16x16x32_bf16 v[28:31], v[204:207], v[168:171], 0
v_mfma_f32_16x16x32_bf16 v[48:51], v[208:211], v[168:171], 0
v_mfma_f32_16x16x32_bf16 v[68:71], v[212:215], v[168:171], 0
ds_read_b128 v[168:171], v242 offset:12288
v_mfma_f32_16x16x32_bf16 v[12:15], v[200:203], v[172:175], 0
v_mfma_f32_16x16x32_bf16 v[32:35], v[204:207], v[172:175], 0
s_waitcnt lgkmcnt(1)
s_mov_b32 m0, s5
s_add_u32 s9, s91, 292864
buffer_load_dwordx4 v233, s[44:47], s9 offen offset:2048 lds
s_add_u32 s8, s91, 422912
buffer_load_dwordx4 v233, s[44:47], s8 offen offset:3072 lds
v_mfma_f32_16x16x32_bf16 v[52:55], v[208:211], v[172:175], 0
v_mfma_f32_16x16x32_bf16 v[72:75], v[212:215], v[172:175], 0
ds_read_b128 v[172:175], v242 offset:13312
v_mfma_f32_16x16x32_bf16 v[16:19], v[200:203], v[176:179], 0
v_mfma_f32_16x16x32_bf16 v[36:39], v[204:207], v[176:179], 0
v_mfma_f32_16x16x32_bf16 v[56:59], v[208:211], v[176:179], 0
v_mfma_f32_16x16x32_bf16 v[76:79], v[212:215], v[176:179], 0
ds_read_b128 v[176:179], v242 offset:14336
v_mfma_f32_16x16x32_bf16 v[0:3], v[216:219], v[180:183], v[0:3]
v_mfma_f32_16x16x32_bf16 v[20:23], v[220:223], v[180:183], v[20:23]
s_waitcnt vmcnt(16)
ds_read_b64_tr_b16 v[200:201], v236 offset:0
ds_read_b64_tr_b16 v[204:205], v237 offset:0
ds_read_b64_tr_b16 v[208:209], v238 offset:0
ds_read_b64_tr_b16 v[212:213], v239 offset:0
v_mfma_f32_16x16x32_bf16 v[40:43], v[224:227], v[180:183], v[40:43]
v_mfma_f32_16x16x32_bf16 v[60:63], v[228:231], v[180:183], v[60:63]
ds_read_b128 v[180:183], v242 offset:15360
v_mfma_f32_16x16x32_bf16 v[4:7], v[216:219], v[184:187], v[4:7]
v_mfma_f32_16x16x32_bf16 v[24:27], v[220:223], v[184:187], v[24:27]
v_mfma_f32_16x16x32_bf16 v[44:47], v[224:227], v[184:187], v[44:47]
s_waitcnt lgkmcnt(1)
s_mov_b32 m0, s4
s_add_u32 s9, s92, 0
buffer_load_dwordx4 v233, s[44:47], s9 offen lds
s_add_u32 s8, s92, 130048
buffer_load_dwordx4 v233, s[44:47], s8 offen offset:1024 lds
v_mfma_f32_16x16x32_bf16 v[64:67], v[228:231], v[184:187], v[64:67]
ds_read_b128 v[184:187], v242 offset:16384
v_mfma_f32_16x16x32_bf16 v[8:11], v[216:219], v[188:191], v[8:11]
s_waitcnt vmcnt(16)
ds_read_b64_tr_b16 v[202:203], v236 offset:2048
ds_read_b64_tr_b16 v[206:207], v237 offset:2048
ds_read_b64_tr_b16 v[210:211], v238 offset:2048
ds_read_b64_tr_b16 v[214:215], v239 offset:2048
v_mfma_f32_16x16x32_bf16 v[28:31], v[220:223], v[188:191], v[28:31]
v_mfma_f32_16x16x32_bf16 v[48:51], v[224:227], v[188:191], v[48:51]
v_mfma_f32_16x16x32_bf16 v[68:71], v[228:231], v[188:191], v[68:71]
ds_read_b128 v[188:191], v242 offset:17408
v_mfma_f32_16x16x32_bf16 v[12:15], v[216:219], v[192:195], v[12:15]
v_mfma_f32_16x16x32_bf16 v[32:35], v[220:223], v[192:195], v[32:35]
s_waitcnt lgkmcnt(1)
s_mov_b32 m0, s4
s_add_u32 s9, s92, 30720
buffer_load_dwordx4 v233, s[44:47], s9 offen offset:2048 lds
s_add_u32 s8, s92, 160768
buffer_load_dwordx4 v233, s[44:47], s8 offen offset:3072 lds
v_mfma_f32_16x16x32_bf16 v[52:55], v[224:227], v[192:195], v[52:55]
v_mfma_f32_16x16x32_bf16 v[72:75], v[228:231], v[192:195], v[72:75]
ds_read_b128 v[192:195], v242 offset:18432
v_mfma_f32_16x16x32_bf16 v[16:19], v[216:219], v[196:199], v[16:19]
v_mfma_f32_16x16x32_bf16 v[36:39], v[220:223], v[196:199], v[36:39]
v_mfma_f32_16x16x32_bf16 v[56:59], v[224:227], v[196:199], v[56:59]
v_mfma_f32_16x16x32_bf16 v[76:79], v[228:231], v[196:199], v[76:79]
ds_read_b128 v[196:199], v242 offset:19456
v_mfma_f32_16x16x32_bf16 v[0:3], v[200:203], v[160:163], v[0:3]
v_mfma_f32_16x16x32_bf16 v[20:23], v[204:207], v[160:163], v[20:23]
s_waitcnt vmcnt(6)
ds_read_b64_tr_b16 v[216:217], v236 offset:4096
ds_read_b64_tr_b16 v[220:221], v237 offset:4096
ds_read_b64_tr_b16 v[224:225], v238 offset:4096
ds_read_b64_tr_b16 v[228:229], v239 offset:4096
v_mfma_f32_16x16x32_bf16 v[40:43], v[208:211], v[160:163], v[40:43]
v_mfma_f32_16x16x32_bf16 v[60:63], v[212:215], v[160:163], v[60:63]
ds_read_b128 v[160:163], v242 offset:20480
v_mfma_f32_16x16x32_bf16 v[4:7], v[200:203], v[164:167], v[4:7]
v_mfma_f32_16x16x32_bf16 v[24:27], v[204:207], v[164:167], v[24:27]
v_mfma_f32_16x16x32_bf16 v[44:47], v[208:211], v[164:167], v[44:47]
s_waitcnt lgkmcnt(1)
s_mov_b32 m0, s5
s_add_u32 s9, s92, 262144
buffer_load_dwordx4 v233, s[44:47], s9 offen lds
s_add_u32 s8, s92, 392192
buffer_load_dwordx4 v233, s[44:47], s8 offen offset:1024 lds
v_mfma_f32_16x16x32_bf16 v[64:67], v[212:215], v[164:167], v[64:67]
ds_read_b128 v[164:167], v242 offset:21504
v_mfma_f32_16x16x32_bf16 v[8:11], v[200:203], v[168:171], v[8:11]
s_waitcnt vmcnt(6)
ds_read_b64_tr_b16 v[218:219], v236 offset:6144
ds_read_b64_tr_b16 v[222:223], v237 offset:6144
ds_read_b64_tr_b16 v[226:227], v238 offset:6144
ds_read_b64_tr_b16 v[230:231], v239 offset:6144
v_mfma_f32_16x16x32_bf16 v[28:31], v[204:207], v[168:171], v[28:31]
v_mfma_f32_16x16x32_bf16 v[48:51], v[208:211], v[168:171], v[48:51]
v_mfma_f32_16x16x32_bf16 v[68:71], v[212:215], v[168:171], v[68:71]
ds_read_b128 v[168:171], v242 offset:22528
v_mfma_f32_16x16x32_bf16 v[12:15], v[200:203], v[172:175], v[12:15]
v_mfma_f32_16x16x32_bf16 v[32:35], v[204:207], v[172:175], v[32:35]
s_waitcnt lgkmcnt(1)
s_mov_b32 m0, s5
s_add_u32 s9, s92, 292864
buffer_load_dwordx4 v233, s[44:47], s9 offen offset:2048 lds
s_add_u32 s8, s92, 422912
buffer_load_dwordx4 v233, s[44:47], s8 offen offset:3072 lds
v_mfma_f32_16x16x32_bf16 v[52:55], v[208:211], v[172:175], v[52:55]
v_mfma_f32_16x16x32_bf16 v[72:75], v[212:215], v[172:175], v[72:75]
ds_read_b128 v[172:175], v242 offset:23552
v_mfma_f32_16x16x32_bf16 v[16:19], v[200:203], v[176:179], v[16:19]
v_mfma_f32_16x16x32_bf16 v[36:39], v[204:207], v[176:179], v[36:39]
v_mfma_f32_16x16x32_bf16 v[56:59], v[208:211], v[176:179], v[56:59]
v_mfma_f32_16x16x32_bf16 v[76:79], v[212:215], v[176:179], v[76:79]
ds_read_b128 v[176:179], v242 offset:24576
v_mfma_f32_16x16x32_bf16 v[0:3], v[216:219], v[180:183], v[0:3]
v_mfma_f32_16x16x32_bf16 v[20:23], v[220:223], v[180:183], v[20:23]
s_waitcnt vmcnt(6)
ds_read_b64_tr_b16 v[200:201], v236 offset:0
ds_read_b64_tr_b16 v[204:205], v237 offset:0
ds_read_b64_tr_b16 v[208:209], v238 offset:0
ds_read_b64_tr_b16 v[212:213], v239 offset:0
v_mfma_f32_16x16x32_bf16 v[40:43], v[224:227], v[180:183], v[40:43]
v_mfma_f32_16x16x32_bf16 v[60:63], v[228:231], v[180:183], v[60:63]
ds_read_b128 v[180:183], v242 offset:25600
v_mfma_f32_16x16x32_bf16 v[4:7], v[216:219], v[184:187], v[4:7]
v_mfma_f32_16x16x32_bf16 v[24:27], v[220:223], v[184:187], v[24:27]
v_mfma_f32_16x16x32_bf16 v[44:47], v[224:227], v[184:187], v[44:47]
s_waitcnt lgkmcnt(1)
s_mov_b32 m0, s4
s_add_u32 s9, s93, 0
buffer_load_dwordx4 v233, s[44:47], s9 offen lds
s_add_u32 s8, s93, 130048
buffer_load_dwordx4 v233, s[44:47], s8 offen offset:1024 lds
v_mfma_f32_16x16x32_bf16 v[64:67], v[228:231], v[184:187], v[64:67]
ds_read_b128 v[184:187], v242 offset:26624
v_mfma_f32_16x16x32_bf16 v[8:11], v[216:219], v[188:191], v[8:11]
s_waitcnt vmcnt(6)
ds_read_b64_tr_b16 v[202:203], v236 offset:2048
ds_read_b64_tr_b16 v[206:207], v237 offset:2048
ds_read_b64_tr_b16 v[210:211], v238 offset:2048
ds_read_b64_tr_b16 v[214:215], v239 offset:2048
v_mfma_f32_16x16x32_bf16 v[28:31], v[220:223], v[188:191], v[28:31]
v_mfma_f32_16x16x32_bf16 v[48:51], v[224:227], v[188:191], v[48:51]
v_mfma_f32_16x16x32_bf16 v[68:71], v[228:231], v[188:191], v[68:71]
ds_read_b128 v[188:191], v242 offset:27648
v_mfma_f32_16x16x32_bf16 v[12:15], v[216:219], v[192:195], v[12:15]
v_mfma_f32_16x16x32_bf16 v[32:35], v[220:223], v[192:195], v[32:35]
s_waitcnt lgkmcnt(1)
s_mov_b32 m0, s4
s_add_u32 s9, s93, 30720
buffer_load_dwordx4 v233, s[44:47], s9 offen offset:2048 lds
s_add_u32 s8, s93, 160768
buffer_load_dwordx4 v233, s[44:47], s8 offen offset:3072 lds
v_mfma_f32_16x16x32_bf16 v[52:55], v[224:227], v[192:195], v[52:55]
v_mfma_f32_16x16x32_bf16 v[72:75], v[228:231], v[192:195], v[72:75]
ds_read_b128 v[192:195], v242 offset:28672
v_mfma_f32_16x16x32_bf16 v[16:19], v[216:219], v[196:199], v[16:19]
v_mfma_f32_16x16x32_bf16 v[36:39], v[220:223], v[196:199], v[36:39]
v_mfma_f32_16x16x32_bf16 v[56:59], v[224:227], v[196:199], v[56:59]
v_mfma_f32_16x16x32_bf16 v[76:79], v[228:231], v[196:199], v[76:79]
ds_read_b128 v[196:199], v242 offset:29696
v_mfma_f32_16x16x32_bf16 v[0:3], v[200:203], v[160:163], v[0:3]
v_mfma_f32_16x16x32_bf16 v[20:23], v[204:207], v[160:163], v[20:23]
s_waitcnt vmcnt(6)
ds_read_b64_tr_b16 v[216:217], v236 offset:4096
ds_read_b64_tr_b16 v[220:221], v237 offset:4096
ds_read_b64_tr_b16 v[224:225], v238 offset:4096
ds_read_b64_tr_b16 v[228:229], v239 offset:4096
v_mfma_f32_16x16x32_bf16 v[40:43], v[208:211], v[160:163], v[40:43]
v_mfma_f32_16x16x32_bf16 v[60:63], v[212:215], v[160:163], v[60:63]
ds_read_b128 v[160:163], v242 offset:30720
v_mfma_f32_16x16x32_bf16 v[4:7], v[200:203], v[164:167], v[4:7]
v_mfma_f32_16x16x32_bf16 v[24:27], v[204:207], v[164:167], v[24:27]
v_mfma_f32_16x16x32_bf16 v[44:47], v[208:211], v[164:167], v[44:47]
s_waitcnt lgkmcnt(1)
s_mov_b32 m0, s5
s_add_u32 s9, s93, 262144
buffer_load_dwordx4 v233, s[44:47], s9 offen lds
s_add_u32 s8, s93, 392192
buffer_load_dwordx4 v233, s[44:47], s8 offen offset:1024 lds
v_mfma_f32_16x16x32_bf16 v[64:67], v[212:215], v[164:167], v[64:67]
ds_read_b128 v[164:167], v242 offset:31744
v_mfma_f32_16x16x32_bf16 v[8:11], v[200:203], v[168:171], v[8:11]
s_waitcnt vmcnt(6)
ds_read_b64_tr_b16 v[218:219], v236 offset:6144
ds_read_b64_tr_b16 v[222:223], v237 offset:6144
ds_read_b64_tr_b16 v[226:227], v238 offset:6144
ds_read_b64_tr_b16 v[230:231], v239 offset:6144
v_mfma_f32_16x16x32_bf16 v[28:31], v[204:207], v[168:171], v[28:31]
v_mfma_f32_16x16x32_bf16 v[48:51], v[208:211], v[168:171], v[48:51]
v_mfma_f32_16x16x32_bf16 v[68:71], v[212:215], v[168:171], v[68:71]
ds_read_b128 v[168:171], v242 offset:32768
v_mfma_f32_16x16x32_bf16 v[12:15], v[200:203], v[172:175], v[12:15]
v_mfma_f32_16x16x32_bf16 v[32:35], v[204:207], v[172:175], v[32:35]
s_waitcnt lgkmcnt(1)
s_mov_b32 m0, s5
s_add_u32 s9, s93, 292864
buffer_load_dwordx4 v233, s[44:47], s9 offen offset:2048 lds
s_add_u32 s8, s93, 422912
buffer_load_dwordx4 v233, s[44:47], s8 offen offset:3072 lds
v_mfma_f32_16x16x32_bf16 v[52:55], v[208:211], v[172:175], v[52:55]
v_mfma_f32_16x16x32_bf16 v[72:75], v[212:215], v[172:175], v[72:75]
ds_read_b128 v[172:175], v242 offset:33792
v_mfma_f32_16x16x32_bf16 v[16:19], v[200:203], v[176:179], v[16:19]
v_mfma_f32_16x16x32_bf16 v[36:39], v[204:207], v[176:179], v[36:39]
v_mfma_f32_16x16x32_bf16 v[56:59], v[208:211], v[176:179], v[56:59]
v_mfma_f32_16x16x32_bf16 v[76:79], v[212:215], v[176:179], v[76:79]
ds_read_b128 v[176:179], v242 offset:34816
v_mfma_f32_16x16x32_bf16 v[0:3], v[216:219], v[180:183], v[0:3]
v_mfma_f32_16x16x32_bf16 v[20:23], v[220:223], v[180:183], v[20:23]
s_waitcnt vmcnt(6)
ds_read_b64_tr_b16 v[200:201], v236 offset:0
ds_read_b64_tr_b16 v[204:205], v237 offset:0
ds_read_b64_tr_b16 v[208:209], v238 offset:0
ds_read_b64_tr_b16 v[212:213], v239 offset:0
v_mfma_f32_16x16x32_bf16 v[40:43], v[224:227], v[180:183], v[40:43]
v_mfma_f32_16x16x32_bf16 v[60:63], v[228:231], v[180:183], v[60:63]
ds_read_b128 v[180:183], v242 offset:35840
v_mfma_f32_16x16x32_bf16 v[4:7], v[216:219], v[184:187], v[4:7]
v_mfma_f32_16x16x32_bf16 v[24:27], v[220:223], v[184:187], v[24:27]
v_mfma_f32_16x16x32_bf16 v[44:47], v[224:227], v[184:187], v[44:47]
s_waitcnt lgkmcnt(1)
s_mov_b32 m0, s4
s_add_u32 s9, s94, 0
buffer_load_dwordx4 v233, s[44:47], s9 offen lds
s_add_u32 s8, s94, 130048
buffer_load_dwordx4 v233, s[44:47], s8 offen offset:1024 lds
v_mfma_f32_16x16x32_bf16 v[64:67], v[228:231], v[184:187], v[64:67]
ds_read_b128 v[184:187], v242 offset:36864
v_mfma_f32_16x16x32_bf16 v[8:11], v[216:219], v[188:191], v[8:11]
s_waitcnt vmcnt(6)
ds_read_b64_tr_b16 v[202:203], v236 offset:2048
ds_read_b64_tr_b16 v[206:207], v237 offset:2048
ds_read_b64_tr_b16 v[210:211], v238 offset:2048
ds_read_b64_tr_b16 v[214:215], v239 offset:2048
v_mfma_f32_16x16x32_bf16 v[28:31], v[220:223], v[188:191], v[28:31]
v_mfma_f32_16x16x32_bf16 v[48:51], v[224:227], v[188:191], v[48:51]
v_mfma_f32_16x16x32_bf16 v[68:71], v[228:231], v[188:191], v[68:71]
ds_read_b128 v[188:191], v242 offset:37888
v_mfma_f32_16x16x32_bf16 v[12:15], v[216:219], v[192:195], v[12:15]
v_mfma_f32_16x16x32_bf16 v[32:35], v[220:223], v[192:195], v[32:35]
s_waitcnt lgkmcnt(1)
s_mov_b32 m0, s4
s_add_u32 s9, s94, 30720
buffer_load_dwordx4 v233, s[44:47], s9 offen offset:2048 lds
s_add_u32 s8, s94, 160768
buffer_load_dwordx4 v233, s[44:47], s8 offen offset:3072 lds
v_mfma_f32_16x16x32_bf16 v[52:55], v[224:227], v[192:195], v[52:55]
v_mfma_f32_16x16x32_bf16 v[72:75], v[228:231], v[192:195], v[72:75]
ds_read_b128 v[192:195], v242 offset:38912
v_mfma_f32_16x16x32_bf16 v[16:19], v[216:219], v[196:199], v[16:19]
v_mfma_f32_16x16x32_bf16 v[36:39], v[220:223], v[196:199], v[36:39]
v_mfma_f32_16x16x32_bf16 v[56:59], v[224:227], v[196:199], v[56:59]
v_mfma_f32_16x16x32_bf16 v[76:79], v[228:231], v[196:199], v[76:79]
ds_read_b128 v[196:199], v242 offset:39936
v_mfma_f32_16x16x32_bf16 v[0:3], v[200:203], v[160:163], v[0:3]
v_mfma_f32_16x16x32_bf16 v[20:23], v[204:207], v[160:163], v[20:23]
s_waitcnt vmcnt(6)
ds_read_b64_tr_b16 v[216:217], v236 offset:4096
ds_read_b64_tr_b16 v[220:221], v237 offset:4096
ds_read_b64_tr_b16 v[224:225], v238 offset:4096
ds_read_b64_tr_b16 v[228:229], v239 offset:4096
v_mfma_f32_16x16x32_bf16 v[40:43], v[208:211], v[160:163], v[40:43]
v_mfma_f32_16x16x32_bf16 v[60:63], v[212:215], v[160:163], v[60:63]
ds_read_b128 v[160:163], v243 offset:0
v_mfma_f32_16x16x32_bf16 v[4:7], v[200:203], v[164:167], v[4:7]
v_mfma_f32_16x16x32_bf16 v[24:27], v[204:207], v[164:167], v[24:27]
v_mfma_f32_16x16x32_bf16 v[44:47], v[208:211], v[164:167], v[44:47]
s_waitcnt lgkmcnt(1)
s_mov_b32 m0, s5
s_add_u32 s9, s94, 262144
buffer_load_dwordx4 v233, s[44:47], s9 offen lds
s_add_u32 s8, s94, 392192
buffer_load_dwordx4 v233, s[44:47], s8 offen offset:1024 lds
v_mfma_f32_16x16x32_bf16 v[64:67], v[212:215], v[164:167], v[64:67]
ds_read_b128 v[164:167], v243 offset:1024
v_mfma_f32_16x16x32_bf16 v[8:11], v[200:203], v[168:171], v[8:11]
s_waitcnt vmcnt(6)
ds_read_b64_tr_b16 v[218:219], v236 offset:6144
ds_read_b64_tr_b16 v[222:223], v237 offset:6144
ds_read_b64_tr_b16 v[226:227], v238 offset:6144
ds_read_b64_tr_b16 v[230:231], v239 offset:6144
v_mfma_f32_16x16x32_bf16 v[28:31], v[204:207], v[168:171], v[28:31]
v_mfma_f32_16x16x32_bf16 v[48:51], v[208:211], v[168:171], v[48:51]
v_mfma_f32_16x16x32_bf16 v[68:71], v[212:215], v[168:171], v[68:71]
ds_read_b128 v[168:171], v243 offset:2048
v_mfma_f32_16x16x32_bf16 v[12:15], v[200:203], v[172:175], v[12:15]
v_mfma_f32_16x16x32_bf16 v[32:35], v[204:207], v[172:175], v[32:35]
s_waitcnt lgkmcnt(1)
s_mov_b32 m0, s5
s_add_u32 s9, s94, 292864
buffer_load_dwordx4 v233, s[44:47], s9 offen offset:2048 lds
s_add_u32 s8, s94, 422912
buffer_load_dwordx4 v233, s[44:47], s8 offen offset:3072 lds
v_mfma_f32_16x16x32_bf16 v[52:55], v[208:211], v[172:175], v[52:55]
v_mfma_f32_16x16x32_bf16 v[72:75], v[212:215], v[172:175], v[72:75]
ds_read_b128 v[172:175], v243 offset:3072
v_mfma_f32_16x16x32_bf16 v[16:19], v[200:203], v[176:179], v[16:19]
v_mfma_f32_16x16x32_bf16 v[36:39], v[204:207], v[176:179], v[36:39]
v_mfma_f32_16x16x32_bf16 v[56:59], v[208:211], v[176:179], v[56:59]
v_mfma_f32_16x16x32_bf16 v[76:79], v[212:215], v[176:179], v[76:79]
ds_read_b128 v[176:179], v243 offset:4096
v_mfma_f32_16x16x32_bf16 v[0:3], v[216:219], v[180:183], v[0:3]
v_mfma_f32_16x16x32_bf16 v[20:23], v[220:223], v[180:183], v[20:23]
s_waitcnt vmcnt(6)
ds_read_b64_tr_b16 v[200:201], v236 offset:0
ds_read_b64_tr_b16 v[204:205], v237 offset:0
ds_read_b64_tr_b16 v[208:209], v238 offset:0
ds_read_b64_tr_b16 v[212:213], v239 offset:0
v_mfma_f32_16x16x32_bf16 v[40:43], v[224:227], v[180:183], v[40:43]
v_mfma_f32_16x16x32_bf16 v[60:63], v[228:231], v[180:183], v[60:63]
ds_read_b128 v[180:183], v243 offset:5120
v_mfma_f32_16x16x32_bf16 v[4:7], v[216:219], v[184:187], v[4:7]
v_mfma_f32_16x16x32_bf16 v[24:27], v[220:223], v[184:187], v[24:27]
v_mfma_f32_16x16x32_bf16 v[44:47], v[224:227], v[184:187], v[44:47]
s_waitcnt lgkmcnt(1)
s_mov_b32 m0, s4
s_add_u32 s9, s95, 0
buffer_load_dwordx4 v233, s[44:47], s9 offen lds
s_add_u32 s8, s95, 130048
buffer_load_dwordx4 v233, s[44:47], s8 offen offset:1024 lds
v_mfma_f32_16x16x32_bf16 v[64:67], v[228:231], v[184:187], v[64:67]
ds_read_b128 v[184:187], v243 offset:6144
v_mfma_f32_16x16x32_bf16 v[8:11], v[216:219], v[188:191], v[8:11]
s_waitcnt vmcnt(6)
ds_read_b64_tr_b16 v[202:203], v236 offset:2048
ds_read_b64_tr_b16 v[206:207], v237 offset:2048
ds_read_b64_tr_b16 v[210:211], v238 offset:2048
ds_read_b64_tr_b16 v[214:215], v239 offset:2048
v_mfma_f32_16x16x32_bf16 v[28:31], v[220:223], v[188:191], v[28:31]
v_mfma_f32_16x16x32_bf16 v[48:51], v[224:227], v[188:191], v[48:51]
v_mfma_f32_16x16x32_bf16 v[68:71], v[228:231], v[188:191], v[68:71]
ds_read_b128 v[188:191], v243 offset:7168
v_mfma_f32_16x16x32_bf16 v[12:15], v[216:219], v[192:195], v[12:15]
v_mfma_f32_16x16x32_bf16 v[32:35], v[220:223], v[192:195], v[32:35]
s_waitcnt lgkmcnt(1)
s_mov_b32 m0, s4
s_add_u32 s9, s95, 30720
buffer_load_dwordx4 v233, s[44:47], s9 offen offset:2048 lds
s_add_u32 s8, s95, 160768
buffer_load_dwordx4 v233, s[44:47], s8 offen offset:3072 lds
v_mfma_f32_16x16x32_bf16 v[52:55], v[224:227], v[192:195], v[52:55]
v_mfma_f32_16x16x32_bf16 v[72:75], v[228:231], v[192:195], v[72:75]
ds_read_b128 v[192:195], v243 offset:8192
v_mfma_f32_16x16x32_bf16 v[16:19], v[216:219], v[196:199], v[16:19]
v_mfma_f32_16x16x32_bf16 v[36:39], v[220:223], v[196:199], v[36:39]
v_mfma_f32_16x16x32_bf16 v[56:59], v[224:227], v[196:199], v[56:59]
v_mfma_f32_16x16x32_bf16 v[76:79], v[228:231], v[196:199], v[76:79]
ds_read_b128 v[196:199], v243 offset:9216
v_mfma_f32_16x16x32_bf16 v[0:3], v[200:203], v[160:163], v[0:3]
v_mfma_f32_16x16x32_bf16 v[20:23], v[204:207], v[160:163], v[20:23]
s_waitcnt vmcnt(6)
ds_read_b64_tr_b16 v[216:217], v236 offset:4096
ds_read_b64_tr_b16 v[220:221], v237 offset:4096
ds_read_b64_tr_b16 v[224:225], v238 offset:4096
ds_read_b64_tr_b16 v[228:229], v239 offset:4096
v_mfma_f32_16x16x32_bf16 v[40:43], v[208:211], v[160:163], v[40:43]
v_mfma_f32_16x16x32_bf16 v[60:63], v[212:215], v[160:163], v[60:63]
ds_read_b128 v[160:163], v243 offset:10240
v_mfma_f32_16x16x32_bf16 v[4:7], v[200:203], v[164:167], v[4:7]
v_mfma_f32_16x16x32_bf16 v[24:27], v[204:207], v[164:167], v[24:27]
v_mfma_f32_16x16x32_bf16 v[44:47], v[208:211], v[164:167], v[44:47]
s_waitcnt lgkmcnt(1)
s_mov_b32 m0, s5
s_add_u32 s9, s95, 262144
buffer_load_dwordx4 v233, s[44:47], s9 offen lds
s_add_u32 s8, s95, 392192
buffer_load_dwordx4 v233, s[44:47], s8 offen offset:1024 lds
v_mfma_f32_16x16x32_bf16 v[64:67], v[212:215], v[164:167], v[64:67]
ds_read_b128 v[164:167], v243 offset:11264
v_mfma_f32_16x16x32_bf16 v[8:11], v[200:203], v[168:171], v[8:11]
s_waitcnt vmcnt(6)
ds_read_b64_tr_b16 v[218:219], v236 offset:6144
ds_read_b64_tr_b16 v[222:223], v237 offset:6144
ds_read_b64_tr_b16 v[226:227], v238 offset:6144
ds_read_b64_tr_b16 v[230:231], v239 offset:6144
v_mfma_f32_16x16x32_bf16 v[28:31], v[204:207], v[168:171], v[28:31]
v_mfma_f32_16x16x32_bf16 v[48:51], v[208:211], v[168:171], v[48:51]
v_mfma_f32_16x16x32_bf16 v[68:71], v[212:215], v[168:171], v[68:71]
ds_read_b128 v[168:171], v243 offset:12288
v_mfma_f32_16x16x32_bf16 v[12:15], v[200:203], v[172:175], v[12:15]
v_mfma_f32_16x16x32_bf16 v[32:35], v[204:207], v[172:175], v[32:35]
s_waitcnt lgkmcnt(1)
s_mov_b32 m0, s5
s_add_u32 s9, s95, 292864
buffer_load_dwordx4 v233, s[44:47], s9 offen offset:2048 lds
s_add_u32 s8, s95, 422912
buffer_load_dwordx4 v233, s[44:47], s8 offen offset:3072 lds
v_mfma_f32_16x16x32_bf16 v[52:55], v[208:211], v[172:175], v[52:55]
v_mfma_f32_16x16x32_bf16 v[72:75], v[212:215], v[172:175], v[72:75]
ds_read_b128 v[172:175], v243 offset:13312
v_mfma_f32_16x16x32_bf16 v[16:19], v[200:203], v[176:179], v[16:19]
v_mfma_f32_16x16x32_bf16 v[36:39], v[204:207], v[176:179], v[36:39]
v_mfma_f32_16x16x32_bf16 v[56:59], v[208:211], v[176:179], v[56:59]
v_mfma_f32_16x16x32_bf16 v[76:79], v[212:215], v[176:179], v[76:79]
ds_read_b128 v[176:179], v243 offset:14336
v_mfma_f32_16x16x32_bf16 v[0:3], v[216:219], v[180:183], v[0:3]
v_mfma_f32_16x16x32_bf16 v[20:23], v[220:223], v[180:183], v[20:23]
s_waitcnt vmcnt(6)
ds_read_b64_tr_b16 v[200:201], v236 offset:0
ds_read_b64_tr_b16 v[204:205], v237 offset:0
ds_read_b64_tr_b16 v[208:209], v238 offset:0
ds_read_b64_tr_b16 v[212:213], v239 offset:0
v_mfma_f32_16x16x32_bf16 v[40:43], v[224:227], v[180:183], v[40:43]
v_mfma_f32_16x16x32_bf16 v[60:63], v[228:231], v[180:183], v[60:63]
ds_read_b128 v[180:183], v243 offset:15360
v_mfma_f32_16x16x32_bf16 v[4:7], v[216:219], v[184:187], v[4:7]
v_mfma_f32_16x16x32_bf16 v[24:27], v[220:223], v[184:187], v[24:27]
v_mfma_f32_16x16x32_bf16 v[44:47], v[224:227], v[184:187], v[44:47]
s_waitcnt lgkmcnt(1)
s_mov_b32 m0, s4
s_add_u32 s9, s96, 0
buffer_load_dwordx4 v233, s[44:47], s9 offen lds
s_add_u32 s8, s96, 130048
buffer_load_dwordx4 v233, s[44:47], s8 offen offset:1024 lds
v_mfma_f32_16x16x32_bf16 v[64:67], v[228:231], v[184:187], v[64:67]
ds_read_b128 v[184:187], v243 offset:16384
v_mfma_f32_16x16x32_bf16 v[8:11], v[216:219], v[188:191], v[8:11]
s_waitcnt vmcnt(6)
ds_read_b64_tr_b16 v[202:203], v236 offset:2048
ds_read_b64_tr_b16 v[206:207], v237 offset:2048
ds_read_b64_tr_b16 v[210:211], v238 offset:2048
ds_read_b64_tr_b16 v[214:215], v239 offset:2048
v_mfma_f32_16x16x32_bf16 v[28:31], v[220:223], v[188:191], v[28:31]
v_mfma_f32_16x16x32_bf16 v[48:51], v[224:227], v[188:191], v[48:51]
v_mfma_f32_16x16x32_bf16 v[68:71], v[228:231], v[188:191], v[68:71]
ds_read_b128 v[188:191], v243 offset:17408
v_mfma_f32_16x16x32_bf16 v[12:15], v[216:219], v[192:195], v[12:15]
v_mfma_f32_16x16x32_bf16 v[32:35], v[220:223], v[192:195], v[32:35]
s_waitcnt lgkmcnt(1)
s_mov_b32 m0, s4
s_add_u32 s9, s96, 30720
buffer_load_dwordx4 v233, s[44:47], s9 offen offset:2048 lds
s_add_u32 s8, s96, 160768
buffer_load_dwordx4 v233, s[44:47], s8 offen offset:3072 lds
v_mfma_f32_16x16x32_bf16 v[52:55], v[224:227], v[192:195], v[52:55]
v_mfma_f32_16x16x32_bf16 v[72:75], v[228:231], v[192:195], v[72:75]
ds_read_b128 v[192:195], v243 offset:18432
v_mfma_f32_16x16x32_bf16 v[16:19], v[216:219], v[196:199], v[16:19]
v_mfma_f32_16x16x32_bf16 v[36:39], v[220:223], v[196:199], v[36:39]
v_mfma_f32_16x16x32_bf16 v[56:59], v[224:227], v[196:199], v[56:59]
v_mfma_f32_16x16x32_bf16 v[76:79], v[228:231], v[196:199], v[76:79]
ds_read_b128 v[196:199], v243 offset:19456
v_mfma_f32_16x16x32_bf16 v[0:3], v[200:203], v[160:163], v[0:3]
v_mfma_f32_16x16x32_bf16 v[20:23], v[204:207], v[160:163], v[20:23]
s_waitcnt vmcnt(6)
ds_read_b64_tr_b16 v[216:217], v236 offset:4096
ds_read_b64_tr_b16 v[220:221], v237 offset:4096
ds_read_b64_tr_b16 v[224:225], v238 offset:4096
ds_read_b64_tr_b16 v[228:229], v239 offset:4096
v_mfma_f32_16x16x32_bf16 v[40:43], v[208:211], v[160:163], v[40:43]
v_mfma_f32_16x16x32_bf16 v[60:63], v[212:215], v[160:163], v[60:63]
ds_read_b128 v[160:163], v243 offset:20480
v_mfma_f32_16x16x32_bf16 v[4:7], v[200:203], v[164:167], v[4:7]
v_mfma_f32_16x16x32_bf16 v[24:27], v[204:207], v[164:167], v[24:27]
v_mfma_f32_16x16x32_bf16 v[44:47], v[208:211], v[164:167], v[44:47]
s_waitcnt lgkmcnt(1)
s_mov_b32 m0, s5
s_add_u32 s9, s96, 262144
buffer_load_dwordx4 v233, s[44:47], s9 offen lds
s_add_u32 s8, s96, 392192
buffer_load_dwordx4 v233, s[44:47], s8 offen offset:1024 lds
v_mfma_f32_16x16x32_bf16 v[64:67], v[212:215], v[164:167], v[64:67]
ds_read_b128 v[164:167], v243 offset:21504
v_mfma_f32_16x16x32_bf16 v[8:11], v[200:203], v[168:171], v[8:11]
s_waitcnt vmcnt(6)
ds_read_b64_tr_b16 v[218:219], v236 offset:6144
ds_read_b64_tr_b16 v[222:223], v237 offset:6144
ds_read_b64_tr_b16 v[226:227], v238 offset:6144
ds_read_b64_tr_b16 v[230:231], v239 offset:6144
v_mfma_f32_16x16x32_bf16 v[28:31], v[204:207], v[168:171], v[28:31]
v_mfma_f32_16x16x32_bf16 v[48:51], v[208:211], v[168:171], v[48:51]
v_mfma_f32_16x16x32_bf16 v[68:71], v[212:215], v[168:171], v[68:71]
ds_read_b128 v[168:171], v243 offset:22528
v_mfma_f32_16x16x32_bf16 v[12:15], v[200:203], v[172:175], v[12:15]
v_mfma_f32_16x16x32_bf16 v[32:35], v[204:207], v[172:175], v[32:35]
s_waitcnt lgkmcnt(1)
s_mov_b32 m0, s5
s_add_u32 s9, s96, 292864
buffer_load_dwordx4 v233, s[44:47], s9 offen offset:2048 lds
s_add_u32 s8, s96, 422912
buffer_load_dwordx4 v233, s[44:47], s8 offen offset:3072 lds
v_mfma_f32_16x16x32_bf16 v[52:55], v[208:211], v[172:175], v[52:55]
v_mfma_f32_16x16x32_bf16 v[72:75], v[212:215], v[172:175], v[72:75]
ds_read_b128 v[172:175], v243 offset:23552
v_mfma_f32_16x16x32_bf16 v[16:19], v[200:203], v[176:179], v[16:19]
v_mfma_f32_16x16x32_bf16 v[36:39], v[204:207], v[176:179], v[36:39]
v_mfma_f32_16x16x32_bf16 v[56:59], v[208:211], v[176:179], v[56:59]
v_mfma_f32_16x16x32_bf16 v[76:79], v[212:215], v[176:179], v[76:79]
ds_read_b128 v[176:179], v243 offset:24576
v_mfma_f32_16x16x32_bf16 v[0:3], v[216:219], v[180:183], v[0:3]
v_lshrrev_b32 v246, 5, v235
v_add_u32 v246, 0, v246
v_lshlrev_b32 v247, 1, v246
v_and_b32 v248, 15, v235
v_xor_b32 v247, v248, v247
v_lshl_add_u32 v247, v246, 4, v247
v_lshlrev_b32 v247, 4, v247
v_bfe_u32 v248, v235, 4, 1
v_lshl_add_u32 v247, v248, 3, v247
v_add_u32 v251, s70, v247
v_lshrrev_b32 v246, 5, v235
v_add_u32 v246, 2, v246
v_lshlrev_b32 v247, 1, v246
v_and_b32 v248, 15, v235
v_xor_b32 v247, v248, v247
v_lshl_add_u32 v247, v246, 4, v247
v_lshlrev_b32 v247, 4, v247
v_bfe_u32 v248, v235, 4, 1
v_lshl_add_u32 v247, v248, 3, v247
v_add_u32 v252, s70, v247
v_mfma_f32_16x16x32_bf16 v[20:23], v[220:223], v[180:183], v[20:23]
s_waitcnt vmcnt(6)
ds_read_b64_tr_b16 v[200:201], v236 offset:0
ds_read_b64_tr_b16 v[204:205], v237 offset:0
ds_read_b64_tr_b16 v[208:209], v238 offset:0
ds_read_b64_tr_b16 v[212:213], v239 offset:0
v_mfma_f32_16x16x32_bf16 v[40:43], v[224:227], v[180:183], v[40:43]
v_mfma_f32_16x16x32_bf16 v[60:63], v[228:231], v[180:183], v[60:63]
ds_read_b128 v[180:183], v243 offset:25600
v_mfma_f32_16x16x32_bf16 v[4:7], v[216:219], v[184:187], v[4:7]
v_mfma_f32_16x16x32_bf16 v[24:27], v[220:223], v[184:187], v[24:27]
v_mfma_f32_16x16x32_bf16 v[44:47], v[224:227], v[184:187], v[44:47]
s_waitcnt lgkmcnt(1)
s_mov_b32 m0, s4
s_add_u32 s9, s66, 0
buffer_load_dwordx4 v232, s[24:27], s9 offen nt lds
s_add_u32 s8, s66, 3072
buffer_load_dwordx4 v232, s[24:27], s8 offen offset:1024 nt lds
v_mfma_f32_16x16x32_bf16 v[64:67], v[228:231], v[184:187], v[64:67]
ds_read_b128 v[184:187], v243 offset:26624
v_mfma_f32_16x16x32_bf16 v[8:11], v[216:219], v[188:191], v[8:11]
s_waitcnt vmcnt(6)
ds_read_b64_tr_b16 v[202:203], v236 offset:2048
ds_read_b64_tr_b16 v[206:207], v237 offset:2048
ds_read_b64_tr_b16 v[210:211], v238 offset:2048
ds_read_b64_tr_b16 v[214:215], v239 offset:2048
v_mfma_f32_16x16x32_bf16 v[28:31], v[220:223], v[188:191], v[28:31]
v_mfma_f32_16x16x32_bf16 v[48:51], v[224:227], v[188:191], v[48:51]
v_mfma_f32_16x16x32_bf16 v[68:71], v[228:231], v[188:191], v[68:71]
ds_read_b128 v[188:191], v243 offset:27648
v_mfma_f32_16x16x32_bf16 v[12:15], v[216:219], v[192:195], v[12:15]
v_mfma_f32_16x16x32_bf16 v[32:35], v[220:223], v[192:195], v[32:35]
s_waitcnt lgkmcnt(1)
s_mov_b32 m0, s4
s_add_u32 s9, s66, 14336
buffer_load_dwordx4 v232, s[24:27], s9 offen offset:2048 nt lds
s_add_u32 s8, s66, 17408
buffer_load_dwordx4 v232, s[24:27], s8 offen offset:3072 nt lds
v_mfma_f32_16x16x32_bf16 v[52:55], v[224:227], v[192:195], v[52:55]
v_mfma_f32_16x16x32_bf16 v[72:75], v[228:231], v[192:195], v[72:75]
ds_read_b128 v[192:195], v243 offset:28672
v_mfma_f32_16x16x32_bf16 v[16:19], v[216:219], v[196:199], v[16:19]
v_mfma_f32_16x16x32_bf16 v[36:39], v[220:223], v[196:199], v[36:39]
v_mfma_f32_16x16x32_bf16 v[56:59], v[224:227], v[196:199], v[56:59]
v_mfma_f32_16x16x32_bf16 v[76:79], v[228:231], v[196:199], v[76:79]
ds_read_b128 v[196:199], v243 offset:29696
v_mfma_f32_16x16x32_bf16 v[0:3], v[200:203], v[160:163], v[0:3]
v_mfma_f32_16x16x32_bf16 v[20:23], v[204:207], v[160:163], v[20:23]
s_waitcnt vmcnt(6)
ds_read_b64_tr_b16 v[216:217], v236 offset:4096
ds_read_b64_tr_b16 v[220:221], v237 offset:4096
ds_read_b64_tr_b16 v[224:225], v238 offset:4096
ds_read_b64_tr_b16 v[228:229], v239 offset:4096
v_mfma_f32_16x16x32_bf16 v[40:43], v[208:211], v[160:163], v[40:43]
v_mfma_f32_16x16x32_bf16 v[60:63], v[212:215], v[160:163], v[60:63]
v_mfma_f32_16x16x32_bf16 v[4:7], v[200:203], v[164:167], v[4:7]
v_mfma_f32_16x16x32_bf16 v[24:27], v[204:207], v[164:167], v[24:27]
v_mfma_f32_16x16x32_bf16 v[44:47], v[208:211], v[164:167], v[44:47]
s_waitcnt lgkmcnt(0)
s_mov_b32 m0, s5
s_add_u32 s9, s67, 0
buffer_load_dwordx4 v232, s[24:27], s9 offen nt lds
s_add_u32 s8, s67, 3072
buffer_load_dwordx4 v232, s[24:27], s8 offen offset:1024 nt lds
v_mfma_f32_16x16x32_bf16 v[64:67], v[212:215], v[164:167], v[64:67]
v_mfma_f32_16x16x32_bf16 v[8:11], v[200:203], v[168:171], v[8:11]
s_waitcnt vmcnt(6)
ds_read_b64_tr_b16 v[218:219], v236 offset:6144
ds_read_b64_tr_b16 v[222:223], v237 offset:6144
ds_read_b64_tr_b16 v[226:227], v238 offset:6144
ds_read_b64_tr_b16 v[230:231], v239 offset:6144
v_mfma_f32_16x16x32_bf16 v[28:31], v[204:207], v[168:171], v[28:31]
v_mfma_f32_16x16x32_bf16 v[48:51], v[208:211], v[168:171], v[48:51]
v_mfma_f32_16x16x32_bf16 v[68:71], v[212:215], v[168:171], v[68:71]
v_mfma_f32_16x16x32_bf16 v[12:15], v[200:203], v[172:175], v[12:15]
s_barrier
v_mfma_f32_16x16x32_bf16 v[32:35], v[204:207], v[172:175], v[32:35]
s_waitcnt lgkmcnt(0)
s_mov_b32 m0, s5
s_add_u32 s9, s67, 14336
buffer_load_dwordx4 v232, s[24:27], s9 offen offset:2048 nt lds
s_add_u32 s8, s67, 17408
buffer_load_dwordx4 v232, s[24:27], s8 offen offset:3072 nt lds
v_mfma_f32_16x16x32_bf16 v[52:55], v[208:211], v[172:175], v[52:55]
v_mfma_f32_16x16x32_bf16 v[72:75], v[212:215], v[172:175], v[72:75]
v_mfma_f32_16x16x32_bf16 v[16:19], v[200:203], v[176:179], v[16:19]
v_mfma_f32_16x16x32_bf16 v[36:39], v[204:207], v[176:179], v[36:39]
v_mfma_f32_16x16x32_bf16 v[56:59], v[208:211], v[176:179], v[56:59]
v_mfma_f32_16x16x32_bf16 v[76:79], v[212:215], v[176:179], v[76:79]
v_mfma_f32_16x16x32_bf16 v[0:3], v[216:219], v[180:183], v[0:3]
v_mfma_f32_16x16x32_bf16 v[20:23], v[220:223], v[180:183], v[20:23]
v_mfma_f32_16x16x32_bf16 v[40:43], v[224:227], v[180:183], v[40:43]
v_mfma_f32_16x16x32_bf16 v[60:63], v[228:231], v[180:183], v[60:63]
v_mfma_f32_16x16x32_bf16 v[4:7], v[216:219], v[184:187], v[4:7]
s_waitcnt vmcnt(6)
s_barrier
v_mfma_f32_16x16x32_bf16 v[24:27], v[220:223], v[184:187], v[24:27]
v_subrev_u32 v236, s13, v236
v_subrev_u32 v237, s13, v237
v_subrev_u32 v238, s13, v238
v_subrev_u32 v239, s13, v239
v_subrev_u32 v240, s13, v240
v_subrev_u32 v241, s13, v241
ds_read_b128 v[200:203], v240 offset:0
ds_read_b128 v[204:207], v241 offset:0
v_mfma_f32_16x16x32_bf16 v[44:47], v[224:227], v[184:187], v[44:47]
v_mfma_f32_16x16x32_bf16 v[64:67], v[228:231], v[184:187], v[64:67]
ds_read_b128 v[208:211], v240 offset:32768
ds_read_b128 v[212:215], v241 offset:32768
v_mfma_f32_16x16x32_bf16 v[8:11], v[216:219], v[188:191], v[8:11]
v_mfma_f32_16x16x32_bf16 v[28:31], v[220:223], v[188:191], v[28:31]
v_mfma_f32_16x16x32_bf16 v[48:51], v[224:227], v[188:191], v[48:51]
v_mfma_f32_16x16x32_bf16 v[68:71], v[228:231], v[188:191], v[68:71]
v_mfma_f32_16x16x32_bf16 v[12:15], v[216:219], v[192:195], v[12:15]
v_cvt_pk_bf16_f32 v0, v0, v1
v_cvt_pk_bf16_f32 v1, v2, v3
ds_write_b64 v251, v[0:1] offset:0
v_cvt_pk_bf16_f32 v20, v20, v21
v_cvt_pk_bf16_f32 v21, v22, v23
ds_write_b64 v252, v[20:21] offset:0
v_cvt_pk_bf16_f32 v40, v40, v41
v_cvt_pk_bf16_f32 v41, v42, v43
ds_write_b64 v251, v[40:41] offset:5120
v_cvt_pk_bf16_f32 v60, v60, v61
v_cvt_pk_bf16_f32 v61, v62, v63
ds_write_b64 v252, v[60:61] offset:5120
v_mfma_f32_16x16x32_bf16 v[32:35], v[220:223], v[192:195], v[32:35]
v_mfma_f32_16x16x32_bf16 v[52:55], v[224:227], v[192:195], v[52:55]
v_mfma_f32_16x16x32_bf16 v[72:75], v[228:231], v[192:195], v[72:75]
v_mfma_f32_16x16x32_bf16 v[16:19], v[216:219], v[196:199], v[16:19]
v_cvt_pk_bf16_f32 v4, v4, v5
v_cvt_pk_bf16_f32 v5, v6, v7
ds_write_b64 v251, v[4:5] offset:1024
v_cvt_pk_bf16_f32 v24, v24, v25
v_cvt_pk_bf16_f32 v25, v26, v27
ds_write_b64 v252, v[24:25] offset:1024
v_cvt_pk_bf16_f32 v44, v44, v45
v_cvt_pk_bf16_f32 v45, v46, v47
ds_write_b64 v251, v[44:45] offset:6144
v_cvt_pk_bf16_f32 v64, v64, v65
v_cvt_pk_bf16_f32 v65, v66, v67
ds_write_b64 v252, v[64:65] offset:6144
v_mfma_f32_16x16x32_bf16 v[36:39], v[220:223], v[196:199], v[36:39]
v_mfma_f32_16x16x32_bf16 v[56:59], v[224:227], v[196:199], v[56:59]
v_mfma_f32_16x16x32_bf16 v[76:79], v[228:231], v[196:199], v[76:79]
s_nop 7
v_cvt_pk_bf16_f32 v8, v8, v9
v_cvt_pk_bf16_f32 v9, v10, v11
ds_write_b64 v251, v[8:9] offset:2048
v_cvt_pk_bf16_f32 v28, v28, v29
v_cvt_pk_bf16_f32 v29, v30, v31
ds_write_b64 v252, v[28:29] offset:2048
v_cvt_pk_bf16_f32 v48, v48, v49
v_cvt_pk_bf16_f32 v49, v50, v51
ds_write_b64 v251, v[48:49] offset:7168
v_cvt_pk_bf16_f32 v68, v68, v69
v_cvt_pk_bf16_f32 v69, v70, v71
ds_write_b64 v252, v[68:69] offset:7168
v_cvt_pk_bf16_f32 v12, v12, v13
v_cvt_pk_bf16_f32 v13, v14, v15
ds_write_b64 v251, v[12:13] offset:3072
v_cvt_pk_bf16_f32 v32, v32, v33
v_cvt_pk_bf16_f32 v33, v34, v35
ds_write_b64 v252, v[32:33] offset:3072
v_cvt_pk_bf16_f32 v52, v52, v53
v_cvt_pk_bf16_f32 v53, v54, v55
ds_write_b64 v251, v[52:53] offset:8192
v_cvt_pk_bf16_f32 v72, v72, v73
v_cvt_pk_bf16_f32 v73, v74, v75
ds_write_b64 v252, v[72:73] offset:8192
v_cvt_pk_bf16_f32 v16, v16, v17
v_cvt_pk_bf16_f32 v17, v18, v19
ds_write_b64 v251, v[16:17] offset:4096
v_cvt_pk_bf16_f32 v36, v36, v37
v_cvt_pk_bf16_f32 v37, v38, v39
ds_write_b64 v252, v[36:37] offset:4096
v_cvt_pk_bf16_f32 v56, v56, v57
v_cvt_pk_bf16_f32 v57, v58, v59
ds_write_b64 v251, v[56:57] offset:9216
v_cvt_pk_bf16_f32 v76, v76, v77
v_cvt_pk_bf16_f32 v77, v78, v79
ds_write_b64 v252, v[76:77] offset:9216
s_waitcnt lgkmcnt(0)
s_barrier
s_mov_b32 m0, s4
s_add_u32 s9, s68, 0
buffer_load_dwordx4 v232, s[24:27], s9 offen nt lds
s_add_u32 s8, s68, 3072
buffer_load_dwordx4 v232, s[24:27], s8 offen offset:1024 nt lds
s_cmp_lg_u32 s3, 0
s_cbranch_scc1 L_sigBAa
s_lshl_b32 s10, s98, 2
v_mov_b32 v253, s10
v_mov_b32 v254, 1
s_mov_b64 exec, 1
global_atomic_add v253, v254, s[86:87] offset:128 sc1
s_mov_b64 exec, -1
L_sigBAa:
ds_read_b128 v[160:163], v244 offset:0
ds_read_b128 v[164:167], v244 offset:1024
ds_read_b128 v[168:171], v244 offset:2048
ds_read_b128 v[172:175], v244 offset:3072
ds_read_b128 v[176:179], v244 offset:4096
ds_read_b128 v[180:183], v244 offset:5120
ds_read_b128 v[184:187], v244 offset:6144
ds_read_b128 v[188:191], v244 offset:7168
ds_read_b128 v[192:195], v244 offset:8192
ds_read_b128 v[196:199], v244 offset:9216
s_waitcnt lgkmcnt(9)
v_mfma_f32_16x16x32_bf16 v[0:3], v[200:203], v[160:163], 0
v_mfma_f32_16x16x32_bf16 v[20:23], v[208:211], v[160:163], 0
s_waitcnt lgkmcnt(8)
v_mfma_f32_16x16x32_bf16 v[4:7], v[200:203], v[164:167], 0
v_mfma_f32_16x16x32_bf16 v[24:27], v[208:211], v[164:167], 0
s_waitcnt lgkmcnt(7)
v_mfma_f32_16x16x32_bf16 v[8:11], v[200:203], v[168:171], 0
s_waitcnt vmcnt(6)
s_barrier
v_mfma_f32_16x16x32_bf16 v[28:31], v[208:211], v[168:171], 0
ds_read_b128 v[216:219], v240 offset:2048
ds_read_b128 v[220:223], v241 offset:2048
s_waitcnt lgkmcnt(8)
v_mfma_f32_16x16x32_bf16 v[12:15], v[200:203], v[172:175], 0
v_mfma_f32_16x16x32_bf16 v[32:35], v[208:211], v[172:175], 0
ds_read_b128 v[224:227], v240 offset:34816
ds_read_b128 v[228:231], v241 offset:34816
s_waitcnt lgkmcnt(9)
v_mfma_f32_16x16x32_bf16 v[16:19], v[200:203], v[176:179], 0
v_mfma_f32_16x16x32_bf16 v[36:39], v[208:211], v[176:179], 0
s_waitcnt lgkmcnt(8)
v_mfma_f32_16x16x32_bf16 v[0:3], v[204:207], v[180:183], v[0:3]
v_mfma_f32_16x16x32_bf16 v[20:23], v[212:215], v[180:183], v[20:23]
s_waitcnt lgkmcnt(7)
v_mfma_f32_16x16x32_bf16 v[4:7], v[204:207], v[184:187], v[4:7]
v_mfma_f32_16x16x32_bf16 v[24:27], v[212:215], v[184:187], v[24:27]
s_waitcnt lgkmcnt(6)
v_mfma_f32_16x16x32_bf16 v[8:11], v[204:207], v[188:191], v[8:11]
v_mfma_f32_16x16x32_bf16 v[28:31], v[212:215], v[188:191], v[28:31]
s_waitcnt lgkmcnt(5)
v_mfma_f32_16x16x32_bf16 v[12:15], v[204:207], v[192:195], v[12:15]
v_mfma_f32_16x16x32_bf16 v[32:35], v[212:215], v[192:195], v[32:35]
s_waitcnt lgkmcnt(4)
v_mfma_f32_16x16x32_bf16 v[16:19], v[204:207], v[196:199], v[16:19]
v_mfma_f32_16x16x32_bf16 v[36:39], v[212:215], v[196:199], v[36:39]
s_waitcnt lgkmcnt(3)
v_mfma_f32_16x16x32_bf16 v[40:43], v[216:219], v[160:163], 0
s_waitcnt lgkmcnt(1)
v_mfma_f32_16x16x32_bf16 v[60:63], v[224:227], v[160:163], 0
ds_read_b128 v[160:163], v244 offset:10240
v_mfma_f32_16x16x32_bf16 v[44:47], v[216:219], v[164:167], 0
v_mfma_f32_16x16x32_bf16 v[64:67], v[224:227], v[164:167], 0
ds_read_b128 v[164:167], v244 offset:11264
v_mfma_f32_16x16x32_bf16 v[48:51], v[216:219], v[168:171], 0
s_waitcnt vmcnt(4)
s_waitcnt lgkmcnt(2)
s_barrier
v_mfma_f32_16x16x32_bf16 v[68:71], v[224:227], v[168:171], 0
ds_read_b128 v[168:171], v244 offset:12288
ds_read_b128 v[200:203], v240 offset:4096
ds_read_b128 v[204:207], v241 offset:4096
v_mfma_f32_16x16x32_bf16 v[52:55], v[216:219], v[172:175], 0
v_mfma_f32_16x16x32_bf16 v[72:75], v[224:227], v[172:175], 0
ds_read_b128 v[172:175], v244 offset:13312
ds_read_b128 v[208:211], v240 offset:36864
ds_read_b128 v[212:215], v241 offset:36864
v_mfma_f32_16x16x32_bf16 v[56:59], v[216:219], v[176:179], 0
v_mfma_f32_16x16x32_bf16 v[76:79], v[224:227], v[176:179], 0
ds_read_b128 v[176:179], v244 offset:14336
s_mov_b32 m0, s4
s_add_u32 s9, s68, 14336
buffer_load_dwordx4 v232, s[24:27], s9 offen offset:2048 nt lds
s_add_u32 s8, s68, 17408
buffer_load_dwordx4 v232, s[24:27], s8 offen offset:3072 nt lds
v_mfma_f32_16x16x32_bf16 v[40:43], v[220:223], v[180:183], v[40:43]
v_mfma_f32_16x16x32_bf16 v[60:63], v[228:231], v[180:183], v[60:63]
ds_read_b128 v[180:183], v244 offset:15360
v_mfma_f32_16x16x32_bf16 v[44:47], v[220:223], v[184:187], v[44:47]
v_mfma_f32_16x16x32_bf16 v[64:67], v[228:231], v[184:187], v[64:67]
ds_read_b128 v[184:187], v244 offset:16384
v_mfma_f32_16x16x32_bf16 v[48:51], v[220:223], v[188:191], v[48:51]
v_mfma_f32_16x16x32_bf16 v[68:71], v[228:231], v[188:191], v[68:71]
ds_read_b128 v[188:191], v244 offset:17408
v_mfma_f32_16x16x32_bf16 v[52:55], v[220:223], v[192:195], v[52:55]
v_mfma_f32_16x16x32_bf16 v[72:75], v[228:231], v[192:195], v[72:75]
ds_read_b128 v[192:195], v244 offset:18432
v_mfma_f32_16x16x32_bf16 v[56:59], v[220:223], v[196:199], v[56:59]
v_mfma_f32_16x16x32_bf16 v[76:79], v[228:231], v[196:199], v[76:79]
ds_read_b128 v[196:199], v244 offset:19456
s_waitcnt lgkmcnt(10)
v_mfma_f32_16x16x32_bf16 v[0:3], v[200:203], v[160:163], v[0:3]
s_waitcnt lgkmcnt(7)
v_mfma_f32_16x16x32_bf16 v[20:23], v[208:211], v[160:163], v[20:23]
v_mfma_f32_16x16x32_bf16 v[4:7], v[200:203], v[164:167], v[4:7]
v_mfma_f32_16x16x32_bf16 v[24:27], v[208:211], v[164:167], v[24:27]
v_mfma_f32_16x16x32_bf16 v[8:11], v[200:203], v[168:171], v[8:11]
s_waitcnt vmcnt(4)
s_waitcnt lgkmcnt(6)
s_barrier
v_mfma_f32_16x16x32_bf16 v[28:31], v[208:211], v[168:171], v[28:31]
ds_read_b128 v[216:219], v240 offset:6144
ds_read_b128 v[220:223], v241 offset:6144
v_mfma_f32_16x16x32_bf16 v[12:15], v[200:203], v[172:175], v[12:15]
v_mfma_f32_16x16x32_bf16 v[32:35], v[208:211], v[172:175], v[32:35]
ds_read_b128 v[224:227], v240 offset:38912
ds_read_b128 v[228:231], v241 offset:38912
s_waitcnt lgkmcnt(9)
v_mfma_f32_16x16x32_bf16 v[16:19], v[200:203], v[176:179], v[16:19]
v_mfma_f32_16x16x32_bf16 v[36:39], v[208:211], v[176:179], v[36:39]
s_mov_b32 m0, s5
s_add_u32 s9, s69, 0
buffer_load_dwordx4 v232, s[24:27], s9 offen nt lds
s_add_u32 s8, s69, 3072
buffer_load_dwordx4 v232, s[24:27], s8 offen offset:1024 nt lds
s_waitcnt lgkmcnt(8)
v_mfma_f32_16x16x32_bf16 v[0:3], v[204:207], v[180:183], v[0:3]
v_mfma_f32_16x16x32_bf16 v[20:23], v[212:215], v[180:183], v[20:23]
s_waitcnt lgkmcnt(7)
v_mfma_f32_16x16x32_bf16 v[4:7], v[204:207], v[184:187], v[4:7]
v_mfma_f32_16x16x32_bf16 v[24:27], v[212:215], v[184:187], v[24:27]
s_waitcnt lgkmcnt(6)
v_mfma_f32_16x16x32_bf16 v[8:11], v[204:207], v[188:191], v[8:11]
v_mfma_f32_16x16x32_bf16 v[28:31], v[212:215], v[188:191], v[28:31]
s_waitcnt lgkmcnt(5)
v_mfma_f32_16x16x32_bf16 v[12:15], v[204:207], v[192:195], v[12:15]
v_mfma_f32_16x16x32_bf16 v[32:35], v[212:215], v[192:195], v[32:35]
s_waitcnt lgkmcnt(4)
v_mfma_f32_16x16x32_bf16 v[16:19], v[204:207], v[196:199], v[16:19]
v_mfma_f32_16x16x32_bf16 v[36:39], v[212:215], v[196:199], v[36:39]
s_waitcnt lgkmcnt(3)
v_mfma_f32_16x16x32_bf16 v[40:43], v[216:219], v[160:163], v[40:43]
s_waitcnt lgkmcnt(1)
v_mfma_f32_16x16x32_bf16 v[60:63], v[224:227], v[160:163], v[60:63]
ds_read_b128 v[160:163], v244 offset:20480
v_mfma_f32_16x16x32_bf16 v[44:47], v[216:219], v[164:167], v[44:47]
v_mfma_f32_16x16x32_bf16 v[64:67], v[224:227], v[164:167], v[64:67]
ds_read_b128 v[164:167], v244 offset:21504
v_mfma_f32_16x16x32_bf16 v[48:51], v[216:219], v[168:171], v[48:51]
s_waitcnt vmcnt(4)
s_waitcnt lgkmcnt(2)
s_barrier
v_mfma_f32_16x16x32_bf16 v[68:71], v[224:227], v[168:171], v[68:71]
ds_read_b128 v[168:171], v244 offset:22528
ds_read_b128 v[200:203], v240 offset:0
ds_read_b128 v[204:207], v241 offset:0
v_mfma_f32_16x16x32_bf16 v[52:55], v[216:219], v[172:175], v[52:55]
v_mfma_f32_16x16x32_bf16 v[72:75], v[224:227], v[172:175], v[72:75]
ds_read_b128 v[172:175], v244 offset:23552
ds_read_b128 v[208:211], v240 offset:32768
ds_read_b128 v[212:215], v241 offset:32768
v_mfma_f32_16x16x32_bf16 v[56:59], v[216:219], v[176:179], v[56:59]
v_mfma_f32_16x16x32_bf16 v[76:79], v[224:227], v[176:179], v[76:79]
ds_read_b128 v[176:179], v244 offset:24576
s_mov_b32 m0, s5
s_add_u32 s9, s69, 14336
buffer_load_dwordx4 v232, s[24:27], s9 offen offset:2048 nt lds
s_add_u32 s8, s69, 17408
buffer_load_dwordx4 v232, s[24:27], s8 offen offset:3072 nt lds
v_mfma_f32_16x16x32_bf16 v[40:43], v[220:223], v[180:183], v[40:43]
v_mfma_f32_16x16x32_bf16 v[60:63], v[228:231], v[180:183], v[60:63]
ds_read_b128 v[180:183], v244 offset:25600
v_mfma_f32_16x16x32_bf16 v[44:47], v[220:223], v[184:187], v[44:47]
v_mfma_f32_16x16x32_bf16 v[64:67], v[228:231], v[184:187], v[64:67]
ds_read_b128 v[184:187], v244 offset:26624
v_mfma_f32_16x16x32_bf16 v[48:51], v[220:223], v[188:191], v[48:51]
v_mfma_f32_16x16x32_bf16 v[68:71], v[228:231], v[188:191], v[68:71]
ds_read_b128 v[188:191], v244 offset:27648
v_mfma_f32_16x16x32_bf16 v[52:55], v[220:223], v[192:195], v[52:55]
v_mfma_f32_16x16x32_bf16 v[72:75], v[228:231], v[192:195], v[72:75]
ds_read_b128 v[192:195], v244 offset:28672
v_mfma_f32_16x16x32_bf16 v[56:59], v[220:223], v[196:199], v[56:59]
v_mfma_f32_16x16x32_bf16 v[76:79], v[228:231], v[196:199], v[76:79]
ds_read_b128 v[196:199], v244 offset:29696
s_waitcnt lgkmcnt(10)
v_mfma_f32_16x16x32_bf16 v[0:3], v[200:203], v[160:163], v[0:3]
s_waitcnt lgkmcnt(7)
v_mfma_f32_16x16x32_bf16 v[20:23], v[208:211], v[160:163], v[20:23]
v_mfma_f32_16x16x32_bf16 v[4:7], v[200:203], v[164:167], v[4:7]
v_mfma_f32_16x16x32_bf16 v[24:27], v[208:211], v[164:167], v[24:27]
v_mfma_f32_16x16x32_bf16 v[8:11], v[200:203], v[168:171], v[8:11]
s_waitcnt vmcnt(4)
s_waitcnt lgkmcnt(6)
s_barrier
v_mfma_f32_16x16x32_bf16 v[28:31], v[208:211], v[168:171], v[28:31]
ds_read_b128 v[216:219], v240 offset:2048
ds_read_b128 v[220:223], v241 offset:2048
v_mfma_f32_16x16x32_bf16 v[12:15], v[200:203], v[172:175], v[12:15]
v_mfma_f32_16x16x32_bf16 v[32:35], v[208:211], v[172:175], v[32:35]
ds_read_b128 v[224:227], v240 offset:34816
ds_read_b128 v[228:231], v241 offset:34816
s_waitcnt lgkmcnt(9)
v_mfma_f32_16x16x32_bf16 v[16:19], v[200:203], v[176:179], v[16:19]
v_mfma_f32_16x16x32_bf16 v[36:39], v[208:211], v[176:179], v[36:39]
s_mov_b32 m0, s4
s_add_u32 s9, s66, 131072
buffer_load_dwordx4 v232, s[24:27], s9 offen nt lds
s_add_u32 s8, s66, 134144
buffer_load_dwordx4 v232, s[24:27], s8 offen offset:1024 nt lds
s_waitcnt lgkmcnt(8)
v_mfma_f32_16x16x32_bf16 v[0:3], v[204:207], v[180:183], v[0:3]
v_mfma_f32_16x16x32_bf16 v[20:23], v[212:215], v[180:183], v[20:23]
s_waitcnt lgkmcnt(7)
v_mfma_f32_16x16x32_bf16 v[4:7], v[204:207], v[184:187], v[4:7]
v_mfma_f32_16x16x32_bf16 v[24:27], v[212:215], v[184:187], v[24:27]
s_waitcnt lgkmcnt(6)
v_mfma_f32_16x16x32_bf16 v[8:11], v[204:207], v[188:191], v[8:11]
v_mfma_f32_16x16x32_bf16 v[28:31], v[212:215], v[188:191], v[28:31]
s_waitcnt lgkmcnt(5)
v_mfma_f32_16x16x32_bf16 v[12:15], v[204:207], v[192:195], v[12:15]
v_mfma_f32_16x16x32_bf16 v[32:35], v[212:215], v[192:195], v[32:35]
s_waitcnt lgkmcnt(4)
v_mfma_f32_16x16x32_bf16 v[16:19], v[204:207], v[196:199], v[16:19]
v_mfma_f32_16x16x32_bf16 v[36:39], v[212:215], v[196:199], v[36:39]
s_waitcnt lgkmcnt(3)
v_mfma_f32_16x16x32_bf16 v[40:43], v[216:219], v[160:163], v[40:43]
s_waitcnt lgkmcnt(1)
v_mfma_f32_16x16x32_bf16 v[60:63], v[224:227], v[160:163], v[60:63]
ds_read_b128 v[160:163], v244 offset:30720
v_mfma_f32_16x16x32_bf16 v[44:47], v[216:219], v[164:167], v[44:47]
v_mfma_f32_16x16x32_bf16 v[64:67], v[224:227], v[164:167], v[64:67]
ds_read_b128 v[164:167], v244 offset:31744
v_mfma_f32_16x16x32_bf16 v[48:51], v[216:219], v[168:171], v[48:51]
s_waitcnt vmcnt(4)
s_waitcnt lgkmcnt(2)
s_barrier
v_mfma_f32_16x16x32_bf16 v[68:71], v[224:227], v[168:171], v[68:71]
ds_read_b128 v[168:171], v244 offset:32768
ds_read_b128 v[200:203], v240 offset:4096
ds_read_b128 v[204:207], v241 offset:4096
v_mfma_f32_16x16x32_bf16 v[52:55], v[216:219], v[172:175], v[52:55]
v_mfma_f32_16x16x32_bf16 v[72:75], v[224:227], v[172:175], v[72:75]
ds_read_b128 v[172:175], v244 offset:33792
ds_read_b128 v[208:211], v240 offset:36864
ds_read_b128 v[212:215], v241 offset:36864
v_mfma_f32_16x16x32_bf16 v[56:59], v[216:219], v[176:179], v[56:59]
v_mfma_f32_16x16x32_bf16 v[76:79], v[224:227], v[176:179], v[76:79]
ds_read_b128 v[176:179], v244 offset:34816
s_mov_b32 m0, s4
s_add_u32 s9, s66, 145408
buffer_load_dwordx4 v232, s[24:27], s9 offen offset:2048 nt lds
s_add_u32 s8, s66, 148480
buffer_load_dwordx4 v232, s[24:27], s8 offen offset:3072 nt lds
v_mfma_f32_16x16x32_bf16 v[40:43], v[220:223], v[180:183], v[40:43]
v_mfma_f32_16x16x32_bf16 v[60:63], v[228:231], v[180:183], v[60:63]
ds_read_b128 v[180:183], v244 offset:35840
v_mfma_f32_16x16x32_bf16 v[44:47], v[220:223], v[184:187], v[44:47]
v_mfma_f32_16x16x32_bf16 v[64:67], v[228:231], v[184:187], v[64:67]
ds_read_b128 v[184:187], v244 offset:36864
v_mfma_f32_16x16x32_bf16 v[48:51], v[220:223], v[188:191], v[48:51]
v_mfma_f32_16x16x32_bf16 v[68:71], v[228:231], v[188:191], v[68:71]
ds_read_b128 v[188:191], v244 offset:37888
v_mfma_f32_16x16x32_bf16 v[52:55], v[220:223], v[192:195], v[52:55]
v_mfma_f32_16x16x32_bf16 v[72:75], v[228:231], v[192:195], v[72:75]
ds_read_b128 v[192:195], v244 offset:38912
v_mfma_f32_16x16x32_bf16 v[56:59], v[220:223], v[196:199], v[56:59]
v_mfma_f32_16x16x32_bf16 v[76:79], v[228:231], v[196:199], v[76:79]
ds_read_b128 v[196:199], v244 offset:39936
s_waitcnt lgkmcnt(10)
v_mfma_f32_16x16x32_bf16 v[0:3], v[200:203], v[160:163], v[0:3]
s_waitcnt lgkmcnt(7)
v_mfma_f32_16x16x32_bf16 v[20:23], v[208:211], v[160:163], v[20:23]
v_mfma_f32_16x16x32_bf16 v[4:7], v[200:203], v[164:167], v[4:7]
v_mfma_f32_16x16x32_bf16 v[24:27], v[208:211], v[164:167], v[24:27]
v_mfma_f32_16x16x32_bf16 v[8:11], v[200:203], v[168:171], v[8:11]
s_waitcnt vmcnt(4)
s_waitcnt lgkmcnt(6)
s_barrier
v_mfma_f32_16x16x32_bf16 v[28:31], v[208:211], v[168:171], v[28:31]
ds_read_b128 v[216:219], v240 offset:6144
ds_read_b128 v[220:223], v241 offset:6144
v_mfma_f32_16x16x32_bf16 v[12:15], v[200:203], v[172:175], v[12:15]
v_mfma_f32_16x16x32_bf16 v[32:35], v[208:211], v[172:175], v[32:35]
ds_read_b128 v[224:227], v240 offset:38912
ds_read_b128 v[228:231], v241 offset:38912
s_waitcnt lgkmcnt(9)
v_mfma_f32_16x16x32_bf16 v[16:19], v[200:203], v[176:179], v[16:19]
v_mfma_f32_16x16x32_bf16 v[36:39], v[208:211], v[176:179], v[36:39]
s_mov_b32 m0, s5
s_add_u32 s9, s67, 131072
buffer_load_dwordx4 v232, s[24:27], s9 offen nt lds
s_add_u32 s8, s67, 134144
buffer_load_dwordx4 v232, s[24:27], s8 offen offset:1024 nt lds
s_waitcnt lgkmcnt(8)
v_mfma_f32_16x16x32_bf16 v[0:3], v[204:207], v[180:183], v[0:3]
v_mfma_f32_16x16x32_bf16 v[20:23], v[212:215], v[180:183], v[20:23]
s_waitcnt lgkmcnt(7)
v_mfma_f32_16x16x32_bf16 v[4:7], v[204:207], v[184:187], v[4:7]
v_mfma_f32_16x16x32_bf16 v[24:27], v[212:215], v[184:187], v[24:27]
s_waitcnt lgkmcnt(6)
v_mfma_f32_16x16x32_bf16 v[8:11], v[204:207], v[188:191], v[8:11]
v_mfma_f32_16x16x32_bf16 v[28:31], v[212:215], v[188:191], v[28:31]
s_waitcnt lgkmcnt(5)
v_mfma_f32_16x16x32_bf16 v[12:15], v[204:207], v[192:195], v[12:15]
v_mfma_f32_16x16x32_bf16 v[32:35], v[212:215], v[192:195], v[32:35]
s_waitcnt lgkmcnt(4)
v_mfma_f32_16x16x32_bf16 v[16:19], v[204:207], v[196:199], v[16:19]
v_mfma_f32_16x16x32_bf16 v[36:39], v[212:215], v[196:199], v[36:39]
s_waitcnt lgkmcnt(3)
v_mfma_f32_16x16x32_bf16 v[40:43], v[216:219], v[160:163], v[40:43]
s_waitcnt lgkmcnt(1)
v_mfma_f32_16x16x32_bf16 v[60:63], v[224:227], v[160:163], v[60:63]
ds_read_b128 v[160:163], v244 offset:0
v_mfma_f32_16x16x32_bf16 v[44:47], v[216:219], v[164:167], v[44:47]
v_mfma_f32_16x16x32_bf16 v[64:67], v[224:227], v[164:167], v[64:67]
ds_read_b128 v[164:167], v244 offset:1024
v_mfma_f32_16x16x32_bf16 v[48:51], v[216:219], v[168:171], v[48:51]
s_waitcnt vmcnt(4)
s_waitcnt lgkmcnt(2)
s_barrier
v_mfma_f32_16x16x32_bf16 v[68:71], v[224:227], v[168:171], v[68:71]
ds_read_b128 v[168:171], v244 offset:2048
ds_read_b128 v[200:203], v240 offset:0
ds_read_b128 v[204:207], v241 offset:0
v_mfma_f32_16x16x32_bf16 v[52:55], v[216:219], v[172:175], v[52:55]
v_mfma_f32_16x16x32_bf16 v[72:75], v[224:227], v[172:175], v[72:75]
ds_read_b128 v[172:175], v244 offset:3072
ds_read_b128 v[208:211], v240 offset:32768
ds_read_b128 v[212:215], v241 offset:32768
v_mfma_f32_16x16x32_bf16 v[56:59], v[216:219], v[176:179], v[56:59]
v_mfma_f32_16x16x32_bf16 v[76:79], v[224:227], v[176:179], v[76:79]
ds_read_b128 v[176:179], v244 offset:4096
s_mov_b32 m0, s5
s_add_u32 s9, s67, 145408
buffer_load_dwordx4 v232, s[24:27], s9 offen offset:2048 nt lds
s_add_u32 s8, s67, 148480
buffer_load_dwordx4 v232, s[24:27], s8 offen offset:3072 nt lds
v_mfma_f32_16x16x32_bf16 v[40:43], v[220:223], v[180:183], v[40:43]
v_mfma_f32_16x16x32_bf16 v[60:63], v[228:231], v[180:183], v[60:63]
ds_read_b128 v[180:183], v244 offset:5120
v_mfma_f32_16x16x32_bf16 v[44:47], v[220:223], v[184:187], v[44:47]
v_mfma_f32_16x16x32_bf16 v[64:67], v[228:231], v[184:187], v[64:67]
ds_read_b128 v[184:187], v244 offset:6144
v_mfma_f32_16x16x32_bf16 v[48:51], v[220:223], v[188:191], v[48:51]
v_mfma_f32_16x16x32_bf16 v[68:71], v[228:231], v[188:191], v[68:71]
ds_read_b128 v[188:191], v244 offset:7168
v_mfma_f32_16x16x32_bf16 v[52:55], v[220:223], v[192:195], v[52:55]
v_mfma_f32_16x16x32_bf16 v[72:75], v[228:231], v[192:195], v[72:75]
ds_read_b128 v[192:195], v244 offset:8192
v_mfma_f32_16x16x32_bf16 v[56:59], v[220:223], v[196:199], v[56:59]
v_mfma_f32_16x16x32_bf16 v[76:79], v[228:231], v[196:199], v[76:79]
ds_read_b128 v[196:199], v244 offset:9216
s_waitcnt lgkmcnt(10)
v_mfma_f32_16x16x32_bf16 v[80:83], v[200:203], v[160:163], 0
s_waitcnt lgkmcnt(7)
v_mfma_f32_16x16x32_bf16 v[100:103], v[208:211], v[160:163], 0
v_mfma_f32_16x16x32_bf16 v[84:87], v[200:203], v[164:167], 0
v_mfma_f32_16x16x32_bf16 v[104:107], v[208:211], v[164:167], 0
v_mfma_f32_16x16x32_bf16 v[88:91], v[200:203], v[168:171], 0
s_waitcnt vmcnt(4)
s_waitcnt lgkmcnt(6)
s_barrier
v_mfma_f32_16x16x32_bf16 v[108:111], v[208:211], v[168:171], 0
ds_read_b128 v[216:219], v240 offset:2048
ds_read_b128 v[220:223], v241 offset:2048
v_mfma_f32_16x16x32_bf16 v[92:95], v[200:203], v[172:175], 0
v_mfma_f32_16x16x32_bf16 v[112:115], v[208:211], v[172:175], 0
ds_read_b128 v[224:227], v240 offset:34816
ds_read_b128 v[228:231], v241 offset:34816
s_waitcnt lgkmcnt(9)
v_mfma_f32_16x16x32_bf16 v[96:99], v[200:203], v[176:179], 0
v_mfma_f32_16x16x32_bf16 v[116:119], v[208:211], v[176:179], 0
s_mov_b32 m0, s4
s_add_u32 s9, s68, 131072
buffer_load_dwordx4 v232, s[24:27], s9 offen nt lds
s_add_u32 s8, s68, 134144
buffer_load_dwordx4 v232, s[24:27], s8 offen offset:1024 nt lds
s_waitcnt lgkmcnt(8)
v_mfma_f32_16x16x32_bf16 v[80:83], v[204:207], v[180:183], v[80:83]
v_mfma_f32_16x16x32_bf16 v[100:103], v[212:215], v[180:183], v[100:103]
s_waitcnt lgkmcnt(7)
v_mfma_f32_16x16x32_bf16 v[84:87], v[204:207], v[184:187], v[84:87]
v_mfma_f32_16x16x32_bf16 v[104:107], v[212:215], v[184:187], v[104:107]
s_waitcnt lgkmcnt(6)
v_mfma_f32_16x16x32_bf16 v[88:91], v[204:207], v[188:191], v[88:91]
v_mfma_f32_16x16x32_bf16 v[108:111], v[212:215], v[188:191], v[108:111]
v_max_f32 v246, v0, v1
s_waitcnt lgkmcnt(5)
v_mfma_f32_16x16x32_bf16 v[92:95], v[204:207], v[192:195], v[92:95]
v_mfma_f32_16x16x32_bf16 v[112:115], v[212:215], v[192:195], v[112:115]
v_max_f32 v247, v4, v5
s_waitcnt lgkmcnt(4)
v_mfma_f32_16x16x32_bf16 v[96:99], v[204:207], v[196:199], v[96:99]
v_mfma_f32_16x16x32_bf16 v[116:119], v[212:215], v[196:199], v[116:119]
v_max_f32 v248, v8, v9
s_waitcnt lgkmcnt(3)
v_mfma_f32_16x16x32_bf16 v[120:123], v[216:219], v[160:163], 0
s_waitcnt lgkmcnt(1)
v_mfma_f32_16x16x32_bf16 v[140:143], v[224:227], v[160:163], 0
v_max_f32 v249, v12, v13
ds_read_b128 v[160:163], v244 offset:10240
v_mfma_f32_16x16x32_bf16 v[124:127], v[216:219], v[164:167], 0
v_mfma_f32_16x16x32_bf16 v[144:147], v[224:227], v[164:167], 0
v_max_f32 v250, v16, v17
ds_read_b128 v[164:167], v244 offset:11264
v_mfma_f32_16x16x32_bf16 v[128:131], v[216:219], v[168:171], 0
s_waitcnt vmcnt(4)
s_waitcnt lgkmcnt(2)
s_barrier
v_mfma_f32_16x16x32_bf16 v[148:151], v[224:227], v[168:171], 0
v_max3_f32 v246, v246, v2, v3
ds_read_b128 v[168:171], v244 offset:12288
ds_read_b128 v[200:203], v240 offset:4096
ds_read_b128 v[204:207], v241 offset:4096
v_mfma_f32_16x16x32_bf16 v[132:135], v[216:219], v[172:175], 0
v_mfma_f32_16x16x32_bf16 v[152:155], v[224:227], v[172:175], 0
v_max3_f32 v247, v247, v6, v7
ds_read_b128 v[172:175], v244 offset:13312
ds_read_b128 v[208:211], v240 offset:36864
ds_read_b128 v[212:215], v241 offset:36864
v_mfma_f32_16x16x32_bf16 v[136:139], v[216:219], v[176:179], 0
v_mfma_f32_16x16x32_bf16 v[156:159], v[224:227], v[176:179], 0
v_max3_f32 v248, v248, v10, v11
ds_read_b128 v[176:179], v244 offset:14336
s_mov_b32 m0, s4
s_add_u32 s9, s68, 145408
buffer_load_dwordx4 v232, s[24:27], s9 offen offset:2048 nt lds
s_add_u32 s8, s68, 148480
buffer_load_dwordx4 v232, s[24:27], s8 offen offset:3072 nt lds
v_mfma_f32_16x16x32_bf16 v[120:123], v[220:223], v[180:183], v[120:123]
v_mfma_f32_16x16x32_bf16 v[140:143], v[228:231], v[180:183], v[140:143]
v_max3_f32 v249, v249, v14, v15
ds_read_b128 v[180:183], v244 offset:15360
v_mfma_f32_16x16x32_bf16 v[124:127], v[220:223], v[184:187], v[124:127]
v_mfma_f32_16x16x32_bf16 v[144:147], v[228:231], v[184:187], v[144:147]
v_max3_f32 v250, v250, v18, v19
ds_read_b128 v[184:187], v244 offset:16384
v_mfma_f32_16x16x32_bf16 v[128:131], v[220:223], v[188:191], v[128:131]
v_mfma_f32_16x16x32_bf16 v[148:151], v[228:231], v[188:191], v[148:151]
v_max3_f32 v246, v246, v20, v21
ds_read_b128 v[188:191], v244 offset:17408
v_mfma_f32_16x16x32_bf16 v[132:135], v[220:223], v[192:195], v[132:135]
v_mfma_f32_16x16x32_bf16 v[152:155], v[228:231], v[192:195], v[152:155]
v_max3_f32 v247, v247, v24, v25
ds_read_b128 v[192:195], v244 offset:18432
v_mfma_f32_16x16x32_bf16 v[136:139], v[220:223], v[196:199], v[136:139]
v_mfma_f32_16x16x32_bf16 v[156:159], v[228:231], v[196:199], v[156:159]
v_max3_f32 v248, v248, v28, v29
ds_read_b128 v[196:199], v244 offset:19456
s_waitcnt lgkmcnt(10)
v_mfma_f32_16x16x32_bf16 v[80:83], v[200:203], v[160:163], v[80:83]
s_waitcnt lgkmcnt(7)
v_mfma_f32_16x16x32_bf16 v[100:103], v[208:211], v[160:163], v[100:103]
v_max3_f32 v249, v249, v32, v33
v_mfma_f32_16x16x32_bf16 v[84:87], v[200:203], v[164:167], v[84:87]
v_mfma_f32_16x16x32_bf16 v[104:107], v[208:211], v[164:167], v[104:107]
v_max3_f32 v250, v250, v36, v37
v_mfma_f32_16x16x32_bf16 v[88:91], v[200:203], v[168:171], v[88:91]
s_waitcnt vmcnt(4)
s_waitcnt lgkmcnt(6)
s_barrier
v_mfma_f32_16x16x32_bf16 v[108:111], v[208:211], v[168:171], v[108:111]
v_max3_f32 v246, v246, v22, v23
ds_read_b128 v[216:219], v240 offset:6144
ds_read_b128 v[220:223], v241 offset:6144
v_mfma_f32_16x16x32_bf16 v[92:95], v[200:203], v[172:175], v[92:95]
v_mfma_f32_16x16x32_bf16 v[112:115], v[208:211], v[172:175], v[112:115]
v_max3_f32 v247, v247, v26, v27
ds_read_b128 v[224:227], v240 offset:38912
ds_read_b128 v[228:231], v241 offset:38912
s_waitcnt lgkmcnt(9)
v_mfma_f32_16x16x32_bf16 v[96:99], v[200:203], v[176:179], v[96:99]
v_mfma_f32_16x16x32_bf16 v[116:119], v[208:211], v[176:179], v[116:119]
v_max3_f32 v248, v248, v30, v31
s_mov_b32 m0, s5
s_add_u32 s9, s69, 131072
buffer_load_dwordx4 v232, s[24:27], s9 offen nt lds
s_add_u32 s8, s69, 134144
buffer_load_dwordx4 v232, s[24:27], s8 offen offset:1024 nt lds
s_waitcnt lgkmcnt(8)
v_mfma_f32_16x16x32_bf16 v[80:83], v[204:207], v[180:183], v[80:83]
v_mfma_f32_16x16x32_bf16 v[100:103], v[212:215], v[180:183], v[100:103]
v_max3_f32 v249, v249, v34, v35
s_waitcnt lgkmcnt(7)
v_mfma_f32_16x16x32_bf16 v[84:87], v[204:207], v[184:187], v[84:87]
v_mfma_f32_16x16x32_bf16 v[104:107], v[212:215], v[184:187], v[104:107]
v_max3_f32 v250, v250, v38, v39
s_waitcnt lgkmcnt(6)
v_mfma_f32_16x16x32_bf16 v[88:91], v[204:207], v[188:191], v[88:91]
v_mfma_f32_16x16x32_bf16 v[108:111], v[212:215], v[188:191], v[108:111]
v_max3_f32 v246, v246, v40, v41
s_waitcnt lgkmcnt(5)
v_mfma_f32_16x16x32_bf16 v[92:95], v[204:207], v[192:195], v[92:95]
v_mfma_f32_16x16x32_bf16 v[112:115], v[212:215], v[192:195], v[112:115]
v_max3_f32 v247, v247, v44, v45
s_waitcnt lgkmcnt(4)
v_mfma_f32_16x16x32_bf16 v[96:99], v[204:207], v[196:199], v[96:99]
v_mfma_f32_16x16x32_bf16 v[116:119], v[212:215], v[196:199], v[116:119]
v_max3_f32 v248, v248, v48, v49
s_waitcnt lgkmcnt(3)
v_mfma_f32_16x16x32_bf16 v[120:123], v[216:219], v[160:163], v[120:123]
s_waitcnt lgkmcnt(1)
v_mfma_f32_16x16x32_bf16 v[140:143], v[224:227], v[160:163], v[140:143]
v_max3_f32 v249, v249, v52, v53
ds_read_b128 v[160:163], v244 offset:20480
v_mfma_f32_16x16x32_bf16 v[124:127], v[216:219], v[164:167], v[124:127]
v_mfma_f32_16x16x32_bf16 v[144:147], v[224:227], v[164:167], v[144:147]
v_max3_f32 v250, v250, v56, v57
ds_read_b128 v[164:167], v244 offset:21504
v_mfma_f32_16x16x32_bf16 v[128:131], v[216:219], v[168:171], v[128:131]
s_waitcnt vmcnt(4)
s_waitcnt lgkmcnt(2)
s_barrier
v_mfma_f32_16x16x32_bf16 v[148:151], v[224:227], v[168:171], v[148:151]
v_max3_f32 v246, v246, v42, v43
ds_read_b128 v[168:171], v244 offset:22528
ds_read_b128 v[200:203], v240 offset:0
ds_read_b128 v[204:207], v241 offset:0
v_mfma_f32_16x16x32_bf16 v[132:135], v[216:219], v[172:175], v[132:135]
v_mfma_f32_16x16x32_bf16 v[152:155], v[224:227], v[172:175], v[152:155]
v_max3_f32 v247, v247, v46, v47
ds_read_b128 v[172:175], v244 offset:23552
ds_read_b128 v[208:211], v240 offset:32768
ds_read_b128 v[212:215], v241 offset:32768
v_mfma_f32_16x16x32_bf16 v[136:139], v[216:219], v[176:179], v[136:139]
v_mfma_f32_16x16x32_bf16 v[156:159], v[224:227], v[176:179], v[156:159]
v_max3_f32 v248, v248, v50, v51
ds_read_b128 v[176:179], v244 offset:24576
s_mov_b32 m0, s5
s_add_u32 s9, s69, 145408
buffer_load_dwordx4 v232, s[24:27], s9 offen offset:2048 nt lds
s_add_u32 s8, s69, 148480
buffer_load_dwordx4 v232, s[24:27], s8 offen offset:3072 nt lds
v_mfma_f32_16x16x32_bf16 v[120:123], v[220:223], v[180:183], v[120:123]
v_mfma_f32_16x16x32_bf16 v[140:143], v[228:231], v[180:183], v[140:143]
v_max3_f32 v249, v249, v54, v55
ds_read_b128 v[180:183], v244 offset:25600
v_mfma_f32_16x16x32_bf16 v[124:127], v[220:223], v[184:187], v[124:127]
v_mfma_f32_16x16x32_bf16 v[144:147], v[228:231], v[184:187], v[144:147]
v_max3_f32 v250, v250, v58, v59
ds_read_b128 v[184:187], v244 offset:26624
v_mfma_f32_16x16x32_bf16 v[128:131], v[220:223], v[188:191], v[128:131]
v_mfma_f32_16x16x32_bf16 v[148:151], v[228:231], v[188:191], v[148:151]
v_max3_f32 v246, v246, v60, v61
ds_read_b128 v[188:191], v244 offset:27648
v_mfma_f32_16x16x32_bf16 v[132:135], v[220:223], v[192:195], v[132:135]
v_mfma_f32_16x16x32_bf16 v[152:155], v[228:231], v[192:195], v[152:155]
v_max3_f32 v247, v247, v64, v65
ds_read_b128 v[192:195], v244 offset:28672
v_mfma_f32_16x16x32_bf16 v[136:139], v[220:223], v[196:199], v[136:139]
v_mfma_f32_16x16x32_bf16 v[156:159], v[228:231], v[196:199], v[156:159]
v_max3_f32 v248, v248, v68, v69
ds_read_b128 v[196:199], v244 offset:29696
s_waitcnt lgkmcnt(10)
v_mfma_f32_16x16x32_bf16 v[80:83], v[200:203], v[160:163], v[80:83]
s_waitcnt lgkmcnt(7)
v_mfma_f32_16x16x32_bf16 v[100:103], v[208:211], v[160:163], v[100:103]
v_max3_f32 v249, v249, v72, v73
v_mfma_f32_16x16x32_bf16 v[84:87], v[200:203], v[164:167], v[84:87]
v_mfma_f32_16x16x32_bf16 v[104:107], v[208:211], v[164:167], v[104:107]
v_max3_f32 v250, v250, v76, v77
v_mfma_f32_16x16x32_bf16 v[88:91], v[200:203], v[168:171], v[88:91]
s_waitcnt vmcnt(4)
s_waitcnt lgkmcnt(6)
s_barrier
v_mfma_f32_16x16x32_bf16 v[108:111], v[208:211], v[168:171], v[108:111]
v_max3_f32 v246, v246, v62, v63
ds_read_b128 v[216:219], v240 offset:2048
ds_read_b128 v[220:223], v241 offset:2048
v_mfma_f32_16x16x32_bf16 v[92:95], v[200:203], v[172:175], v[92:95]
v_mfma_f32_16x16x32_bf16 v[112:115], v[208:211], v[172:175], v[112:115]
v_max3_f32 v247, v247, v66, v67
ds_read_b128 v[224:227], v240 offset:34816
ds_read_b128 v[228:231], v241 offset:34816
s_waitcnt lgkmcnt(9)
v_mfma_f32_16x16x32_bf16 v[96:99], v[200:203], v[176:179], v[96:99]
v_mfma_f32_16x16x32_bf16 v[116:119], v[208:211], v[176:179], v[116:119]
v_max3_f32 v248, v248, v70, v71
s_mov_b32 m0, s4
s_mov_b32 s9, 0
buffer_load_dwordx4 v232, s[28:31], s9 offen nt lds
s_mov_b32 s8, 3072
buffer_load_dwordx4 v232, s[28:31], s8 offen offset:1024 nt lds
s_waitcnt lgkmcnt(8)
v_mfma_f32_16x16x32_bf16 v[80:83], v[204:207], v[180:183], v[80:83]
v_mfma_f32_16x16x32_bf16 v[100:103], v[212:215], v[180:183], v[100:103]
v_max3_f32 v249, v249, v74, v75
s_waitcnt lgkmcnt(7)
v_mfma_f32_16x16x32_bf16 v[84:87], v[204:207], v[184:187], v[84:87]
v_mfma_f32_16x16x32_bf16 v[104:107], v[212:215], v[184:187], v[104:107]
v_max3_f32 v250, v250, v78, v79
s_waitcnt lgkmcnt(6)
v_mfma_f32_16x16x32_bf16 v[88:91], v[204:207], v[188:191], v[88:91]
v_mfma_f32_16x16x32_bf16 v[108:111], v[212:215], v[188:191], v[108:111]
s_waitcnt lgkmcnt(5)
v_mfma_f32_16x16x32_bf16 v[92:95], v[204:207], v[192:195], v[92:95]
v_mfma_f32_16x16x32_bf16 v[112:115], v[212:215], v[192:195], v[112:115]
s_waitcnt lgkmcnt(4)
v_mfma_f32_16x16x32_bf16 v[96:99], v[204:207], v[196:199], v[96:99]
v_mfma_f32_16x16x32_bf16 v[116:119], v[212:215], v[196:199], v[116:119]
s_waitcnt lgkmcnt(3)
v_mfma_f32_16x16x32_bf16 v[120:123], v[216:219], v[160:163], v[120:123]
s_waitcnt lgkmcnt(1)
v_mfma_f32_16x16x32_bf16 v[140:143], v[224:227], v[160:163], v[140:143]
ds_read_b128 v[160:163], v244 offset:30720
v_mfma_f32_16x16x32_bf16 v[124:127], v[216:219], v[164:167], v[124:127]
v_mfma_f32_16x16x32_bf16 v[144:147], v[224:227], v[164:167], v[144:147]
ds_read_b128 v[164:167], v244 offset:31744
v_mfma_f32_16x16x32_bf16 v[128:131], v[216:219], v[168:171], v[128:131]
s_waitcnt vmcnt(4)
s_waitcnt lgkmcnt(2)
s_barrier
v_mfma_f32_16x16x32_bf16 v[148:151], v[224:227], v[168:171], v[148:151]
ds_read_b128 v[168:171], v244 offset:32768
ds_read_b128 v[200:203], v240 offset:4096
ds_read_b128 v[204:207], v241 offset:4096
v_mfma_f32_16x16x32_bf16 v[132:135], v[216:219], v[172:175], v[132:135]
v_mfma_f32_16x16x32_bf16 v[152:155], v[224:227], v[172:175], v[152:155]
ds_read_b128 v[172:175], v244 offset:33792
ds_read_b128 v[208:211], v240 offset:36864
ds_read_b128 v[212:215], v241 offset:36864
v_mfma_f32_16x16x32_bf16 v[136:139], v[216:219], v[176:179], v[136:139]
v_mfma_f32_16x16x32_bf16 v[156:159], v[224:227], v[176:179], v[156:159]
ds_read_b128 v[176:179], v244 offset:34816
s_mov_b32 m0, s4
s_mov_b32 s9, 14336
buffer_load_dwordx4 v232, s[28:31], s9 offen offset:2048 nt lds
s_mov_b32 s8, 17408
buffer_load_dwordx4 v232, s[28:31], s8 offen offset:3072 nt lds
v_mfma_f32_16x16x32_bf16 v[120:123], v[220:223], v[180:183], v[120:123]
v_mfma_f32_16x16x32_bf16 v[140:143], v[228:231], v[180:183], v[140:143]
ds_read_b128 v[180:183], v244 offset:35840
v_mfma_f32_16x16x32_bf16 v[124:127], v[220:223], v[184:187], v[124:127]
v_mfma_f32_16x16x32_bf16 v[144:147], v[228:231], v[184:187], v[144:147]
ds_read_b128 v[184:187], v244 offset:36864
v_mfma_f32_16x16x32_bf16 v[128:131], v[220:223], v[188:191], v[128:131]
v_mfma_f32_16x16x32_bf16 v[148:151], v[228:231], v[188:191], v[148:151]
ds_read_b128 v[188:191], v244 offset:37888
v_mfma_f32_16x16x32_bf16 v[132:135], v[220:223], v[192:195], v[132:135]
v_mfma_f32_16x16x32_bf16 v[152:155], v[228:231], v[192:195], v[152:155]
ds_read_b128 v[192:195], v244 offset:38912
v_mfma_f32_16x16x32_bf16 v[136:139], v[220:223], v[196:199], v[136:139]
v_mfma_f32_16x16x32_bf16 v[156:159], v[228:231], v[196:199], v[156:159]
ds_read_b128 v[196:199], v244 offset:39936
s_waitcnt lgkmcnt(10)
v_mfma_f32_16x16x32_bf16 v[80:83], v[200:203], v[160:163], v[80:83]
s_waitcnt lgkmcnt(7)
v_mfma_f32_16x16x32_bf16 v[100:103], v[208:211], v[160:163], v[100:103]
v_mfma_f32_16x16x32_bf16 v[84:87], v[200:203], v[164:167], v[84:87]
v_mfma_f32_16x16x32_bf16 v[104:107], v[208:211], v[164:167], v[104:107]
v_mfma_f32_16x16x32_bf16 v[88:91], v[200:203], v[168:171], v[88:91]
s_waitcnt vmcnt(4)
s_waitcnt lgkmcnt(6)
s_barrier
v_mfma_f32_16x16x32_bf16 v[108:111], v[208:211], v[168:171], v[108:111]
ds_read_b128 v[216:219], v240 offset:6144
ds_read_b128 v[220:223], v241 offset:6144
v_mfma_f32_16x16x32_bf16 v[92:95], v[200:203], v[172:175], v[92:95]
v_mfma_f32_16x16x32_bf16 v[112:115], v[208:211], v[172:175], v[112:115]
ds_read_b128 v[224:227], v240 offset:38912
ds_read_b128 v[228:231], v241 offset:38912
s_waitcnt lgkmcnt(9)
v_mfma_f32_16x16x32_bf16 v[96:99], v[200:203], v[176:179], v[96:99]
v_mfma_f32_16x16x32_bf16 v[116:119], v[208:211], v[176:179], v[116:119]
s_mov_b32 m0, s5
s_mov_b32 s9, 32768
buffer_load_dwordx4 v232, s[28:31], s9 offen nt lds
s_mov_b32 s8, 35840
buffer_load_dwordx4 v232, s[28:31], s8 offen offset:1024 nt lds
s_waitcnt lgkmcnt(8)
v_mfma_f32_16x16x32_bf16 v[80:83], v[204:207], v[180:183], v[80:83]
v_mfma_f32_16x16x32_bf16 v[100:103], v[212:215], v[180:183], v[100:103]
s_waitcnt lgkmcnt(7)
v_mfma_f32_16x16x32_bf16 v[84:87], v[204:207], v[184:187], v[84:87]
v_mfma_f32_16x16x32_bf16 v[104:107], v[212:215], v[184:187], v[104:107]
s_waitcnt lgkmcnt(6)
v_mfma_f32_16x16x32_bf16 v[88:91], v[204:207], v[188:191], v[88:91]
v_mfma_f32_16x16x32_bf16 v[108:111], v[212:215], v[188:191], v[108:111]
s_waitcnt lgkmcnt(5)
v_mfma_f32_16x16x32_bf16 v[92:95], v[204:207], v[192:195], v[92:95]
v_mfma_f32_16x16x32_bf16 v[112:115], v[212:215], v[192:195], v[112:115]
s_waitcnt lgkmcnt(4)
v_mfma_f32_16x16x32_bf16 v[96:99], v[204:207], v[196:199], v[96:99]
v_mfma_f32_16x16x32_bf16 v[116:119], v[212:215], v[196:199], v[116:119]
s_waitcnt lgkmcnt(3)
v_mfma_f32_16x16x32_bf16 v[120:123], v[216:219], v[160:163], v[120:123]
s_waitcnt lgkmcnt(1)
v_mfma_f32_16x16x32_bf16 v[140:143], v[224:227], v[160:163], v[140:143]
v_mfma_f32_16x16x32_bf16 v[124:127], v[216:219], v[164:167], v[124:127]
v_mfma_f32_16x16x32_bf16 v[144:147], v[224:227], v[164:167], v[144:147]
v_mfma_f32_16x16x32_bf16 v[128:131], v[216:219], v[168:171], v[128:131]
s_waitcnt vmcnt(4)
s_waitcnt lgkmcnt(0)
s_barrier
v_mfma_f32_16x16x32_bf16 v[148:151], v[224:227], v[168:171], v[148:151]
ds_read_b64_tr_b16 v[200:201], v236 offset:0
ds_read_b64_tr_b16 v[204:205], v237 offset:0
ds_read_b64_tr_b16 v[208:209], v238 offset:0
ds_read_b64_tr_b16 v[212:213], v239 offset:0
v_mfma_f32_16x16x32_bf16 v[132:135], v[216:219], v[172:175], v[132:135]
v_mfma_f32_16x16x32_bf16 v[152:155], v[224:227], v[172:175], v[152:155]
ds_read_b64_tr_b16 v[202:203], v236 offset:32768
ds_read_b64_tr_b16 v[206:207], v237 offset:32768
ds_read_b64_tr_b16 v[210:211], v238 offset:32768
ds_read_b64_tr_b16 v[214:215], v239 offset:32768
v_mfma_f32_16x16x32_bf16 v[136:139], v[216:219], v[176:179], v[136:139]
v_mfma_f32_16x16x32_bf16 v[156:159], v[224:227], v[176:179], v[156:159]
s_mov_b32 m0, s5
s_mov_b32 s9, 47104
buffer_load_dwordx4 v232, s[28:31], s9 offen offset:2048 nt lds
s_mov_b32 s8, 50176
buffer_load_dwordx4 v232, s[28:31], s8 offen offset:3072 nt lds
v_mfma_f32_16x16x32_bf16 v[120:123], v[220:223], v[180:183], v[120:123]
v_mfma_f32_16x16x32_bf16 v[140:143], v[228:231], v[180:183], v[140:143]
v_mfma_f32_16x16x32_bf16 v[124:127], v[220:223], v[184:187], v[124:127]
v_mfma_f32_16x16x32_bf16 v[144:147], v[228:231], v[184:187], v[144:147]
v_mfma_f32_16x16x32_bf16 v[128:131], v[220:223], v[188:191], v[128:131]
v_mfma_f32_16x16x32_bf16 v[148:151], v[228:231], v[188:191], v[148:151]
v_mfma_f32_16x16x32_bf16 v[132:135], v[220:223], v[192:195], v[132:135]
v_mfma_f32_16x16x32_bf16 v[152:155], v[228:231], v[192:195], v[152:155]
v_mfma_f32_16x16x32_bf16 v[136:139], v[220:223], v[196:199], v[136:139]
v_mfma_f32_16x16x32_bf16 v[156:159], v[228:231], v[196:199], v[156:159]
s_nop 7
s_cmp_lg_u32 s3, 0
s_cbranch_scc1 L_flBA
s_lshl_b32 s10, s98, 2
v_mov_b32 v228, s10
s_mov_b64 exec, 1
global_load_dword v255, v228, s[86:87] offset:128 sc1
s_mov_b64 exec, -1
L_flBA:
v_max3_f32 v246, v246, v80, v81
v_max3_f32 v247, v247, v84, v85
v_max3_f32 v248, v248, v88, v89
v_max3_f32 v249, v249, v92, v93
v_max3_f32 v250, v250, v96, v97
v_max3_f32 v246, v246, v82, v83
v_max3_f32 v247, v247, v86, v87
v_max3_f32 v248, v248, v90, v91
v_max3_f32 v249, v249, v94, v95
v_max3_f32 v250, v250, v98, v99
v_max3_f32 v246, v246, v100, v101
v_max3_f32 v247, v247, v104, v105
v_max3_f32 v248, v248, v108, v109
v_max3_f32 v249, v249, v112, v113
v_max3_f32 v250, v250, v116, v117
v_max3_f32 v246, v246, v102, v103
v_max3_f32 v247, v247, v106, v107
v_max3_f32 v248, v248, v110, v111
v_max3_f32 v249, v249, v114, v115
v_max3_f32 v250, v250, v118, v119
v_max3_f32 v246, v246, v120, v121
v_max3_f32 v247, v247, v124, v125
v_max3_f32 v248, v248, v128, v129
v_max3_f32 v249, v249, v132, v133
v_max3_f32 v250, v250, v136, v137
v_max3_f32 v246, v246, v122, v123
v_max3_f32 v247, v247, v126, v127
v_max3_f32 v248, v248, v130, v131
v_max3_f32 v249, v249, v134, v135
v_max3_f32 v250, v250, v138, v139
v_max3_f32 v246, v246, v140, v141
v_max3_f32 v247, v247, v144, v145
v_max3_f32 v248, v248, v148, v149
v_max3_f32 v249, v249, v152, v153
v_max3_f32 v250, v250, v156, v157
v_max3_f32 v246, v246, v142, v143
v_max3_f32 v247, v247, v146, v147
v_max3_f32 v248, v248, v150, v151
v_max3_f32 v249, v249, v154, v155
v_max3_f32 v250, v250, v158, v159
v_lshlrev_b32 v217, 4, v235
s_lshl_b32 s10, s14, 11
s_lshl_b32 s11, s15, 2
s_add_u32 s10, s10, s11
s_add_u32 s10, s10, 147456
v_add_u32 v217, s10, v217
v_mov_b32 v216, v250
s_nop 1
v_permlane32_swap_b32 v246, v248
v_permlane32_swap_b32 v247, v249
v_permlane32_swap_b32 v250, v216
v_max_f32 v246, v246, v248
v_max_f32 v247, v247, v249
v_max_f32 v250, v250, v216
v_mov_b32 v216, v250
s_nop 1
v_permlane16_swap_b32 v246, v247
v_permlane16_swap_b32 v250, v216
v_max_f32 v246, v246, v247
v_max_f32 v250, v250, v216
ds_write_b32 v217, v246 offset:0
ds_write_b32 v217, v250 offset:1024
s_waitcnt lgkmcnt(0)
s_barrier
s_mov_b32 m0, s4
s_mov_b32 s9, 65536
buffer_load_dwordx4 v232, s[28:31], s9 offen nt lds
s_mov_b32 s8, 68608
buffer_load_dwordx4 v232, s[28:31], s8 offen offset:1024 nt lds
v_and_b32 v217, 15, v235
v_lshlrev_b32 v217, 4, v217
s_lshl_b32 s10, s14, 11
s_add_u32 s10, s10, 147456
v_add_u32 v217, s10, v217
ds_read_b128 v[160:163], v217 offset:0
ds_read_b128 v[164:167], v217 offset:256
ds_read_b128 v[168:171], v217 offset:512
ds_read_b128 v[172:175], v217 offset:768
ds_read_b128 v[176:179], v217 offset:1024
s_waitcnt lgkmcnt(4)
v_max_f32 v246, v160, v161
v_max3_f32 v246, v246, v162, v163
s_waitcnt lgkmcnt(3)
v_max_f32 v247, v164, v165
v_max3_f32 v247, v247, v166, v167
s_waitcnt lgkmcnt(2)
v_max_f32 v248, v168, v169
v_max3_f32 v248, v248, v170, v171
s_waitcnt lgkmcnt(1)
v_max_f32 v249, v172, v173
v_max3_f32 v249, v249, v174, v175
s_waitcnt lgkmcnt(0)
v_max_f32 v250, v176, v177
v_max3_f32 v250, v250, v178, v179
v_mul_f32 v246, s6, v246
v_mul_f32 v247, s6, v247
v_mul_f32 v248, s6, v248
v_mul_f32 v249, s6, v249
v_mul_f32 v250, s6, v250
v_add_u32 v197, s12, v242
v_pk_fma_f32 v[0:1], v[0:1], s[6:7], v[246:247] op_sel:[0,0,0] op_sel_hi:[1,0,0] neg_lo:[0,0,1] neg_hi:[0,0,1]
v_pk_fma_f32 v[2:3], v[2:3], s[6:7], v[246:247] op_sel:[0,0,0] op_sel_hi:[1,0,0] neg_lo:[0,0,1] neg_hi:[0,0,1]
v_pk_fma_f32 v[20:21], v[20:21], s[6:7], v[246:247] op_sel:[0,0,0] op_sel_hi:[1,0,0] neg_lo:[0,0,1] neg_hi:[0,0,1]
v_pk_fma_f32 v[22:23], v[22:23], s[6:7], v[246:247] op_sel:[0,0,0] op_sel_hi:[1,0,0] neg_lo:[0,0,1] neg_hi:[0,0,1]
v_exp_f32 v0, v0
v_exp_f32 v1, v1
v_exp_f32 v2, v2
v_exp_f32 v3, v3
v_exp_f32 v20, v20
v_exp_f32 v21, v21
v_exp_f32 v22, v22
v_exp_f32 v23, v23
v_pk_add_f32 v[220:221], v[0:1], v[2:3]
v_pk_add_f32 v[222:223], v[20:21], v[22:23]
v_cvt_pk_bf16_f32 v0, v0, v1
v_cvt_pk_bf16_f32 v1, v2, v3
v_cvt_pk_bf16_f32 v2, v20, v21
v_cvt_pk_bf16_f32 v3, v22, v23
v_pk_add_f32 v[220:221], v[220:221], v[222:223]
v_add_f32 v192, v220, v221
ds_write_b128 v197, v[0:3] offset:0
v_pk_fma_f32 v[4:5], v[4:5], s[6:7], v[246:247] op_sel:[0,0,1] op_sel_hi:[1,0,1] neg_lo:[0,0,1] neg_hi:[0,0,1]
v_pk_fma_f32 v[6:7], v[6:7], s[6:7], v[246:247] op_sel:[0,0,1] op_sel_hi:[1,0,1] neg_lo:[0,0,1] neg_hi:[0,0,1]
v_pk_fma_f32 v[24:25], v[24:25], s[6:7], v[246:247] op_sel:[0,0,1] op_sel_hi:[1,0,1] neg_lo:[0,0,1] neg_hi:[0,0,1]
v_pk_fma_f32 v[26:27], v[26:27], s[6:7], v[246:247] op_sel:[0,0,1] op_sel_hi:[1,0,1] neg_lo:[0,0,1] neg_hi:[0,0,1]
v_exp_f32 v4, v4
v_exp_f32 v5, v5
v_exp_f32 v6, v6
v_exp_f32 v7, v7
v_exp_f32 v24, v24
v_exp_f32 v25, v25
v_exp_f32 v26, v26
v_exp_f32 v27, v27
v_pk_add_f32 v[224:225], v[4:5], v[6:7]
v_pk_add_f32 v[226:227], v[24:25], v[26:27]
v_cvt_pk_bf16_f32 v4, v4, v5
v_cvt_pk_bf16_f32 v5, v6, v7
v_cvt_pk_bf16_f32 v6, v24, v25
v_cvt_pk_bf16_f32 v7, v26, v27
v_pk_add_f32 v[224:225], v[224:225], v[226:227]
v_add_f32 v193, v224, v225
ds_write_b128 v197, v[4:7] offset:1024
v_pk_fma_f32 v[8:9], v[8:9], s[6:7], v[248:249] op_sel:[0,0,0] op_sel_hi:[1,0,0] neg_lo:[0,0,1] neg_hi:[0,0,1]
v_pk_fma_f32 v[10:11], v[10:11], s[6:7], v[248:249] op_sel:[0,0,0] op_sel_hi:[1,0,0] neg_lo:[0,0,1] neg_hi:[0,0,1]
v_pk_fma_f32 v[28:29], v[28:29], s[6:7], v[248:249] op_sel:[0,0,0] op_sel_hi:[1,0,0] neg_lo:[0,0,1] neg_hi:[0,0,1]
v_pk_fma_f32 v[30:31], v[30:31], s[6:7], v[248:249] op_sel:[0,0,0] op_sel_hi:[1,0,0] neg_lo:[0,0,1] neg_hi:[0,0,1]
v_exp_f32 v8, v8
v_exp_f32 v9, v9
v_exp_f32 v10, v10
v_exp_f32 v11, v11
v_exp_f32 v28, v28
v_exp_f32 v29, v29
v_exp_f32 v30, v30
v_exp_f32 v31, v31
v_pk_add_f32 v[220:221], v[8:9], v[10:11]
v_pk_add_f32 v[222:223], v[28:29], v[30:31]
v_cvt_pk_bf16_f32 v8, v8, v9
v_cvt_pk_bf16_f32 v9, v10, v11
v_cvt_pk_bf16_f32 v10, v28, v29
v_cvt_pk_bf16_f32 v11, v30, v31
v_pk_add_f32 v[220:221], v[220:221], v[222:223]
v_add_f32 v194, v220, v221
ds_write_b128 v197, v[8:11] offset:2048
v_pk_fma_f32 v[12:13], v[12:13], s[6:7], v[248:249] op_sel:[0,0,1] op_sel_hi:[1,0,1] neg_lo:[0,0,1] neg_hi:[0,0,1]
v_pk_fma_f32 v[14:15], v[14:15], s[6:7], v[248:249] op_sel:[0,0,1] op_sel_hi:[1,0,1] neg_lo:[0,0,1] neg_hi:[0,0,1]
v_pk_fma_f32 v[32:33], v[32:33], s[6:7], v[248:249] op_sel:[0,0,1] op_sel_hi:[1,0,1] neg_lo:[0,0,1] neg_hi:[0,0,1]
v_pk_fma_f32 v[34:35], v[34:35], s[6:7], v[248:249] op_sel:[0,0,1] op_sel_hi:[1,0,1] neg_lo:[0,0,1] neg_hi:[0,0,1]
v_exp_f32 v12, v12
v_exp_f32 v13, v13
v_exp_f32 v14, v14
v_exp_f32 v15, v15
v_exp_f32 v32, v32
v_exp_f32 v33, v33
v_exp_f32 v34, v34
v_exp_f32 v35, v35
v_pk_add_f32 v[224:225], v[12:13], v[14:15]
v_pk_add_f32 v[226:227], v[32:33], v[34:35]
v_cvt_pk_bf16_f32 v12, v12, v13
v_cvt_pk_bf16_f32 v13, v14, v15
v_cvt_pk_bf16_f32 v14, v32, v33
v_cvt_pk_bf16_f32 v15, v34, v35
v_pk_add_f32 v[224:225], v[224:225], v[226:227]
v_add_f32 v195, v224, v225
ds_write_b128 v197, v[12:15] offset:3072
v_pk_fma_f32 v[16:17], v[16:17], s[6:7], v[250:251] op_sel:[0,0,0] op_sel_hi:[1,0,0] neg_lo:[0,0,1] neg_hi:[0,0,1]
v_pk_fma_f32 v[18:19], v[18:19], s[6:7], v[250:251] op_sel:[0,0,0] op_sel_hi:[1,0,0] neg_lo:[0,0,1] neg_hi:[0,0,1]
v_pk_fma_f32 v[36:37], v[36:37], s[6:7], v[250:251] op_sel:[0,0,0] op_sel_hi:[1,0,0] neg_lo:[0,0,1] neg_hi:[0,0,1]
v_pk_fma_f32 v[38:39], v[38:39], s[6:7], v[250:251] op_sel:[0,0,0] op_sel_hi:[1,0,0] neg_lo:[0,0,1] neg_hi:[0,0,1]
v_exp_f32 v16, v16
v_exp_f32 v17, v17
v_exp_f32 v18, v18
v_exp_f32 v19, v19
v_exp_f32 v36, v36
v_exp_f32 v37, v37
v_exp_f32 v38, v38
v_exp_f32 v39, v39
v_pk_add_f32 v[220:221], v[16:17], v[18:19]
v_pk_add_f32 v[222:223], v[36:37], v[38:39]
v_cvt_pk_bf16_f32 v16, v16, v17
v_cvt_pk_bf16_f32 v17, v18, v19
v_cvt_pk_bf16_f32 v18, v36, v37
v_cvt_pk_bf16_f32 v19, v38, v39
v_pk_add_f32 v[220:221], v[220:221], v[222:223]
v_add_f32 v196, v220, v221
ds_write_b128 v197, v[16:19] offset:4096
v_pk_fma_f32 v[40:41], v[40:41], s[6:7], v[246:247] op_sel:[0,0,0] op_sel_hi:[1,0,0] neg_lo:[0,0,1] neg_hi:[0,0,1]
v_pk_fma_f32 v[42:43], v[42:43], s[6:7], v[246:247] op_sel:[0,0,0] op_sel_hi:[1,0,0] neg_lo:[0,0,1] neg_hi:[0,0,1]
v_pk_fma_f32 v[60:61], v[60:61], s[6:7], v[246:247] op_sel:[0,0,0] op_sel_hi:[1,0,0] neg_lo:[0,0,1] neg_hi:[0,0,1]
v_pk_fma_f32 v[62:63], v[62:63], s[6:7], v[246:247] op_sel:[0,0,0] op_sel_hi:[1,0,0] neg_lo:[0,0,1] neg_hi:[0,0,1]
v_exp_f32 v40, v40
v_exp_f32 v41, v41
v_exp_f32 v42, v42
v_exp_f32 v43, v43
v_exp_f32 v60, v60
v_exp_f32 v61, v61
v_exp_f32 v62, v62
v_exp_f32 v63, v63
v_pk_add_f32 v[224:225], v[40:41], v[42:43]
v_pk_add_f32 v[226:227], v[60:61], v[62:63]
v_cvt_pk_bf16_f32 v40, v40, v41
v_cvt_pk_bf16_f32 v41, v42, v43
v_cvt_pk_bf16_f32 v42, v60, v61
v_cvt_pk_bf16_f32 v43, v62, v63
v_pk_add_f32 v[224:225], v[224:225], v[226:227]
v_add_f32 v192, v192, v224
v_add_f32 v192, v192, v225
ds_write_b128 v197, v[40:43] offset:5120
v_pk_fma_f32 v[44:45], v[44:45], s[6:7], v[246:247] op_sel:[0,0,1] op_sel_hi:[1,0,1] neg_lo:[0,0,1] neg_hi:[0,0,1]
v_pk_fma_f32 v[46:47], v[46:47], s[6:7], v[246:247] op_sel:[0,0,1] op_sel_hi:[1,0,1] neg_lo:[0,0,1] neg_hi:[0,0,1]
v_pk_fma_f32 v[64:65], v[64:65], s[6:7], v[246:247] op_sel:[0,0,1] op_sel_hi:[1,0,1] neg_lo:[0,0,1] neg_hi:[0,0,1]
v_pk_fma_f32 v[66:67], v[66:67], s[6:7], v[246:247] op_sel:[0,0,1] op_sel_hi:[1,0,1] neg_lo:[0,0,1] neg_hi:[0,0,1]
v_exp_f32 v44, v44
v_exp_f32 v45, v45
v_exp_f32 v46, v46
v_exp_f32 v47, v47
v_exp_f32 v64, v64
v_exp_f32 v65, v65
v_exp_f32 v66, v66
v_exp_f32 v67, v67
v_pk_add_f32 v[220:221], v[44:45], v[46:47]
v_pk_add_f32 v[222:223], v[64:65], v[66:67]
v_cvt_pk_bf16_f32 v44, v44, v45
v_cvt_pk_bf16_f32 v45, v46, v47
v_cvt_pk_bf16_f32 v46, v64, v65
v_cvt_pk_bf16_f32 v47, v66, v67
v_pk_add_f32 v[220:221], v[220:221], v[222:223]
v_add_f32 v193, v193, v220
v_add_f32 v193, v193, v221
ds_write_b128 v197, v[44:47] offset:6144
v_pk_fma_f32 v[48:49], v[48:49], s[6:7], v[248:249] op_sel:[0,0,0] op_sel_hi:[1,0,0] neg_lo:[0,0,1] neg_hi:[0,0,1]
v_pk_fma_f32 v[50:51], v[50:51], s[6:7], v[248:249] op_sel:[0,0,0] op_sel_hi:[1,0,0] neg_lo:[0,0,1] neg_hi:[0,0,1]
v_pk_fma_f32 v[68:69], v[68:69], s[6:7], v[248:249] op_sel:[0,0,0] op_sel_hi:[1,0,0] neg_lo:[0,0,1] neg_hi:[0,0,1]
v_pk_fma_f32 v[70:71], v[70:71], s[6:7], v[248:249] op_sel:[0,0,0] op_sel_hi:[1,0,0] neg_lo:[0,0,1] neg_hi:[0,0,1]
v_exp_f32 v48, v48
v_exp_f32 v49, v49
v_exp_f32 v50, v50
v_exp_f32 v51, v51
v_exp_f32 v68, v68
v_exp_f32 v69, v69
v_exp_f32 v70, v70
v_exp_f32 v71, v71
v_pk_add_f32 v[224:225], v[48:49], v[50:51]
v_pk_add_f32 v[226:227], v[68:69], v[70:71]
v_cvt_pk_bf16_f32 v48, v48, v49
v_cvt_pk_bf16_f32 v49, v50, v51
v_cvt_pk_bf16_f32 v50, v68, v69
v_cvt_pk_bf16_f32 v51, v70, v71
v_pk_add_f32 v[224:225], v[224:225], v[226:227]
v_add_f32 v194, v194, v224
v_add_f32 v194, v194, v225
ds_write_b128 v197, v[48:51] offset:7168
v_pk_fma_f32 v[52:53], v[52:53], s[6:7], v[248:249] op_sel:[0,0,1] op_sel_hi:[1,0,1] neg_lo:[0,0,1] neg_hi:[0,0,1]
v_pk_fma_f32 v[54:55], v[54:55], s[6:7], v[248:249] op_sel:[0,0,1] op_sel_hi:[1,0,1] neg_lo:[0,0,1] neg_hi:[0,0,1]
v_pk_fma_f32 v[72:73], v[72:73], s[6:7], v[248:249] op_sel:[0,0,1] op_sel_hi:[1,0,1] neg_lo:[0,0,1] neg_hi:[0,0,1]
v_pk_fma_f32 v[74:75], v[74:75], s[6:7], v[248:249] op_sel:[0,0,1] op_sel_hi:[1,0,1] neg_lo:[0,0,1] neg_hi:[0,0,1]
v_exp_f32 v52, v52
v_exp_f32 v53, v53
v_exp_f32 v54, v54
v_exp_f32 v55, v55
v_exp_f32 v72, v72
v_exp_f32 v73, v73
v_exp_f32 v74, v74
v_exp_f32 v75, v75
v_pk_add_f32 v[220:221], v[52:53], v[54:55]
v_pk_add_f32 v[222:223], v[72:73], v[74:75]
v_cvt_pk_bf16_f32 v52, v52, v53
v_cvt_pk_bf16_f32 v53, v54, v55
v_cvt_pk_bf16_f32 v54, v72, v73
v_cvt_pk_bf16_f32 v55, v74, v75
v_pk_add_f32 v[220:221], v[220:221], v[222:223]
v_add_f32 v195, v195, v220
v_add_f32 v195, v195, v221
ds_write_b128 v197, v[52:55] offset:8192
v_pk_fma_f32 v[56:57], v[56:57], s[6:7], v[250:251] op_sel:[0,0,0] op_sel_hi:[1,0,0] neg_lo:[0,0,1] neg_hi:[0,0,1]
v_pk_fma_f32 v[58:59], v[58:59], s[6:7], v[250:251] op_sel:[0,0,0] op_sel_hi:[1,0,0] neg_lo:[0,0,1] neg_hi:[0,0,1]
v_pk_fma_f32 v[76:77], v[76:77], s[6:7], v[250:251] op_sel:[0,0,0] op_sel_hi:[1,0,0] neg_lo:[0,0,1] neg_hi:[0,0,1]
v_pk_fma_f32 v[78:79], v[78:79], s[6:7], v[250:251] op_sel:[0,0,0] op_sel_hi:[1,0,0] neg_lo:[0,0,1] neg_hi:[0,0,1]
v_exp_f32 v56, v56
v_exp_f32 v57, v57
v_exp_f32 v58, v58
v_exp_f32 v59, v59
v_exp_f32 v76, v76
v_exp_f32 v77, v77
v_exp_f32 v78, v78
v_exp_f32 v79, v79
v_pk_add_f32 v[224:225], v[56:57], v[58:59]
v_pk_add_f32 v[226:227], v[76:77], v[78:79]
v_cvt_pk_bf16_f32 v56, v56, v57
v_cvt_pk_bf16_f32 v57, v58, v59
v_cvt_pk_bf16_f32 v58, v76, v77
v_cvt_pk_bf16_f32 v59, v78, v79
v_pk_add_f32 v[224:225], v[224:225], v[226:227]
v_add_f32 v196, v196, v224
v_add_f32 v196, v196, v225
ds_write_b128 v197, v[56:59] offset:9216
v_pk_fma_f32 v[80:81], v[80:81], s[6:7], v[246:247] op_sel:[0,0,0] op_sel_hi:[1,0,0] neg_lo:[0,0,1] neg_hi:[0,0,1]
v_pk_fma_f32 v[82:83], v[82:83], s[6:7], v[246:247] op_sel:[0,0,0] op_sel_hi:[1,0,0] neg_lo:[0,0,1] neg_hi:[0,0,1]
v_pk_fma_f32 v[100:101], v[100:101], s[6:7], v[246:247] op_sel:[0,0,0] op_sel_hi:[1,0,0] neg_lo:[0,0,1] neg_hi:[0,0,1]
v_pk_fma_f32 v[102:103], v[102:103], s[6:7], v[246:247] op_sel:[0,0,0] op_sel_hi:[1,0,0] neg_lo:[0,0,1] neg_hi:[0,0,1]
v_exp_f32 v80, v80
v_exp_f32 v81, v81
v_exp_f32 v82, v82
v_exp_f32 v83, v83
v_exp_f32 v100, v100
v_exp_f32 v101, v101
v_exp_f32 v102, v102
v_exp_f32 v103, v103
v_pk_add_f32 v[220:221], v[80:81], v[82:83]
v_pk_add_f32 v[222:223], v[100:101], v[102:103]
v_cvt_pk_bf16_f32 v80, v80, v81
v_cvt_pk_bf16_f32 v81, v82, v83
v_cvt_pk_bf16_f32 v82, v100, v101
v_cvt_pk_bf16_f32 v83, v102, v103
v_pk_add_f32 v[220:221], v[220:221], v[222:223]
v_add_f32 v192, v192, v220
v_add_f32 v192, v192, v221
v_pk_fma_f32 v[84:85], v[84:85], s[6:7], v[246:247] op_sel:[0,0,1] op_sel_hi:[1,0,1] neg_lo:[0,0,1] neg_hi:[0,0,1]
v_pk_fma_f32 v[86:87], v[86:87], s[6:7], v[246:247] op_sel:[0,0,1] op_sel_hi:[1,0,1] neg_lo:[0,0,1] neg_hi:[0,0,1]
v_pk_fma_f32 v[104:105], v[104:105], s[6:7], v[246:247] op_sel:[0,0,1] op_sel_hi:[1,0,1] neg_lo:[0,0,1] neg_hi:[0,0,1]
v_pk_fma_f32 v[106:107], v[106:107], s[6:7], v[246:247] op_sel:[0,0,1] op_sel_hi:[1,0,1] neg_lo:[0,0,1] neg_hi:[0,0,1]
v_exp_f32 v84, v84
v_exp_f32 v85, v85
v_exp_f32 v86, v86
v_exp_f32 v87, v87
v_exp_f32 v104, v104
v_exp_f32 v105, v105
v_exp_f32 v106, v106
v_exp_f32 v107, v107
v_pk_add_f32 v[224:225], v[84:85], v[86:87]
v_pk_add_f32 v[226:227], v[104:105], v[106:107]
v_cvt_pk_bf16_f32 v84, v84, v85
v_cvt_pk_bf16_f32 v85, v86, v87
v_cvt_pk_bf16_f32 v86, v104, v105
v_cvt_pk_bf16_f32 v87, v106, v107
v_pk_add_f32 v[224:225], v[224:225], v[226:227]
v_add_f32 v193, v193, v224
v_add_f32 v193, v193, v225
v_pk_fma_f32 v[88:89], v[88:89], s[6:7], v[248:249] op_sel:[0,0,0] op_sel_hi:[1,0,0] neg_lo:[0,0,1] neg_hi:[0,0,1]
v_pk_fma_f32 v[90:91], v[90:91], s[6:7], v[248:249] op_sel:[0,0,0] op_sel_hi:[1,0,0] neg_lo:[0,0,1] neg_hi:[0,0,1]
v_pk_fma_f32 v[108:109], v[108:109], s[6:7], v[248:249] op_sel:[0,0,0] op_sel_hi:[1,0,0] neg_lo:[0,0,1] neg_hi:[0,0,1]
v_pk_fma_f32 v[110:111], v[110:111], s[6:7], v[248:249] op_sel:[0,0,0] op_sel_hi:[1,0,0] neg_lo:[0,0,1] neg_hi:[0,0,1]
v_exp_f32 v88, v88
v_exp_f32 v89, v89
v_exp_f32 v90, v90
v_exp_f32 v91, v91
v_exp_f32 v108, v108
v_exp_f32 v109, v109
v_exp_f32 v110, v110
v_exp_f32 v111, v111
v_pk_add_f32 v[220:221], v[88:89], v[90:91]
v_pk_add_f32 v[222:223], v[108:109], v[110:111]
v_cvt_pk_bf16_f32 v88, v88, v89
v_cvt_pk_bf16_f32 v89, v90, v91
v_cvt_pk_bf16_f32 v90, v108, v109
v_cvt_pk_bf16_f32 v91, v110, v111
v_pk_add_f32 v[220:221], v[220:221], v[222:223]
v_add_f32 v194, v194, v220
v_add_f32 v194, v194, v221
v_pk_fma_f32 v[92:93], v[92:93], s[6:7], v[248:249] op_sel:[0,0,1] op_sel_hi:[1,0,1] neg_lo:[0,0,1] neg_hi:[0,0,1]
v_pk_fma_f32 v[94:95], v[94:95], s[6:7], v[248:249] op_sel:[0,0,1] op_sel_hi:[1,0,1] neg_lo:[0,0,1] neg_hi:[0,0,1]
v_pk_fma_f32 v[112:113], v[112:113], s[6:7], v[248:249] op_sel:[0,0,1] op_sel_hi:[1,0,1] neg_lo:[0,0,1] neg_hi:[0,0,1]
v_pk_fma_f32 v[114:115], v[114:115], s[6:7], v[248:249] op_sel:[0,0,1] op_sel_hi:[1,0,1] neg_lo:[0,0,1] neg_hi:[0,0,1]
v_exp_f32 v92, v92
v_exp_f32 v93, v93
v_exp_f32 v94, v94
v_exp_f32 v95, v95
v_exp_f32 v112, v112
v_exp_f32 v113, v113
v_exp_f32 v114, v114
v_exp_f32 v115, v115
v_pk_add_f32 v[224:225], v[92:93], v[94:95]
v_pk_add_f32 v[226:227], v[112:113], v[114:115]
v_cvt_pk_bf16_f32 v92, v92, v93
v_cvt_pk_bf16_f32 v93, v94, v95
v_cvt_pk_bf16_f32 v94, v112, v113
v_cvt_pk_bf16_f32 v95, v114, v115
v_pk_add_f32 v[224:225], v[224:225], v[226:227]
v_add_f32 v195, v195, v224
v_add_f32 v195, v195, v225
v_pk_fma_f32 v[96:97], v[96:97], s[6:7], v[250:251] op_sel:[0,0,0] op_sel_hi:[1,0,0] neg_lo:[0,0,1] neg_hi:[0,0,1]
v_pk_fma_f32 v[98:99], v[98:99], s[6:7], v[250:251] op_sel:[0,0,0] op_sel_hi:[1,0,0] neg_lo:[0,0,1] neg_hi:[0,0,1]
v_pk_fma_f32 v[116:117], v[116:117], s[6:7], v[250:251] op_sel:[0,0,0] op_sel_hi:[1,0,0] neg_lo:[0,0,1] neg_hi:[0,0,1]
v_pk_fma_f32 v[118:119], v[118:119], s[6:7], v[250:251] op_sel:[0,0,0] op_sel_hi:[1,0,0] neg_lo:[0,0,1] neg_hi:[0,0,1]
v_exp_f32 v96, v96
v_exp_f32 v97, v97
v_exp_f32 v98, v98
v_exp_f32 v99, v99
v_exp_f32 v116, v116
v_exp_f32 v117, v117
v_exp_f32 v118, v118
v_exp_f32 v119, v119
v_pk_add_f32 v[220:221], v[96:97], v[98:99]
v_pk_add_f32 v[222:223], v[116:117], v[118:119]
v_cvt_pk_bf16_f32 v96, v96, v97
v_cvt_pk_bf16_f32 v97, v98, v99
v_cvt_pk_bf16_f32 v98, v116, v117
v_cvt_pk_bf16_f32 v99, v118, v119
v_pk_add_f32 v[220:221], v[220:221], v[222:223]
v_add_f32 v196, v196, v220
v_add_f32 v196, v196, v221
s_waitcnt lgkmcnt(0)
s_barrier
ds_read_b128 v[160:163], v244 offset:0
ds_read_b128 v[164:167], v244 offset:1024
ds_read_b128 v[168:171], v244 offset:2048
ds_read_b128 v[172:175], v244 offset:3072
ds_read_b128 v[176:179], v244 offset:4096
ds_read_b128 v[180:183], v244 offset:5120
ds_read_b128 v[184:187], v244 offset:6144
ds_read_b128 v[188:191], v244 offset:7168
s_waitcnt lgkmcnt(7)
v_mfma_f32_16x16x32_bf16 v[0:3], v[200:203], v[160:163], 0
v_mfma_f32_16x16x32_bf16 v[20:23], v[204:207], v[160:163], 0
v_mfma_f32_16x16x32_bf16 v[40:43], v[208:211], v[160:163], 0
v_fma_f32 v120, v120, s6, -v246
v_fma_f32 v121, v121, s6, -v246
v_mfma_f32_16x16x32_bf16 v[60:63], v[212:215], v[160:163], 0
v_fma_f32 v122, v122, s6, -v246
ds_read_b128 v[160:163], v244 offset:8192
s_waitcnt lgkmcnt(7)
v_mfma_f32_16x16x32_bf16 v[4:7], v[200:203], v[164:167], 0
v_fma_f32 v123, v123, s6, -v246
s_waitcnt vmcnt(6)
s_barrier
v_mfma_f32_16x16x32_bf16 v[24:27], v[204:207], v[164:167], 0
v_fma_f32 v140, v140, s6, -v246
ds_read_b64_tr_b16 v[216:217], v236 offset:2048
ds_read_b64_tr_b16 v[220:221], v237 offset:2048
ds_read_b64_tr_b16 v[224:225], v238 offset:2048
ds_read_b64_tr_b16 v[228:229], v239 offset:2048
v_mfma_f32_16x16x32_bf16 v[44:47], v[208:211], v[164:167], 0
v_fma_f32 v141, v141, s6, -v246
v_mfma_f32_16x16x32_bf16 v[64:67], v[212:215], v[164:167], 0
v_fma_f32 v142, v142, s6, -v246
ds_read_b128 v[164:167], v244 offset:9216
ds_read_b64_tr_b16 v[218:219], v236 offset:34816
ds_read_b64_tr_b16 v[222:223], v237 offset:34816
ds_read_b64_tr_b16 v[226:227], v238 offset:34816
ds_read_b64_tr_b16 v[230:231], v239 offset:34816
s_waitcnt lgkmcnt(15)
v_mfma_f32_16x16x32_bf16 v[8:11], v[200:203], v[168:171], 0
v_fma_f32 v143, v143, s6, -v246
v_mfma_f32_16x16x32_bf16 v[28:31], v[204:207], v[168:171], 0
v_exp_f32 v120, v120
v_mfma_f32_16x16x32_bf16 v[48:51], v[208:211], v[168:171], 0
v_exp_f32 v121, v121
v_mfma_f32_16x16x32_bf16 v[68:71], v[212:215], v[168:171], 0
v_exp_f32 v122, v122
ds_read_b128 v[168:171], v244 offset:10240
s_waitcnt lgkmcnt(15)
v_mfma_f32_16x16x32_bf16 v[12:15], v[200:203], v[172:175], 0
v_exp_f32 v123, v123
v_mfma_f32_16x16x32_bf16 v[32:35], v[204:207], v[172:175], 0
v_exp_f32 v140, v140
v_mfma_f32_16x16x32_bf16 v[52:55], v[208:211], v[172:175], 0
v_exp_f32 v141, v141
v_mfma_f32_16x16x32_bf16 v[72:75], v[212:215], v[172:175], 0
v_exp_f32 v142, v142
ds_read_b128 v[172:175], v244 offset:11264
s_waitcnt lgkmcnt(15)
v_mfma_f32_16x16x32_bf16 v[16:19], v[200:203], v[176:179], 0
v_exp_f32 v143, v143
v_mfma_f32_16x16x32_bf16 v[36:39], v[204:207], v[176:179], 0
v_pk_add_f32 v[100:101], v[120:121], v[122:123]
v_mfma_f32_16x16x32_bf16 v[56:59], v[208:211], v[176:179], 0
v_pk_add_f32 v[102:103], v[140:141], v[142:143]
v_mfma_f32_16x16x32_bf16 v[76:79], v[212:215], v[176:179], 0
v_cvt_pk_bf16_f32 v120, v120, v121
ds_read_b128 v[176:179], v244 offset:12288
s_waitcnt lgkmcnt(6)
v_mfma_f32_16x16x32_bf16 v[0:3], v[216:219], v[180:183], v[0:3]
v_cvt_pk_bf16_f32 v121, v122, v123
s_waitcnt lgkmcnt(5)
v_mfma_f32_16x16x32_bf16 v[20:23], v[220:223], v[180:183], v[20:23]
v_cvt_pk_bf16_f32 v122, v140, v141
s_waitcnt lgkmcnt(4)
v_mfma_f32_16x16x32_bf16 v[40:43], v[224:227], v[180:183], v[40:43]
v_cvt_pk_bf16_f32 v123, v142, v143
s_waitcnt lgkmcnt(3)
v_mfma_f32_16x16x32_bf16 v[60:63], v[228:231], v[180:183], v[60:63]
v_pk_add_f32 v[100:101], v[100:101], v[102:103]
ds_read_b128 v[180:183], v244 offset:13312
v_mfma_f32_16x16x32_bf16 v[4:7], v[216:219], v[184:187], v[4:7]
v_add_f32 v192, v192, v100
s_waitcnt vmcnt(4)
s_barrier
v_mfma_f32_16x16x32_bf16 v[24:27], v[220:223], v[184:187], v[24:27]
v_add_f32 v192, v192, v101
ds_read_b64_tr_b16 v[200:201], v236 offset:4096
ds_read_b64_tr_b16 v[204:205], v237 offset:4096
ds_read_b64_tr_b16 v[208:209], v238 offset:4096
ds_read_b64_tr_b16 v[212:213], v239 offset:4096
v_mfma_f32_16x16x32_bf16 v[44:47], v[224:227], v[184:187], v[44:47]
v_fma_f32 v124, v124, s6, -v247
v_fma_f32 v125, v125, s6, -v247
v_mfma_f32_16x16x32_bf16 v[64:67], v[228:231], v[184:187], v[64:67]
v_fma_f32 v126, v126, s6, -v247
ds_read_b128 v[184:187], v244 offset:14336
ds_read_b64_tr_b16 v[202:203], v236 offset:36864
ds_read_b64_tr_b16 v[206:207], v237 offset:36864
ds_read_b64_tr_b16 v[210:211], v238 offset:36864
ds_read_b64_tr_b16 v[214:215], v239 offset:36864
v_mfma_f32_16x16x32_bf16 v[8:11], v[216:219], v[188:191], v[8:11]
v_fma_f32 v127, v127, s6, -v247
v_mfma_f32_16x16x32_bf16 v[28:31], v[220:223], v[188:191], v[28:31]
v_fma_f32 v144, v144, s6, -v247
s_mov_b32 m0, s4
s_mov_b32 s9, 79872
buffer_load_dwordx4 v232, s[28:31], s9 offen offset:2048 nt lds
s_mov_b32 s8, 82944
buffer_load_dwordx4 v232, s[28:31], s8 offen offset:3072 nt lds
v_mfma_f32_16x16x32_bf16 v[48:51], v[224:227], v[188:191], v[48:51]
v_fma_f32 v145, v145, s6, -v247
v_mfma_f32_16x16x32_bf16 v[68:71], v[228:231], v[188:191], v[68:71]
v_fma_f32 v146, v146, s6, -v247
ds_read_b128 v[188:191], v244 offset:15360
v_mfma_f32_16x16x32_bf16 v[12:15], v[216:219], v[160:163], v[12:15]
v_fma_f32 v147, v147, s6, -v247
v_mfma_f32_16x16x32_bf16 v[32:35], v[220:223], v[160:163], v[32:35]
v_exp_f32 v124, v124
v_mfma_f32_16x16x32_bf16 v[52:55], v[224:227], v[160:163], v[52:55]
v_exp_f32 v125, v125
v_mfma_f32_16x16x32_bf16 v[72:75], v[228:231], v[160:163], v[72:75]
v_exp_f32 v126, v126
ds_read_b128 v[160:163], v244 offset:16384
v_mfma_f32_16x16x32_bf16 v[16:19], v[216:219], v[164:167], v[16:19]
v_exp_f32 v127, v127
v_mfma_f32_16x16x32_bf16 v[36:39], v[220:223], v[164:167], v[36:39]
v_exp_f32 v144, v144
v_mfma_f32_16x16x32_bf16 v[56:59], v[224:227], v[164:167], v[56:59]
v_exp_f32 v145, v145
v_mfma_f32_16x16x32_bf16 v[76:79], v[228:231], v[164:167], v[76:79]
v_exp_f32 v146, v146
ds_read_b128 v[164:167], v244 offset:17408
s_waitcnt lgkmcnt(6)
v_mfma_f32_16x16x32_bf16 v[0:3], v[200:203], v[168:171], v[0:3]
v_exp_f32 v147, v147
s_waitcnt lgkmcnt(5)
v_mfma_f32_16x16x32_bf16 v[20:23], v[204:207], v[168:171], v[20:23]
v_pk_add_f32 v[100:101], v[124:125], v[126:127]
s_waitcnt lgkmcnt(4)
v_mfma_f32_16x16x32_bf16 v[40:43], v[208:211], v[168:171], v[40:43]
v_pk_add_f32 v[102:103], v[144:145], v[146:147]
s_waitcnt lgkmcnt(3)
v_mfma_f32_16x16x32_bf16 v[60:63], v[212:215], v[168:171], v[60:63]
v_cvt_pk_bf16_f32 v124, v124, v125
ds_read_b128 v[168:171], v244 offset:18432
v_mfma_f32_16x16x32_bf16 v[4:7], v[200:203], v[172:175], v[4:7]
v_cvt_pk_bf16_f32 v125, v126, v127
s_waitcnt vmcnt(4)
s_barrier
v_mfma_f32_16x16x32_bf16 v[24:27], v[204:207], v[172:175], v[24:27]
v_cvt_pk_bf16_f32 v126, v144, v145
ds_read_b64_tr_b16 v[216:217], v236 offset:6144
ds_read_b64_tr_b16 v[220:221], v237 offset:6144
ds_read_b64_tr_b16 v[224:225], v238 offset:6144
ds_read_b64_tr_b16 v[228:229], v239 offset:6144
v_mfma_f32_16x16x32_bf16 v[44:47], v[208:211], v[172:175], v[44:47]
v_cvt_pk_bf16_f32 v127, v146, v147
v_mfma_f32_16x16x32_bf16 v[64:67], v[212:215], v[172:175], v[64:67]
v_pk_add_f32 v[100:101], v[100:101], v[102:103]
ds_read_b128 v[172:175], v244 offset:19456
ds_read_b64_tr_b16 v[218:219], v236 offset:38912
ds_read_b64_tr_b16 v[222:223], v237 offset:38912
ds_read_b64_tr_b16 v[226:227], v238 offset:38912
ds_read_b64_tr_b16 v[230:231], v239 offset:38912
v_mfma_f32_16x16x32_bf16 v[8:11], v[200:203], v[176:179], v[8:11]
v_add_f32 v193, v193, v100
v_mfma_f32_16x16x32_bf16 v[28:31], v[204:207], v[176:179], v[28:31]
v_add_f32 v193, v193, v101
s_mov_b32 m0, s5
s_mov_b32 s9, 98304
buffer_load_dwordx4 v232, s[28:31], s9 offen nt lds
s_mov_b32 s8, 101376
buffer_load_dwordx4 v232, s[28:31], s8 offen offset:1024 nt lds
v_mfma_f32_16x16x32_bf16 v[48:51], v[208:211], v[176:179], v[48:51]
v_fma_f32 v128, v128, s6, -v248
v_fma_f32 v129, v129, s6, -v248
v_mfma_f32_16x16x32_bf16 v[68:71], v[212:215], v[176:179], v[68:71]
v_fma_f32 v130, v130, s6, -v248
ds_read_b128 v[176:179], v244 offset:20480
v_mfma_f32_16x16x32_bf16 v[12:15], v[200:203], v[180:183], v[12:15]
v_fma_f32 v131, v131, s6, -v248
v_mfma_f32_16x16x32_bf16 v[32:35], v[204:207], v[180:183], v[32:35]
v_fma_f32 v148, v148, s6, -v248
v_mfma_f32_16x16x32_bf16 v[52:55], v[208:211], v[180:183], v[52:55]
v_fma_f32 v149, v149, s6, -v248
v_mfma_f32_16x16x32_bf16 v[72:75], v[212:215], v[180:183], v[72:75]
v_fma_f32 v150, v150, s6, -v248
ds_read_b128 v[180:183], v244 offset:21504
v_mfma_f32_16x16x32_bf16 v[16:19], v[200:203], v[184:187], v[16:19]
v_fma_f32 v151, v151, s6, -v248
v_mfma_f32_16x16x32_bf16 v[36:39], v[204:207], v[184:187], v[36:39]
v_exp_f32 v128, v128
v_mfma_f32_16x16x32_bf16 v[56:59], v[208:211], v[184:187], v[56:59]
v_exp_f32 v129, v129
v_mfma_f32_16x16x32_bf16 v[76:79], v[212:215], v[184:187], v[76:79]
v_exp_f32 v130, v130
ds_read_b128 v[184:187], v244 offset:22528
s_waitcnt lgkmcnt(6)
v_mfma_f32_16x16x32_bf16 v[0:3], v[216:219], v[188:191], v[0:3]
v_exp_f32 v131, v131
s_waitcnt lgkmcnt(5)
v_mfma_f32_16x16x32_bf16 v[20:23], v[220:223], v[188:191], v[20:23]
v_exp_f32 v148, v148
s_waitcnt lgkmcnt(4)
v_mfma_f32_16x16x32_bf16 v[40:43], v[224:227], v[188:191], v[40:43]
v_exp_f32 v149, v149
s_waitcnt lgkmcnt(3)
v_mfma_f32_16x16x32_bf16 v[60:63], v[228:231], v[188:191], v[60:63]
v_exp_f32 v150, v150
ds_read_b128 v[188:191], v244 offset:23552
v_mfma_f32_16x16x32_bf16 v[4:7], v[216:219], v[160:163], v[4:7]
v_exp_f32 v151, v151
s_waitcnt vmcnt(4)
s_barrier
v_mfma_f32_16x16x32_bf16 v[24:27], v[220:223], v[160:163], v[24:27]
v_pk_add_f32 v[100:101], v[128:129], v[130:131]
ds_read_b64_tr_b16 v[200:201], v236 offset:0
ds_read_b64_tr_b16 v[204:205], v237 offset:0
ds_read_b64_tr_b16 v[208:209], v238 offset:0
ds_read_b64_tr_b16 v[212:213], v239 offset:0
v_mfma_f32_16x16x32_bf16 v[44:47], v[224:227], v[160:163], v[44:47]
v_pk_add_f32 v[102:103], v[148:149], v[150:151]
v_mfma_f32_16x16x32_bf16 v[64:67], v[228:231], v[160:163], v[64:67]
v_cvt_pk_bf16_f32 v128, v128, v129
ds_read_b128 v[160:163], v244 offset:24576
ds_read_b64_tr_b16 v[202:203], v236 offset:32768
ds_read_b64_tr_b16 v[206:207], v237 offset:32768
ds_read_b64_tr_b16 v[210:211], v238 offset:32768
ds_read_b64_tr_b16 v[214:215], v239 offset:32768
v_mfma_f32_16x16x32_bf16 v[8:11], v[216:219], v[164:167], v[8:11]
v_cvt_pk_bf16_f32 v129, v130, v131
v_mfma_f32_16x16x32_bf16 v[28:31], v[220:223], v[164:167], v[28:31]
v_cvt_pk_bf16_f32 v130, v148, v149
s_mov_b32 m0, s5
s_mov_b32 s9, 112640
buffer_load_dwordx4 v232, s[28:31], s9 offen offset:2048 nt lds
s_mov_b32 s8, 115712
buffer_load_dwordx4 v232, s[28:31], s8 offen offset:3072 nt lds
v_mfma_f32_16x16x32_bf16 v[48:51], v[224:227], v[164:167], v[48:51]
v_cvt_pk_bf16_f32 v131, v150, v151
v_mfma_f32_16x16x32_bf16 v[68:71], v[228:231], v[164:167], v[68:71]
v_pk_add_f32 v[100:101], v[100:101], v[102:103]
ds_read_b128 v[164:167], v244 offset:25600
v_mfma_f32_16x16x32_bf16 v[12:15], v[216:219], v[168:171], v[12:15]
v_add_f32 v194, v194, v100
v_mfma_f32_16x16x32_bf16 v[32:35], v[220:223], v[168:171], v[32:35]
v_add_f32 v194, v194, v101
v_mfma_f32_16x16x32_bf16 v[52:55], v[224:227], v[168:171], v[52:55]
v_fma_f32 v132, v132, s6, -v249
v_fma_f32 v133, v133, s6, -v249
v_mfma_f32_16x16x32_bf16 v[72:75], v[228:231], v[168:171], v[72:75]
v_fma_f32 v134, v134, s6, -v249
ds_read_b128 v[168:171], v244 offset:26624
v_mfma_f32_16x16x32_bf16 v[16:19], v[216:219], v[172:175], v[16:19]
v_fma_f32 v135, v135, s6, -v249
v_mfma_f32_16x16x32_bf16 v[36:39], v[220:223], v[172:175], v[36:39]
v_fma_f32 v152, v152, s6, -v249
v_mfma_f32_16x16x32_bf16 v[56:59], v[224:227], v[172:175], v[56:59]
v_fma_f32 v153, v153, s6, -v249
v_mfma_f32_16x16x32_bf16 v[76:79], v[228:231], v[172:175], v[76:79]
v_fma_f32 v154, v154, s6, -v249
ds_read_b128 v[172:175], v244 offset:27648
s_waitcnt lgkmcnt(6)
v_mfma_f32_16x16x32_bf16 v[0:3], v[200:203], v[176:179], v[0:3]
v_fma_f32 v155, v155, s6, -v249
s_waitcnt lgkmcnt(5)
v_mfma_f32_16x16x32_bf16 v[20:23], v[204:207], v[176:179], v[20:23]
v_exp_f32 v132, v132
s_waitcnt lgkmcnt(4)
v_mfma_f32_16x16x32_bf16 v[40:43], v[208:211], v[176:179], v[40:43]
v_exp_f32 v133, v133
s_waitcnt lgkmcnt(3)
v_mfma_f32_16x16x32_bf16 v[60:63], v[212:215], v[176:179], v[60:63]
v_exp_f32 v134, v134
ds_read_b128 v[176:179], v244 offset:28672
v_mfma_f32_16x16x32_bf16 v[4:7], v[200:203], v[180:183], v[4:7]
v_exp_f32 v135, v135
s_waitcnt vmcnt(4)
s_barrier
v_mfma_f32_16x16x32_bf16 v[24:27], v[204:207], v[180:183], v[24:27]
v_exp_f32 v152, v152
ds_read_b64_tr_b16 v[216:217], v236 offset:2048
ds_read_b64_tr_b16 v[220:221], v237 offset:2048
ds_read_b64_tr_b16 v[224:225], v238 offset:2048
ds_read_b64_tr_b16 v[228:229], v239 offset:2048
v_mfma_f32_16x16x32_bf16 v[44:47], v[208:211], v[180:183], v[44:47]
v_exp_f32 v153, v153
v_mfma_f32_16x16x32_bf16 v[64:67], v[212:215], v[180:183], v[64:67]
v_exp_f32 v154, v154
ds_read_b128 v[180:183], v244 offset:29696
ds_read_b64_tr_b16 v[218:219], v236 offset:34816
ds_read_b64_tr_b16 v[222:223], v237 offset:34816
ds_read_b64_tr_b16 v[226:227], v238 offset:34816
ds_read_b64_tr_b16 v[230:231], v239 offset:34816
v_mfma_f32_16x16x32_bf16 v[8:11], v[200:203], v[184:187], v[8:11]
v_exp_f32 v155, v155
v_mfma_f32_16x16x32_bf16 v[28:31], v[204:207], v[184:187], v[28:31]
v_pk_add_f32 v[100:101], v[132:133], v[134:135]
s_mov_b32 m0, s4
s_mov_b32 s9, 131072
buffer_load_dwordx4 v232, s[28:31], s9 offen nt lds
s_mov_b32 s8, 134144
buffer_load_dwordx4 v232, s[28:31], s8 offen offset:1024 nt lds
v_mfma_f32_16x16x32_bf16 v[48:51], v[208:211], v[184:187], v[48:51]
v_pk_add_f32 v[102:103], v[152:153], v[154:155]
v_mfma_f32_16x16x32_bf16 v[68:71], v[212:215], v[184:187], v[68:71]
v_cvt_pk_bf16_f32 v132, v132, v133
ds_read_b128 v[184:187], v244 offset:30720
v_mfma_f32_16x16x32_bf16 v[12:15], v[200:203], v[188:191], v[12:15]
v_cvt_pk_bf16_f32 v133, v134, v135
v_mfma_f32_16x16x32_bf16 v[32:35], v[204:207], v[188:191], v[32:35]
v_cvt_pk_bf16_f32 v134, v152, v153
v_mfma_f32_16x16x32_bf16 v[52:55], v[208:211], v[188:191], v[52:55]
v_cvt_pk_bf16_f32 v135, v154, v155
v_mfma_f32_16x16x32_bf16 v[72:75], v[212:215], v[188:191], v[72:75]
v_pk_add_f32 v[100:101], v[100:101], v[102:103]
ds_read_b128 v[188:191], v244 offset:31744
v_mfma_f32_16x16x32_bf16 v[16:19], v[200:203], v[160:163], v[16:19]
v_add_f32 v195, v195, v100
v_mfma_f32_16x16x32_bf16 v[36:39], v[204:207], v[160:163], v[36:39]
v_add_f32 v195, v195, v101
v_mfma_f32_16x16x32_bf16 v[56:59], v[208:211], v[160:163], v[56:59]
v_fma_f32 v136, v136, s6, -v250
v_fma_f32 v137, v137, s6, -v250
v_mfma_f32_16x16x32_bf16 v[76:79], v[212:215], v[160:163], v[76:79]
v_fma_f32 v138, v138, s6, -v250
ds_read_b128 v[160:163], v244 offset:32768
s_waitcnt lgkmcnt(6)
v_mfma_f32_16x16x32_bf16 v[0:3], v[216:219], v[164:167], v[0:3]
v_fma_f32 v139, v139, s6, -v250
s_waitcnt lgkmcnt(5)
v_mfma_f32_16x16x32_bf16 v[20:23], v[220:223], v[164:167], v[20:23]
v_fma_f32 v156, v156, s6, -v250
s_waitcnt lgkmcnt(4)
v_mfma_f32_16x16x32_bf16 v[40:43], v[224:227], v[164:167], v[40:43]
v_fma_f32 v157, v157, s6, -v250
s_waitcnt lgkmcnt(3)
v_mfma_f32_16x16x32_bf16 v[60:63], v[228:231], v[164:167], v[60:63]
v_fma_f32 v158, v158, s6, -v250
ds_read_b128 v[164:167], v244 offset:33792
v_mfma_f32_16x16x32_bf16 v[4:7], v[216:219], v[168:171], v[4:7]
v_fma_f32 v159, v159, s6, -v250
s_waitcnt vmcnt(4)
s_barrier
v_mfma_f32_16x16x32_bf16 v[24:27], v[220:223], v[168:171], v[24:27]
v_exp_f32 v136, v136
ds_read_b64_tr_b16 v[200:201], v236 offset:4096
ds_read_b64_tr_b16 v[204:205], v237 offset:4096
ds_read_b64_tr_b16 v[208:209], v238 offset:4096
ds_read_b64_tr_b16 v[212:213], v239 offset:4096
v_mfma_f32_16x16x32_bf16 v[44:47], v[224:227], v[168:171], v[44:47]
v_exp_f32 v137, v137
v_mfma_f32_16x16x32_bf16 v[64:67], v[228:231], v[168:171], v[64:67]
v_exp_f32 v138, v138
ds_read_b128 v[168:171], v244 offset:34816
ds_read_b64_tr_b16 v[202:203], v236 offset:36864
ds_read_b64_tr_b16 v[206:207], v237 offset:36864
ds_read_b64_tr_b16 v[210:211], v238 offset:36864
ds_read_b64_tr_b16 v[214:215], v239 offset:36864
v_mfma_f32_16x16x32_bf16 v[8:11], v[216:219], v[172:175], v[8:11]
v_exp_f32 v139, v139
v_mfma_f32_16x16x32_bf16 v[28:31], v[220:223], v[172:175], v[28:31]
v_exp_f32 v156, v156
s_mov_b32 m0, s4
s_mov_b32 s9, 145408
buffer_load_dwordx4 v232, s[28:31], s9 offen offset:2048 nt lds
s_mov_b32 s8, 148480
buffer_load_dwordx4 v232, s[28:31], s8 offen offset:3072 nt lds
v_mfma_f32_16x16x32_bf16 v[48:51], v[224:227], v[172:175], v[48:51]
v_exp_f32 v157, v157
v_mfma_f32_16x16x32_bf16 v[68:71], v[228:231], v[172:175], v[68:71]
v_exp_f32 v158, v158
ds_read_b128 v[172:175], v244 offset:35840
v_mfma_f32_16x16x32_bf16 v[12:15], v[216:219], v[176:179], v[12:15]
v_exp_f32 v159, v159
v_mfma_f32_16x16x32_bf16 v[32:35], v[220:223], v[176:179], v[32:35]
v_pk_add_f32 v[100:101], v[136:137], v[138:139]
v_mfma_f32_16x16x32_bf16 v[52:55], v[224:227], v[176:179], v[52:55]
v_pk_add_f32 v[102:103], v[156:157], v[158:159]
v_mfma_f32_16x16x32_bf16 v[72:75], v[228:231], v[176:179], v[72:75]
v_cvt_pk_bf16_f32 v136, v136, v137
ds_read_b128 v[176:179], v244 offset:36864
v_mfma_f32_16x16x32_bf16 v[16:19], v[216:219], v[180:183], v[16:19]
v_cvt_pk_bf16_f32 v137, v138, v139
v_mfma_f32_16x16x32_bf16 v[36:39], v[220:223], v[180:183], v[36:39]
v_cvt_pk_bf16_f32 v138, v156, v157
v_mfma_f32_16x16x32_bf16 v[56:59], v[224:227], v[180:183], v[56:59]
v_cvt_pk_bf16_f32 v139, v158, v159
v_mfma_f32_16x16x32_bf16 v[76:79], v[228:231], v[180:183], v[76:79]
v_pk_add_f32 v[100:101], v[100:101], v[102:103]
ds_read_b128 v[180:183], v244 offset:37888
s_waitcnt lgkmcnt(6)
v_mfma_f32_16x16x32_bf16 v[0:3], v[200:203], v[184:187], v[0:3]
v_add_f32 v196, v196, v100
s_waitcnt lgkmcnt(5)
v_mfma_f32_16x16x32_bf16 v[20:23], v[204:207], v[184:187], v[20:23]
v_add_f32 v196, v196, v101
s_waitcnt lgkmcnt(4)
v_mfma_f32_16x16x32_bf16 v[40:43], v[208:211], v[184:187], v[40:43]
s_waitcnt lgkmcnt(3)
v_mfma_f32_16x16x32_bf16 v[60:63], v[212:215], v[184:187], v[60:63]
ds_read_b128 v[184:187], v244 offset:38912
v_mfma_f32_16x16x32_bf16 v[4:7], v[200:203], v[188:191], v[4:7]
v_lshlrev_b32 v199, 4, v235
s_lshl_b32 s10, s14, 11
s_lshl_b32 s11, s15, 2
s_add_u32 s10, s10, s11
s_add_u32 s10, s10, 151552
v_add_u32 v199, s10, v199
v_mov_b32 v198, v196
s_nop 1
v_permlane32_swap_b32 v192, v194
v_permlane32_swap_b32 v193, v195
v_permlane32_swap_b32 v196, v198
v_add_f32 v192, v192, v194
v_add_f32 v193, v193, v195
v_add_f32 v196, v196, v198
v_mov_b32 v198, v196
s_nop 1
v_permlane16_swap_b32 v192, v193
v_permlane16_swap_b32 v196, v198
v_add_f32 v192, v192, v193
v_add_f32 v196, v196, v198
ds_write_b32 v199, v192 offset:0
ds_write_b32 v199, v196 offset:1024
s_waitcnt vmcnt(4)
s_barrier
v_mfma_f32_16x16x32_bf16 v[24:27], v[204:207], v[188:191], v[24:27]
ds_read_b64_tr_b16 v[216:217], v236 offset:6144
ds_read_b64_tr_b16 v[220:221], v237 offset:6144
ds_read_b64_tr_b16 v[224:225], v238 offset:6144
ds_read_b64_tr_b16 v[228:229], v239 offset:6144
v_mfma_f32_16x16x32_bf16 v[44:47], v[208:211], v[188:191], v[44:47]
v_mfma_f32_16x16x32_bf16 v[64:67], v[212:215], v[188:191], v[64:67]
ds_read_b128 v[188:191], v244 offset:39936
ds_read_b64_tr_b16 v[218:219], v236 offset:38912
ds_read_b64_tr_b16 v[222:223], v237 offset:38912
ds_read_b64_tr_b16 v[226:227], v238 offset:38912
ds_read_b64_tr_b16 v[230:231], v239 offset:38912
v_mfma_f32_16x16x32_bf16 v[8:11], v[200:203], v[160:163], v[8:11]
v_mfma_f32_16x16x32_bf16 v[28:31], v[204:207], v[160:163], v[28:31]
s_mov_b32 m0, s5
s_mov_b32 s9, 163840
buffer_load_dwordx4 v232, s[28:31], s9 offen nt lds
s_mov_b32 s8, 166912
buffer_load_dwordx4 v232, s[28:31], s8 offen offset:1024 nt lds
v_mfma_f32_16x16x32_bf16 v[48:51], v[208:211], v[160:163], v[48:51]
v_mfma_f32_16x16x32_bf16 v[68:71], v[212:215], v[160:163], v[68:71]
v_mfma_f32_16x16x32_bf16 v[12:15], v[200:203], v[164:167], v[12:15]
v_mfma_f32_16x16x32_bf16 v[32:35], v[204:207], v[164:167], v[32:35]
v_mfma_f32_16x16x32_bf16 v[52:55], v[208:211], v[164:167], v[52:55]
v_mfma_f32_16x16x32_bf16 v[72:75], v[212:215], v[164:167], v[72:75]
v_mfma_f32_16x16x32_bf16 v[16:19], v[200:203], v[168:171], v[16:19]
s_waitcnt lgkmcnt(4)
s_barrier
ds_write_b128 v197, v[80:83] offset:0
v_mfma_f32_16x16x32_bf16 v[36:39], v[204:207], v[168:171], v[36:39]
ds_write_b128 v197, v[84:87] offset:1024
v_mfma_f32_16x16x32_bf16 v[56:59], v[208:211], v[168:171], v[56:59]
ds_write_b128 v197, v[88:91] offset:2048
v_mfma_f32_16x16x32_bf16 v[76:79], v[212:215], v[168:171], v[76:79]
ds_write_b128 v197, v[92:95] offset:3072
s_waitcnt lgkmcnt(7)
v_mfma_f32_16x16x32_bf16 v[0:3], v[216:219], v[172:175], v[0:3]
ds_write_b128 v197, v[96:99] offset:4096
s_waitcnt lgkmcnt(7)
v_mfma_f32_16x16x32_bf16 v[20:23], v[220:223], v[172:175], v[20:23]
ds_write_b128 v197, v[120:123] offset:5120
s_waitcnt lgkmcnt(7)
v_mfma_f32_16x16x32_bf16 v[40:43], v[224:227], v[172:175], v[40:43]
ds_write_b128 v197, v[124:127] offset:6144
s_waitcnt lgkmcnt(7)
v_mfma_f32_16x16x32_bf16 v[60:63], v[228:231], v[172:175], v[60:63]
ds_write_b128 v197, v[128:131] offset:7168
v_mfma_f32_16x16x32_bf16 v[4:7], v[216:219], v[176:179], v[4:7]
ds_write_b128 v197, v[132:135] offset:8192
s_waitcnt vmcnt(4)
s_barrier
v_mfma_f32_16x16x32_bf16 v[24:27], v[220:223], v[176:179], v[24:27]
ds_write_b128 v197, v[136:139] offset:9216
ds_read_b64_tr_b16 v[200:201], v236 offset:0
ds_read_b64_tr_b16 v[204:205], v237 offset:0
ds_read_b64_tr_b16 v[208:209], v238 offset:0
ds_read_b64_tr_b16 v[212:213], v239 offset:0
v_mfma_f32_16x16x32_bf16 v[44:47], v[224:227], v[176:179], v[44:47]
v_mfma_f32_16x16x32_bf16 v[64:67], v[228:231], v[176:179], v[64:67]
ds_read_b64_tr_b16 v[202:203], v236 offset:32768
ds_read_b64_tr_b16 v[206:207], v237 offset:32768
ds_read_b64_tr_b16 v[210:211], v238 offset:32768
ds_read_b64_tr_b16 v[214:215], v239 offset:32768
v_mfma_f32_16x16x32_bf16 v[8:11], v[216:219], v[180:183], v[8:11]
v_mfma_f32_16x16x32_bf16 v[28:31], v[220:223], v[180:183], v[28:31]
s_mov_b32 m0, s5
s_mov_b32 s9, 178176
buffer_load_dwordx4 v232, s[28:31], s9 offen offset:2048 nt lds
s_mov_b32 s8, 181248
buffer_load_dwordx4 v232, s[28:31], s8 offen offset:3072 nt lds
v_mfma_f32_16x16x32_bf16 v[48:51], v[224:227], v[180:183], v[48:51]
v_mfma_f32_16x16x32_bf16 v[68:71], v[228:231], v[180:183], v[68:71]
v_mfma_f32_16x16x32_bf16 v[12:15], v[216:219], v[184:187], v[12:15]
v_mfma_f32_16x16x32_bf16 v[32:35], v[220:223], v[184:187], v[32:35]
v_mfma_f32_16x16x32_bf16 v[52:55], v[224:227], v[184:187], v[52:55]
v_mfma_f32_16x16x32_bf16 v[72:75], v[228:231], v[184:187], v[72:75]
v_mfma_f32_16x16x32_bf16 v[16:19], v[216:219], v[188:191], v[16:19]
v_mfma_f32_16x16x32_bf16 v[36:39], v[220:223], v[188:191], v[36:39]
v_mfma_f32_16x16x32_bf16 v[56:59], v[224:227], v[188:191], v[56:59]
s_waitcnt lgkmcnt(8)
s_barrier
ds_read_b128 v[160:163], v244 offset:0
ds_read_b128 v[164:167], v244 offset:1024
ds_read_b128 v[168:171], v244 offset:2048
v_mfma_f32_16x16x32_bf16 v[76:79], v[228:231], v[188:191], v[76:79]
ds_read_b128 v[172:175], v244 offset:3072
ds_read_b128 v[176:179], v244 offset:4096
ds_read_b128 v[180:183], v244 offset:5120
s_waitcnt lgkmcnt(5)
v_mfma_f32_16x16x32_bf16 v[0:3], v[200:203], v[160:163], v[0:3]
ds_read_b128 v[184:187], v244 offset:6144
ds_read_b128 v[188:191], v244 offset:7168
v_mfma_f32_16x16x32_bf16 v[20:23], v[204:207], v[160:163], v[20:23]
v_mfma_f32_16x16x32_bf16 v[40:43], v[208:211], v[160:163], v[40:43]
v_mfma_f32_16x16x32_bf16 v[60:63], v[212:215], v[160:163], v[60:63]
ds_read_b128 v[160:163], v244 offset:8192
s_waitcnt lgkmcnt(7)
v_mfma_f32_16x16x32_bf16 v[4:7], v[200:203], v[164:167], v[4:7]
s_waitcnt vmcnt(4)
s_barrier
v_mfma_f32_16x16x32_bf16 v[24:27], v[204:207], v[164:167], v[24:27]
ds_read_b64_tr_b16 v[216:217], v236 offset:2048
ds_read_b64_tr_b16 v[220:221], v237 offset:2048
ds_read_b64_tr_b16 v[224:225], v238 offset:2048
ds_read_b64_tr_b16 v[228:229], v239 offset:2048
v_mfma_f32_16x16x32_bf16 v[44:47], v[208:211], v[164:167], v[44:47]
v_mfma_f32_16x16x32_bf16 v[64:67], v[212:215], v[164:167], v[64:67]
ds_read_b128 v[164:167], v244 offset:9216
ds_read_b64_tr_b16 v[218:219], v236 offset:34816
ds_read_b64_tr_b16 v[222:223], v237 offset:34816
ds_read_b64_tr_b16 v[226:227], v238 offset:34816
ds_read_b64_tr_b16 v[230:231], v239 offset:34816
s_waitcnt lgkmcnt(15)
v_mfma_f32_16x16x32_bf16 v[8:11], v[200:203], v[168:171], v[8:11]
v_mfma_f32_16x16x32_bf16 v[28:31], v[204:207], v[168:171], v[28:31]
s_mov_b32 m0, s4
s_mov_b32 s9, 196608
buffer_load_dwordx4 v232, s[28:31], s9 offen nt lds
s_mov_b32 s8, 199680
buffer_load_dwordx4 v232, s[28:31], s8 offen offset:1024 nt lds
v_mfma_f32_16x16x32_bf16 v[48:51], v[208:211], v[168:171], v[48:51]
v_mfma_f32_16x16x32_bf16 v[68:71], v[212:215], v[168:171], v[68:71]
ds_read_b128 v[168:171], v244 offset:10240
s_waitcnt lgkmcnt(15)
v_mfma_f32_16x16x32_bf16 v[12:15], v[200:203], v[172:175], v[12:15]
v_mfma_f32_16x16x32_bf16 v[32:35], v[204:207], v[172:175], v[32:35]
v_mfma_f32_16x16x32_bf16 v[52:55], v[208:211], v[172:175], v[52:55]
v_mfma_f32_16x16x32_bf16 v[72:75], v[212:215], v[172:175], v[72:75]
ds_read_b128 v[172:175], v244 offset:11264
s_waitcnt lgkmcnt(15)
v_mfma_f32_16x16x32_bf16 v[16:19], v[200:203], v[176:179], v[16:19]
v_mfma_f32_16x16x32_bf16 v[36:39], v[204:207], v[176:179], v[36:39]
v_mfma_f32_16x16x32_bf16 v[56:59], v[208:211], v[176:179], v[56:59]
v_mfma_f32_16x16x32_bf16 v[76:79], v[212:215], v[176:179], v[76:79]
ds_read_b128 v[176:179], v244 offset:12288
s_waitcnt lgkmcnt(6)
v_mfma_f32_16x16x32_bf16 v[0:3], v[216:219], v[180:183], v[0:3]
s_waitcnt lgkmcnt(5)
v_mfma_f32_16x16x32_bf16 v[20:23], v[220:223], v[180:183], v[20:23]
s_waitcnt lgkmcnt(4)
v_mfma_f32_16x16x32_bf16 v[40:43], v[224:227], v[180:183], v[40:43]
s_waitcnt lgkmcnt(3)
v_mfma_f32_16x16x32_bf16 v[60:63], v[228:231], v[180:183], v[60:63]
ds_read_b128 v[180:183], v244 offset:13312
v_mfma_f32_16x16x32_bf16 v[4:7], v[216:219], v[184:187], v[4:7]
s_waitcnt vmcnt(4)
s_barrier
v_mfma_f32_16x16x32_bf16 v[24:27], v[220:223], v[184:187], v[24:27]
ds_read_b64_tr_b16 v[200:201], v236 offset:4096
ds_read_b64_tr_b16 v[204:205], v237 offset:4096
ds_read_b64_tr_b16 v[208:209], v238 offset:4096
ds_read_b64_tr_b16 v[212:213], v239 offset:4096
v_mfma_f32_16x16x32_bf16 v[44:47], v[224:227], v[184:187], v[44:47]
v_mfma_f32_16x16x32_bf16 v[64:67], v[228:231], v[184:187], v[64:67]
ds_read_b128 v[184:187], v244 offset:14336
ds_read_b64_tr_b16 v[202:203], v236 offset:36864
ds_read_b64_tr_b16 v[206:207], v237 offset:36864
ds_read_b64_tr_b16 v[210:211], v238 offset:36864
ds_read_b64_tr_b16 v[214:215], v239 offset:36864
v_mfma_f32_16x16x32_bf16 v[8:11], v[216:219], v[188:191], v[8:11]
v_mfma_f32_16x16x32_bf16 v[28:31], v[220:223], v[188:191], v[28:31]
s_mov_b32 m0, s4
s_mov_b32 s9, 210944
buffer_load_dwordx4 v232, s[28:31], s9 offen offset:2048 nt lds
s_mov_b32 s8, 214016
buffer_load_dwordx4 v232, s[28:31], s8 offen offset:3072 nt lds
v_mfma_f32_16x16x32_bf16 v[48:51], v[224:227], v[188:191], v[48:51]
v_mfma_f32_16x16x32_bf16 v[68:71], v[228:231], v[188:191], v[68:71]
ds_read_b128 v[188:191], v244 offset:15360
v_mfma_f32_16x16x32_bf16 v[12:15], v[216:219], v[160:163], v[12:15]
v_mfma_f32_16x16x32_bf16 v[32:35], v[220:223], v[160:163], v[32:35]
v_mfma_f32_16x16x32_bf16 v[52:55], v[224:227], v[160:163], v[52:55]
v_mfma_f32_16x16x32_bf16 v[72:75], v[228:231], v[160:163], v[72:75]
ds_read_b128 v[160:163], v244 offset:16384
v_mfma_f32_16x16x32_bf16 v[16:19], v[216:219], v[164:167], v[16:19]
v_mfma_f32_16x16x32_bf16 v[36:39], v[220:223], v[164:167], v[36:39]
v_mfma_f32_16x16x32_bf16 v[56:59], v[224:227], v[164:167], v[56:59]
v_mfma_f32_16x16x32_bf16 v[76:79], v[228:231], v[164:167], v[76:79]
ds_read_b128 v[164:167], v244 offset:17408
s_waitcnt lgkmcnt(6)
v_mfma_f32_16x16x32_bf16 v[0:3], v[200:203], v[168:171], v[0:3]
s_mul_i32 s10, s98, 143360
s_add_u32 s20, s84, s10
s_addc_u32 s21, s85, 0
s_mov_b32 s22, 143360
s_mov_b32 s23, 0x20000
s_mul_i32 s10, s97, 560
s_lshl_b32 s11, s3, 6
s_add_u32 s11, s11, s10
s_add_u32 s10, s10, 512
v_add_u32 v104, s11, v235
v_add_u32 v105, s10, v235
v_lshlrev_b32 v112, 4, v104
v_lshrrev_b32 v106, 6, v104
v_mul_u32_u24 v107, 205, v106
v_lshrrev_b32 v107, 10, v107
v_mul_u32_u24 v108, 5, v107
v_sub_u32 v108, v106, v108
v_and_b32 v109, 15, v104
v_lshl_add_u32 v108, v108, 4, v109
v_mul_u32_u24 v108, 1792, v108
v_lshl_add_u32 v108, v107, 6, v108
v_bfe_u32 v109, v104, 4, 2
v_lshl_add_u32 v114, v109, 3, v108
v_lshlrev_b32 v113, 4, v105
v_lshrrev_b32 v106, 6, v105
v_mul_u32_u24 v107, 205, v106
v_lshrrev_b32 v107, 10, v107
v_mul_u32_u24 v108, 5, v107
v_sub_u32 v108, v106, v108
v_and_b32 v109, 15, v105
v_lshl_add_u32 v108, v108, 4, v109
v_mul_u32_u24 v108, 1792, v108
v_lshl_add_u32 v108, v107, 6, v108
v_bfe_u32 v109, v105, 4, 2
v_lshl_add_u32 v115, v109, 3, v108
v_cmp_gt_u32 vcc, 48, v235
v_mov_b32 v106, 0x7ff00000
s_nop 1
v_cndmask_b32 v113, v106, v113, vcc
v_cndmask_b32 v115, v106, v115, vcc
s_waitcnt lgkmcnt(5)
v_mfma_f32_16x16x32_bf16 v[20:23], v[204:207], v[168:171], v[20:23]
s_waitcnt lgkmcnt(4)
v_mfma_f32_16x16x32_bf16 v[40:43], v[208:211], v[168:171], v[40:43]
s_waitcnt lgkmcnt(3)
v_mfma_f32_16x16x32_bf16 v[60:63], v[212:215], v[168:171], v[60:63]
ds_read_b128 v[168:171], v244 offset:18432
v_mfma_f32_16x16x32_bf16 v[4:7], v[200:203], v[172:175], v[4:7]
s_waitcnt vmcnt(4)
s_barrier
v_mfma_f32_16x16x32_bf16 v[24:27], v[204:207], v[172:175], v[24:27]
ds_read_b64_tr_b16 v[216:217], v236 offset:6144
ds_read_b64_tr_b16 v[220:221], v237 offset:6144
ds_read_b64_tr_b16 v[224:225], v238 offset:6144
ds_read_b64_tr_b16 v[228:229], v239 offset:6144
v_mfma_f32_16x16x32_bf16 v[44:47], v[208:211], v[172:175], v[44:47]
v_mfma_f32_16x16x32_bf16 v[64:67], v[212:215], v[172:175], v[64:67]
ds_read_b128 v[172:175], v244 offset:19456
ds_read_b64_tr_b16 v[218:219], v236 offset:38912
ds_read_b64_tr_b16 v[222:223], v237 offset:38912
ds_read_b64_tr_b16 v[226:227], v238 offset:38912
ds_read_b64_tr_b16 v[230:231], v239 offset:38912
v_mfma_f32_16x16x32_bf16 v[8:11], v[200:203], v[176:179], v[8:11]
v_mfma_f32_16x16x32_bf16 v[28:31], v[204:207], v[176:179], v[28:31]
s_mov_b32 m0, s5
s_mov_b32 s9, 229376
buffer_load_dwordx4 v232, s[28:31], s9 offen nt lds
s_mov_b32 s8, 232448
buffer_load_dwordx4 v232, s[28:31], s8 offen offset:1024 nt lds
v_mfma_f32_16x16x32_bf16 v[48:51], v[208:211], v[176:179], v[48:51]
v_mfma_f32_16x16x32_bf16 v[68:71], v[212:215], v[176:179], v[68:71]
ds_read_b128 v[176:179], v244 offset:20480
v_mfma_f32_16x16x32_bf16 v[12:15], v[200:203], v[180:183], v[12:15]
v_mfma_f32_16x16x32_bf16 v[32:35], v[204:207], v[180:183], v[32:35]
v_mfma_f32_16x16x32_bf16 v[52:55], v[208:211], v[180:183], v[52:55]
v_mfma_f32_16x16x32_bf16 v[72:75], v[212:215], v[180:183], v[72:75]
ds_read_b128 v[180:183], v244 offset:21504
v_mfma_f32_16x16x32_bf16 v[16:19], v[200:203], v[184:187], v[16:19]
v_mfma_f32_16x16x32_bf16 v[36:39], v[204:207], v[184:187], v[36:39]
v_mfma_f32_16x16x32_bf16 v[56:59], v[208:211], v[184:187], v[56:59]
v_mfma_f32_16x16x32_bf16 v[76:79], v[212:215], v[184:187], v[76:79]
ds_read_b128 v[184:187], v244 offset:22528
s_waitcnt lgkmcnt(6)
v_mfma_f32_16x16x32_bf16 v[0:3], v[216:219], v[188:191], v[0:3]
v_and_b32 v253, 15, v235
v_lshlrev_b32 v253, 4, v253
s_lshl_b32 s10, s14, 11
s_add_u32 s10, s10, 151552
v_add_u32 v253, s10, v253
ds_read_b128 v[140:143], v253 offset:0
ds_read_b128 v[144:147], v253 offset:256
ds_read_b128 v[148:151], v253 offset:512
ds_read_b128 v[152:155], v253 offset:768
ds_read_b128 v[156:159], v253 offset:1024
s_waitcnt lgkmcnt(4)
v_pk_add_f32 v[140:141], v[140:141], v[142:143]
v_add_f32 v246, v140, v141
s_waitcnt lgkmcnt(3)
v_pk_add_f32 v[144:145], v[144:145], v[146:147]
v_add_f32 v247, v144, v145
s_waitcnt lgkmcnt(2)
v_pk_add_f32 v[148:149], v[148:149], v[150:151]
v_add_f32 v248, v148, v149
s_waitcnt lgkmcnt(1)
v_pk_add_f32 v[152:153], v[152:153], v[154:155]
v_add_f32 v249, v152, v153
s_waitcnt lgkmcnt(0)
v_pk_add_f32 v[156:157], v[156:157], v[158:159]
v_add_f32 v250, v156, v157
v_rcp_f32 v246, v246
v_rcp_f32 v247, v247
v_rcp_f32 v248, v248
v_rcp_f32 v249, v249
v_rcp_f32 v250, v250
v_mfma_f32_16x16x32_bf16 v[20:23], v[220:223], v[188:191], v[20:23]
v_mfma_f32_16x16x32_bf16 v[40:43], v[224:227], v[188:191], v[40:43]
v_mfma_f32_16x16x32_bf16 v[60:63], v[228:231], v[188:191], v[60:63]
ds_read_b128 v[188:191], v244 offset:23552
v_mfma_f32_16x16x32_bf16 v[4:7], v[216:219], v[160:163], v[4:7]
s_waitcnt vmcnt(4)
s_barrier
v_mfma_f32_16x16x32_bf16 v[24:27], v[220:223], v[160:163], v[24:27]
ds_read_b64_tr_b16 v[200:201], v236 offset:0
ds_read_b64_tr_b16 v[204:205], v237 offset:0
ds_read_b64_tr_b16 v[208:209], v238 offset:0
ds_read_b64_tr_b16 v[212:213], v239 offset:0
v_mfma_f32_16x16x32_bf16 v[44:47], v[224:227], v[160:163], v[44:47]
v_mfma_f32_16x16x32_bf16 v[64:67], v[228:231], v[160:163], v[64:67]
ds_read_b128 v[160:163], v244 offset:24576
ds_read_b64_tr_b16 v[202:203], v236 offset:32768
ds_read_b64_tr_b16 v[206:207], v237 offset:32768
ds_read_b64_tr_b16 v[210:211], v238 offset:32768
ds_read_b64_tr_b16 v[214:215], v239 offset:32768
v_mfma_f32_16x16x32_bf16 v[8:11], v[216:219], v[164:167], v[8:11]
v_mfma_f32_16x16x32_bf16 v[28:31], v[220:223], v[164:167], v[28:31]
s_mov_b32 m0, s5
s_mov_b32 s9, 243712
buffer_load_dwordx4 v232, s[28:31], s9 offen offset:2048 nt lds
s_mov_b32 s8, 246784
buffer_load_dwordx4 v232, s[28:31], s8 offen offset:3072 nt lds
v_mfma_f32_16x16x32_bf16 v[48:51], v[224:227], v[164:167], v[48:51]
v_mfma_f32_16x16x32_bf16 v[68:71], v[228:231], v[164:167], v[68:71]
ds_read_b128 v[164:167], v244 offset:25600
v_mfma_f32_16x16x32_bf16 v[12:15], v[216:219], v[168:171], v[12:15]
v_mfma_f32_16x16x32_bf16 v[32:35], v[220:223], v[168:171], v[32:35]
v_mfma_f32_16x16x32_bf16 v[52:55], v[224:227], v[168:171], v[52:55]
v_mfma_f32_16x16x32_bf16 v[72:75], v[228:231], v[168:171], v[72:75]
ds_read_b128 v[168:171], v244 offset:26624
v_mfma_f32_16x16x32_bf16 v[16:19], v[216:219], v[172:175], v[16:19]
v_mfma_f32_16x16x32_bf16 v[36:39], v[220:223], v[172:175], v[36:39]
v_mfma_f32_16x16x32_bf16 v[56:59], v[224:227], v[172:175], v[56:59]
v_mfma_f32_16x16x32_bf16 v[76:79], v[228:231], v[172:175], v[76:79]
ds_read_b128 v[172:175], v244 offset:27648
s_waitcnt lgkmcnt(6)
v_mfma_f32_16x16x32_bf16 v[0:3], v[200:203], v[176:179], v[0:3]
s_waitcnt lgkmcnt(5)
v_mfma_f32_16x16x32_bf16 v[20:23], v[204:207], v[176:179], v[20:23]
s_waitcnt lgkmcnt(4)
v_mfma_f32_16x16x32_bf16 v[40:43], v[208:211], v[176:179], v[40:43]
s_waitcnt lgkmcnt(3)
v_mfma_f32_16x16x32_bf16 v[60:63], v[212:215], v[176:179], v[60:63]
ds_read_b128 v[176:179], v244 offset:28672
v_mfma_f32_16x16x32_bf16 v[4:7], v[200:203], v[180:183], v[4:7]
s_waitcnt vmcnt(4)
s_barrier
v_mfma_f32_16x16x32_bf16 v[24:27], v[204:207], v[180:183], v[24:27]
ds_read_b64_tr_b16 v[216:217], v236 offset:2048
ds_read_b64_tr_b16 v[220:221], v237 offset:2048
ds_read_b64_tr_b16 v[224:225], v238 offset:2048
ds_read_b64_tr_b16 v[228:229], v239 offset:2048
v_mfma_f32_16x16x32_bf16 v[44:47], v[208:211], v[180:183], v[44:47]
v_mfma_f32_16x16x32_bf16 v[64:67], v[212:215], v[180:183], v[64:67]
ds_read_b128 v[180:183], v244 offset:29696
ds_read_b64_tr_b16 v[218:219], v236 offset:34816
ds_read_b64_tr_b16 v[222:223], v237 offset:34816
ds_read_b64_tr_b16 v[226:227], v238 offset:34816
ds_read_b64_tr_b16 v[230:231], v239 offset:34816
v_mfma_f32_16x16x32_bf16 v[8:11], v[200:203], v[184:187], v[8:11]
v_mfma_f32_16x16x32_bf16 v[28:31], v[204:207], v[184:187], v[28:31]
s_mov_b32 m0, s4
s_add_u32 s9, s76, 0
buffer_load_dwordx4 v234, s[32:35], s9 offen lds
s_add_u32 s8, s76, 6144
buffer_load_dwordx4 v234, s[32:35], s8 offen offset:1024 lds
v_mfma_f32_16x16x32_bf16 v[48:51], v[208:211], v[184:187], v[48:51]
s_cmp_lg_u32 s3, 0
s_cbranch_scc1 L_fBAgo
v_readfirstlane_b32 s10, v255
s_nop 3
s_cmp_ge_u32 s10, 8
s_cbranch_scc1 L_fBAgo
s_lshl_b32 s10, s98, 2
v_mov_b32 v116, s10
L_fBApoll:
s_mov_b64 exec, 1
global_load_dword v117, v116, s[86:87] offset:128 sc1
s_mov_b64 exec, -1
s_waitcnt vmcnt(0)
v_readfirstlane_b32 s10, v117
s_nop 3
s_cmp_ge_u32 s10, 8
s_cbranch_scc1 L_fBAgo
s_sleep 4
s_branch L_fBApoll
L_fBAgo:
v_mfma_f32_16x16x32_bf16 v[68:71], v[212:215], v[184:187], v[68:71]
ds_read_b128 v[184:187], v244 offset:30720
v_mfma_f32_16x16x32_bf16 v[12:15], v[200:203], v[188:191], v[12:15]
v_mfma_f32_16x16x32_bf16 v[32:35], v[204:207], v[188:191], v[32:35]
v_mfma_f32_16x16x32_bf16 v[52:55], v[208:211], v[188:191], v[52:55]
v_mfma_f32_16x16x32_bf16 v[72:75], v[212:215], v[188:191], v[72:75]
ds_read_b128 v[188:191], v244 offset:31744
v_mfma_f32_16x16x32_bf16 v[16:19], v[200:203], v[160:163], v[16:19]
v_mfma_f32_16x16x32_bf16 v[36:39], v[204:207], v[160:163], v[36:39]
v_mfma_f32_16x16x32_bf16 v[56:59], v[208:211], v[160:163], v[56:59]
v_mfma_f32_16x16x32_bf16 v[76:79], v[212:215], v[160:163], v[76:79]
ds_read_b128 v[160:163], v244 offset:32768
s_waitcnt lgkmcnt(6)
v_mfma_f32_16x16x32_bf16 v[0:3], v[216:219], v[164:167], v[0:3]
s_waitcnt lgkmcnt(5)
v_mfma_f32_16x16x32_bf16 v[20:23], v[220:223], v[164:167], v[20:23]
s_waitcnt lgkmcnt(4)
v_mfma_f32_16x16x32_bf16 v[40:43], v[224:227], v[164:167], v[40:43]
s_waitcnt lgkmcnt(3)
v_mfma_f32_16x16x32_bf16 v[60:63], v[228:231], v[164:167], v[60:63]
ds_read_b128 v[164:167], v244 offset:33792
v_mfma_f32_16x16x32_bf16 v[4:7], v[216:219], v[168:171], v[4:7]
s_waitcnt vmcnt(4)
s_barrier
v_mfma_f32_16x16x32_bf16 v[24:27], v[220:223], v[168:171], v[24:27]
ds_read_b64_tr_b16 v[200:201], v236 offset:4096
ds_read_b64_tr_b16 v[204:205], v237 offset:4096
ds_read_b64_tr_b16 v[208:209], v238 offset:4096
ds_read_b64_tr_b16 v[212:213], v239 offset:4096
v_mfma_f32_16x16x32_bf16 v[44:47], v[224:227], v[168:171], v[44:47]
v_mfma_f32_16x16x32_bf16 v[64:67], v[228:231], v[168:171], v[64:67]
ds_read_b128 v[168:171], v244 offset:34816
ds_read_b64_tr_b16 v[202:203], v236 offset:36864
ds_read_b64_tr_b16 v[206:207], v237 offset:36864
ds_read_b64_tr_b16 v[210:211], v238 offset:36864
ds_read_b64_tr_b16 v[214:215], v239 offset:36864
v_mfma_f32_16x16x32_bf16 v[8:11], v[216:219], v[172:175], v[8:11]
v_mfma_f32_16x16x32_bf16 v[28:31], v[220:223], v[172:175], v[28:31]
s_mov_b32 m0, s4
s_add_u32 s9, s76, 12288
buffer_load_dwordx4 v234, s[32:35], s9 offen offset:2048 lds
s_add_u32 s8, s76, 18432
buffer_load_dwordx4 v234, s[32:35], s8 offen offset:3072 lds
v_mfma_f32_16x16x32_bf16 v[48:51], v[224:227], v[172:175], v[48:51]
v_mfma_f32_16x16x32_bf16 v[68:71], v[228:231], v[172:175], v[68:71]
ds_read_b128 v[172:175], v244 offset:35840
v_mfma_f32_16x16x32_bf16 v[12:15], v[216:219], v[176:179], v[12:15]
v_mfma_f32_16x16x32_bf16 v[32:35], v[220:223], v[176:179], v[32:35]
v_mfma_f32_16x16x32_bf16 v[52:55], v[224:227], v[176:179], v[52:55]
v_mfma_f32_16x16x32_bf16 v[72:75], v[228:231], v[176:179], v[72:75]
ds_read_b128 v[176:179], v244 offset:36864
v_mfma_f32_16x16x32_bf16 v[16:19], v[216:219], v[180:183], v[16:19]
v_mfma_f32_16x16x32_bf16 v[36:39], v[220:223], v[180:183], v[36:39]
v_mfma_f32_16x16x32_bf16 v[56:59], v[224:227], v[180:183], v[56:59]
v_mfma_f32_16x16x32_bf16 v[76:79], v[228:231], v[180:183], v[76:79]
ds_read_b128 v[180:183], v244 offset:37888
s_waitcnt lgkmcnt(6)
v_mfma_f32_16x16x32_bf16 v[0:3], v[200:203], v[184:187], v[0:3]
s_waitcnt lgkmcnt(5)
v_mfma_f32_16x16x32_bf16 v[20:23], v[204:207], v[184:187], v[20:23]
s_waitcnt lgkmcnt(4)
v_mfma_f32_16x16x32_bf16 v[40:43], v[208:211], v[184:187], v[40:43]
s_waitcnt lgkmcnt(3)
v_mfma_f32_16x16x32_bf16 v[60:63], v[212:215], v[184:187], v[60:63]
ds_read_b128 v[184:187], v244 offset:38912
v_mfma_f32_16x16x32_bf16 v[4:7], v[200:203], v[188:191], v[4:7]
s_waitcnt vmcnt(4)
s_barrier
v_mfma_f32_16x16x32_bf16 v[24:27], v[204:207], v[188:191], v[24:27]
ds_read_b64_tr_b16 v[216:217], v236 offset:6144
ds_read_b64_tr_b16 v[220:221], v237 offset:6144
ds_read_b64_tr_b16 v[224:225], v238 offset:6144
ds_read_b64_tr_b16 v[228:229], v239 offset:6144
v_mfma_f32_16x16x32_bf16 v[44:47], v[208:211], v[188:191], v[44:47]
v_mfma_f32_16x16x32_bf16 v[64:67], v[212:215], v[188:191], v[64:67]
ds_read_b128 v[188:191], v244 offset:39936
ds_read_b64_tr_b16 v[218:219], v236 offset:38912
ds_read_b64_tr_b16 v[222:223], v237 offset:38912
ds_read_b64_tr_b16 v[226:227], v238 offset:38912
ds_read_b64_tr_b16 v[230:231], v239 offset:38912
v_mfma_f32_16x16x32_bf16 v[8:11], v[200:203], v[160:163], v[8:11]
v_mfma_f32_16x16x32_bf16 v[28:31], v[204:207], v[160:163], v[28:31]
s_mov_b32 m0, s5
s_add_u32 s9, s76, 28672
buffer_load_dwordx4 v234, s[32:35], s9 offen lds
s_add_u32 s8, s76, 34816
buffer_load_dwordx4 v234, s[32:35], s8 offen offset:1024 lds
v_mfma_f32_16x16x32_bf16 v[48:51], v[208:211], v[160:163], v[48:51]
v_mfma_f32_16x16x32_bf16 v[68:71], v[212:215], v[160:163], v[68:71]
v_mfma_f32_16x16x32_bf16 v[12:15], v[200:203], v[164:167], v[12:15]
v_mfma_f32_16x16x32_bf16 v[32:35], v[204:207], v[164:167], v[32:35]
v_mfma_f32_16x16x32_bf16 v[52:55], v[208:211], v[164:167], v[52:55]
v_mfma_f32_16x16x32_bf16 v[72:75], v[212:215], v[164:167], v[72:75]
v_mfma_f32_16x16x32_bf16 v[16:19], v[200:203], v[168:171], v[16:19]
s_waitcnt lgkmcnt(4)
s_barrier
v_mfma_f32_16x16x32_bf16 v[36:39], v[204:207], v[168:171], v[36:39]
v_mfma_f32_16x16x32_bf16 v[56:59], v[208:211], v[168:171], v[56:59]
v_mfma_f32_16x16x32_bf16 v[76:79], v[212:215], v[168:171], v[76:79]
s_waitcnt lgkmcnt(3)
v_mfma_f32_16x16x32_bf16 v[0:3], v[216:219], v[172:175], v[0:3]
s_waitcnt lgkmcnt(2)
v_mfma_f32_16x16x32_bf16 v[20:23], v[220:223], v[172:175], v[20:23]
s_waitcnt lgkmcnt(0)
s_barrier
s_mov_b32 m0, s5
s_add_u32 s9, s76, 40960
buffer_load_dwordx4 v234, s[32:35], s9 offen offset:2048 lds
s_add_u32 s8, s76, 47104
buffer_load_dwordx4 v234, s[32:35], s8 offen offset:3072 lds
s_waitcnt vmcnt(6)
v_add_u32 v236, s13, v236
v_add_u32 v237, s13, v237
v_add_u32 v238, s13, v238
v_add_u32 v239, s13, v239
v_add_u32 v240, s13, v240
v_add_u32 v241, s13, v241
ds_read_b64_tr_b16 v[200:201], v236 offset:0
ds_read_b64_tr_b16 v[204:205], v237 offset:0
ds_read_b64_tr_b16 v[208:209], v238 offset:0
ds_read_b64_tr_b16 v[212:213], v239 offset:0
v_mfma_f32_16x16x32_bf16 v[40:43], v[224:227], v[172:175], v[40:43]
v_mfma_f32_16x16x32_bf16 v[60:63], v[228:231], v[172:175], v[60:63]
v_mfma_f32_16x16x32_bf16 v[4:7], v[216:219], v[176:179], v[4:7]
v_mfma_f32_16x16x32_bf16 v[24:27], v[220:223], v[176:179], v[24:27]
v_mfma_f32_16x16x32_bf16 v[44:47], v[224:227], v[176:179], v[44:47]
s_waitcnt lgkmcnt(0)
s_mov_b32 m0, s4
s_add_u32 s9, s77, 0
buffer_load_dwordx4 v234, s[32:35], s9 offen lds
s_add_u32 s8, s77, 6144
buffer_load_dwordx4 v234, s[32:35], s8 offen offset:1024 lds
v_mfma_f32_16x16x32_bf16 v[64:67], v[228:231], v[176:179], v[64:67]
v_mfma_f32_16x16x32_bf16 v[8:11], v[216:219], v[180:183], v[8:11]
s_waitcnt vmcnt(6)
ds_read_b64_tr_b16 v[202:203], v236 offset:2048
ds_read_b64_tr_b16 v[206:207], v237 offset:2048
ds_read_b64_tr_b16 v[210:211], v238 offset:2048
ds_read_b64_tr_b16 v[214:215], v239 offset:2048
v_mfma_f32_16x16x32_bf16 v[28:31], v[220:223], v[180:183], v[28:31]
v_mfma_f32_16x16x32_bf16 v[48:51], v[224:227], v[180:183], v[48:51]
v_mfma_f32_16x16x32_bf16 v[68:71], v[228:231], v[180:183], v[68:71]
v_mfma_f32_16x16x32_bf16 v[12:15], v[216:219], v[184:187], v[12:15]
v_mfma_f32_16x16x32_bf16 v[32:35], v[220:223], v[184:187], v[32:35]
s_waitcnt lgkmcnt(0)
s_mov_b32 m0, s4
s_add_u32 s9, s77, 12288
buffer_load_dwordx4 v234, s[32:35], s9 offen offset:2048 lds
s_add_u32 s8, s77, 18432
buffer_load_dwordx4 v234, s[32:35], s8 offen offset:3072 lds
v_mfma_f32_16x16x32_bf16 v[52:55], v[224:227], v[184:187], v[52:55]
v_mfma_f32_16x16x32_bf16 v[72:75], v[228:231], v[184:187], v[72:75]
v_mfma_f32_16x16x32_bf16 v[16:19], v[216:219], v[188:191], v[16:19]
v_mfma_f32_16x16x32_bf16 v[36:39], v[220:223], v[188:191], v[36:39]
v_mfma_f32_16x16x32_bf16 v[56:59], v[224:227], v[188:191], v[56:59]
v_mfma_f32_16x16x32_bf16 v[76:79], v[228:231], v[188:191], v[76:79]
s_nop 7
v_add_u32 v252, s71, v242
v_mul_f32 v0, v0, v246
v_mul_f32 v1, v1, v246
v_mul_f32 v2, v2, v246
v_mul_f32 v3, v3, v246
v_mul_f32 v20, v20, v246
v_mul_f32 v21, v21, v246
v_mul_f32 v22, v22, v246
v_mul_f32 v23, v23, v246
v_cvt_pk_bf16_f32 v0, v0, v1
v_cvt_pk_bf16_f32 v1, v2, v3
v_cvt_pk_bf16_f32 v2, v20, v21
v_cvt_pk_bf16_f32 v3, v22, v23
ds_write_b128 v252, v[0:3] offset:0
v_mul_f32 v40, v40, v246
v_mul_f32 v41, v41, v246
v_mul_f32 v42, v42, v246
v_mul_f32 v43, v43, v246
v_mul_f32 v60, v60, v246
v_mul_f32 v61, v61, v246
v_mul_f32 v62, v62, v246
v_mul_f32 v63, v63, v246
v_cvt_pk_bf16_f32 v40, v40, v41
v_cvt_pk_bf16_f32 v41, v42, v43
v_cvt_pk_bf16_f32 v42, v60, v61
v_cvt_pk_bf16_f32 v43, v62, v63
ds_write_b128 v252, v[40:43] offset:5120
v_mul_f32 v4, v4, v247
v_mul_f32 v5, v5, v247
v_mul_f32 v6, v6, v247
v_mul_f32 v7, v7, v247
v_mul_f32 v24, v24, v247
v_mul_f32 v25, v25, v247
v_mul_f32 v26, v26, v247
v_mul_f32 v27, v27, v247
v_cvt_pk_bf16_f32 v4, v4, v5
v_cvt_pk_bf16_f32 v5, v6, v7
v_cvt_pk_bf16_f32 v6, v24, v25
v_cvt_pk_bf16_f32 v7, v26, v27
ds_write_b128 v252, v[4:7] offset:1024
v_mul_f32 v44, v44, v247
v_mul_f32 v45, v45, v247
v_mul_f32 v46, v46, v247
v_mul_f32 v47, v47, v247
v_mul_f32 v64, v64, v247
v_mul_f32 v65, v65, v247
v_mul_f32 v66, v66, v247
v_mul_f32 v67, v67, v247
v_cvt_pk_bf16_f32 v44, v44, v45
v_cvt_pk_bf16_f32 v45, v46, v47
v_cvt_pk_bf16_f32 v46, v64, v65
v_cvt_pk_bf16_f32 v47, v66, v67
ds_write_b128 v252, v[44:47] offset:6144
v_mul_f32 v8, v8, v248
v_mul_f32 v9, v9, v248
v_mul_f32 v10, v10, v248
v_mul_f32 v11, v11, v248
v_mul_f32 v28, v28, v248
v_mul_f32 v29, v29, v248
v_mul_f32 v30, v30, v248
v_mul_f32 v31, v31, v248
v_cvt_pk_bf16_f32 v8, v8, v9
v_cvt_pk_bf16_f32 v9, v10, v11
v_cvt_pk_bf16_f32 v10, v28, v29
v_cvt_pk_bf16_f32 v11, v30, v31
ds_write_b128 v252, v[8:11] offset:2048
v_mul_f32 v48, v48, v248
v_mul_f32 v49, v49, v248
v_mul_f32 v50, v50, v248
v_mul_f32 v51, v51, v248
v_mul_f32 v68, v68, v248
v_mul_f32 v69, v69, v248
v_mul_f32 v70, v70, v248
v_mul_f32 v71, v71, v248
v_cvt_pk_bf16_f32 v48, v48, v49
v_cvt_pk_bf16_f32 v49, v50, v51
v_cvt_pk_bf16_f32 v50, v68, v69
v_cvt_pk_bf16_f32 v51, v70, v71
ds_write_b128 v252, v[48:51] offset:7168
v_mul_f32 v12, v12, v249
v_mul_f32 v13, v13, v249
v_mul_f32 v14, v14, v249
v_mul_f32 v15, v15, v249
v_mul_f32 v32, v32, v249
v_mul_f32 v33, v33, v249
v_mul_f32 v34, v34, v249
v_mul_f32 v35, v35, v249
v_cvt_pk_bf16_f32 v12, v12, v13
v_cvt_pk_bf16_f32 v13, v14, v15
v_cvt_pk_bf16_f32 v14, v32, v33
v_cvt_pk_bf16_f32 v15, v34, v35
ds_write_b128 v252, v[12:15] offset:3072
v_mul_f32 v52, v52, v249
v_mul_f32 v53, v53, v249
v_mul_f32 v54, v54, v249
v_mul_f32 v55, v55, v249
v_mul_f32 v72, v72, v249
v_mul_f32 v73, v73, v249
v_mul_f32 v74, v74, v249
v_mul_f32 v75, v75, v249
v_cvt_pk_bf16_f32 v52, v52, v53
v_cvt_pk_bf16_f32 v53, v54, v55
v_cvt_pk_bf16_f32 v54, v72, v73
v_cvt_pk_bf16_f32 v55, v74, v75
ds_write_b128 v252, v[52:55] offset:8192
v_mul_f32 v16, v16, v250
v_mul_f32 v17, v17, v250
v_mul_f32 v18, v18, v250
v_mul_f32 v19, v19, v250
v_mul_f32 v36, v36, v250
v_mul_f32 v37, v37, v250
v_mul_f32 v38, v38, v250
v_mul_f32 v39, v39, v250
v_cvt_pk_bf16_f32 v16, v16, v17
v_cvt_pk_bf16_f32 v17, v18, v19
v_cvt_pk_bf16_f32 v18, v36, v37
v_cvt_pk_bf16_f32 v19, v38, v39
ds_write_b128 v252, v[16:19] offset:4096
v_mul_f32 v56, v56, v250
v_mul_f32 v57, v57, v250
v_mul_f32 v58, v58, v250
v_mul_f32 v59, v59, v250
v_mul_f32 v76, v76, v250
v_mul_f32 v77, v77, v250
v_mul_f32 v78, v78, v250
v_mul_f32 v79, v79, v250
v_cvt_pk_bf16_f32 v56, v56, v57
v_cvt_pk_bf16_f32 v57, v58, v59
v_cvt_pk_bf16_f32 v58, v76, v77
v_cvt_pk_bf16_f32 v59, v78, v79
ds_write_b128 v252, v[56:59] offset:9216
s_waitcnt lgkmcnt(0)
s_barrier
ds_read_b128 v[160:163], v242 offset:0
ds_read_b128 v[164:167], v242 offset:1024
ds_read_b128 v[168:171], v242 offset:2048
ds_read_b128 v[172:175], v242 offset:3072
ds_read_b128 v[176:179], v242 offset:4096
ds_read_b128 v[180:183], v242 offset:5120
ds_read_b128 v[184:187], v242 offset:6144
ds_read_b128 v[188:191], v242 offset:7168
ds_read_b128 v[192:195], v242 offset:8192
ds_read_b128 v[196:199], v242 offset:9216
s_waitcnt lgkmcnt(9)
v_mfma_f32_16x16x32_bf16 v[0:3], v[200:203], v[160:163], 0
v_mfma_f32_16x16x32_bf16 v[20:23], v[204:207], v[160:163], 0
s_waitcnt vmcnt(6)
ds_read_b64_tr_b16 v[216:217], v236 offset:4096
ds_read_b64_tr_b16 v[220:221], v237 offset:4096
ds_read_b64_tr_b16 v[224:225], v238 offset:4096
ds_read_b64_tr_b16 v[228:229], v239 offset:4096
v_mfma_f32_16x16x32_bf16 v[40:43], v[208:211], v[160:163], 0
v_mfma_f32_16x16x32_bf16 v[60:63], v[212:215], v[160:163], 0
ds_read_b128 v[160:163], v242 offset:10240
s_waitcnt lgkmcnt(13)
v_mfma_f32_16x16x32_bf16 v[4:7], v[200:203], v[164:167], 0
v_mfma_f32_16x16x32_bf16 v[24:27], v[204:207], v[164:167], 0
v_mfma_f32_16x16x32_bf16 v[44:47], v[208:211], v[164:167], 0
s_waitcnt lgkmcnt(1)
s_mov_b32 m0, s5
s_add_u32 s9, s77, 28672
buffer_load_dwordx4 v234, s[32:35], s9 offen lds
s_add_u32 s8, s77, 34816
buffer_load_dwordx4 v234, s[32:35], s8 offen offset:1024 lds
v_mfma_f32_16x16x32_bf16 v[64:67], v[212:215], v[164:167], 0
ds_read_b128 v[164:167], v242 offset:11264
v_mfma_f32_16x16x32_bf16 v[8:11], v[200:203], v[168:171], 0
s_waitcnt vmcnt(6)
ds_read_b64_tr_b16 v[218:219], v236 offset:6144
ds_read_b64_tr_b16 v[222:223], v237 offset:6144
ds_read_b64_tr_b16 v[226:227], v238 offset:6144
ds_read_b64_tr_b16 v[230:231], v239 offset:6144
v_mfma_f32_16x16x32_bf16 v[28:31], v[204:207], v[168:171], 0
v_mfma_f32_16x16x32_bf16 v[48:51], v[208:211], v[168:171], 0
v_mfma_f32_16x16x32_bf16 v[68:71], v[212:215], v[168:171], 0
ds_read_b128 v[168:171], v242 offset:12288
v_mfma_f32_16x16x32_bf16 v[12:15], v[200:203], v[172:175], 0
v_mfma_f32_16x16x32_bf16 v[32:35], v[204:207], v[172:175], 0
s_waitcnt lgkmcnt(1)
s_mov_b32 m0, s5
s_add_u32 s9, s77, 40960
buffer_load_dwordx4 v234, s[32:35], s9 offen offset:2048 lds
s_add_u32 s8, s77, 47104
buffer_load_dwordx4 v234, s[32:35], s8 offen offset:3072 lds
v_mfma_f32_16x16x32_bf16 v[52:55], v[208:211], v[172:175], 0
v_mfma_f32_16x16x32_bf16 v[72:75], v[212:215], v[172:175], 0
ds_read_b128 v[172:175], v242 offset:13312
v_mfma_f32_16x16x32_bf16 v[16:19], v[200:203], v[176:179], 0
v_mfma_f32_16x16x32_bf16 v[36:39], v[204:207], v[176:179], 0
v_mfma_f32_16x16x32_bf16 v[56:59], v[208:211], v[176:179], 0
v_mfma_f32_16x16x32_bf16 v[76:79], v[212:215], v[176:179], 0
ds_read_b128 v[176:179], v242 offset:14336
v_mfma_f32_16x16x32_bf16 v[0:3], v[216:219], v[180:183], v[0:3]
v_mfma_f32_16x16x32_bf16 v[20:23], v[220:223], v[180:183], v[20:23]
s_waitcnt vmcnt(6)
ds_read_b64_tr_b16 v[200:201], v236 offset:0
ds_read_b64_tr_b16 v[204:205], v237 offset:0
ds_read_b64_tr_b16 v[208:209], v238 offset:0
ds_read_b64_tr_b16 v[212:213], v239 offset:0
v_mfma_f32_16x16x32_bf16 v[40:43], v[224:227], v[180:183], v[40:43]
v_mfma_f32_16x16x32_bf16 v[60:63], v[228:231], v[180:183], v[60:63]
ds_read_b128 v[180:183], v242 offset:15360
v_mfma_f32_16x16x32_bf16 v[4:7], v[216:219], v[184:187], v[4:7]
v_mfma_f32_16x16x32_bf16 v[24:27], v[220:223], v[184:187], v[24:27]
v_mfma_f32_16x16x32_bf16 v[44:47], v[224:227], v[184:187], v[44:47]
s_waitcnt lgkmcnt(1)
s_mov_b32 m0, s4
s_add_u32 s9, s78, 0
buffer_load_dwordx4 v234, s[32:35], s9 offen lds
s_add_u32 s8, s78, 6144
buffer_load_dwordx4 v234, s[32:35], s8 offen offset:1024 lds
v_mfma_f32_16x16x32_bf16 v[64:67], v[228:231], v[184:187], v[64:67]
ds_read_b128 v[184:187], v242 offset:16384
v_mfma_f32_16x16x32_bf16 v[8:11], v[216:219], v[188:191], v[8:11]
s_waitcnt vmcnt(6)
ds_read_b64_tr_b16 v[202:203], v236 offset:2048
ds_read_b64_tr_b16 v[206:207], v237 offset:2048
ds_read_b64_tr_b16 v[210:211], v238 offset:2048
ds_read_b64_tr_b16 v[214:215], v239 offset:2048
v_mfma_f32_16x16x32_bf16 v[28:31], v[220:223], v[188:191], v[28:31]
v_mfma_f32_16x16x32_bf16 v[48:51], v[224:227], v[188:191], v[48:51]
v_mfma_f32_16x16x32_bf16 v[68:71], v[228:231], v[188:191], v[68:71]
ds_read_b128 v[188:191], v242 offset:17408
v_mfma_f32_16x16x32_bf16 v[12:15], v[216:219], v[192:195], v[12:15]
v_mfma_f32_16x16x32_bf16 v[32:35], v[220:223], v[192:195], v[32:35]
s_waitcnt lgkmcnt(1)
s_mov_b32 m0, s4
s_add_u32 s9, s78, 12288
buffer_load_dwordx4 v234, s[32:35], s9 offen offset:2048 lds
s_add_u32 s8, s78, 18432
buffer_load_dwordx4 v234, s[32:35], s8 offen offset:3072 lds
v_mfma_f32_16x16x32_bf16 v[52:55], v[224:227], v[192:195], v[52:55]
v_mfma_f32_16x16x32_bf16 v[72:75], v[228:231], v[192:195], v[72:75]
ds_read_b128 v[192:195], v242 offset:18432
v_mfma_f32_16x16x32_bf16 v[16:19], v[216:219], v[196:199], v[16:19]
v_mfma_f32_16x16x32_bf16 v[36:39], v[220:223], v[196:199], v[36:39]
v_mfma_f32_16x16x32_bf16 v[56:59], v[224:227], v[196:199], v[56:59]
v_mfma_f32_16x16x32_bf16 v[76:79], v[228:231], v[196:199], v[76:79]
ds_read_b128 v[196:199], v242 offset:19456
v_mfma_f32_16x16x32_bf16 v[0:3], v[200:203], v[160:163], v[0:3]
v_mfma_f32_16x16x32_bf16 v[20:23], v[204:207], v[160:163], v[20:23]
s_waitcnt vmcnt(6)
ds_read_b64_tr_b16 v[216:217], v236 offset:4096
ds_read_b64_tr_b16 v[220:221], v237 offset:4096
ds_read_b64_tr_b16 v[224:225], v238 offset:4096
ds_read_b64_tr_b16 v[228:229], v239 offset:4096
v_mfma_f32_16x16x32_bf16 v[40:43], v[208:211], v[160:163], v[40:43]
v_mfma_f32_16x16x32_bf16 v[60:63], v[212:215], v[160:163], v[60:63]
ds_read_b128 v[160:163], v242 offset:20480
v_mfma_f32_16x16x32_bf16 v[4:7], v[200:203], v[164:167], v[4:7]
v_mfma_f32_16x16x32_bf16 v[24:27], v[204:207], v[164:167], v[24:27]
v_mfma_f32_16x16x32_bf16 v[44:47], v[208:211], v[164:167], v[44:47]
s_waitcnt lgkmcnt(1)
s_mov_b32 m0, s5
s_add_u32 s9, s78, 28672
buffer_load_dwordx4 v234, s[32:35], s9 offen lds
s_add_u32 s8, s78, 34816
buffer_load_dwordx4 v234, s[32:35], s8 offen offset:1024 lds
v_mfma_f32_16x16x32_bf16 v[64:67], v[212:215], v[164:167], v[64:67]
ds_read_b128 v[164:167], v242 offset:21504
v_mfma_f32_16x16x32_bf16 v[8:11], v[200:203], v[168:171], v[8:11]
s_waitcnt vmcnt(6)
ds_read_b64_tr_b16 v[218:219], v236 offset:6144
ds_read_b64_tr_b16 v[222:223], v237 offset:6144
ds_read_b64_tr_b16 v[226:227], v238 offset:6144
ds_read_b64_tr_b16 v[230:231], v239 offset:6144
v_mfma_f32_16x16x32_bf16 v[28:31], v[204:207], v[168:171], v[28:31]
v_mfma_f32_16x16x32_bf16 v[48:51], v[208:211], v[168:171], v[48:51]
v_mfma_f32_16x16x32_bf16 v[68:71], v[212:215], v[168:171], v[68:71]
ds_read_b128 v[168:171], v242 offset:22528
v_mfma_f32_16x16x32_bf16 v[12:15], v[200:203], v[172:175], v[12:15]
v_mfma_f32_16x16x32_bf16 v[32:35], v[204:207], v[172:175], v[32:35]
s_waitcnt lgkmcnt(1)
s_mov_b32 m0, s5
s_add_u32 s9, s78, 40960
buffer_load_dwordx4 v234, s[32:35], s9 offen offset:2048 lds
s_add_u32 s8, s78, 47104
buffer_load_dwordx4 v234, s[32:35], s8 offen offset:3072 lds
v_mfma_f32_16x16x32_bf16 v[52:55], v[208:211], v[172:175], v[52:55]
v_mfma_f32_16x16x32_bf16 v[72:75], v[212:215], v[172:175], v[72:75]
ds_read_b128 v[172:175], v242 offset:23552
v_mfma_f32_16x16x32_bf16 v[16:19], v[200:203], v[176:179], v[16:19]
v_mfma_f32_16x16x32_bf16 v[36:39], v[204:207], v[176:179], v[36:39]
v_mfma_f32_16x16x32_bf16 v[56:59], v[208:211], v[176:179], v[56:59]
v_mfma_f32_16x16x32_bf16 v[76:79], v[212:215], v[176:179], v[76:79]
ds_read_b128 v[176:179], v242 offset:24576
v_mfma_f32_16x16x32_bf16 v[0:3], v[216:219], v[180:183], v[0:3]
v_mfma_f32_16x16x32_bf16 v[20:23], v[220:223], v[180:183], v[20:23]
s_waitcnt vmcnt(6)
ds_read_b64_tr_b16 v[200:201], v236 offset:0
ds_read_b64_tr_b16 v[204:205], v237 offset:0
ds_read_b64_tr_b16 v[208:209], v238 offset:0
ds_read_b64_tr_b16 v[212:213], v239 offset:0
v_mfma_f32_16x16x32_bf16 v[40:43], v[224:227], v[180:183], v[40:43]
v_mfma_f32_16x16x32_bf16 v[60:63], v[228:231], v[180:183], v[60:63]
ds_read_b128 v[180:183], v242 offset:25600
v_mfma_f32_16x16x32_bf16 v[4:7], v[216:219], v[184:187], v[4:7]
v_mfma_f32_16x16x32_bf16 v[24:27], v[220:223], v[184:187], v[24:27]
v_mfma_f32_16x16x32_bf16 v[44:47], v[224:227], v[184:187], v[44:47]
s_waitcnt lgkmcnt(1)
s_mov_b32 m0, s4
s_add_u32 s9, s79, 0
buffer_load_dwordx4 v234, s[32:35], s9 offen lds
s_add_u32 s8, s79, 6144
buffer_load_dwordx4 v234, s[32:35], s8 offen offset:1024 lds
v_mfma_f32_16x16x32_bf16 v[64:67], v[228:231], v[184:187], v[64:67]
ds_read_b128 v[184:187], v242 offset:26624
v_mfma_f32_16x16x32_bf16 v[8:11], v[216:219], v[188:191], v[8:11]
s_waitcnt vmcnt(6)
ds_read_b64_tr_b16 v[202:203], v236 offset:2048
ds_read_b64_tr_b16 v[206:207], v237 offset:2048
ds_read_b64_tr_b16 v[210:211], v238 offset:2048
ds_read_b64_tr_b16 v[214:215], v239 offset:2048
v_mfma_f32_16x16x32_bf16 v[28:31], v[220:223], v[188:191], v[28:31]
v_mfma_f32_16x16x32_bf16 v[48:51], v[224:227], v[188:191], v[48:51]
v_mfma_f32_16x16x32_bf16 v[68:71], v[228:231], v[188:191], v[68:71]
ds_read_b128 v[188:191], v242 offset:27648
v_mfma_f32_16x16x32_bf16 v[12:15], v[216:219], v[192:195], v[12:15]
v_mfma_f32_16x16x32_bf16 v[32:35], v[220:223], v[192:195], v[32:35]
s_waitcnt lgkmcnt(1)
s_mov_b32 m0, s4
s_add_u32 s9, s79, 12288
buffer_load_dwordx4 v234, s[32:35], s9 offen offset:2048 lds
s_add_u32 s8, s79, 18432
buffer_load_dwordx4 v234, s[32:35], s8 offen offset:3072 lds
v_mfma_f32_16x16x32_bf16 v[52:55], v[224:227], v[192:195], v[52:55]
v_mfma_f32_16x16x32_bf16 v[72:75], v[228:231], v[192:195], v[72:75]
ds_read_b128 v[192:195], v242 offset:28672
v_mfma_f32_16x16x32_bf16 v[16:19], v[216:219], v[196:199], v[16:19]
v_mfma_f32_16x16x32_bf16 v[36:39], v[220:223], v[196:199], v[36:39]
v_mfma_f32_16x16x32_bf16 v[56:59], v[224:227], v[196:199], v[56:59]
v_mfma_f32_16x16x32_bf16 v[76:79], v[228:231], v[196:199], v[76:79]
ds_read_b128 v[196:199], v242 offset:29696
v_mfma_f32_16x16x32_bf16 v[0:3], v[200:203], v[160:163], v[0:3]
v_mfma_f32_16x16x32_bf16 v[20:23], v[204:207], v[160:163], v[20:23]
s_waitcnt vmcnt(6)
ds_read_b64_tr_b16 v[216:217], v236 offset:4096
ds_read_b64_tr_b16 v[220:221], v237 offset:4096
ds_read_b64_tr_b16 v[224:225], v238 offset:4096
ds_read_b64_tr_b16 v[228:229], v239 offset:4096
v_mfma_f32_16x16x32_bf16 v[40:43], v[208:211], v[160:163], v[40:43]
v_mfma_f32_16x16x32_bf16 v[60:63], v[212:215], v[160:163], v[60:63]
ds_read_b128 v[160:163], v242 offset:30720
v_mfma_f32_16x16x32_bf16 v[4:7], v[200:203], v[164:167], v[4:7]
v_mfma_f32_16x16x32_bf16 v[24:27], v[204:207], v[164:167], v[24:27]
v_mfma_f32_16x16x32_bf16 v[44:47], v[208:211], v[164:167], v[44:47]
s_waitcnt lgkmcnt(1)
s_mov_b32 m0, s5
s_add_u32 s9, s79, 28672
buffer_load_dwordx4 v234, s[32:35], s9 offen lds
s_add_u32 s8, s79, 34816
buffer_load_dwordx4 v234, s[32:35], s8 offen offset:1024 lds
v_mfma_f32_16x16x32_bf16 v[64:67], v[212:215], v[164:167], v[64:67]
ds_read_b128 v[164:167], v242 offset:31744
v_mfma_f32_16x16x32_bf16 v[8:11], v[200:203], v[168:171], v[8:11]
s_waitcnt vmcnt(6)
ds_read_b64_tr_b16 v[218:219], v236 offset:6144
ds_read_b64_tr_b16 v[222:223], v237 offset:6144
ds_read_b64_tr_b16 v[226:227], v238 offset:6144
ds_read_b64_tr_b16 v[230:231], v239 offset:6144
v_mfma_f32_16x16x32_bf16 v[28:31], v[204:207], v[168:171], v[28:31]
v_mfma_f32_16x16x32_bf16 v[48:51], v[208:211], v[168:171], v[48:51]
v_mfma_f32_16x16x32_bf16 v[68:71], v[212:215], v[168:171], v[68:71]
ds_read_b128 v[168:171], v242 offset:32768
v_mfma_f32_16x16x32_bf16 v[12:15], v[200:203], v[172:175], v[12:15]
v_mfma_f32_16x16x32_bf16 v[32:35], v[204:207], v[172:175], v[32:35]
s_waitcnt lgkmcnt(1)
s_mov_b32 m0, s5
s_add_u32 s9, s79, 40960
buffer_load_dwordx4 v234, s[32:35], s9 offen offset:2048 lds
s_add_u32 s8, s79, 47104
buffer_load_dwordx4 v234, s[32:35], s8 offen offset:3072 lds
v_mfma_f32_16x16x32_bf16 v[52:55], v[208:211], v[172:175], v[52:55]
v_mfma_f32_16x16x32_bf16 v[72:75], v[212:215], v[172:175], v[72:75]
ds_read_b128 v[172:175], v242 offset:33792
v_mfma_f32_16x16x32_bf16 v[16:19], v[200:203], v[176:179], v[16:19]
v_mfma_f32_16x16x32_bf16 v[36:39], v[204:207], v[176:179], v[36:39]
v_mfma_f32_16x16x32_bf16 v[56:59], v[208:211], v[176:179], v[56:59]
v_mfma_f32_16x16x32_bf16 v[76:79], v[212:215], v[176:179], v[76:79]
ds_read_b128 v[176:179], v242 offset:34816
v_mfma_f32_16x16x32_bf16 v[0:3], v[216:219], v[180:183], v[0:3]
v_mfma_f32_16x16x32_bf16 v[20:23], v[220:223], v[180:183], v[20:23]
s_waitcnt vmcnt(6)
ds_read_b64_tr_b16 v[200:201], v236 offset:0
ds_read_b64_tr_b16 v[204:205], v237 offset:0
ds_read_b64_tr_b16 v[208:209], v238 offset:0
ds_read_b64_tr_b16 v[212:213], v239 offset:0
v_mfma_f32_16x16x32_bf16 v[40:43], v[224:227], v[180:183], v[40:43]
v_mfma_f32_16x16x32_bf16 v[60:63], v[228:231], v[180:183], v[60:63]
ds_read_b128 v[180:183], v242 offset:35840
v_mfma_f32_16x16x32_bf16 v[4:7], v[216:219], v[184:187], v[4:7]
v_mfma_f32_16x16x32_bf16 v[24:27], v[220:223], v[184:187], v[24:27]
v_mfma_f32_16x16x32_bf16 v[44:47], v[224:227], v[184:187], v[44:47]
s_waitcnt lgkmcnt(1)
s_mov_b32 m0, s4
s_add_u32 s9, s80, 0
buffer_load_dwordx4 v234, s[32:35], s9 offen lds
s_add_u32 s8, s80, 6144
buffer_load_dwordx4 v234, s[32:35], s8 offen offset:1024 lds
v_mfma_f32_16x16x32_bf16 v[64:67], v[228:231], v[184:187], v[64:67]
ds_read_b128 v[184:187], v242 offset:36864
v_mfma_f32_16x16x32_bf16 v[8:11], v[216:219], v[188:191], v[8:11]
s_waitcnt vmcnt(6)
ds_read_b64_tr_b16 v[202:203], v236 offset:2048
ds_read_b64_tr_b16 v[206:207], v237 offset:2048
ds_read_b64_tr_b16 v[210:211], v238 offset:2048
ds_read_b64_tr_b16 v[214:215], v239 offset:2048
v_mfma_f32_16x16x32_bf16 v[28:31], v[220:223], v[188:191], v[28:31]
v_mfma_f32_16x16x32_bf16 v[48:51], v[224:227], v[188:191], v[48:51]
v_mfma_f32_16x16x32_bf16 v[68:71], v[228:231], v[188:191], v[68:71]
ds_read_b128 v[188:191], v242 offset:37888
v_mfma_f32_16x16x32_bf16 v[12:15], v[216:219], v[192:195], v[12:15]
v_mfma_f32_16x16x32_bf16 v[32:35], v[220:223], v[192:195], v[32:35]
s_waitcnt lgkmcnt(1)
s_mov_b32 m0, s4
s_add_u32 s9, s80, 12288
buffer_load_dwordx4 v234, s[32:35], s9 offen offset:2048 lds
s_add_u32 s8, s80, 18432
buffer_load_dwordx4 v234, s[32:35], s8 offen offset:3072 lds
v_mfma_f32_16x16x32_bf16 v[52:55], v[224:227], v[192:195], v[52:55]
v_mfma_f32_16x16x32_bf16 v[72:75], v[228:231], v[192:195], v[72:75]
ds_read_b128 v[192:195], v242 offset:38912
v_mfma_f32_16x16x32_bf16 v[16:19], v[216:219], v[196:199], v[16:19]
v_mfma_f32_16x16x32_bf16 v[36:39], v[220:223], v[196:199], v[36:39]
v_mfma_f32_16x16x32_bf16 v[56:59], v[224:227], v[196:199], v[56:59]
v_mfma_f32_16x16x32_bf16 v[76:79], v[228:231], v[196:199], v[76:79]
ds_read_b128 v[196:199], v242 offset:39936
v_mfma_f32_16x16x32_bf16 v[0:3], v[200:203], v[160:163], v[0:3]
v_mfma_f32_16x16x32_bf16 v[20:23], v[204:207], v[160:163], v[20:23]
s_waitcnt vmcnt(6)
ds_read_b64_tr_b16 v[216:217], v236 offset:4096
ds_read_b64_tr_b16 v[220:221], v237 offset:4096
ds_read_b64_tr_b16 v[224:225], v238 offset:4096
ds_read_b64_tr_b16 v[228:229], v239 offset:4096
v_mfma_f32_16x16x32_bf16 v[40:43], v[208:211], v[160:163], v[40:43]
v_mfma_f32_16x16x32_bf16 v[60:63], v[212:215], v[160:163], v[60:63]
ds_read_b128 v[160:163], v243 offset:0
v_mfma_f32_16x16x32_bf16 v[4:7], v[200:203], v[164:167], v[4:7]
v_mfma_f32_16x16x32_bf16 v[24:27], v[204:207], v[164:167], v[24:27]
v_mfma_f32_16x16x32_bf16 v[44:47], v[208:211], v[164:167], v[44:47]
s_waitcnt lgkmcnt(1)
s_mov_b32 m0, s5
s_add_u32 s9, s80, 28672
buffer_load_dwordx4 v234, s[32:35], s9 offen lds
s_add_u32 s8, s80, 34816
buffer_load_dwordx4 v234, s[32:35], s8 offen offset:1024 lds
v_mfma_f32_16x16x32_bf16 v[64:67], v[212:215], v[164:167], v[64:67]
ds_read_b128 v[164:167], v243 offset:1024
v_mfma_f32_16x16x32_bf16 v[8:11], v[200:203], v[168:171], v[8:11]
s_waitcnt vmcnt(6)
ds_read_b64_tr_b16 v[218:219], v236 offset:6144
ds_read_b64_tr_b16 v[222:223], v237 offset:6144
ds_read_b64_tr_b16 v[226:227], v238 offset:6144
ds_read_b64_tr_b16 v[230:231], v239 offset:6144
v_mfma_f32_16x16x32_bf16 v[28:31], v[204:207], v[168:171], v[28:31]
v_mfma_f32_16x16x32_bf16 v[48:51], v[208:211], v[168:171], v[48:51]
v_mfma_f32_16x16x32_bf16 v[68:71], v[212:215], v[168:171], v[68:71]
ds_read_b128 v[168:171], v243 offset:2048
v_mfma_f32_16x16x32_bf16 v[12:15], v[200:203], v[172:175], v[12:15]
v_mfma_f32_16x16x32_bf16 v[32:35], v[204:207], v[172:175], v[32:35]
s_waitcnt lgkmcnt(1)
s_mov_b32 m0, s5
s_add_u32 s9, s80, 40960
buffer_load_dwordx4 v234, s[32:35], s9 offen offset:2048 lds
s_add_u32 s8, s80, 47104
buffer_load_dwordx4 v234, s[32:35], s8 offen offset:3072 lds
v_mfma_f32_16x16x32_bf16 v[52:55], v[208:211], v[172:175], v[52:55]
v_mfma_f32_16x16x32_bf16 v[72:75], v[212:215], v[172:175], v[72:75]
ds_read_b128 v[172:175], v243 offset:3072
v_mfma_f32_16x16x32_bf16 v[16:19], v[200:203], v[176:179], v[16:19]
v_mfma_f32_16x16x32_bf16 v[36:39], v[204:207], v[176:179], v[36:39]
v_mfma_f32_16x16x32_bf16 v[56:59], v[208:211], v[176:179], v[56:59]
v_mfma_f32_16x16x32_bf16 v[76:79], v[212:215], v[176:179], v[76:79]
ds_read_b128 v[176:179], v243 offset:4096
v_mfma_f32_16x16x32_bf16 v[0:3], v[216:219], v[180:183], v[0:3]
v_mfma_f32_16x16x32_bf16 v[20:23], v[220:223], v[180:183], v[20:23]
s_waitcnt vmcnt(6)
ds_read_b64_tr_b16 v[200:201], v236 offset:0
ds_read_b64_tr_b16 v[204:205], v237 offset:0
ds_read_b64_tr_b16 v[208:209], v238 offset:0
ds_read_b64_tr_b16 v[212:213], v239 offset:0
v_mfma_f32_16x16x32_bf16 v[40:43], v[224:227], v[180:183], v[40:43]
v_mfma_f32_16x16x32_bf16 v[60:63], v[228:231], v[180:183], v[60:63]
ds_read_b128 v[180:183], v243 offset:5120
v_mfma_f32_16x16x32_bf16 v[4:7], v[216:219], v[184:187], v[4:7]
v_mfma_f32_16x16x32_bf16 v[24:27], v[220:223], v[184:187], v[24:27]
v_mfma_f32_16x16x32_bf16 v[44:47], v[224:227], v[184:187], v[44:47]
s_waitcnt lgkmcnt(1)
s_mov_b32 m0, s4
s_add_u32 s9, s81, 0
buffer_load_dwordx4 v234, s[32:35], s9 offen lds
s_add_u32 s8, s81, 6144
buffer_load_dwordx4 v234, s[32:35], s8 offen offset:1024 lds
v_mfma_f32_16x16x32_bf16 v[64:67], v[228:231], v[184:187], v[64:67]
ds_read_b128 v[184:187], v243 offset:6144
v_mfma_f32_16x16x32_bf16 v[8:11], v[216:219], v[188:191], v[8:11]
s_waitcnt vmcnt(6)
ds_read_b64_tr_b16 v[202:203], v236 offset:2048
ds_read_b64_tr_b16 v[206:207], v237 offset:2048
ds_read_b64_tr_b16 v[210:211], v238 offset:2048
ds_read_b64_tr_b16 v[214:215], v239 offset:2048
v_mfma_f32_16x16x32_bf16 v[28:31], v[220:223], v[188:191], v[28:31]
v_mfma_f32_16x16x32_bf16 v[48:51], v[224:227], v[188:191], v[48:51]
v_mfma_f32_16x16x32_bf16 v[68:71], v[228:231], v[188:191], v[68:71]
ds_read_b128 v[188:191], v243 offset:7168
v_mfma_f32_16x16x32_bf16 v[12:15], v[216:219], v[192:195], v[12:15]
v_mfma_f32_16x16x32_bf16 v[32:35], v[220:223], v[192:195], v[32:35]
s_waitcnt lgkmcnt(1)
s_mov_b32 m0, s4
s_add_u32 s9, s81, 12288
buffer_load_dwordx4 v234, s[32:35], s9 offen offset:2048 lds
s_add_u32 s8, s81, 18432
buffer_load_dwordx4 v234, s[32:35], s8 offen offset:3072 lds
v_mfma_f32_16x16x32_bf16 v[52:55], v[224:227], v[192:195], v[52:55]
v_mfma_f32_16x16x32_bf16 v[72:75], v[228:231], v[192:195], v[72:75]
ds_read_b128 v[192:195], v243 offset:8192
v_mfma_f32_16x16x32_bf16 v[16:19], v[216:219], v[196:199], v[16:19]
v_mfma_f32_16x16x32_bf16 v[36:39], v[220:223], v[196:199], v[36:39]
v_mfma_f32_16x16x32_bf16 v[56:59], v[224:227], v[196:199], v[56:59]
v_mfma_f32_16x16x32_bf16 v[76:79], v[228:231], v[196:199], v[76:79]
ds_read_b128 v[196:199], v243 offset:9216
v_mfma_f32_16x16x32_bf16 v[0:3], v[200:203], v[160:163], v[0:3]
v_mfma_f32_16x16x32_bf16 v[20:23], v[204:207], v[160:163], v[20:23]
s_waitcnt vmcnt(6)
ds_read_b64_tr_b16 v[216:217], v236 offset:4096
ds_read_b64_tr_b16 v[220:221], v237 offset:4096
ds_read_b64_tr_b16 v[224:225], v238 offset:4096
ds_read_b64_tr_b16 v[228:229], v239 offset:4096
v_mfma_f32_16x16x32_bf16 v[40:43], v[208:211], v[160:163], v[40:43]
v_mfma_f32_16x16x32_bf16 v[60:63], v[212:215], v[160:163], v[60:63]
ds_read_b128 v[160:163], v243 offset:10240
v_mfma_f32_16x16x32_bf16 v[4:7], v[200:203], v[164:167], v[4:7]
v_mfma_f32_16x16x32_bf16 v[24:27], v[204:207], v[164:167], v[24:27]
v_mfma_f32_16x16x32_bf16 v[44:47], v[208:211], v[164:167], v[44:47]
s_waitcnt lgkmcnt(1)
s_mov_b32 m0, s5
s_add_u32 s9, s81, 28672
buffer_load_dwordx4 v234, s[32:35], s9 offen lds
s_add_u32 s8, s81, 34816
buffer_load_dwordx4 v234, s[32:35], s8 offen offset:1024 lds
v_mfma_f32_16x16x32_bf16 v[64:67], v[212:215], v[164:167], v[64:67]
ds_read_b128 v[164:167], v243 offset:11264
v_mfma_f32_16x16x32_bf16 v[8:11], v[200:203], v[168:171], v[8:11]
s_waitcnt vmcnt(6)
ds_read_b64_tr_b16 v[218:219], v236 offset:6144
ds_read_b64_tr_b16 v[222:223], v237 offset:6144
ds_read_b64_tr_b16 v[226:227], v238 offset:6144
ds_read_b64_tr_b16 v[230:231], v239 offset:6144
v_mfma_f32_16x16x32_bf16 v[28:31], v[204:207], v[168:171], v[28:31]
v_mfma_f32_16x16x32_bf16 v[48:51], v[208:211], v[168:171], v[48:51]
v_mfma_f32_16x16x32_bf16 v[68:71], v[212:215], v[168:171], v[68:71]
ds_read_b128 v[168:171], v243 offset:12288
v_mfma_f32_16x16x32_bf16 v[12:15], v[200:203], v[172:175], v[12:15]
v_mfma_f32_16x16x32_bf16 v[32:35], v[204:207], v[172:175], v[32:35]
s_waitcnt lgkmcnt(1)
s_mov_b32 m0, s5
s_add_u32 s9, s81, 40960
buffer_load_dwordx4 v234, s[32:35], s9 offen offset:2048 lds
s_add_u32 s8, s81, 47104
buffer_load_dwordx4 v234, s[32:35], s8 offen offset:3072 lds
v_mfma_f32_16x16x32_bf16 v[52:55], v[208:211], v[172:175], v[52:55]
v_mfma_f32_16x16x32_bf16 v[72:75], v[212:215], v[172:175], v[72:75]
ds_read_b128 v[172:175], v243 offset:13312
v_mfma_f32_16x16x32_bf16 v[16:19], v[200:203], v[176:179], v[16:19]
v_mfma_f32_16x16x32_bf16 v[36:39], v[204:207], v[176:179], v[36:39]
v_mfma_f32_16x16x32_bf16 v[56:59], v[208:211], v[176:179], v[56:59]
v_mfma_f32_16x16x32_bf16 v[76:79], v[212:215], v[176:179], v[76:79]
ds_read_b128 v[176:179], v243 offset:14336
v_mfma_f32_16x16x32_bf16 v[0:3], v[216:219], v[180:183], v[0:3]
v_mfma_f32_16x16x32_bf16 v[20:23], v[220:223], v[180:183], v[20:23]
s_waitcnt vmcnt(6)
ds_read_b64_tr_b16 v[200:201], v236 offset:0
ds_read_b64_tr_b16 v[204:205], v237 offset:0
ds_read_b64_tr_b16 v[208:209], v238 offset:0
ds_read_b64_tr_b16 v[212:213], v239 offset:0
v_mfma_f32_16x16x32_bf16 v[40:43], v[224:227], v[180:183], v[40:43]
v_mfma_f32_16x16x32_bf16 v[60:63], v[228:231], v[180:183], v[60:63]
ds_read_b128 v[180:183], v243 offset:15360
v_mfma_f32_16x16x32_bf16 v[4:7], v[216:219], v[184:187], v[4:7]
v_mfma_f32_16x16x32_bf16 v[24:27], v[220:223], v[184:187], v[24:27]
v_mfma_f32_16x16x32_bf16 v[44:47], v[224:227], v[184:187], v[44:47]
s_waitcnt lgkmcnt(1)
s_mov_b32 m0, s4
s_add_u32 s9, s82, 0
buffer_load_dwordx4 v234, s[32:35], s9 offen lds
s_add_u32 s8, s82, 6144
buffer_load_dwordx4 v234, s[32:35], s8 offen offset:1024 lds
v_mfma_f32_16x16x32_bf16 v[64:67], v[228:231], v[184:187], v[64:67]
ds_read_b128 v[184:187], v243 offset:16384
v_mfma_f32_16x16x32_bf16 v[8:11], v[216:219], v[188:191], v[8:11]
s_waitcnt vmcnt(6)
ds_read_b64_tr_b16 v[202:203], v236 offset:2048
ds_read_b64_tr_b16 v[206:207], v237 offset:2048
ds_read_b64_tr_b16 v[210:211], v238 offset:2048
ds_read_b64_tr_b16 v[214:215], v239 offset:2048
v_mfma_f32_16x16x32_bf16 v[28:31], v[220:223], v[188:191], v[28:31]
v_mfma_f32_16x16x32_bf16 v[48:51], v[224:227], v[188:191], v[48:51]
v_mfma_f32_16x16x32_bf16 v[68:71], v[228:231], v[188:191], v[68:71]
ds_read_b128 v[188:191], v243 offset:17408
v_mfma_f32_16x16x32_bf16 v[12:15], v[216:219], v[192:195], v[12:15]
v_mfma_f32_16x16x32_bf16 v[32:35], v[220:223], v[192:195], v[32:35]
s_waitcnt lgkmcnt(1)
s_mov_b32 m0, s4
s_add_u32 s9, s82, 12288
buffer_load_dwordx4 v234, s[32:35], s9 offen offset:2048 lds
s_add_u32 s8, s82, 18432
buffer_load_dwordx4 v234, s[32:35], s8 offen offset:3072 lds
v_mfma_f32_16x16x32_bf16 v[52:55], v[224:227], v[192:195], v[52:55]
v_mfma_f32_16x16x32_bf16 v[72:75], v[228:231], v[192:195], v[72:75]
ds_read_b128 v[192:195], v243 offset:18432
v_mfma_f32_16x16x32_bf16 v[16:19], v[216:219], v[196:199], v[16:19]
v_mfma_f32_16x16x32_bf16 v[36:39], v[220:223], v[196:199], v[36:39]
v_mfma_f32_16x16x32_bf16 v[56:59], v[224:227], v[196:199], v[56:59]
v_mfma_f32_16x16x32_bf16 v[76:79], v[228:231], v[196:199], v[76:79]
ds_read_b128 v[196:199], v243 offset:19456
v_mfma_f32_16x16x32_bf16 v[0:3], v[200:203], v[160:163], v[0:3]
v_mfma_f32_16x16x32_bf16 v[20:23], v[204:207], v[160:163], v[20:23]
s_waitcnt vmcnt(6)
ds_read_b64_tr_b16 v[216:217], v236 offset:4096
ds_read_b64_tr_b16 v[220:221], v237 offset:4096
ds_read_b64_tr_b16 v[224:225], v238 offset:4096
ds_read_b64_tr_b16 v[228:229], v239 offset:4096
v_mfma_f32_16x16x32_bf16 v[40:43], v[208:211], v[160:163], v[40:43]
v_mfma_f32_16x16x32_bf16 v[60:63], v[212:215], v[160:163], v[60:63]
ds_read_b128 v[160:163], v243 offset:20480
v_mfma_f32_16x16x32_bf16 v[4:7], v[200:203], v[164:167], v[4:7]
v_mfma_f32_16x16x32_bf16 v[24:27], v[204:207], v[164:167], v[24:27]
v_mfma_f32_16x16x32_bf16 v[44:47], v[208:211], v[164:167], v[44:47]
s_waitcnt lgkmcnt(1)
s_mov_b32 m0, s5
s_add_u32 s9, s82, 28672
buffer_load_dwordx4 v234, s[32:35], s9 offen lds
s_add_u32 s8, s82, 34816
buffer_load_dwordx4 v234, s[32:35], s8 offen offset:1024 lds
v_mfma_f32_16x16x32_bf16 v[64:67], v[212:215], v[164:167], v[64:67]
ds_read_b128 v[164:167], v243 offset:21504
v_mfma_f32_16x16x32_bf16 v[8:11], v[200:203], v[168:171], v[8:11]
s_waitcnt vmcnt(6)
ds_read_b64_tr_b16 v[218:219], v236 offset:6144
ds_read_b64_tr_b16 v[222:223], v237 offset:6144
ds_read_b64_tr_b16 v[226:227], v238 offset:6144
ds_read_b64_tr_b16 v[230:231], v239 offset:6144
v_mfma_f32_16x16x32_bf16 v[28:31], v[204:207], v[168:171], v[28:31]
v_mfma_f32_16x16x32_bf16 v[48:51], v[208:211], v[168:171], v[48:51]
v_mfma_f32_16x16x32_bf16 v[68:71], v[212:215], v[168:171], v[68:71]
ds_read_b128 v[168:171], v243 offset:22528
v_mfma_f32_16x16x32_bf16 v[12:15], v[200:203], v[172:175], v[12:15]
v_mfma_f32_16x16x32_bf16 v[32:35], v[204:207], v[172:175], v[32:35]
s_waitcnt lgkmcnt(1)
s_mov_b32 m0, s5
s_add_u32 s9, s82, 40960
buffer_load_dwordx4 v234, s[32:35], s9 offen offset:2048 lds
s_add_u32 s8, s82, 47104
buffer_load_dwordx4 v234, s[32:35], s8 offen offset:3072 lds
v_mfma_f32_16x16x32_bf16 v[52:55], v[208:211], v[172:175], v[52:55]
v_mfma_f32_16x16x32_bf16 v[72:75], v[212:215], v[172:175], v[72:75]
ds_read_b128 v[172:175], v243 offset:23552
v_mfma_f32_16x16x32_bf16 v[16:19], v[200:203], v[176:179], v[16:19]
v_mfma_f32_16x16x32_bf16 v[36:39], v[204:207], v[176:179], v[36:39]
v_mfma_f32_16x16x32_bf16 v[56:59], v[208:211], v[176:179], v[56:59]
v_mfma_f32_16x16x32_bf16 v[76:79], v[212:215], v[176:179], v[76:79]
ds_read_b128 v[176:179], v243 offset:24576
v_mfma_f32_16x16x32_bf16 v[0:3], v[216:219], v[180:183], v[0:3]
v_mfma_f32_16x16x32_bf16 v[20:23], v[220:223], v[180:183], v[20:23]
s_waitcnt vmcnt(6)
ds_read_b64_tr_b16 v[200:201], v236 offset:0
ds_read_b64_tr_b16 v[204:205], v237 offset:0
ds_read_b64_tr_b16 v[208:209], v238 offset:0
ds_read_b64_tr_b16 v[212:213], v239 offset:0
v_mfma_f32_16x16x32_bf16 v[40:43], v[224:227], v[180:183], v[40:43]
v_mfma_f32_16x16x32_bf16 v[60:63], v[228:231], v[180:183], v[60:63]
ds_read_b128 v[180:183], v243 offset:25600
v_mfma_f32_16x16x32_bf16 v[4:7], v[216:219], v[184:187], v[4:7]
v_mfma_f32_16x16x32_bf16 v[24:27], v[220:223], v[184:187], v[24:27]
v_mfma_f32_16x16x32_bf16 v[44:47], v[224:227], v[184:187], v[44:47]
s_waitcnt lgkmcnt(1)
s_mov_b32 m0, s4
s_add_u32 s9, s83, 0
buffer_load_dwordx4 v234, s[32:35], s9 offen lds
s_add_u32 s8, s83, 6144
buffer_load_dwordx4 v234, s[32:35], s8 offen offset:1024 lds
v_mfma_f32_16x16x32_bf16 v[64:67], v[228:231], v[184:187], v[64:67]
ds_read_b128 v[184:187], v243 offset:26624
v_mfma_f32_16x16x32_bf16 v[8:11], v[216:219], v[188:191], v[8:11]
s_waitcnt vmcnt(6)
ds_read_b64_tr_b16 v[202:203], v236 offset:2048
ds_read_b64_tr_b16 v[206:207], v237 offset:2048
ds_read_b64_tr_b16 v[210:211], v238 offset:2048
ds_read_b64_tr_b16 v[214:215], v239 offset:2048
v_mfma_f32_16x16x32_bf16 v[28:31], v[220:223], v[188:191], v[28:31]
v_mfma_f32_16x16x32_bf16 v[48:51], v[224:227], v[188:191], v[48:51]
v_mfma_f32_16x16x32_bf16 v[68:71], v[228:231], v[188:191], v[68:71]
ds_read_b128 v[188:191], v243 offset:27648
v_mfma_f32_16x16x32_bf16 v[12:15], v[216:219], v[192:195], v[12:15]
v_mfma_f32_16x16x32_bf16 v[32:35], v[220:223], v[192:195], v[32:35]
s_waitcnt lgkmcnt(1)
s_mov_b32 m0, s4
s_add_u32 s9, s83, 12288
buffer_load_dwordx4 v234, s[32:35], s9 offen offset:2048 lds
s_add_u32 s8, s83, 18432
buffer_load_dwordx4 v234, s[32:35], s8 offen offset:3072 lds
v_mfma_f32_16x16x32_bf16 v[52:55], v[224:227], v[192:195], v[52:55]
v_mfma_f32_16x16x32_bf16 v[72:75], v[228:231], v[192:195], v[72:75]
ds_read_b128 v[192:195], v243 offset:28672
v_mfma_f32_16x16x32_bf16 v[16:19], v[216:219], v[196:199], v[16:19]
v_mfma_f32_16x16x32_bf16 v[36:39], v[220:223], v[196:199], v[36:39]
v_mfma_f32_16x16x32_bf16 v[56:59], v[224:227], v[196:199], v[56:59]
v_mfma_f32_16x16x32_bf16 v[76:79], v[228:231], v[196:199], v[76:79]
ds_read_b128 v[196:199], v243 offset:29696
v_mfma_f32_16x16x32_bf16 v[0:3], v[200:203], v[160:163], v[0:3]
v_mfma_f32_16x16x32_bf16 v[20:23], v[204:207], v[160:163], v[20:23]
s_waitcnt vmcnt(6)
ds_read_b64_tr_b16 v[216:217], v236 offset:4096
ds_read_b64_tr_b16 v[220:221], v237 offset:4096
ds_read_b64_tr_b16 v[224:225], v238 offset:4096
ds_read_b64_tr_b16 v[228:229], v239 offset:4096
v_mfma_f32_16x16x32_bf16 v[40:43], v[208:211], v[160:163], v[40:43]
v_mfma_f32_16x16x32_bf16 v[60:63], v[212:215], v[160:163], v[60:63]
ds_read_b128 v[160:163], v243 offset:30720
v_mfma_f32_16x16x32_bf16 v[4:7], v[200:203], v[164:167], v[4:7]
v_mfma_f32_16x16x32_bf16 v[24:27], v[204:207], v[164:167], v[24:27]
v_mfma_f32_16x16x32_bf16 v[44:47], v[208:211], v[164:167], v[44:47]
s_waitcnt lgkmcnt(1)
s_mov_b32 m0, s5
s_add_u32 s9, s83, 28672
buffer_load_dwordx4 v234, s[32:35], s9 offen lds
s_add_u32 s8, s83, 34816
buffer_load_dwordx4 v234, s[32:35], s8 offen offset:1024 lds
v_mfma_f32_16x16x32_bf16 v[64:67], v[212:215], v[164:167], v[64:67]
ds_read_b128 v[164:167], v243 offset:31744
v_mfma_f32_16x16x32_bf16 v[8:11], v[200:203], v[168:171], v[8:11]
s_waitcnt vmcnt(6)
ds_read_b64_tr_b16 v[218:219], v236 offset:6144
ds_read_b64_tr_b16 v[222:223], v237 offset:6144
ds_read_b64_tr_b16 v[226:227], v238 offset:6144
ds_read_b64_tr_b16 v[230:231], v239 offset:6144
v_mfma_f32_16x16x32_bf16 v[28:31], v[204:207], v[168:171], v[28:31]
v_mfma_f32_16x16x32_bf16 v[48:51], v[208:211], v[168:171], v[48:51]
v_mfma_f32_16x16x32_bf16 v[68:71], v[212:215], v[168:171], v[68:71]
ds_read_b128 v[168:171], v243 offset:32768
v_mfma_f32_16x16x32_bf16 v[12:15], v[200:203], v[172:175], v[12:15]
v_mfma_f32_16x16x32_bf16 v[32:35], v[204:207], v[172:175], v[32:35]
s_waitcnt lgkmcnt(1)
s_mov_b32 m0, s5
s_add_u32 s9, s83, 40960
buffer_load_dwordx4 v234, s[32:35], s9 offen offset:2048 lds
s_add_u32 s8, s83, 47104
buffer_load_dwordx4 v234, s[32:35], s8 offen offset:3072 lds
v_mfma_f32_16x16x32_bf16 v[52:55], v[208:211], v[172:175], v[52:55]
v_mfma_f32_16x16x32_bf16 v[72:75], v[212:215], v[172:175], v[72:75]
ds_read_b128 v[172:175], v243 offset:35840
v_mfma_f32_16x16x32_bf16 v[16:19], v[200:203], v[176:179], v[16:19]
v_mfma_f32_16x16x32_bf16 v[36:39], v[204:207], v[176:179], v[36:39]
v_mfma_f32_16x16x32_bf16 v[56:59], v[208:211], v[176:179], v[56:59]
v_mfma_f32_16x16x32_bf16 v[76:79], v[212:215], v[176:179], v[76:79]
ds_read_b128 v[176:179], v243 offset:36864
v_mfma_f32_16x16x32_bf16 v[0:3], v[216:219], v[180:183], v[0:3]
v_mfma_f32_16x16x32_bf16 v[20:23], v[220:223], v[180:183], v[20:23]
s_waitcnt vmcnt(6)
ds_read_b64_tr_b16 v[200:201], v236 offset:0
ds_read_b64_tr_b16 v[204:205], v237 offset:0
ds_read_b64_tr_b16 v[208:209], v238 offset:0
ds_read_b64_tr_b16 v[212:213], v239 offset:0
v_mfma_f32_16x16x32_bf16 v[40:43], v[224:227], v[180:183], v[40:43]
v_mfma_f32_16x16x32_bf16 v[60:63], v[228:231], v[180:183], v[60:63]
ds_read_b128 v[180:183], v243 offset:37888
v_mfma_f32_16x16x32_bf16 v[4:7], v[216:219], v[184:187], v[4:7]
v_mfma_f32_16x16x32_bf16 v[24:27], v[220:223], v[184:187], v[24:27]
v_mfma_f32_16x16x32_bf16 v[44:47], v[224:227], v[184:187], v[44:47]
v_mfma_f32_16x16x32_bf16 v[64:67], v[228:231], v[184:187], v[64:67]
ds_read_b128 v[184:187], v243 offset:33792
v_mfma_f32_16x16x32_bf16 v[8:11], v[216:219], v[188:191], v[8:11]
s_waitcnt vmcnt(4)
ds_read_b64_tr_b16 v[202:203], v236 offset:2048
ds_read_b64_tr_b16 v[206:207], v237 offset:2048
ds_read_b64_tr_b16 v[210:211], v238 offset:2048
ds_read_b64_tr_b16 v[214:215], v239 offset:2048
v_mfma_f32_16x16x32_bf16 v[28:31], v[220:223], v[188:191], v[28:31]
v_mfma_f32_16x16x32_bf16 v[48:51], v[224:227], v[188:191], v[48:51]
v_mfma_f32_16x16x32_bf16 v[68:71], v[228:231], v[188:191], v[68:71]
ds_read_b128 v[188:191], v243 offset:38912
v_mfma_f32_16x16x32_bf16 v[12:15], v[216:219], v[192:195], v[12:15]
v_mfma_f32_16x16x32_bf16 v[32:35], v[220:223], v[192:195], v[32:35]
v_mfma_f32_16x16x32_bf16 v[52:55], v[224:227], v[192:195], v[52:55]
v_mfma_f32_16x16x32_bf16 v[72:75], v[228:231], v[192:195], v[72:75]
ds_read_b128 v[192:195], v243 offset:34816
v_mfma_f32_16x16x32_bf16 v[16:19], v[216:219], v[196:199], v[16:19]
v_mfma_f32_16x16x32_bf16 v[36:39], v[220:223], v[196:199], v[36:39]
v_mfma_f32_16x16x32_bf16 v[56:59], v[224:227], v[196:199], v[56:59]
v_mfma_f32_16x16x32_bf16 v[76:79], v[228:231], v[196:199], v[76:79]
ds_read_b128 v[196:199], v243 offset:39936
s_waitcnt lgkmcnt(6)
v_mfma_f32_16x16x32_bf16 v[0:3], v[200:203], v[160:163], v[0:3]
s_waitcnt vmcnt(2)
ds_read_b64_tr_b16 v[216:217], v236 offset:4096
ds_read_b64_tr_b16 v[220:221], v237 offset:4096
ds_read_b64_tr_b16 v[224:225], v238 offset:4096
ds_read_b64_tr_b16 v[228:229], v239 offset:4096
s_waitcnt lgkmcnt(9)
v_mfma_f32_16x16x32_bf16 v[20:23], v[204:207], v[160:163], v[20:23]
s_waitcnt vmcnt(0)
ds_read_b64_tr_b16 v[218:219], v236 offset:6144
ds_read_b64_tr_b16 v[222:223], v237 offset:6144
ds_read_b64_tr_b16 v[226:227], v238 offset:6144
ds_read_b64_tr_b16 v[230:231], v239 offset:6144
s_waitcnt lgkmcnt(12)
v_mfma_f32_16x16x32_bf16 v[40:43], v[208:211], v[160:163], v[40:43]
s_waitcnt lgkmcnt(11)
v_mfma_f32_16x16x32_bf16 v[60:63], v[212:215], v[160:163], v[60:63]
v_mfma_f32_16x16x32_bf16 v[4:7], v[200:203], v[164:167], v[4:7]
v_mfma_f32_16x16x32_bf16 v[24:27], v[204:207], v[164:167], v[24:27]
v_mfma_f32_16x16x32_bf16 v[44:47], v[208:211], v[164:167], v[44:47]
v_mfma_f32_16x16x32_bf16 v[64:67], v[212:215], v[164:167], v[64:67]
v_mfma_f32_16x16x32_bf16 v[8:11], v[200:203], v[168:171], v[8:11]
v_mfma_f32_16x16x32_bf16 v[28:31], v[204:207], v[168:171], v[28:31]
v_mfma_f32_16x16x32_bf16 v[48:51], v[208:211], v[168:171], v[48:51]
v_mfma_f32_16x16x32_bf16 v[68:71], v[212:215], v[168:171], v[68:71]
s_waitcnt lgkmcnt(3)
v_mfma_f32_16x16x32_bf16 v[0:3], v[216:219], v[172:175], v[0:3]
s_waitcnt lgkmcnt(2)
v_mfma_f32_16x16x32_bf16 v[20:23], v[220:223], v[172:175], v[20:23]
s_waitcnt lgkmcnt(1)
v_mfma_f32_16x16x32_bf16 v[40:43], v[224:227], v[172:175], v[40:43]
s_waitcnt lgkmcnt(0)
v_mfma_f32_16x16x32_bf16 v[60:63], v[228:231], v[172:175], v[60:63]
v_mfma_f32_16x16x32_bf16 v[4:7], v[216:219], v[176:179], v[4:7]
v_mfma_f32_16x16x32_bf16 v[24:27], v[220:223], v[176:179], v[24:27]
v_mfma_f32_16x16x32_bf16 v[44:47], v[224:227], v[176:179], v[44:47]
v_mfma_f32_16x16x32_bf16 v[64:67], v[228:231], v[176:179], v[64:67]
v_mfma_f32_16x16x32_bf16 v[8:11], v[216:219], v[180:183], v[8:11]
s_nop 2
v_lshlrev_b32 v254, 4, v235
v_cvt_pk_bf16_f32 v0, v0, v1
v_cvt_pk_bf16_f32 v1, v2, v3
v_cvt_pk_bf16_f32 v2, v20, v21
v_cvt_pk_bf16_f32 v3, v22, v23
s_mov_b32 s9, 0
buffer_store_dwordx4 v[0:3], v254, s[36:39], s9 offen sc1
v_cvt_pk_bf16_f32 v40, v40, v41
v_cvt_pk_bf16_f32 v41, v42, v43
v_cvt_pk_bf16_f32 v42, v60, v61
v_cvt_pk_bf16_f32 v43, v62, v63
s_mov_b32 s8, 5120
buffer_store_dwordx4 v[40:43], v254, s[36:39], s8 offen sc1
v_mfma_f32_16x16x32_bf16 v[28:31], v[220:223], v[180:183], v[28:31]
v_mfma_f32_16x16x32_bf16 v[48:51], v[224:227], v[180:183], v[48:51]
v_mfma_f32_16x16x32_bf16 v[68:71], v[228:231], v[180:183], v[68:71]
v_mfma_f32_16x16x32_bf16 v[12:15], v[200:203], v[184:187], v[12:15]
s_nop 2
v_cvt_pk_bf16_f32 v4, v4, v5
v_cvt_pk_bf16_f32 v5, v6, v7
v_cvt_pk_bf16_f32 v6, v24, v25
v_cvt_pk_bf16_f32 v7, v26, v27
s_mov_b32 s9, 1024
buffer_store_dwordx4 v[4:7], v254, s[36:39], s9 offen sc1
v_cvt_pk_bf16_f32 v44, v44, v45
v_cvt_pk_bf16_f32 v45, v46, v47
v_cvt_pk_bf16_f32 v46, v64, v65
v_cvt_pk_bf16_f32 v47, v66, v67
s_mov_b32 s8, 6144
buffer_store_dwordx4 v[44:47], v254, s[36:39], s8 offen sc1
v_mfma_f32_16x16x32_bf16 v[32:35], v[204:207], v[184:187], v[32:35]
v_mfma_f32_16x16x32_bf16 v[52:55], v[208:211], v[184:187], v[52:55]
v_mfma_f32_16x16x32_bf16 v[72:75], v[212:215], v[184:187], v[72:75]
v_mfma_f32_16x16x32_bf16 v[12:15], v[216:219], v[188:191], v[12:15]
s_nop 2
v_cvt_pk_bf16_f32 v8, v8, v9
v_cvt_pk_bf16_f32 v9, v10, v11
v_cvt_pk_bf16_f32 v10, v28, v29
v_cvt_pk_bf16_f32 v11, v30, v31
s_mov_b32 s9, 2048
buffer_store_dwordx4 v[8:11], v254, s[36:39], s9 offen sc1
v_cvt_pk_bf16_f32 v48, v48, v49
v_cvt_pk_bf16_f32 v49, v50, v51
v_cvt_pk_bf16_f32 v50, v68, v69
v_cvt_pk_bf16_f32 v51, v70, v71
s_mov_b32 s8, 7168
buffer_store_dwordx4 v[48:51], v254, s[36:39], s8 offen sc1
v_mfma_f32_16x16x32_bf16 v[32:35], v[220:223], v[188:191], v[32:35]
v_mfma_f32_16x16x32_bf16 v[52:55], v[224:227], v[188:191], v[52:55]
v_mfma_f32_16x16x32_bf16 v[72:75], v[228:231], v[188:191], v[72:75]
v_mfma_f32_16x16x32_bf16 v[16:19], v[200:203], v[192:195], v[16:19]
v_mfma_f32_16x16x32_bf16 v[36:39], v[204:207], v[192:195], v[36:39]
v_mfma_f32_16x16x32_bf16 v[56:59], v[208:211], v[192:195], v[56:59]
v_mfma_f32_16x16x32_bf16 v[76:79], v[212:215], v[192:195], v[76:79]
v_mfma_f32_16x16x32_bf16 v[16:19], v[216:219], v[196:199], v[16:19]
s_nop 2
v_cvt_pk_bf16_f32 v12, v12, v13
v_cvt_pk_bf16_f32 v13, v14, v15
v_cvt_pk_bf16_f32 v14, v32, v33
v_cvt_pk_bf16_f32 v15, v34, v35
s_mov_b32 s9, 3072
buffer_store_dwordx4 v[12:15], v254, s[36:39], s9 offen sc1
v_cvt_pk_bf16_f32 v52, v52, v53
v_cvt_pk_bf16_f32 v53, v54, v55
v_cvt_pk_bf16_f32 v54, v72, v73
v_cvt_pk_bf16_f32 v55, v74, v75
s_mov_b32 s8, 8192
buffer_store_dwordx4 v[52:55], v254, s[36:39], s8 offen sc1
v_mfma_f32_16x16x32_bf16 v[36:39], v[220:223], v[196:199], v[36:39]
v_mfma_f32_16x16x32_bf16 v[56:59], v[224:227], v[196:199], v[56:59]
v_mfma_f32_16x16x32_bf16 v[76:79], v[228:231], v[196:199], v[76:79]
s_nop 7
v_cvt_pk_bf16_f32 v16, v16, v17
v_cvt_pk_bf16_f32 v17, v18, v19
v_cvt_pk_bf16_f32 v18, v36, v37
v_cvt_pk_bf16_f32 v19, v38, v39
s_mov_b32 s9, 4096
buffer_store_dwordx4 v[16:19], v254, s[36:39], s9 offen sc1
v_cvt_pk_bf16_f32 v56, v56, v57
v_cvt_pk_bf16_f32 v57, v58, v59
v_cvt_pk_bf16_f32 v58, v76, v77
v_cvt_pk_bf16_f32 v59, v78, v79
s_mov_b32 s8, 9216
buffer_store_dwordx4 v[56:59], v254, s[36:39], s8 offen sc1
s_add_u32 s10, s98, 32
s_mul_i32 s10, s10, 573440
s_add_u32 s16, s88, s10
s_addc_u32 s17, s89, 0
s_mov_b32 s18, 573440
s_mov_b32 s19, 0x20000
s_cmp_lg_u32 s3, 7
s_cbranch_scc1 L_rBA1p1
s_mov_b32 s10, 0
buffer_load_dwordx4 v[80:83], v113, s[16:19], s10 offen sc1
s_add_u32 s10, s10, 71680
buffer_load_dwordx4 v[84:87], v113, s[16:19], s10 offen sc1
s_add_u32 s10, s10, 71680
buffer_load_dwordx4 v[88:91], v113, s[16:19], s10 offen sc1
s_add_u32 s10, s10, 71680
buffer_load_dwordx4 v[92:95], v113, s[16:19], s10 offen sc1
s_add_u32 s10, s10, 71680
buffer_load_dwordx4 v[96:99], v113, s[16:19], s10 offen sc1
s_add_u32 s10, s10, 71680
buffer_load_dwordx4 v[100:103], v113, s[16:19], s10 offen sc1
s_add_u32 s10, s10, 71680
buffer_load_dwordx4 v[104:107], v113, s[16:19], s10 offen sc1
s_add_u32 s10, s10, 71680
buffer_load_dwordx4 v[108:111], v113, s[16:19], s10 offen sc1
L_rBA1p1:
s_mov_b32 s10, 0
buffer_load_dwordx4 v[120:123], v112, s[16:19], s10 offen sc1
s_add_u32 s10, s10, 71680
buffer_load_dwordx4 v[124:127], v112, s[16:19], s10 offen sc1
s_add_u32 s10, s10, 71680
buffer_load_dwordx4 v[128:131], v112, s[16:19], s10 offen sc1
s_add_u32 s10, s10, 71680
buffer_load_dwordx4 v[132:135], v112, s[16:19], s10 offen sc1
s_add_u32 s10, s10, 71680
buffer_load_dwordx4 v[136:139], v112, s[16:19], s10 offen sc1
s_add_u32 s10, s10, 71680
buffer_load_dwordx4 v[140:143], v112, s[16:19], s10 offen sc1
s_add_u32 s10, s10, 71680
buffer_load_dwordx4 v[144:147], v112, s[16:19], s10 offen sc1
s_add_u32 s10, s10, 71680
buffer_load_dwordx4 v[148:151], v112, s[16:19], s10 offen sc1
s_waitcnt vmcnt(8)
s_waitcnt lgkmcnt(0)
s_barrier
s_cmp_lg_u32 s3, 0
s_cbranch_scc1 L_sigBAb
s_mul_i32 s10, s98, 4352
s_add_u32 s10, s10, 41943040
v_mov_b32 v253, s10
v_mov_b32 v254, 1
s_mov_b64 exec, 1
global_atomic_add v253, v254, s[88:89] offset:0 sc1
s_mov_b64 exec, -1
L_sigBAb:
s_waitcnt vmcnt(7)
s_cmp_lg_u32 s3, 7
s_cbranch_scc1 L_rBA1p2
v_lshlrev_b32 v160, 16, v80
v_and_b32 v161, 0xffff0000, v80
v_lshlrev_b32 v162, 16, v81
v_and_b32 v163, 0xffff0000, v81
v_lshlrev_b32 v164, 16, v82
v_and_b32 v165, 0xffff0000, v82
v_lshlrev_b32 v166, 16, v83
v_and_b32 v167, 0xffff0000, v83
v_lshlrev_b32 v168, 16, v84
v_and_b32 v169, 0xffff0000, v84
v_lshlrev_b32 v170, 16, v85
v_and_b32 v171, 0xffff0000, v85
v_lshlrev_b32 v172, 16, v86
v_and_b32 v173, 0xffff0000, v86
v_lshlrev_b32 v174, 16, v87
v_and_b32 v175, 0xffff0000, v87
v_pk_add_f32 v[160:161], v[160:161], v[168:169]
v_pk_add_f32 v[162:163], v[162:163], v[170:171]
v_pk_add_f32 v[164:165], v[164:165], v[172:173]
v_pk_add_f32 v[166:167], v[166:167], v[174:175]
v_lshlrev_b32 v168, 16, v88
v_and_b32 v169, 0xffff0000, v88
v_lshlrev_b32 v170, 16, v89
v_and_b32 v171, 0xffff0000, v89
v_lshlrev_b32 v172, 16, v90
v_and_b32 v173, 0xffff0000, v90
v_lshlrev_b32 v174, 16, v91
v_and_b32 v175, 0xffff0000, v91
v_pk_add_f32 v[160:161], v[160:161], v[168:169]
v_pk_add_f32 v[162:163], v[162:163], v[170:171]
v_pk_add_f32 v[164:165], v[164:165], v[172:173]
v_pk_add_f32 v[166:167], v[166:167], v[174:175]
v_lshlrev_b32 v168, 16, v92
v_and_b32 v169, 0xffff0000, v92
v_lshlrev_b32 v170, 16, v93
v_and_b32 v171, 0xffff0000, v93
v_lshlrev_b32 v172, 16, v94
v_and_b32 v173, 0xffff0000, v94
v_lshlrev_b32 v174, 16, v95
v_and_b32 v175, 0xffff0000, v95
v_pk_add_f32 v[160:161], v[160:161], v[168:169]
v_pk_add_f32 v[162:163], v[162:163], v[170:171]
v_pk_add_f32 v[164:165], v[164:165], v[172:173]
v_pk_add_f32 v[166:167], v[166:167], v[174:175]
v_lshlrev_b32 v168, 16, v96
v_and_b32 v169, 0xffff0000, v96
v_lshlrev_b32 v170, 16, v97
v_and_b32 v171, 0xffff0000, v97
v_lshlrev_b32 v172, 16, v98
v_and_b32 v173, 0xffff0000, v98
v_lshlrev_b32 v174, 16, v99
v_and_b32 v175, 0xffff0000, v99
v_pk_add_f32 v[160:161], v[160:161], v[168:169]
v_pk_add_f32 v[162:163], v[162:163], v[170:171]
v_pk_add_f32 v[164:165], v[164:165], v[172:173]
v_pk_add_f32 v[166:167], v[166:167], v[174:175]
v_lshlrev_b32 v168, 16, v100
v_and_b32 v169, 0xffff0000, v100
v_lshlrev_b32 v170, 16, v101
v_and_b32 v171, 0xffff0000, v101
v_lshlrev_b32 v172, 16, v102
v_and_b32 v173, 0xffff0000, v102
v_lshlrev_b32 v174, 16, v103
v_and_b32 v175, 0xffff0000, v103
v_pk_add_f32 v[160:161], v[160:161], v[168:169]
v_pk_add_f32 v[162:163], v[162:163], v[170:171]
v_pk_add_f32 v[164:165], v[164:165], v[172:173]
v_pk_add_f32 v[166:167], v[166:167], v[174:175]
v_lshlrev_b32 v168, 16, v104
v_and_b32 v169, 0xffff0000, v104
v_lshlrev_b32 v170, 16, v105
v_and_b32 v171, 0xffff0000, v105
v_lshlrev_b32 v172, 16, v106
v_and_b32 v173, 0xffff0000, v106
v_lshlrev_b32 v174, 16, v107
v_and_b32 v175, 0xffff0000, v107
v_pk_add_f32 v[160:161], v[160:161], v[168:169]
v_pk_add_f32 v[162:163], v[162:163], v[170:171]
v_pk_add_f32 v[164:165], v[164:165], v[172:173]
v_pk_add_f32 v[166:167], v[166:167], v[174:175]
v_lshlrev_b32 v168, 16, v108
v_and_b32 v169, 0xffff0000, v108
v_lshlrev_b32 v170, 16, v109
v_and_b32 v171, 0xffff0000, v109
v_lshlrev_b32 v172, 16, v110
v_and_b32 v173, 0xffff0000, v110
v_lshlrev_b32 v174, 16, v111
v_and_b32 v175, 0xffff0000, v111
v_pk_add_f32 v[160:161], v[160:161], v[168:169]
v_pk_add_f32 v[162:163], v[162:163], v[170:171]
v_pk_add_f32 v[164:165], v[164:165], v[172:173]
v_pk_add_f32 v[166:167], v[166:167], v[174:175]
v_cvt_pk_bf16_f32 v180, v160, v161
v_cvt_pk_bf16_f32 v181, v162, v163
v_cvt_pk_bf16_f32 v182, v164, v165
v_cvt_pk_bf16_f32 v183, v166, v167
buffer_store_dwordx2 v[180:181], v115, s[20:23], 0 offen offset:896
buffer_store_dwordx2 v[182:183], v115, s[20:23], 0 offen offset:928
L_rBA1p2:
v_lshlrev_b32 v160, 16, v120
v_and_b32 v161, 0xffff0000, v120
v_lshlrev_b32 v162, 16, v121
v_and_b32 v163, 0xffff0000, v121
v_lshlrev_b32 v164, 16, v122
v_and_b32 v165, 0xffff0000, v122
v_lshlrev_b32 v166, 16, v123
v_and_b32 v167, 0xffff0000, v123
s_waitcnt vmcnt(6)
v_lshlrev_b32 v168, 16, v124
v_and_b32 v169, 0xffff0000, v124
v_lshlrev_b32 v170, 16, v125
v_and_b32 v171, 0xffff0000, v125
v_lshlrev_b32 v172, 16, v126
v_and_b32 v173, 0xffff0000, v126
v_lshlrev_b32 v174, 16, v127
v_and_b32 v175, 0xffff0000, v127
v_pk_add_f32 v[160:161], v[160:161], v[168:169]
v_pk_add_f32 v[162:163], v[162:163], v[170:171]
v_pk_add_f32 v[164:165], v[164:165], v[172:173]
v_pk_add_f32 v[166:167], v[166:167], v[174:175]
s_waitcnt vmcnt(5)
v_lshlrev_b32 v168, 16, v128
v_and_b32 v169, 0xffff0000, v128
v_lshlrev_b32 v170, 16, v129
v_and_b32 v171, 0xffff0000, v129
v_lshlrev_b32 v172, 16, v130
v_and_b32 v173, 0xffff0000, v130
v_lshlrev_b32 v174, 16, v131
v_and_b32 v175, 0xffff0000, v131
v_pk_add_f32 v[160:161], v[160:161], v[168:169]
v_pk_add_f32 v[162:163], v[162:163], v[170:171]
v_pk_add_f32 v[164:165], v[164:165], v[172:173]
v_pk_add_f32 v[166:167], v[166:167], v[174:175]
s_waitcnt vmcnt(4)
v_lshlrev_b32 v168, 16, v132
v_and_b32 v169, 0xffff0000, v132
v_lshlrev_b32 v170, 16, v133
v_and_b32 v171, 0xffff0000, v133
v_lshlrev_b32 v172, 16, v134
v_and_b32 v173, 0xffff0000, v134
v_lshlrev_b32 v174, 16, v135
v_and_b32 v175, 0xffff0000, v135
v_pk_add_f32 v[160:161], v[160:161], v[168:169]
v_pk_add_f32 v[162:163], v[162:163], v[170:171]
v_pk_add_f32 v[164:165], v[164:165], v[172:173]
v_pk_add_f32 v[166:167], v[166:167], v[174:175]
s_waitcnt vmcnt(3)
v_lshlrev_b32 v168, 16, v136
v_and_b32 v169, 0xffff0000, v136
v_lshlrev_b32 v170, 16, v137
v_and_b32 v171, 0xffff0000, v137
v_lshlrev_b32 v172, 16, v138
v_and_b32 v173, 0xffff0000, v138
v_lshlrev_b32 v174, 16, v139
v_and_b32 v175, 0xffff0000, v139
v_pk_add_f32 v[160:161], v[160:161], v[168:169]
v_pk_add_f32 v[162:163], v[162:163], v[170:171]
v_pk_add_f32 v[164:165], v[164:165], v[172:173]
v_pk_add_f32 v[166:167], v[166:167], v[174:175]
s_waitcnt vmcnt(2)
v_lshlrev_b32 v168, 16, v140
v_and_b32 v169, 0xffff0000, v140
v_lshlrev_b32 v170, 16, v141
v_and_b32 v171, 0xffff0000, v141
v_lshlrev_b32 v172, 16, v142
v_and_b32 v173, 0xffff0000, v142
v_lshlrev_b32 v174, 16, v143
v_and_b32 v175, 0xffff0000, v143
v_pk_add_f32 v[160:161], v[160:161], v[168:169]
v_pk_add_f32 v[162:163], v[162:163], v[170:171]
v_pk_add_f32 v[164:165], v[164:165], v[172:173]
v_pk_add_f32 v[166:167], v[166:167], v[174:175]
s_waitcnt vmcnt(1)
v_lshlrev_b32 v168, 16, v144
v_and_b32 v169, 0xffff0000, v144
v_lshlrev_b32 v170, 16, v145
v_and_b32 v171, 0xffff0000, v145
v_lshlrev_b32 v172, 16, v146
v_and_b32 v173, 0xffff0000, v146
v_lshlrev_b32 v174, 16, v147
v_and_b32 v175, 0xffff0000, v147
v_pk_add_f32 v[160:161], v[160:161], v[168:169]
v_pk_add_f32 v[162:163], v[162:163], v[170:171]
v_pk_add_f32 v[164:165], v[164:165], v[172:173]
v_pk_add_f32 v[166:167], v[166:167], v[174:175]
s_waitcnt vmcnt(0)
v_lshlrev_b32 v168, 16, v148
v_and_b32 v169, 0xffff0000, v148
v_lshlrev_b32 v170, 16, v149
v_and_b32 v171, 0xffff0000, v149
v_lshlrev_b32 v172, 16, v150
v_and_b32 v173, 0xffff0000, v150
v_lshlrev_b32 v174, 16, v151
v_and_b32 v175, 0xffff0000, v151
v_pk_add_f32 v[160:161], v[160:161], v[168:169]
v_pk_add_f32 v[162:163], v[162:163], v[170:171]
v_pk_add_f32 v[164:165], v[164:165], v[172:173]
v_pk_add_f32 v[166:167], v[166:167], v[174:175]
v_cvt_pk_bf16_f32 v176, v160, v161
v_cvt_pk_bf16_f32 v177, v162, v163
v_cvt_pk_bf16_f32 v178, v164, v165
v_cvt_pk_bf16_f32 v179, v166, v167
buffer_store_dwordx2 v[176:177], v114, s[20:23], 0 offen offset:896
buffer_store_dwordx2 v[178:179], v114, s[20:23], 0 offen offset:928
s_cmp_lg_u32 s3, 0
s_cbranch_scc1 L_rBA2go
s_mul_i32 s10, s98, 4352
s_add_u32 s10, s10, 41943040
v_mov_b32 v116, s10
L_rBA2poll:
s_mov_b64 exec, 1
global_load_dword v117, v116, s[88:89] offset:0 sc1
s_mov_b64 exec, -1
s_waitcnt vmcnt(0)
v_readfirstlane_b32 s10, v117
s_nop 3
s_cmp_ge_u32 s10, 8
s_cbranch_scc1 L_rBA2go
s_sleep 4
s_branch L_rBA2poll
L_rBA2go:
s_barrier
s_add_u32 s10, s98, 0
s_mul_i32 s10, s10, 573440
s_add_u32 s16, s88, s10
s_addc_u32 s17, s89, 0
s_mov_b32 s18, 573440
s_mov_b32 s19, 0x20000
s_cmp_lg_u32 s3, 7
s_cbranch_scc1 L_rBA2p1
s_mov_b32 s10, 0
buffer_load_dwordx4 v[80:83], v113, s[16:19], s10 offen sc1
s_add_u32 s10, s10, 71680
buffer_load_dwordx4 v[84:87], v113, s[16:19], s10 offen sc1
s_add_u32 s10, s10, 71680
buffer_load_dwordx4 v[88:91], v113, s[16:19], s10 offen sc1
s_add_u32 s10, s10, 71680
buffer_load_dwordx4 v[92:95], v113, s[16:19], s10 offen sc1
s_add_u32 s10, s10, 71680
buffer_load_dwordx4 v[96:99], v113, s[16:19], s10 offen sc1
s_add_u32 s10, s10, 71680
buffer_load_dwordx4 v[100:103], v113, s[16:19], s10 offen sc1
s_add_u32 s10, s10, 71680
buffer_load_dwordx4 v[104:107], v113, s[16:19], s10 offen sc1
s_add_u32 s10, s10, 71680
buffer_load_dwordx4 v[108:111], v113, s[16:19], s10 offen sc1
L_rBA2p1:
s_mov_b32 s10, 0
buffer_load_dwordx4 v[120:123], v112, s[16:19], s10 offen sc1
s_add_u32 s10, s10, 71680
buffer_load_dwordx4 v[124:127], v112, s[16:19], s10 offen sc1
s_add_u32 s10, s10, 71680
buffer_load_dwordx4 v[128:131], v112, s[16:19], s10 offen sc1
s_add_u32 s10, s10, 71680
buffer_load_dwordx4 v[132:135], v112, s[16:19], s10 offen sc1
s_add_u32 s10, s10, 71680
buffer_load_dwordx4 v[136:139], v112, s[16:19], s10 offen sc1
s_add_u32 s10, s10, 71680
buffer_load_dwordx4 v[140:143], v112, s[16:19], s10 offen sc1
s_add_u32 s10, s10, 71680
buffer_load_dwordx4 v[144:147], v112, s[16:19], s10 offen sc1
s_add_u32 s10, s10, 71680
buffer_load_dwordx4 v[148:151], v112, s[16:19], s10 offen sc1
s_waitcnt vmcnt(7)
s_cmp_lg_u32 s3, 7
s_cbranch_scc1 L_rBA2p2
v_lshlrev_b32 v160, 16, v80
v_and_b32 v161, 0xffff0000, v80
v_lshlrev_b32 v162, 16, v81
v_and_b32 v163, 0xffff0000, v81
v_lshlrev_b32 v164, 16, v82
v_and_b32 v165, 0xffff0000, v82
v_lshlrev_b32 v166, 16, v83
v_and_b32 v167, 0xffff0000, v83
v_lshlrev_b32 v168, 16, v84
v_and_b32 v169, 0xffff0000, v84
v_lshlrev_b32 v170, 16, v85
v_and_b32 v171, 0xffff0000, v85
v_lshlrev_b32 v172, 16, v86
v_and_b32 v173, 0xffff0000, v86
v_lshlrev_b32 v174, 16, v87
v_and_b32 v175, 0xffff0000, v87
v_pk_add_f32 v[160:161], v[160:161], v[168:169]
v_pk_add_f32 v[162:163], v[162:163], v[170:171]
v_pk_add_f32 v[164:165], v[164:165], v[172:173]
v_pk_add_f32 v[166:167], v[166:167], v[174:175]
v_lshlrev_b32 v168, 16, v88
v_and_b32 v169, 0xffff0000, v88
v_lshlrev_b32 v170, 16, v89
v_and_b32 v171, 0xffff0000, v89
v_lshlrev_b32 v172, 16, v90
v_and_b32 v173, 0xffff0000, v90
v_lshlrev_b32 v174, 16, v91
v_and_b32 v175, 0xffff0000, v91
v_pk_add_f32 v[160:161], v[160:161], v[168:169]
v_pk_add_f32 v[162:163], v[162:163], v[170:171]
v_pk_add_f32 v[164:165], v[164:165], v[172:173]
v_pk_add_f32 v[166:167], v[166:167], v[174:175]
v_lshlrev_b32 v168, 16, v92
v_and_b32 v169, 0xffff0000, v92
v_lshlrev_b32 v170, 16, v93
v_and_b32 v171, 0xffff0000, v93
v_lshlrev_b32 v172, 16, v94
v_and_b32 v173, 0xffff0000, v94
v_lshlrev_b32 v174, 16, v95
v_and_b32 v175, 0xffff0000, v95
v_pk_add_f32 v[160:161], v[160:161], v[168:169]
v_pk_add_f32 v[162:163], v[162:163], v[170:171]
v_pk_add_f32 v[164:165], v[164:165], v[172:173]
v_pk_add_f32 v[166:167], v[166:167], v[174:175]
v_lshlrev_b32 v168, 16, v96
v_and_b32 v169, 0xffff0000, v96
v_lshlrev_b32 v170, 16, v97
v_and_b32 v171, 0xffff0000, v97
v_lshlrev_b32 v172, 16, v98
v_and_b32 v173, 0xffff0000, v98
v_lshlrev_b32 v174, 16, v99
v_and_b32 v175, 0xffff0000, v99
v_pk_add_f32 v[160:161], v[160:161], v[168:169]
v_pk_add_f32 v[162:163], v[162:163], v[170:171]
v_pk_add_f32 v[164:165], v[164:165], v[172:173]
v_pk_add_f32 v[166:167], v[166:167], v[174:175]
v_lshlrev_b32 v168, 16, v100
v_and_b32 v169, 0xffff0000, v100
v_lshlrev_b32 v170, 16, v101
v_and_b32 v171, 0xffff0000, v101
v_lshlrev_b32 v172, 16, v102
v_and_b32 v173, 0xffff0000, v102
v_lshlrev_b32 v174, 16, v103
v_and_b32 v175, 0xffff0000, v103
v_pk_add_f32 v[160:161], v[160:161], v[168:169]
v_pk_add_f32 v[162:163], v[162:163], v[170:171]
v_pk_add_f32 v[164:165], v[164:165], v[172:173]
v_pk_add_f32 v[166:167], v[166:167], v[174:175]
v_lshlrev_b32 v168, 16, v104
v_and_b32 v169, 0xffff0000, v104
v_lshlrev_b32 v170, 16, v105
v_and_b32 v171, 0xffff0000, v105
v_lshlrev_b32 v172, 16, v106
v_and_b32 v173, 0xffff0000, v106
v_lshlrev_b32 v174, 16, v107
v_and_b32 v175, 0xffff0000, v107
v_pk_add_f32 v[160:161], v[160:161], v[168:169]
v_pk_add_f32 v[162:163], v[162:163], v[170:171]
v_pk_add_f32 v[164:165], v[164:165], v[172:173]
v_pk_add_f32 v[166:167], v[166:167], v[174:175]
v_lshlrev_b32 v168, 16, v108
v_and_b32 v169, 0xffff0000, v108
v_lshlrev_b32 v170, 16, v109
v_and_b32 v171, 0xffff0000, v109
v_lshlrev_b32 v172, 16, v110
v_and_b32 v173, 0xffff0000, v110
v_lshlrev_b32 v174, 16, v111
v_and_b32 v175, 0xffff0000, v111
v_pk_add_f32 v[160:161], v[160:161], v[168:169]
v_pk_add_f32 v[162:163], v[162:163], v[170:171]
v_pk_add_f32 v[164:165], v[164:165], v[172:173]
v_pk_add_f32 v[166:167], v[166:167], v[174:175]
v_cvt_pk_bf16_f32 v180, v160, v161
v_cvt_pk_bf16_f32 v181, v162, v163
v_cvt_pk_bf16_f32 v182, v164, v165
v_cvt_pk_bf16_f32 v183, v166, v167
buffer_store_dwordx2 v[180:181], v115, s[20:23], 0 offen offset:0
buffer_store_dwordx2 v[182:183], v115, s[20:23], 0 offen offset:32
L_rBA2p2:
v_lshlrev_b32 v160, 16, v120
v_and_b32 v161, 0xffff0000, v120
v_lshlrev_b32 v162, 16, v121
v_and_b32 v163, 0xffff0000, v121
v_lshlrev_b32 v164, 16, v122
v_and_b32 v165, 0xffff0000, v122
v_lshlrev_b32 v166, 16, v123
v_and_b32 v167, 0xffff0000, v123
s_waitcnt vmcnt(6)
v_lshlrev_b32 v168, 16, v124
v_and_b32 v169, 0xffff0000, v124
v_lshlrev_b32 v170, 16, v125
v_and_b32 v171, 0xffff0000, v125
v_lshlrev_b32 v172, 16, v126
v_and_b32 v173, 0xffff0000, v126
v_lshlrev_b32 v174, 16, v127
v_and_b32 v175, 0xffff0000, v127
v_pk_add_f32 v[160:161], v[160:161], v[168:169]
v_pk_add_f32 v[162:163], v[162:163], v[170:171]
v_pk_add_f32 v[164:165], v[164:165], v[172:173]
v_pk_add_f32 v[166:167], v[166:167], v[174:175]
s_waitcnt vmcnt(5)
v_lshlrev_b32 v168, 16, v128
v_and_b32 v169, 0xffff0000, v128
v_lshlrev_b32 v170, 16, v129
v_and_b32 v171, 0xffff0000, v129
v_lshlrev_b32 v172, 16, v130
v_and_b32 v173, 0xffff0000, v130
v_lshlrev_b32 v174, 16, v131
v_and_b32 v175, 0xffff0000, v131
v_pk_add_f32 v[160:161], v[160:161], v[168:169]
v_pk_add_f32 v[162:163], v[162:163], v[170:171]
v_pk_add_f32 v[164:165], v[164:165], v[172:173]
v_pk_add_f32 v[166:167], v[166:167], v[174:175]
s_waitcnt vmcnt(4)
v_lshlrev_b32 v168, 16, v132
v_and_b32 v169, 0xffff0000, v132
v_lshlrev_b32 v170, 16, v133
v_and_b32 v171, 0xffff0000, v133
v_lshlrev_b32 v172, 16, v134
v_and_b32 v173, 0xffff0000, v134
v_lshlrev_b32 v174, 16, v135
v_and_b32 v175, 0xffff0000, v135
v_pk_add_f32 v[160:161], v[160:161], v[168:169]
v_pk_add_f32 v[162:163], v[162:163], v[170:171]
v_pk_add_f32 v[164:165], v[164:165], v[172:173]
v_pk_add_f32 v[166:167], v[166:167], v[174:175]
s_waitcnt vmcnt(3)
v_lshlrev_b32 v168, 16, v136
v_and_b32 v169, 0xffff0000, v136
v_lshlrev_b32 v170, 16, v137
v_and_b32 v171, 0xffff0000, v137
v_lshlrev_b32 v172, 16, v138
v_and_b32 v173, 0xffff0000, v138
v_lshlrev_b32 v174, 16, v139
v_and_b32 v175, 0xffff0000, v139
v_pk_add_f32 v[160:161], v[160:161], v[168:169]
v_pk_add_f32 v[162:163], v[162:163], v[170:171]
v_pk_add_f32 v[164:165], v[164:165], v[172:173]
v_pk_add_f32 v[166:167], v[166:167], v[174:175]
s_waitcnt vmcnt(2)
v_lshlrev_b32 v168, 16, v140
v_and_b32 v169, 0xffff0000, v140
v_lshlrev_b32 v170, 16, v141
v_and_b32 v171, 0xffff0000, v141
v_lshlrev_b32 v172, 16, v142
v_and_b32 v173, 0xffff0000, v142
v_lshlrev_b32 v174, 16, v143
v_and_b32 v175, 0xffff0000, v143
v_pk_add_f32 v[160:161], v[160:161], v[168:169]
v_pk_add_f32 v[162:163], v[162:163], v[170:171]
v_pk_add_f32 v[164:165], v[164:165], v[172:173]
v_pk_add_f32 v[166:167], v[166:167], v[174:175]
s_waitcnt vmcnt(1)
v_lshlrev_b32 v168, 16, v144
v_and_b32 v169, 0xffff0000, v144
v_lshlrev_b32 v170, 16, v145
v_and_b32 v171, 0xffff0000, v145
v_lshlrev_b32 v172, 16, v146
v_and_b32 v173, 0xffff0000, v146
v_lshlrev_b32 v174, 16, v147
v_and_b32 v175, 0xffff0000, v147
v_pk_add_f32 v[160:161], v[160:161], v[168:169]
v_pk_add_f32 v[162:163], v[162:163], v[170:171]
v_pk_add_f32 v[164:165], v[164:165], v[172:173]
v_pk_add_f32 v[166:167], v[166:167], v[174:175]
s_waitcnt vmcnt(0)
v_lshlrev_b32 v168, 16, v148
v_and_b32 v169, 0xffff0000, v148
v_lshlrev_b32 v170, 16, v149
v_and_b32 v171, 0xffff0000, v149
v_lshlrev_b32 v172, 16, v150
v_and_b32 v173, 0xffff0000, v150
v_lshlrev_b32 v174, 16, v151
v_and_b32 v175, 0xffff0000, v151
v_pk_add_f32 v[160:161], v[160:161], v[168:169]
v_pk_add_f32 v[162:163], v[162:163], v[170:171]
v_pk_add_f32 v[164:165], v[164:165], v[172:173]
v_pk_add_f32 v[166:167], v[166:167], v[174:175]
v_cvt_pk_bf16_f32 v176, v160, v161
v_cvt_pk_bf16_f32 v177, v162, v163
v_cvt_pk_bf16_f32 v178, v164, v165
v_cvt_pk_bf16_f32 v179, v166, v167
buffer_store_dwordx2 v[176:177], v114, s[20:23], 0 offen offset:0
buffer_store_dwordx2 v[178:179], v114, s[20:23], 0 offen offset:32
s_endpgm
L_exit:
s_endpgm
L_other:
v_mfma_f32_16x16x32_bf16 v[44:47], v[224:227], v[184:187], v[44:47]
s_waitcnt lgkmcnt(1)
s_mov_b32 m0, s4
s_add_u32 s9, s66, 0
buffer_load_dwordx4 v232, s[24:27], s9 offen nt lds
s_add_u32 s8, s66, 3072
buffer_load_dwordx4 v232, s[24:27], s8 offen offset:1024 nt lds
v_mfma_f32_16x16x32_bf16 v[64:67], v[228:231], v[184:187], v[64:67]
ds_read_b128 v[184:187], v243 offset:26624
v_mfma_f32_16x16x32_bf16 v[8:11], v[216:219], v[188:191], v[8:11]
s_waitcnt vmcnt(6)
ds_read_b64_tr_b16 v[202:203], v236 offset:2048
ds_read_b64_tr_b16 v[206:207], v237 offset:2048
ds_read_b64_tr_b16 v[210:211], v238 offset:2048
ds_read_b64_tr_b16 v[214:215], v239 offset:2048
v_mfma_f32_16x16x32_bf16 v[28:31], v[220:223], v[188:191], v[28:31]
v_mfma_f32_16x16x32_bf16 v[48:51], v[224:227], v[188:191], v[48:51]
v_mfma_f32_16x16x32_bf16 v[68:71], v[228:231], v[188:191], v[68:71]
ds_read_b128 v[188:191], v243 offset:27648
v_mfma_f32_16x16x32_bf16 v[12:15], v[216:219], v[192:195], v[12:15]
v_mfma_f32_16x16x32_bf16 v[32:35], v[220:223], v[192:195], v[32:35]
s_waitcnt lgkmcnt(1)
s_mov_b32 m0, s4
s_add_u32 s9, s66, 14336
buffer_load_dwordx4 v232, s[24:27], s9 offen offset:2048 nt lds
s_add_u32 s8, s66, 17408
buffer_load_dwordx4 v232, s[24:27], s8 offen offset:3072 nt lds
v_mfma_f32_16x16x32_bf16 v[52:55], v[224:227], v[192:195], v[52:55]
v_mfma_f32_16x16x32_bf16 v[72:75], v[228:231], v[192:195], v[72:75]
ds_read_b128 v[192:195], v243 offset:28672
v_mfma_f32_16x16x32_bf16 v[16:19], v[216:219], v[196:199], v[16:19]
v_mfma_f32_16x16x32_bf16 v[36:39], v[220:223], v[196:199], v[36:39]
v_mfma_f32_16x16x32_bf16 v[56:59], v[224:227], v[196:199], v[56:59]
v_mfma_f32_16x16x32_bf16 v[76:79], v[228:231], v[196:199], v[76:79]
ds_read_b128 v[196:199], v243 offset:29696
v_mfma_f32_16x16x32_bf16 v[0:3], v[200:203], v[160:163], v[0:3]
v_mfma_f32_16x16x32_bf16 v[20:23], v[204:207], v[160:163], v[20:23]
s_waitcnt vmcnt(6)
ds_read_b64_tr_b16 v[216:217], v236 offset:4096
ds_read_b64_tr_b16 v[220:221], v237 offset:4096
ds_read_b64_tr_b16 v[224:225], v238 offset:4096
ds_read_b64_tr_b16 v[228:229], v239 offset:4096
v_mfma_f32_16x16x32_bf16 v[40:43], v[208:211], v[160:163], v[40:43]
v_mfma_f32_16x16x32_bf16 v[60:63], v[212:215], v[160:163], v[60:63]
v_mfma_f32_16x16x32_bf16 v[4:7], v[200:203], v[164:167], v[4:7]
v_mfma_f32_16x16x32_bf16 v[24:27], v[204:207], v[164:167], v[24:27]
v_mfma_f32_16x16x32_bf16 v[44:47], v[208:211], v[164:167], v[44:47]
s_waitcnt lgkmcnt(0)
s_mov_b32 m0, s5
s_add_u32 s9, s67, 0
buffer_load_dwordx4 v232, s[24:27], s9 offen nt lds
s_add_u32 s8, s67, 3072
buffer_load_dwordx4 v232, s[24:27], s8 offen offset:1024 nt lds
v_mfma_f32_16x16x32_bf16 v[64:67], v[212:215], v[164:167], v[64:67]
v_mfma_f32_16x16x32_bf16 v[8:11], v[200:203], v[168:171], v[8:11]
s_waitcnt vmcnt(6)
ds_read_b64_tr_b16 v[218:219], v236 offset:6144
ds_read_b64_tr_b16 v[222:223], v237 offset:6144
ds_read_b64_tr_b16 v[226:227], v238 offset:6144
ds_read_b64_tr_b16 v[230:231], v239 offset:6144
v_mfma_f32_16x16x32_bf16 v[28:31], v[204:207], v[168:171], v[28:31]
v_mfma_f32_16x16x32_bf16 v[48:51], v[208:211], v[168:171], v[48:51]
v_mfma_f32_16x16x32_bf16 v[68:71], v[212:215], v[168:171], v[68:71]
v_mfma_f32_16x16x32_bf16 v[12:15], v[200:203], v[172:175], v[12:15]
s_barrier
v_mfma_f32_16x16x32_bf16 v[32:35], v[204:207], v[172:175], v[32:35]
s_waitcnt lgkmcnt(0)
s_mov_b32 m0, s5
s_add_u32 s9, s67, 14336
buffer_load_dwordx4 v232, s[24:27], s9 offen offset:2048 nt lds
s_add_u32 s8, s67, 17408
buffer_load_dwordx4 v232, s[24:27], s8 offen offset:3072 nt lds
v_mfma_f32_16x16x32_bf16 v[52:55], v[208:211], v[172:175], v[52:55]
v_mfma_f32_16x16x32_bf16 v[72:75], v[212:215], v[172:175], v[72:75]
v_mfma_f32_16x16x32_bf16 v[16:19], v[200:203], v[176:179], v[16:19]
v_mfma_f32_16x16x32_bf16 v[36:39], v[204:207], v[176:179], v[36:39]
v_mfma_f32_16x16x32_bf16 v[56:59], v[208:211], v[176:179], v[56:59]
v_mfma_f32_16x16x32_bf16 v[76:79], v[212:215], v[176:179], v[76:79]
v_mfma_f32_16x16x32_bf16 v[0:3], v[216:219], v[180:183], v[0:3]
v_mfma_f32_16x16x32_bf16 v[20:23], v[220:223], v[180:183], v[20:23]
v_mfma_f32_16x16x32_bf16 v[40:43], v[224:227], v[180:183], v[40:43]
v_mfma_f32_16x16x32_bf16 v[60:63], v[228:231], v[180:183], v[60:63]
v_mfma_f32_16x16x32_bf16 v[4:7], v[216:219], v[184:187], v[4:7]
s_waitcnt vmcnt(6)
s_barrier
v_mfma_f32_16x16x32_bf16 v[24:27], v[220:223], v[184:187], v[24:27]
v_subrev_u32 v236, s13, v236
v_subrev_u32 v237, s13, v237
v_subrev_u32 v238, s13, v238
v_subrev_u32 v239, s13, v239
v_subrev_u32 v240, s13, v240
v_subrev_u32 v241, s13, v241
ds_read_b128 v[200:203], v240 offset:0
ds_read_b128 v[204:207], v241 offset:0
v_mfma_f32_16x16x32_bf16 v[44:47], v[224:227], v[184:187], v[44:47]
v_mfma_f32_16x16x32_bf16 v[64:67], v[228:231], v[184:187], v[64:67]
ds_read_b128 v[208:211], v240 offset:32768
ds_read_b128 v[212:215], v241 offset:32768
v_mfma_f32_16x16x32_bf16 v[8:11], v[216:219], v[188:191], v[8:11]
v_mfma_f32_16x16x32_bf16 v[28:31], v[220:223], v[188:191], v[28:31]
v_mfma_f32_16x16x32_bf16 v[48:51], v[224:227], v[188:191], v[48:51]
v_mfma_f32_16x16x32_bf16 v[68:71], v[228:231], v[188:191], v[68:71]
v_mfma_f32_16x16x32_bf16 v[12:15], v[216:219], v[192:195], v[12:15]
v_cvt_pk_bf16_f32 v0, v0, v1
v_cvt_pk_bf16_f32 v1, v2, v3
ds_write_b64 v251, v[0:1] offset:0
v_cvt_pk_bf16_f32 v20, v20, v21
v_cvt_pk_bf16_f32 v21, v22, v23
ds_write_b64 v252, v[20:21] offset:0
v_cvt_pk_bf16_f32 v40, v40, v41
v_cvt_pk_bf16_f32 v41, v42, v43
ds_write_b64 v251, v[40:41] offset:5120
v_cvt_pk_bf16_f32 v60, v60, v61
v_cvt_pk_bf16_f32 v61, v62, v63
ds_write_b64 v252, v[60:61] offset:5120
v_mfma_f32_16x16x32_bf16 v[32:35], v[220:223], v[192:195], v[32:35]
v_mfma_f32_16x16x32_bf16 v[52:55], v[224:227], v[192:195], v[52:55]
v_mfma_f32_16x16x32_bf16 v[72:75], v[228:231], v[192:195], v[72:75]
v_mfma_f32_16x16x32_bf16 v[16:19], v[216:219], v[196:199], v[16:19]
v_cvt_pk_bf16_f32 v4, v4, v5
v_cvt_pk_bf16_f32 v5, v6, v7
ds_write_b64 v251, v[4:5] offset:1024
v_cvt_pk_bf16_f32 v24, v24, v25
v_cvt_pk_bf16_f32 v25, v26, v27
ds_write_b64 v252, v[24:25] offset:1024
v_cvt_pk_bf16_f32 v44, v44, v45
v_cvt_pk_bf16_f32 v45, v46, v47
ds_write_b64 v251, v[44:45] offset:6144
v_cvt_pk_bf16_f32 v64, v64, v65
v_cvt_pk_bf16_f32 v65, v66, v67
ds_write_b64 v252, v[64:65] offset:6144
v_mfma_f32_16x16x32_bf16 v[36:39], v[220:223], v[196:199], v[36:39]
v_mfma_f32_16x16x32_bf16 v[56:59], v[224:227], v[196:199], v[56:59]
v_mfma_f32_16x16x32_bf16 v[76:79], v[228:231], v[196:199], v[76:79]
s_nop 7
v_cvt_pk_bf16_f32 v8, v8, v9
v_cvt_pk_bf16_f32 v9, v10, v11
ds_write_b64 v251, v[8:9] offset:2048
v_cvt_pk_bf16_f32 v28, v28, v29
v_cvt_pk_bf16_f32 v29, v30, v31
ds_write_b64 v252, v[28:29] offset:2048
v_cvt_pk_bf16_f32 v48, v48, v49
v_cvt_pk_bf16_f32 v49, v50, v51
ds_write_b64 v251, v[48:49] offset:7168
v_cvt_pk_bf16_f32 v68, v68, v69
v_cvt_pk_bf16_f32 v69, v70, v71
ds_write_b64 v252, v[68:69] offset:7168
v_cvt_pk_bf16_f32 v12, v12, v13
v_cvt_pk_bf16_f32 v13, v14, v15
ds_write_b64 v251, v[12:13] offset:3072
v_cvt_pk_bf16_f32 v32, v32, v33
v_cvt_pk_bf16_f32 v33, v34, v35
ds_write_b64 v252, v[32:33] offset:3072
v_cvt_pk_bf16_f32 v52, v52, v53
v_cvt_pk_bf16_f32 v53, v54, v55
ds_write_b64 v251, v[52:53] offset:8192
v_cvt_pk_bf16_f32 v72, v72, v73
v_cvt_pk_bf16_f32 v73, v74, v75
ds_write_b64 v252, v[72:73] offset:8192
v_cvt_pk_bf16_f32 v16, v16, v17
v_cvt_pk_bf16_f32 v17, v18, v19
ds_write_b64 v251, v[16:17] offset:4096
v_cvt_pk_bf16_f32 v36, v36, v37
v_cvt_pk_bf16_f32 v37, v38, v39
ds_write_b64 v252, v[36:37] offset:4096
v_cvt_pk_bf16_f32 v56, v56, v57
v_cvt_pk_bf16_f32 v57, v58, v59
ds_write_b64 v251, v[56:57] offset:9216
v_cvt_pk_bf16_f32 v76, v76, v77
v_cvt_pk_bf16_f32 v77, v78, v79
ds_write_b64 v252, v[76:77] offset:9216
s_waitcnt lgkmcnt(0)
s_barrier
s_mov_b32 m0, s4
s_add_u32 s9, s68, 0
buffer_load_dwordx4 v232, s[24:27], s9 offen nt lds
s_add_u32 s8, s68, 3072
buffer_load_dwordx4 v232, s[24:27], s8 offen offset:1024 nt lds
s_or_b32 s10, s3, s97
s_cmp_lg_u32 s10, 0
s_cbranch_scc1 L_rstAB
s_mul_i32 s10, s98, 4352
s_add_u32 s10, s10, 41943040
v_mov_b32 v253, s10
v_mov_b32 v254, 0
s_mov_b64 exec, 1
global_store_dword v253, v254, s[88:89] sc1
s_mov_b64 exec, -1
L_rstAB:
ds_read_b128 v[160:163], v244 offset:0
ds_read_b128 v[164:167], v244 offset:1024
ds_read_b128 v[168:171], v244 offset:2048
ds_read_b128 v[172:175], v244 offset:3072
ds_read_b128 v[176:179], v244 offset:4096
ds_read_b128 v[180:183], v244 offset:5120
ds_read_b128 v[184:187], v244 offset:6144
ds_read_b128 v[188:191], v244 offset:7168
ds_read_b128 v[192:195], v244 offset:8192
ds_read_b128 v[196:199], v244 offset:9216
s_waitcnt lgkmcnt(9)
v_mfma_f32_16x16x32_bf16 v[0:3], v[200:203], v[160:163], 0
v_mfma_f32_16x16x32_bf16 v[20:23], v[208:211], v[160:163], 0
s_waitcnt lgkmcnt(8)
v_mfma_f32_16x16x32_bf16 v[4:7], v[200:203], v[164:167], 0
v_mfma_f32_16x16x32_bf16 v[24:27], v[208:211], v[164:167], 0
s_waitcnt lgkmcnt(7)
v_mfma_f32_16x16x32_bf16 v[8:11], v[200:203], v[168:171], 0
s_waitcnt vmcnt(6)
s_barrier
v_mfma_f32_16x16x32_bf16 v[28:31], v[208:211], v[168:171], 0
ds_read_b128 v[216:219], v240 offset:2048
ds_read_b128 v[220:223], v241 offset:2048
s_waitcnt lgkmcnt(8)
v_mfma_f32_16x16x32_bf16 v[12:15], v[200:203], v[172:175], 0
v_mfma_f32_16x16x32_bf16 v[32:35], v[208:211], v[172:175], 0
ds_read_b128 v[224:227], v240 offset:34816
ds_read_b128 v[228:231], v241 offset:34816
s_waitcnt lgkmcnt(9)
v_mfma_f32_16x16x32_bf16 v[16:19], v[200:203], v[176:179], 0
v_mfma_f32_16x16x32_bf16 v[36:39], v[208:211], v[176:179], 0
s_waitcnt lgkmcnt(8)
v_mfma_f32_16x16x32_bf16 v[0:3], v[204:207], v[180:183], v[0:3]
v_mfma_f32_16x16x32_bf16 v[20:23], v[212:215], v[180:183], v[20:23]
s_waitcnt lgkmcnt(7)
v_mfma_f32_16x16x32_bf16 v[4:7], v[204:207], v[184:187], v[4:7]
v_mfma_f32_16x16x32_bf16 v[24:27], v[212:215], v[184:187], v[24:27]
s_waitcnt lgkmcnt(6)
v_mfma_f32_16x16x32_bf16 v[8:11], v[204:207], v[188:191], v[8:11]
v_mfma_f32_16x16x32_bf16 v[28:31], v[212:215], v[188:191], v[28:31]
s_waitcnt lgkmcnt(5)
v_mfma_f32_16x16x32_bf16 v[12:15], v[204:207], v[192:195], v[12:15]
v_mfma_f32_16x16x32_bf16 v[32:35], v[212:215], v[192:195], v[32:35]
s_waitcnt lgkmcnt(4)
v_mfma_f32_16x16x32_bf16 v[16:19], v[204:207], v[196:199], v[16:19]
v_mfma_f32_16x16x32_bf16 v[36:39], v[212:215], v[196:199], v[36:39]
s_waitcnt lgkmcnt(3)
v_mfma_f32_16x16x32_bf16 v[40:43], v[216:219], v[160:163], 0
s_waitcnt lgkmcnt(1)
v_mfma_f32_16x16x32_bf16 v[60:63], v[224:227], v[160:163], 0
ds_read_b128 v[160:163], v244 offset:10240
v_mfma_f32_16x16x32_bf16 v[44:47], v[216:219], v[164:167], 0
v_mfma_f32_16x16x32_bf16 v[64:67], v[224:227], v[164:167], 0
ds_read_b128 v[164:167], v244 offset:11264
v_mfma_f32_16x16x32_bf16 v[48:51], v[216:219], v[168:171], 0
s_waitcnt vmcnt(4)
s_waitcnt lgkmcnt(2)
s_barrier
v_mfma_f32_16x16x32_bf16 v[68:71], v[224:227], v[168:171], 0
ds_read_b128 v[168:171], v244 offset:12288
ds_read_b128 v[200:203], v240 offset:4096
ds_read_b128 v[204:207], v241 offset:4096
v_mfma_f32_16x16x32_bf16 v[52:55], v[216:219], v[172:175], 0
v_mfma_f32_16x16x32_bf16 v[72:75], v[224:227], v[172:175], 0
ds_read_b128 v[172:175], v244 offset:13312
ds_read_b128 v[208:211], v240 offset:36864
ds_read_b128 v[212:215], v241 offset:36864
v_mfma_f32_16x16x32_bf16 v[56:59], v[216:219], v[176:179], 0
v_mfma_f32_16x16x32_bf16 v[76:79], v[224:227], v[176:179], 0
ds_read_b128 v[176:179], v244 offset:14336
s_mov_b32 m0, s4
s_add_u32 s9, s68, 14336
buffer_load_dwordx4 v232, s[24:27], s9 offen offset:2048 nt lds
s_add_u32 s8, s68, 17408
buffer_load_dwordx4 v232, s[24:27], s8 offen offset:3072 nt lds
v_mfma_f32_16x16x32_bf16 v[40:43], v[220:223], v[180:183], v[40:43]
v_mfma_f32_16x16x32_bf16 v[60:63], v[228:231], v[180:183], v[60:63]
ds_read_b128 v[180:183], v244 offset:15360
v_mfma_f32_16x16x32_bf16 v[44:47], v[220:223], v[184:187], v[44:47]
v_mfma_f32_16x16x32_bf16 v[64:67], v[228:231], v[184:187], v[64:67]
ds_read_b128 v[184:187], v244 offset:16384
v_mfma_f32_16x16x32_bf16 v[48:51], v[220:223], v[188:191], v[48:51]
v_mfma_f32_16x16x32_bf16 v[68:71], v[228:231], v[188:191], v[68:71]
ds_read_b128 v[188:191], v244 offset:17408
v_mfma_f32_16x16x32_bf16 v[52:55], v[220:223], v[192:195], v[52:55]
v_mfma_f32_16x16x32_bf16 v[72:75], v[228:231], v[192:195], v[72:75]
ds_read_b128 v[192:195], v244 offset:18432
v_mfma_f32_16x16x32_bf16 v[56:59], v[220:223], v[196:199], v[56:59]
v_mfma_f32_16x16x32_bf16 v[76:79], v[228:231], v[196:199], v[76:79]
ds_read_b128 v[196:199], v244 offset:19456
s_waitcnt lgkmcnt(10)
v_mfma_f32_16x16x32_bf16 v[0:3], v[200:203], v[160:163], v[0:3]
s_waitcnt lgkmcnt(7)
v_mfma_f32_16x16x32_bf16 v[20:23], v[208:211], v[160:163], v[20:23]
v_mfma_f32_16x16x32_bf16 v[4:7], v[200:203], v[164:167], v[4:7]
v_mfma_f32_16x16x32_bf16 v[24:27], v[208:211], v[164:167], v[24:27]
v_mfma_f32_16x16x32_bf16 v[8:11], v[200:203], v[168:171], v[8:11]
s_waitcnt vmcnt(4)
s_waitcnt lgkmcnt(6)
s_barrier
v_mfma_f32_16x16x32_bf16 v[28:31], v[208:211], v[168:171], v[28:31]
ds_read_b128 v[216:219], v240 offset:6144
ds_read_b128 v[220:223], v241 offset:6144
v_mfma_f32_16x16x32_bf16 v[12:15], v[200:203], v[172:175], v[12:15]
v_mfma_f32_16x16x32_bf16 v[32:35], v[208:211], v[172:175], v[32:35]
ds_read_b128 v[224:227], v240 offset:38912
ds_read_b128 v[228:231], v241 offset:38912
s_waitcnt lgkmcnt(9)
v_mfma_f32_16x16x32_bf16 v[16:19], v[200:203], v[176:179], v[16:19]
v_mfma_f32_16x16x32_bf16 v[36:39], v[208:211], v[176:179], v[36:39]
s_mov_b32 m0, s5
s_add_u32 s9, s69, 0
buffer_load_dwordx4 v232, s[24:27], s9 offen nt lds
s_add_u32 s8, s69, 3072
buffer_load_dwordx4 v232, s[24:27], s8 offen offset:1024 nt lds
s_waitcnt lgkmcnt(8)
v_mfma_f32_16x16x32_bf16 v[0:3], v[204:207], v[180:183], v[0:3]
v_mfma_f32_16x16x32_bf16 v[20:23], v[212:215], v[180:183], v[20:23]
s_waitcnt lgkmcnt(7)
v_mfma_f32_16x16x32_bf16 v[4:7], v[204:207], v[184:187], v[4:7]
v_mfma_f32_16x16x32_bf16 v[24:27], v[212:215], v[184:187], v[24:27]
s_waitcnt lgkmcnt(6)
v_mfma_f32_16x16x32_bf16 v[8:11], v[204:207], v[188:191], v[8:11]
v_mfma_f32_16x16x32_bf16 v[28:31], v[212:215], v[188:191], v[28:31]
s_waitcnt lgkmcnt(5)
v_mfma_f32_16x16x32_bf16 v[12:15], v[204:207], v[192:195], v[12:15]
v_mfma_f32_16x16x32_bf16 v[32:35], v[212:215], v[192:195], v[32:35]
s_waitcnt lgkmcnt(4)
v_mfma_f32_16x16x32_bf16 v[16:19], v[204:207], v[196:199], v[16:19]
v_mfma_f32_16x16x32_bf16 v[36:39], v[212:215], v[196:199], v[36:39]
s_waitcnt lgkmcnt(3)
v_mfma_f32_16x16x32_bf16 v[40:43], v[216:219], v[160:163], v[40:43]
s_waitcnt lgkmcnt(1)
v_mfma_f32_16x16x32_bf16 v[60:63], v[224:227], v[160:163], v[60:63]
ds_read_b128 v[160:163], v244 offset:20480
v_mfma_f32_16x16x32_bf16 v[44:47], v[216:219], v[164:167], v[44:47]
v_mfma_f32_16x16x32_bf16 v[64:67], v[224:227], v[164:167], v[64:67]
ds_read_b128 v[164:167], v244 offset:21504
v_mfma_f32_16x16x32_bf16 v[48:51], v[216:219], v[168:171], v[48:51]
s_waitcnt vmcnt(4)
s_waitcnt lgkmcnt(2)
s_barrier
v_mfma_f32_16x16x32_bf16 v[68:71], v[224:227], v[168:171], v[68:71]
ds_read_b128 v[168:171], v244 offset:22528
ds_read_b128 v[200:203], v240 offset:0
ds_read_b128 v[204:207], v241 offset:0
v_mfma_f32_16x16x32_bf16 v[52:55], v[216:219], v[172:175], v[52:55]
v_mfma_f32_16x16x32_bf16 v[72:75], v[224:227], v[172:175], v[72:75]
ds_read_b128 v[172:175], v244 offset:23552
ds_read_b128 v[208:211], v240 offset:32768
ds_read_b128 v[212:215], v241 offset:32768
v_mfma_f32_16x16x32_bf16 v[56:59], v[216:219], v[176:179], v[56:59]
v_mfma_f32_16x16x32_bf16 v[76:79], v[224:227], v[176:179], v[76:79]
ds_read_b128 v[176:179], v244 offset:24576
s_mov_b32 m0, s5
s_add_u32 s9, s69, 14336
buffer_load_dwordx4 v232, s[24:27], s9 offen offset:2048 nt lds
s_add_u32 s8, s69, 17408
buffer_load_dwordx4 v232, s[24:27], s8 offen offset:3072 nt lds
v_mfma_f32_16x16x32_bf16 v[40:43], v[220:223], v[180:183], v[40:43]
v_mfma_f32_16x16x32_bf16 v[60:63], v[228:231], v[180:183], v[60:63]
ds_read_b128 v[180:183], v244 offset:25600
v_mfma_f32_16x16x32_bf16 v[44:47], v[220:223], v[184:187], v[44:47]
v_mfma_f32_16x16x32_bf16 v[64:67], v[228:231], v[184:187], v[64:67]
ds_read_b128 v[184:187], v244 offset:26624
v_mfma_f32_16x16x32_bf16 v[48:51], v[220:223], v[188:191], v[48:51]
v_mfma_f32_16x16x32_bf16 v[68:71], v[228:231], v[188:191], v[68:71]
ds_read_b128 v[188:191], v244 offset:27648
v_mfma_f32_16x16x32_bf16 v[52:55], v[220:223], v[192:195], v[52:55]
v_mfma_f32_16x16x32_bf16 v[72:75], v[228:231], v[192:195], v[72:75]
ds_read_b128 v[192:195], v244 offset:28672
v_mfma_f32_16x16x32_bf16 v[56:59], v[220:223], v[196:199], v[56:59]
v_mfma_f32_16x16x32_bf16 v[76:79], v[228:231], v[196:199], v[76:79]
ds_read_b128 v[196:199], v244 offset:29696
s_waitcnt lgkmcnt(10)
v_mfma_f32_16x16x32_bf16 v[0:3], v[200:203], v[160:163], v[0:3]
s_waitcnt lgkmcnt(7)
v_mfma_f32_16x16x32_bf16 v[20:23], v[208:211], v[160:163], v[20:23]
v_mfma_f32_16x16x32_bf16 v[4:7], v[200:203], v[164:167], v[4:7]
v_mfma_f32_16x16x32_bf16 v[24:27], v[208:211], v[164:167], v[24:27]
v_mfma_f32_16x16x32_bf16 v[8:11], v[200:203], v[168:171], v[8:11]
s_waitcnt vmcnt(4)
s_waitcnt lgkmcnt(6)
s_barrier
v_mfma_f32_16x16x32_bf16 v[28:31], v[208:211], v[168:171], v[28:31]
ds_read_b128 v[216:219], v240 offset:2048
ds_read_b128 v[220:223], v241 offset:2048
v_mfma_f32_16x16x32_bf16 v[12:15], v[200:203], v[172:175], v[12:15]
v_mfma_f32_16x16x32_bf16 v[32:35], v[208:211], v[172:175], v[32:35]
ds_read_b128 v[224:227], v240 offset:34816
ds_read_b128 v[228:231], v241 offset:34816
s_waitcnt lgkmcnt(9)
v_mfma_f32_16x16x32_bf16 v[16:19], v[200:203], v[176:179], v[16:19]
v_mfma_f32_16x16x32_bf16 v[36:39], v[208:211], v[176:179], v[36:39]
s_mov_b32 m0, s4
s_add_u32 s9, s66, 131072
buffer_load_dwordx4 v232, s[24:27], s9 offen nt lds
s_add_u32 s8, s66, 134144
buffer_load_dwordx4 v232, s[24:27], s8 offen offset:1024 nt lds
s_waitcnt lgkmcnt(8)
v_mfma_f32_16x16x32_bf16 v[0:3], v[204:207], v[180:183], v[0:3]
v_mfma_f32_16x16x32_bf16 v[20:23], v[212:215], v[180:183], v[20:23]
s_waitcnt lgkmcnt(7)
v_mfma_f32_16x16x32_bf16 v[4:7], v[204:207], v[184:187], v[4:7]
v_mfma_f32_16x16x32_bf16 v[24:27], v[212:215], v[184:187], v[24:27]
s_waitcnt lgkmcnt(6)
v_mfma_f32_16x16x32_bf16 v[8:11], v[204:207], v[188:191], v[8:11]
v_mfma_f32_16x16x32_bf16 v[28:31], v[212:215], v[188:191], v[28:31]
s_waitcnt lgkmcnt(5)
v_mfma_f32_16x16x32_bf16 v[12:15], v[204:207], v[192:195], v[12:15]
v_mfma_f32_16x16x32_bf16 v[32:35], v[212:215], v[192:195], v[32:35]
s_waitcnt lgkmcnt(4)
v_mfma_f32_16x16x32_bf16 v[16:19], v[204:207], v[196:199], v[16:19]
v_mfma_f32_16x16x32_bf16 v[36:39], v[212:215], v[196:199], v[36:39]
s_waitcnt lgkmcnt(3)
v_mfma_f32_16x16x32_bf16 v[40:43], v[216:219], v[160:163], v[40:43]
s_waitcnt lgkmcnt(1)
v_mfma_f32_16x16x32_bf16 v[60:63], v[224:227], v[160:163], v[60:63]
ds_read_b128 v[160:163], v244 offset:30720
v_mfma_f32_16x16x32_bf16 v[44:47], v[216:219], v[164:167], v[44:47]
v_mfma_f32_16x16x32_bf16 v[64:67], v[224:227], v[164:167], v[64:67]
ds_read_b128 v[164:167], v244 offset:31744
v_mfma_f32_16x16x32_bf16 v[48:51], v[216:219], v[168:171], v[48:51]
s_waitcnt vmcnt(4)
s_waitcnt lgkmcnt(2)
s_barrier
v_mfma_f32_16x16x32_bf16 v[68:71], v[224:227], v[168:171], v[68:71]
ds_read_b128 v[168:171], v244 offset:32768
ds_read_b128 v[200:203], v240 offset:4096
ds_read_b128 v[204:207], v241 offset:4096
v_mfma_f32_16x16x32_bf16 v[52:55], v[216:219], v[172:175], v[52:55]
v_mfma_f32_16x16x32_bf16 v[72:75], v[224:227], v[172:175], v[72:75]
ds_read_b128 v[172:175], v244 offset:33792
ds_read_b128 v[208:211], v240 offset:36864
ds_read_b128 v[212:215], v241 offset:36864
v_mfma_f32_16x16x32_bf16 v[56:59], v[216:219], v[176:179], v[56:59]
v_mfma_f32_16x16x32_bf16 v[76:79], v[224:227], v[176:179], v[76:79]
ds_read_b128 v[176:179], v244 offset:34816
s_mov_b32 m0, s4
s_add_u32 s9, s66, 145408
buffer_load_dwordx4 v232, s[24:27], s9 offen offset:2048 nt lds
s_add_u32 s8, s66, 148480
buffer_load_dwordx4 v232, s[24:27], s8 offen offset:3072 nt lds
v_mfma_f32_16x16x32_bf16 v[40:43], v[220:223], v[180:183], v[40:43]
v_mfma_f32_16x16x32_bf16 v[60:63], v[228:231], v[180:183], v[60:63]
ds_read_b128 v[180:183], v244 offset:35840
v_mfma_f32_16x16x32_bf16 v[44:47], v[220:223], v[184:187], v[44:47]
v_mfma_f32_16x16x32_bf16 v[64:67], v[228:231], v[184:187], v[64:67]
ds_read_b128 v[184:187], v244 offset:36864
v_mfma_f32_16x16x32_bf16 v[48:51], v[220:223], v[188:191], v[48:51]
v_mfma_f32_16x16x32_bf16 v[68:71], v[228:231], v[188:191], v[68:71]
ds_read_b128 v[188:191], v244 offset:37888
v_mfma_f32_16x16x32_bf16 v[52:55], v[220:223], v[192:195], v[52:55]
v_mfma_f32_16x16x32_bf16 v[72:75], v[228:231], v[192:195], v[72:75]
ds_read_b128 v[192:195], v244 offset:38912
v_mfma_f32_16x16x32_bf16 v[56:59], v[220:223], v[196:199], v[56:59]
v_mfma_f32_16x16x32_bf16 v[76:79], v[228:231], v[196:199], v[76:79]
ds_read_b128 v[196:199], v244 offset:39936
s_waitcnt lgkmcnt(10)
v_mfma_f32_16x16x32_bf16 v[0:3], v[200:203], v[160:163], v[0:3]
s_waitcnt lgkmcnt(7)
v_mfma_f32_16x16x32_bf16 v[20:23], v[208:211], v[160:163], v[20:23]
v_mfma_f32_16x16x32_bf16 v[4:7], v[200:203], v[164:167], v[4:7]
v_mfma_f32_16x16x32_bf16 v[24:27], v[208:211], v[164:167], v[24:27]
v_mfma_f32_16x16x32_bf16 v[8:11], v[200:203], v[168:171], v[8:11]
s_waitcnt vmcnt(4)
s_waitcnt lgkmcnt(6)
s_barrier
v_mfma_f32_16x16x32_bf16 v[28:31], v[208:211], v[168:171], v[28:31]
ds_read_b128 v[216:219], v240 offset:6144
ds_read_b128 v[220:223], v241 offset:6144
v_mfma_f32_16x16x32_bf16 v[12:15], v[200:203], v[172:175], v[12:15]
v_mfma_f32_16x16x32_bf16 v[32:35], v[208:211], v[172:175], v[32:35]
ds_read_b128 v[224:227], v240 offset:38912
ds_read_b128 v[228:231], v241 offset:38912
s_waitcnt lgkmcnt(9)
v_mfma_f32_16x16x32_bf16 v[16:19], v[200:203], v[176:179], v[16:19]
v_mfma_f32_16x16x32_bf16 v[36:39], v[208:211], v[176:179], v[36:39]
s_mov_b32 m0, s5
s_add_u32 s9, s67, 131072
buffer_load_dwordx4 v232, s[24:27], s9 offen nt lds
s_add_u32 s8, s67, 134144
buffer_load_dwordx4 v232, s[24:27], s8 offen offset:1024 nt lds
s_waitcnt lgkmcnt(8)
v_mfma_f32_16x16x32_bf16 v[0:3], v[204:207], v[180:183], v[0:3]
v_mfma_f32_16x16x32_bf16 v[20:23], v[212:215], v[180:183], v[20:23]
s_waitcnt lgkmcnt(7)
v_mfma_f32_16x16x32_bf16 v[4:7], v[204:207], v[184:187], v[4:7]
v_mfma_f32_16x16x32_bf16 v[24:27], v[212:215], v[184:187], v[24:27]
s_waitcnt lgkmcnt(6)
v_mfma_f32_16x16x32_bf16 v[8:11], v[204:207], v[188:191], v[8:11]
v_mfma_f32_16x16x32_bf16 v[28:31], v[212:215], v[188:191], v[28:31]
s_waitcnt lgkmcnt(5)
v_mfma_f32_16x16x32_bf16 v[12:15], v[204:207], v[192:195], v[12:15]
v_mfma_f32_16x16x32_bf16 v[32:35], v[212:215], v[192:195], v[32:35]
s_waitcnt lgkmcnt(4)
v_mfma_f32_16x16x32_bf16 v[16:19], v[204:207], v[196:199], v[16:19]
v_mfma_f32_16x16x32_bf16 v[36:39], v[212:215], v[196:199], v[36:39]
s_waitcnt lgkmcnt(3)
v_mfma_f32_16x16x32_bf16 v[40:43], v[216:219], v[160:163], v[40:43]
s_waitcnt lgkmcnt(1)
v_mfma_f32_16x16x32_bf16 v[60:63], v[224:227], v[160:163], v[60:63]
ds_read_b128 v[160:163], v244 offset:0
v_mfma_f32_16x16x32_bf16 v[44:47], v[216:219], v[164:167], v[44:47]
v_mfma_f32_16x16x32_bf16 v[64:67], v[224:227], v[164:167], v[64:67]
ds_read_b128 v[164:167], v244 offset:1024
v_mfma_f32_16x16x32_bf16 v[48:51], v[216:219], v[168:171], v[48:51]
s_waitcnt vmcnt(4)
s_waitcnt lgkmcnt(2)
s_barrier
v_mfma_f32_16x16x32_bf16 v[68:71], v[224:227], v[168:171], v[68:71]
ds_read_b128 v[168:171], v244 offset:2048
ds_read_b128 v[200:203], v240 offset:0
ds_read_b128 v[204:207], v241 offset:0
v_mfma_f32_16x16x32_bf16 v[52:55], v[216:219], v[172:175], v[52:55]
v_mfma_f32_16x16x32_bf16 v[72:75], v[224:227], v[172:175], v[72:75]
ds_read_b128 v[172:175], v244 offset:3072
ds_read_b128 v[208:211], v240 offset:32768
ds_read_b128 v[212:215], v241 offset:32768
v_mfma_f32_16x16x32_bf16 v[56:59], v[216:219], v[176:179], v[56:59]
v_mfma_f32_16x16x32_bf16 v[76:79], v[224:227], v[176:179], v[76:79]
ds_read_b128 v[176:179], v244 offset:4096
s_mov_b32 m0, s5
s_add_u32 s9, s67, 145408
buffer_load_dwordx4 v232, s[24:27], s9 offen offset:2048 nt lds
s_add_u32 s8, s67, 148480
buffer_load_dwordx4 v232, s[24:27], s8 offen offset:3072 nt lds
v_mfma_f32_16x16x32_bf16 v[40:43], v[220:223], v[180:183], v[40:43]
v_mfma_f32_16x16x32_bf16 v[60:63], v[228:231], v[180:183], v[60:63]
ds_read_b128 v[180:183], v244 offset:5120
v_mfma_f32_16x16x32_bf16 v[44:47], v[220:223], v[184:187], v[44:47]
v_mfma_f32_16x16x32_bf16 v[64:67], v[228:231], v[184:187], v[64:67]
ds_read_b128 v[184:187], v244 offset:6144
v_mfma_f32_16x16x32_bf16 v[48:51], v[220:223], v[188:191], v[48:51]
v_mfma_f32_16x16x32_bf16 v[68:71], v[228:231], v[188:191], v[68:71]
ds_read_b128 v[188:191], v244 offset:7168
v_mfma_f32_16x16x32_bf16 v[52:55], v[220:223], v[192:195], v[52:55]
v_mfma_f32_16x16x32_bf16 v[72:75], v[228:231], v[192:195], v[72:75]
ds_read_b128 v[192:195], v244 offset:8192
v_mfma_f32_16x16x32_bf16 v[56:59], v[220:223], v[196:199], v[56:59]
v_mfma_f32_16x16x32_bf16 v[76:79], v[228:231], v[196:199], v[76:79]
ds_read_b128 v[196:199], v244 offset:9216
s_waitcnt lgkmcnt(10)
v_mfma_f32_16x16x32_bf16 v[80:83], v[200:203], v[160:163], 0
s_waitcnt lgkmcnt(7)
v_mfma_f32_16x16x32_bf16 v[100:103], v[208:211], v[160:163], 0
v_mfma_f32_16x16x32_bf16 v[84:87], v[200:203], v[164:167], 0
v_mfma_f32_16x16x32_bf16 v[104:107], v[208:211], v[164:167], 0
v_mfma_f32_16x16x32_bf16 v[88:91], v[200:203], v[168:171], 0
s_waitcnt vmcnt(4)
s_waitcnt lgkmcnt(6)
s_barrier
v_mfma_f32_16x16x32_bf16 v[108:111], v[208:211], v[168:171], 0
ds_read_b128 v[216:219], v240 offset:2048
ds_read_b128 v[220:223], v241 offset:2048
v_mfma_f32_16x16x32_bf16 v[92:95], v[200:203], v[172:175], 0
v_mfma_f32_16x16x32_bf16 v[112:115], v[208:211], v[172:175], 0
ds_read_b128 v[224:227], v240 offset:34816
ds_read_b128 v[228:231], v241 offset:34816
s_waitcnt lgkmcnt(9)
v_mfma_f32_16x16x32_bf16 v[96:99], v[200:203], v[176:179], 0
v_mfma_f32_16x16x32_bf16 v[116:119], v[208:211], v[176:179], 0
s_mov_b32 m0, s4
s_add_u32 s9, s68, 131072
buffer_load_dwordx4 v232, s[24:27], s9 offen nt lds
s_add_u32 s8, s68, 134144
buffer_load_dwordx4 v232, s[24:27], s8 offen offset:1024 nt lds
s_waitcnt lgkmcnt(8)
v_mfma_f32_16x16x32_bf16 v[80:83], v[204:207], v[180:183], v[80:83]
v_mfma_f32_16x16x32_bf16 v[100:103], v[212:215], v[180:183], v[100:103]
s_waitcnt lgkmcnt(7)
v_mfma_f32_16x16x32_bf16 v[84:87], v[204:207], v[184:187], v[84:87]
v_mfma_f32_16x16x32_bf16 v[104:107], v[212:215], v[184:187], v[104:107]
s_waitcnt lgkmcnt(6)
v_mfma_f32_16x16x32_bf16 v[88:91], v[204:207], v[188:191], v[88:91]
v_mfma_f32_16x16x32_bf16 v[108:111], v[212:215], v[188:191], v[108:111]
v_max_f32 v246, v0, v1
s_waitcnt lgkmcnt(5)
v_mfma_f32_16x16x32_bf16 v[92:95], v[204:207], v[192:195], v[92:95]
v_mfma_f32_16x16x32_bf16 v[112:115], v[212:215], v[192:195], v[112:115]
v_max_f32 v247, v4, v5
s_waitcnt lgkmcnt(4)
v_mfma_f32_16x16x32_bf16 v[96:99], v[204:207], v[196:199], v[96:99]
v_mfma_f32_16x16x32_bf16 v[116:119], v[212:215], v[196:199], v[116:119]
v_max_f32 v248, v8, v9
s_waitcnt lgkmcnt(3)
v_mfma_f32_16x16x32_bf16 v[120:123], v[216:219], v[160:163], 0
s_waitcnt lgkmcnt(1)
v_mfma_f32_16x16x32_bf16 v[140:143], v[224:227], v[160:163], 0
v_max_f32 v249, v12, v13
ds_read_b128 v[160:163], v244 offset:10240
v_mfma_f32_16x16x32_bf16 v[124:127], v[216:219], v[164:167], 0
v_mfma_f32_16x16x32_bf16 v[144:147], v[224:227], v[164:167], 0
v_max_f32 v250, v16, v17
ds_read_b128 v[164:167], v244 offset:11264
v_mfma_f32_16x16x32_bf16 v[128:131], v[216:219], v[168:171], 0
s_waitcnt vmcnt(4)
s_waitcnt lgkmcnt(2)
s_barrier
v_mfma_f32_16x16x32_bf16 v[148:151], v[224:227], v[168:171], 0
v_max3_f32 v246, v246, v2, v3
ds_read_b128 v[168:171], v244 offset:12288
ds_read_b128 v[200:203], v240 offset:4096
ds_read_b128 v[204:207], v241 offset:4096
v_mfma_f32_16x16x32_bf16 v[132:135], v[216:219], v[172:175], 0
v_mfma_f32_16x16x32_bf16 v[152:155], v[224:227], v[172:175], 0
v_max3_f32 v247, v247, v6, v7
ds_read_b128 v[172:175], v244 offset:13312
ds_read_b128 v[208:211], v240 offset:36864
ds_read_b128 v[212:215], v241 offset:36864
v_mfma_f32_16x16x32_bf16 v[136:139], v[216:219], v[176:179], 0
v_mfma_f32_16x16x32_bf16 v[156:159], v[224:227], v[176:179], 0
v_max3_f32 v248, v248, v10, v11
ds_read_b128 v[176:179], v244 offset:14336
s_mov_b32 m0, s4
s_add_u32 s9, s68, 145408
buffer_load_dwordx4 v232, s[24:27], s9 offen offset:2048 nt lds
s_add_u32 s8, s68, 148480
buffer_load_dwordx4 v232, s[24:27], s8 offen offset:3072 nt lds
v_mfma_f32_16x16x32_bf16 v[120:123], v[220:223], v[180:183], v[120:123]
v_mfma_f32_16x16x32_bf16 v[140:143], v[228:231], v[180:183], v[140:143]
v_max3_f32 v249, v249, v14, v15
ds_read_b128 v[180:183], v244 offset:15360
v_mfma_f32_16x16x32_bf16 v[124:127], v[220:223], v[184:187], v[124:127]
v_mfma_f32_16x16x32_bf16 v[144:147], v[228:231], v[184:187], v[144:147]
v_max3_f32 v250, v250, v18, v19
ds_read_b128 v[184:187], v244 offset:16384
v_mfma_f32_16x16x32_bf16 v[128:131], v[220:223], v[188:191], v[128:131]
v_mfma_f32_16x16x32_bf16 v[148:151], v[228:231], v[188:191], v[148:151]
v_max3_f32 v246, v246, v20, v21
ds_read_b128 v[188:191], v244 offset:17408
v_mfma_f32_16x16x32_bf16 v[132:135], v[220:223], v[192:195], v[132:135]
v_mfma_f32_16x16x32_bf16 v[152:155], v[228:231], v[192:195], v[152:155]
v_max3_f32 v247, v247, v24, v25
ds_read_b128 v[192:195], v244 offset:18432
v_mfma_f32_16x16x32_bf16 v[136:139], v[220:223], v[196:199], v[136:139]
v_mfma_f32_16x16x32_bf16 v[156:159], v[228:231], v[196:199], v[156:159]
v_max3_f32 v248, v248, v28, v29
ds_read_b128 v[196:199], v244 offset:19456
s_waitcnt lgkmcnt(10)
v_mfma_f32_16x16x32_bf16 v[80:83], v[200:203], v[160:163], v[80:83]
s_waitcnt lgkmcnt(7)
v_mfma_f32_16x16x32_bf16 v[100:103], v[208:211], v[160:163], v[100:103]
v_max3_f32 v249, v249, v32, v33
v_mfma_f32_16x16x32_bf16 v[84:87], v[200:203], v[164:167], v[84:87]
v_mfma_f32_16x16x32_bf16 v[104:107], v[208:211], v[164:167], v[104:107]
v_max3_f32 v250, v250, v36, v37
v_mfma_f32_16x16x32_bf16 v[88:91], v[200:203], v[168:171], v[88:91]
s_waitcnt vmcnt(4)
s_waitcnt lgkmcnt(6)
s_barrier
v_mfma_f32_16x16x32_bf16 v[108:111], v[208:211], v[168:171], v[108:111]
v_max3_f32 v246, v246, v22, v23
ds_read_b128 v[216:219], v240 offset:6144
ds_read_b128 v[220:223], v241 offset:6144
v_mfma_f32_16x16x32_bf16 v[92:95], v[200:203], v[172:175], v[92:95]
v_mfma_f32_16x16x32_bf16 v[112:115], v[208:211], v[172:175], v[112:115]
v_max3_f32 v247, v247, v26, v27
ds_read_b128 v[224:227], v240 offset:38912
ds_read_b128 v[228:231], v241 offset:38912
s_waitcnt lgkmcnt(9)
v_mfma_f32_16x16x32_bf16 v[96:99], v[200:203], v[176:179], v[96:99]
v_mfma_f32_16x16x32_bf16 v[116:119], v[208:211], v[176:179], v[116:119]
v_max3_f32 v248, v248, v30, v31
s_mov_b32 m0, s5
s_add_u32 s9, s69, 131072
buffer_load_dwordx4 v232, s[24:27], s9 offen nt lds
s_add_u32 s8, s69, 134144
buffer_load_dwordx4 v232, s[24:27], s8 offen offset:1024 nt lds
s_waitcnt lgkmcnt(8)
v_mfma_f32_16x16x32_bf16 v[80:83], v[204:207], v[180:183], v[80:83]
v_mfma_f32_16x16x32_bf16 v[100:103], v[212:215], v[180:183], v[100:103]
v_max3_f32 v249, v249, v34, v35
s_waitcnt lgkmcnt(7)
v_mfma_f32_16x16x32_bf16 v[84:87], v[204:207], v[184:187], v[84:87]
v_mfma_f32_16x16x32_bf16 v[104:107], v[212:215], v[184:187], v[104:107]
v_max3_f32 v250, v250, v38, v39
s_waitcnt lgkmcnt(6)
v_mfma_f32_16x16x32_bf16 v[88:91], v[204:207], v[188:191], v[88:91]
v_mfma_f32_16x16x32_bf16 v[108:111], v[212:215], v[188:191], v[108:111]
v_max3_f32 v246, v246, v40, v41
s_waitcnt lgkmcnt(5)
v_mfma_f32_16x16x32_bf16 v[92:95], v[204:207], v[192:195], v[92:95]
v_mfma_f32_16x16x32_bf16 v[112:115], v[212:215], v[192:195], v[112:115]
v_max3_f32 v247, v247, v44, v45
s_waitcnt lgkmcnt(4)
v_mfma_f32_16x16x32_bf16 v[96:99], v[204:207], v[196:199], v[96:99]
v_mfma_f32_16x16x32_bf16 v[116:119], v[212:215], v[196:199], v[116:119]
v_max3_f32 v248, v248, v48, v49
s_waitcnt lgkmcnt(3)
v_mfma_f32_16x16x32_bf16 v[120:123], v[216:219], v[160:163], v[120:123]
s_waitcnt lgkmcnt(1)
v_mfma_f32_16x16x32_bf16 v[140:143], v[224:227], v[160:163], v[140:143]
v_max3_f32 v249, v249, v52, v53
ds_read_b128 v[160:163], v244 offset:20480
v_mfma_f32_16x16x32_bf16 v[124:127], v[216:219], v[164:167], v[124:127]
v_mfma_f32_16x16x32_bf16 v[144:147], v[224:227], v[164:167], v[144:147]
v_max3_f32 v250, v250, v56, v57
ds_read_b128 v[164:167], v244 offset:21504
v_mfma_f32_16x16x32_bf16 v[128:131], v[216:219], v[168:171], v[128:131]
s_waitcnt vmcnt(4)
s_waitcnt lgkmcnt(2)
s_barrier
v_mfma_f32_16x16x32_bf16 v[148:151], v[224:227], v[168:171], v[148:151]
v_max3_f32 v246, v246, v42, v43
ds_read_b128 v[168:171], v244 offset:22528
ds_read_b128 v[200:203], v240 offset:0
ds_read_b128 v[204:207], v241 offset:0
v_mfma_f32_16x16x32_bf16 v[132:135], v[216:219], v[172:175], v[132:135]
v_mfma_f32_16x16x32_bf16 v[152:155], v[224:227], v[172:175], v[152:155]
v_max3_f32 v247, v247, v46, v47
ds_read_b128 v[172:175], v244 offset:23552
ds_read_b128 v[208:211], v240 offset:32768
ds_read_b128 v[212:215], v241 offset:32768
v_mfma_f32_16x16x32_bf16 v[136:139], v[216:219], v[176:179], v[136:139]
v_mfma_f32_16x16x32_bf16 v[156:159], v[224:227], v[176:179], v[156:159]
v_max3_f32 v248, v248, v50, v51
ds_read_b128 v[176:179], v244 offset:24576
s_mov_b32 m0, s5
s_add_u32 s9, s69, 145408
buffer_load_dwordx4 v232, s[24:27], s9 offen offset:2048 nt lds
s_add_u32 s8, s69, 148480
buffer_load_dwordx4 v232, s[24:27], s8 offen offset:3072 nt lds
v_mfma_f32_16x16x32_bf16 v[120:123], v[220:223], v[180:183], v[120:123]
v_mfma_f32_16x16x32_bf16 v[140:143], v[228:231], v[180:183], v[140:143]
v_max3_f32 v249, v249, v54, v55
ds_read_b128 v[180:183], v244 offset:25600
v_mfma_f32_16x16x32_bf16 v[124:127], v[220:223], v[184:187], v[124:127]
v_mfma_f32_16x16x32_bf16 v[144:147], v[228:231], v[184:187], v[144:147]
v_max3_f32 v250, v250, v58, v59
ds_read_b128 v[184:187], v244 offset:26624
v_mfma_f32_16x16x32_bf16 v[128:131], v[220:223], v[188:191], v[128:131]
v_mfma_f32_16x16x32_bf16 v[148:151], v[228:231], v[188:191], v[148:151]
v_max3_f32 v246, v246, v60, v61
ds_read_b128 v[188:191], v244 offset:27648
v_mfma_f32_16x16x32_bf16 v[132:135], v[220:223], v[192:195], v[132:135]
v_mfma_f32_16x16x32_bf16 v[152:155], v[228:231], v[192:195], v[152:155]
v_max3_f32 v247, v247, v64, v65
ds_read_b128 v[192:195], v244 offset:28672
v_mfma_f32_16x16x32_bf16 v[136:139], v[220:223], v[196:199], v[136:139]
v_mfma_f32_16x16x32_bf16 v[156:159], v[228:231], v[196:199], v[156:159]
v_max3_f32 v248, v248, v68, v69
ds_read_b128 v[196:199], v244 offset:29696
s_waitcnt lgkmcnt(10)
v_mfma_f32_16x16x32_bf16 v[80:83], v[200:203], v[160:163], v[80:83]
s_waitcnt lgkmcnt(7)
v_mfma_f32_16x16x32_bf16 v[100:103], v[208:211], v[160:163], v[100:103]
v_max3_f32 v249, v249, v72, v73
v_mfma_f32_16x16x32_bf16 v[84:87], v[200:203], v[164:167], v[84:87]
v_mfma_f32_16x16x32_bf16 v[104:107], v[208:211], v[164:167], v[104:107]
v_max3_f32 v250, v250, v76, v77
v_mfma_f32_16x16x32_bf16 v[88:91], v[200:203], v[168:171], v[88:91]
s_waitcnt vmcnt(4)
s_waitcnt lgkmcnt(6)
s_barrier
v_mfma_f32_16x16x32_bf16 v[108:111], v[208:211], v[168:171], v[108:111]
v_max3_f32 v246, v246, v62, v63
ds_read_b128 v[216:219], v240 offset:2048
ds_read_b128 v[220:223], v241 offset:2048
v_mfma_f32_16x16x32_bf16 v[92:95], v[200:203], v[172:175], v[92:95]
v_mfma_f32_16x16x32_bf16 v[112:115], v[208:211], v[172:175], v[112:115]
v_max3_f32 v247, v247, v66, v67
ds_read_b128 v[224:227], v240 offset:34816
ds_read_b128 v[228:231], v241 offset:34816
s_waitcnt lgkmcnt(9)
v_mfma_f32_16x16x32_bf16 v[96:99], v[200:203], v[176:179], v[96:99]
v_mfma_f32_16x16x32_bf16 v[116:119], v[208:211], v[176:179], v[116:119]
v_max3_f32 v248, v248, v70, v71
s_mov_b32 m0, s4
s_mov_b32 s9, 0
buffer_load_dwordx4 v232, s[28:31], s9 offen nt lds
s_mov_b32 s8, 3072
buffer_load_dwordx4 v232, s[28:31], s8 offen offset:1024 nt lds
s_waitcnt lgkmcnt(8)
v_mfma_f32_16x16x32_bf16 v[80:83], v[204:207], v[180:183], v[80:83]
v_mfma_f32_16x16x32_bf16 v[100:103], v[212:215], v[180:183], v[100:103]
v_max3_f32 v249, v249, v74, v75
s_waitcnt lgkmcnt(7)
v_mfma_f32_16x16x32_bf16 v[84:87], v[204:207], v[184:187], v[84:87]
v_mfma_f32_16x16x32_bf16 v[104:107], v[212:215], v[184:187], v[104:107]
v_max3_f32 v250, v250, v78, v79
s_waitcnt lgkmcnt(6)
v_mfma_f32_16x16x32_bf16 v[88:91], v[204:207], v[188:191], v[88:91]
v_mfma_f32_16x16x32_bf16 v[108:111], v[212:215], v[188:191], v[108:111]
s_waitcnt lgkmcnt(5)
v_mfma_f32_16x16x32_bf16 v[92:95], v[204:207], v[192:195], v[92:95]
v_mfma_f32_16x16x32_bf16 v[112:115], v[212:215], v[192:195], v[112:115]
s_waitcnt lgkmcnt(4)
v_mfma_f32_16x16x32_bf16 v[96:99], v[204:207], v[196:199], v[96:99]
v_mfma_f32_16x16x32_bf16 v[116:119], v[212:215], v[196:199], v[116:119]
s_waitcnt lgkmcnt(3)
v_mfma_f32_16x16x32_bf16 v[120:123], v[216:219], v[160:163], v[120:123]
s_waitcnt lgkmcnt(1)
v_mfma_f32_16x16x32_bf16 v[140:143], v[224:227], v[160:163], v[140:143]
ds_read_b128 v[160:163], v244 offset:30720
v_mfma_f32_16x16x32_bf16 v[124:127], v[216:219], v[164:167], v[124:127]
v_mfma_f32_16x16x32_bf16 v[144:147], v[224:227], v[164:167], v[144:147]
ds_read_b128 v[164:167], v244 offset:31744
v_mfma_f32_16x16x32_bf16 v[128:131], v[216:219], v[168:171], v[128:131]
s_waitcnt vmcnt(4)
s_waitcnt lgkmcnt(2)
s_barrier
v_mfma_f32_16x16x32_bf16 v[148:151], v[224:227], v[168:171], v[148:151]
ds_read_b128 v[168:171], v244 offset:32768
ds_read_b128 v[200:203], v240 offset:4096
ds_read_b128 v[204:207], v241 offset:4096
v_mfma_f32_16x16x32_bf16 v[132:135], v[216:219], v[172:175], v[132:135]
v_mfma_f32_16x16x32_bf16 v[152:155], v[224:227], v[172:175], v[152:155]
ds_read_b128 v[172:175], v244 offset:33792
ds_read_b128 v[208:211], v240 offset:36864
ds_read_b128 v[212:215], v241 offset:36864
v_mfma_f32_16x16x32_bf16 v[136:139], v[216:219], v[176:179], v[136:139]
v_mfma_f32_16x16x32_bf16 v[156:159], v[224:227], v[176:179], v[156:159]
ds_read_b128 v[176:179], v244 offset:34816
s_mov_b32 m0, s4
s_mov_b32 s9, 14336
buffer_load_dwordx4 v232, s[28:31], s9 offen offset:2048 nt lds
s_mov_b32 s8, 17408
buffer_load_dwordx4 v232, s[28:31], s8 offen offset:3072 nt lds
v_mfma_f32_16x16x32_bf16 v[120:123], v[220:223], v[180:183], v[120:123]
v_mfma_f32_16x16x32_bf16 v[140:143], v[228:231], v[180:183], v[140:143]
ds_read_b128 v[180:183], v244 offset:35840
v_mfma_f32_16x16x32_bf16 v[124:127], v[220:223], v[184:187], v[124:127]
v_mfma_f32_16x16x32_bf16 v[144:147], v[228:231], v[184:187], v[144:147]
ds_read_b128 v[184:187], v244 offset:36864
v_mfma_f32_16x16x32_bf16 v[128:131], v[220:223], v[188:191], v[128:131]
v_mfma_f32_16x16x32_bf16 v[148:151], v[228:231], v[188:191], v[148:151]
ds_read_b128 v[188:191], v244 offset:37888
v_mfma_f32_16x16x32_bf16 v[132:135], v[220:223], v[192:195], v[132:135]
v_mfma_f32_16x16x32_bf16 v[152:155], v[228:231], v[192:195], v[152:155]
ds_read_b128 v[192:195], v244 offset:38912
v_mfma_f32_16x16x32_bf16 v[136:139], v[220:223], v[196:199], v[136:139]
v_mfma_f32_16x16x32_bf16 v[156:159], v[228:231], v[196:199], v[156:159]
ds_read_b128 v[196:199], v244 offset:39936
s_waitcnt lgkmcnt(10)
v_mfma_f32_16x16x32_bf16 v[80:83], v[200:203], v[160:163], v[80:83]
s_waitcnt lgkmcnt(7)
v_mfma_f32_16x16x32_bf16 v[100:103], v[208:211], v[160:163], v[100:103]
v_mfma_f32_16x16x32_bf16 v[84:87], v[200:203], v[164:167], v[84:87]
v_mfma_f32_16x16x32_bf16 v[104:107], v[208:211], v[164:167], v[104:107]
v_mfma_f32_16x16x32_bf16 v[88:91], v[200:203], v[168:171], v[88:91]
s_waitcnt vmcnt(4)
s_waitcnt lgkmcnt(6)
s_barrier
v_mfma_f32_16x16x32_bf16 v[108:111], v[208:211], v[168:171], v[108:111]
ds_read_b128 v[216:219], v240 offset:6144
ds_read_b128 v[220:223], v241 offset:6144
v_mfma_f32_16x16x32_bf16 v[92:95], v[200:203], v[172:175], v[92:95]
v_mfma_f32_16x16x32_bf16 v[112:115], v[208:211], v[172:175], v[112:115]
ds_read_b128 v[224:227], v240 offset:38912
ds_read_b128 v[228:231], v241 offset:38912
s_waitcnt lgkmcnt(9)
v_mfma_f32_16x16x32_bf16 v[96:99], v[200:203], v[176:179], v[96:99]
v_mfma_f32_16x16x32_bf16 v[116:119], v[208:211], v[176:179], v[116:119]
s_mov_b32 m0, s5
s_mov_b32 s9, 32768
buffer_load_dwordx4 v232, s[28:31], s9 offen nt lds
s_mov_b32 s8, 35840
buffer_load_dwordx4 v232, s[28:31], s8 offen offset:1024 nt lds
s_waitcnt lgkmcnt(8)
v_mfma_f32_16x16x32_bf16 v[80:83], v[204:207], v[180:183], v[80:83]
v_mfma_f32_16x16x32_bf16 v[100:103], v[212:215], v[180:183], v[100:103]
s_waitcnt lgkmcnt(7)
v_mfma_f32_16x16x32_bf16 v[84:87], v[204:207], v[184:187], v[84:87]
v_mfma_f32_16x16x32_bf16 v[104:107], v[212:215], v[184:187], v[104:107]
s_waitcnt lgkmcnt(6)
v_mfma_f32_16x16x32_bf16 v[88:91], v[204:207], v[188:191], v[88:91]
v_mfma_f32_16x16x32_bf16 v[108:111], v[212:215], v[188:191], v[108:111]
s_waitcnt lgkmcnt(5)
v_mfma_f32_16x16x32_bf16 v[92:95], v[204:207], v[192:195], v[92:95]
v_mfma_f32_16x16x32_bf16 v[112:115], v[212:215], v[192:195], v[112:115]
s_waitcnt lgkmcnt(4)
v_mfma_f32_16x16x32_bf16 v[96:99], v[204:207], v[196:199], v[96:99]
v_mfma_f32_16x16x32_bf16 v[116:119], v[212:215], v[196:199], v[116:119]
s_waitcnt lgkmcnt(3)
v_mfma_f32_16x16x32_bf16 v[120:123], v[216:219], v[160:163], v[120:123]
s_waitcnt lgkmcnt(1)
v_mfma_f32_16x16x32_bf16 v[140:143], v[224:227], v[160:163], v[140:143]
v_mfma_f32_16x16x32_bf16 v[124:127], v[216:219], v[164:167], v[124:127]
v_mfma_f32_16x16x32_bf16 v[144:147], v[224:227], v[164:167], v[144:147]
v_mfma_f32_16x16x32_bf16 v[128:131], v[216:219], v[168:171], v[128:131]
s_waitcnt vmcnt(4)
s_waitcnt lgkmcnt(0)
s_barrier
v_mfma_f32_16x16x32_bf16 v[148:151], v[224:227], v[168:171], v[148:151]
ds_read_b64_tr_b16 v[200:201], v236 offset:0
ds_read_b64_tr_b16 v[204:205], v237 offset:0
ds_read_b64_tr_b16 v[208:209], v238 offset:0
ds_read_b64_tr_b16 v[212:213], v239 offset:0
v_mfma_f32_16x16x32_bf16 v[132:135], v[216:219], v[172:175], v[132:135]
v_mfma_f32_16x16x32_bf16 v[152:155], v[224:227], v[172:175], v[152:155]
ds_read_b64_tr_b16 v[202:203], v236 offset:32768
ds_read_b64_tr_b16 v[206:207], v237 offset:32768
ds_read_b64_tr_b16 v[210:211], v238 offset:32768
ds_read_b64_tr_b16 v[214:215], v239 offset:32768
v_mfma_f32_16x16x32_bf16 v[136:139], v[216:219], v[176:179], v[136:139]
v_mfma_f32_16x16x32_bf16 v[156:159], v[224:227], v[176:179], v[156:159]
s_mov_b32 m0, s5
s_mov_b32 s9, 47104
buffer_load_dwordx4 v232, s[28:31], s9 offen offset:2048 nt lds
s_mov_b32 s8, 50176
buffer_load_dwordx4 v232, s[28:31], s8 offen offset:3072 nt lds
v_mfma_f32_16x16x32_bf16 v[120:123], v[220:223], v[180:183], v[120:123]
v_mfma_f32_16x16x32_bf16 v[140:143], v[228:231], v[180:183], v[140:143]
v_mfma_f32_16x16x32_bf16 v[124:127], v[220:223], v[184:187], v[124:127]
v_mfma_f32_16x16x32_bf16 v[144:147], v[228:231], v[184:187], v[144:147]
v_mfma_f32_16x16x32_bf16 v[128:131], v[220:223], v[188:191], v[128:131]
v_mfma_f32_16x16x32_bf16 v[148:151], v[228:231], v[188:191], v[148:151]
v_mfma_f32_16x16x32_bf16 v[132:135], v[220:223], v[192:195], v[132:135]
v_mfma_f32_16x16x32_bf16 v[152:155], v[228:231], v[192:195], v[152:155]
v_mfma_f32_16x16x32_bf16 v[136:139], v[220:223], v[196:199], v[136:139]
v_mfma_f32_16x16x32_bf16 v[156:159], v[228:231], v[196:199], v[156:159]
s_nop 7
v_max3_f32 v246, v246, v80, v81
v_max3_f32 v247, v247, v84, v85
v_max3_f32 v248, v248, v88, v89
v_max3_f32 v249, v249, v92, v93
v_max3_f32 v250, v250, v96, v97
v_max3_f32 v246, v246, v82, v83
v_max3_f32 v247, v247, v86, v87
v_max3_f32 v248, v248, v90, v91
v_max3_f32 v249, v249, v94, v95
v_max3_f32 v250, v250, v98, v99
v_max3_f32 v246, v246, v100, v101
v_max3_f32 v247, v247, v104, v105
v_max3_f32 v248, v248, v108, v109
v_max3_f32 v249, v249, v112, v113
v_max3_f32 v250, v250, v116, v117
v_max3_f32 v246, v246, v102, v103
v_max3_f32 v247, v247, v106, v107
v_max3_f32 v248, v248, v110, v111
v_max3_f32 v249, v249, v114, v115
v_max3_f32 v250, v250, v118, v119
v_max3_f32 v246, v246, v120, v121
v_max3_f32 v247, v247, v124, v125
v_max3_f32 v248, v248, v128, v129
v_max3_f32 v249, v249, v132, v133
v_max3_f32 v250, v250, v136, v137
v_max3_f32 v246, v246, v122, v123
v_max3_f32 v247, v247, v126, v127
v_max3_f32 v248, v248, v130, v131
v_max3_f32 v249, v249, v134, v135
v_max3_f32 v250, v250, v138, v139
v_max3_f32 v246, v246, v140, v141
v_max3_f32 v247, v247, v144, v145
v_max3_f32 v248, v248, v148, v149
v_max3_f32 v249, v249, v152, v153
v_max3_f32 v250, v250, v156, v157
v_max3_f32 v246, v246, v142, v143
v_max3_f32 v247, v247, v146, v147
v_max3_f32 v248, v248, v150, v151
v_max3_f32 v249, v249, v154, v155
v_max3_f32 v250, v250, v158, v159
v_lshlrev_b32 v217, 4, v235
s_lshl_b32 s10, s14, 11
s_lshl_b32 s11, s15, 2
s_add_u32 s10, s10, s11
s_add_u32 s10, s10, 147456
v_add_u32 v217, s10, v217
v_mov_b32 v216, v250
s_nop 1
v_permlane32_swap_b32 v246, v248
v_permlane32_swap_b32 v247, v249
v_permlane32_swap_b32 v250, v216
v_max_f32 v246, v246, v248
v_max_f32 v247, v247, v249
v_max_f32 v250, v250, v216
v_mov_b32 v216, v250
s_nop 1
v_permlane16_swap_b32 v246, v247
v_permlane16_swap_b32 v250, v216
v_max_f32 v246, v246, v247
v_max_f32 v250, v250, v216
ds_write_b32 v217, v246 offset:0
ds_write_b32 v217, v250 offset:1024
s_waitcnt lgkmcnt(0)
s_barrier
s_mov_b32 m0, s4
s_mov_b32 s9, 65536
buffer_load_dwordx4 v232, s[28:31], s9 offen nt lds
s_mov_b32 s8, 68608
buffer_load_dwordx4 v232, s[28:31], s8 offen offset:1024 nt lds
v_and_b32 v217, 15, v235
v_lshlrev_b32 v217, 4, v217
s_lshl_b32 s10, s14, 11
s_add_u32 s10, s10, 147456
v_add_u32 v217, s10, v217
ds_read_b128 v[160:163], v217 offset:0
ds_read_b128 v[164:167], v217 offset:256
ds_read_b128 v[168:171], v217 offset:512
ds_read_b128 v[172:175], v217 offset:768
ds_read_b128 v[176:179], v217 offset:1024
s_waitcnt lgkmcnt(4)
v_max_f32 v246, v160, v161
v_max3_f32 v246, v246, v162, v163
s_waitcnt lgkmcnt(3)
v_max_f32 v247, v164, v165
v_max3_f32 v247, v247, v166, v167
s_waitcnt lgkmcnt(2)
v_max_f32 v248, v168, v169
v_max3_f32 v248, v248, v170, v171
s_waitcnt lgkmcnt(1)
v_max_f32 v249, v172, v173
v_max3_f32 v249, v249, v174, v175
s_waitcnt lgkmcnt(0)
v_max_f32 v250, v176, v177
v_max3_f32 v250, v250, v178, v179
v_mul_f32 v246, s6, v246
v_mul_f32 v247, s6, v247
v_mul_f32 v248, s6, v248
v_mul_f32 v249, s6, v249
v_mul_f32 v250, s6, v250
v_add_u32 v197, s12, v242
v_pk_fma_f32 v[0:1], v[0:1], s[6:7], v[246:247] op_sel:[0,0,0] op_sel_hi:[1,0,0] neg_lo:[0,0,1] neg_hi:[0,0,1]
v_pk_fma_f32 v[2:3], v[2:3], s[6:7], v[246:247] op_sel:[0,0,0] op_sel_hi:[1,0,0] neg_lo:[0,0,1] neg_hi:[0,0,1]
v_pk_fma_f32 v[20:21], v[20:21], s[6:7], v[246:247] op_sel:[0,0,0] op_sel_hi:[1,0,0] neg_lo:[0,0,1] neg_hi:[0,0,1]
v_pk_fma_f32 v[22:23], v[22:23], s[6:7], v[246:247] op_sel:[0,0,0] op_sel_hi:[1,0,0] neg_lo:[0,0,1] neg_hi:[0,0,1]
v_exp_f32 v0, v0
v_exp_f32 v1, v1
v_exp_f32 v2, v2
v_exp_f32 v3, v3
v_exp_f32 v20, v20
v_exp_f32 v21, v21
v_exp_f32 v22, v22
v_exp_f32 v23, v23
v_pk_add_f32 v[220:221], v[0:1], v[2:3]
v_pk_add_f32 v[222:223], v[20:21], v[22:23]
v_cvt_pk_bf16_f32 v0, v0, v1
v_cvt_pk_bf16_f32 v1, v2, v3
v_cvt_pk_bf16_f32 v2, v20, v21
v_cvt_pk_bf16_f32 v3, v22, v23
v_pk_add_f32 v[220:221], v[220:221], v[222:223]
v_add_f32 v192, v220, v221
ds_write_b128 v197, v[0:3] offset:0
v_pk_fma_f32 v[4:5], v[4:5], s[6:7], v[246:247] op_sel:[0,0,1] op_sel_hi:[1,0,1] neg_lo:[0,0,1] neg_hi:[0,0,1]
v_pk_fma_f32 v[6:7], v[6:7], s[6:7], v[246:247] op_sel:[0,0,1] op_sel_hi:[1,0,1] neg_lo:[0,0,1] neg_hi:[0,0,1]
v_pk_fma_f32 v[24:25], v[24:25], s[6:7], v[246:247] op_sel:[0,0,1] op_sel_hi:[1,0,1] neg_lo:[0,0,1] neg_hi:[0,0,1]
v_pk_fma_f32 v[26:27], v[26:27], s[6:7], v[246:247] op_sel:[0,0,1] op_sel_hi:[1,0,1] neg_lo:[0,0,1] neg_hi:[0,0,1]
v_exp_f32 v4, v4
v_exp_f32 v5, v5
v_exp_f32 v6, v6
v_exp_f32 v7, v7
v_exp_f32 v24, v24
v_exp_f32 v25, v25
v_exp_f32 v26, v26
v_exp_f32 v27, v27
v_pk_add_f32 v[224:225], v[4:5], v[6:7]
v_pk_add_f32 v[226:227], v[24:25], v[26:27]
v_cvt_pk_bf16_f32 v4, v4, v5
v_cvt_pk_bf16_f32 v5, v6, v7
v_cvt_pk_bf16_f32 v6, v24, v25
v_cvt_pk_bf16_f32 v7, v26, v27
v_pk_add_f32 v[224:225], v[224:225], v[226:227]
v_add_f32 v193, v224, v225
ds_write_b128 v197, v[4:7] offset:1024
v_pk_fma_f32 v[8:9], v[8:9], s[6:7], v[248:249] op_sel:[0,0,0] op_sel_hi:[1,0,0] neg_lo:[0,0,1] neg_hi:[0,0,1]
v_pk_fma_f32 v[10:11], v[10:11], s[6:7], v[248:249] op_sel:[0,0,0] op_sel_hi:[1,0,0] neg_lo:[0,0,1] neg_hi:[0,0,1]
v_pk_fma_f32 v[28:29], v[28:29], s[6:7], v[248:249] op_sel:[0,0,0] op_sel_hi:[1,0,0] neg_lo:[0,0,1] neg_hi:[0,0,1]
v_pk_fma_f32 v[30:31], v[30:31], s[6:7], v[248:249] op_sel:[0,0,0] op_sel_hi:[1,0,0] neg_lo:[0,0,1] neg_hi:[0,0,1]
v_exp_f32 v8, v8
v_exp_f32 v9, v9
v_exp_f32 v10, v10
v_exp_f32 v11, v11
v_exp_f32 v28, v28
v_exp_f32 v29, v29
v_exp_f32 v30, v30
v_exp_f32 v31, v31
v_pk_add_f32 v[220:221], v[8:9], v[10:11]
v_pk_add_f32 v[222:223], v[28:29], v[30:31]
v_cvt_pk_bf16_f32 v8, v8, v9
v_cvt_pk_bf16_f32 v9, v10, v11
v_cvt_pk_bf16_f32 v10, v28, v29
v_cvt_pk_bf16_f32 v11, v30, v31
v_pk_add_f32 v[220:221], v[220:221], v[222:223]
v_add_f32 v194, v220, v221
ds_write_b128 v197, v[8:11] offset:2048
v_pk_fma_f32 v[12:13], v[12:13], s[6:7], v[248:249] op_sel:[0,0,1] op_sel_hi:[1,0,1] neg_lo:[0,0,1] neg_hi:[0,0,1]
v_pk_fma_f32 v[14:15], v[14:15], s[6:7], v[248:249] op_sel:[0,0,1] op_sel_hi:[1,0,1] neg_lo:[0,0,1] neg_hi:[0,0,1]
v_pk_fma_f32 v[32:33], v[32:33], s[6:7], v[248:249] op_sel:[0,0,1] op_sel_hi:[1,0,1] neg_lo:[0,0,1] neg_hi:[0,0,1]
v_pk_fma_f32 v[34:35], v[34:35], s[6:7], v[248:249] op_sel:[0,0,1] op_sel_hi:[1,0,1] neg_lo:[0,0,1] neg_hi:[0,0,1]
v_exp_f32 v12, v12
v_exp_f32 v13, v13
v_exp_f32 v14, v14
v_exp_f32 v15, v15
v_exp_f32 v32, v32
v_exp_f32 v33, v33
v_exp_f32 v34, v34
v_exp_f32 v35, v35
v_pk_add_f32 v[224:225], v[12:13], v[14:15]
v_pk_add_f32 v[226:227], v[32:33], v[34:35]
v_cvt_pk_bf16_f32 v12, v12, v13
v_cvt_pk_bf16_f32 v13, v14, v15
v_cvt_pk_bf16_f32 v14, v32, v33
v_cvt_pk_bf16_f32 v15, v34, v35
v_pk_add_f32 v[224:225], v[224:225], v[226:227]
v_add_f32 v195, v224, v225
ds_write_b128 v197, v[12:15] offset:3072
v_pk_fma_f32 v[16:17], v[16:17], s[6:7], v[250:251] op_sel:[0,0,0] op_sel_hi:[1,0,0] neg_lo:[0,0,1] neg_hi:[0,0,1]
v_pk_fma_f32 v[18:19], v[18:19], s[6:7], v[250:251] op_sel:[0,0,0] op_sel_hi:[1,0,0] neg_lo:[0,0,1] neg_hi:[0,0,1]
v_pk_fma_f32 v[36:37], v[36:37], s[6:7], v[250:251] op_sel:[0,0,0] op_sel_hi:[1,0,0] neg_lo:[0,0,1] neg_hi:[0,0,1]
v_pk_fma_f32 v[38:39], v[38:39], s[6:7], v[250:251] op_sel:[0,0,0] op_sel_hi:[1,0,0] neg_lo:[0,0,1] neg_hi:[0,0,1]
v_exp_f32 v16, v16
v_exp_f32 v17, v17
v_exp_f32 v18, v18
v_exp_f32 v19, v19
v_exp_f32 v36, v36
v_exp_f32 v37, v37
v_exp_f32 v38, v38
v_exp_f32 v39, v39
v_pk_add_f32 v[220:221], v[16:17], v[18:19]
v_pk_add_f32 v[222:223], v[36:37], v[38:39]
v_cvt_pk_bf16_f32 v16, v16, v17
v_cvt_pk_bf16_f32 v17, v18, v19
v_cvt_pk_bf16_f32 v18, v36, v37
v_cvt_pk_bf16_f32 v19, v38, v39
v_pk_add_f32 v[220:221], v[220:221], v[222:223]
v_add_f32 v196, v220, v221
ds_write_b128 v197, v[16:19] offset:4096
v_pk_fma_f32 v[40:41], v[40:41], s[6:7], v[246:247] op_sel:[0,0,0] op_sel_hi:[1,0,0] neg_lo:[0,0,1] neg_hi:[0,0,1]
v_pk_fma_f32 v[42:43], v[42:43], s[6:7], v[246:247] op_sel:[0,0,0] op_sel_hi:[1,0,0] neg_lo:[0,0,1] neg_hi:[0,0,1]
v_pk_fma_f32 v[60:61], v[60:61], s[6:7], v[246:247] op_sel:[0,0,0] op_sel_hi:[1,0,0] neg_lo:[0,0,1] neg_hi:[0,0,1]
v_pk_fma_f32 v[62:63], v[62:63], s[6:7], v[246:247] op_sel:[0,0,0] op_sel_hi:[1,0,0] neg_lo:[0,0,1] neg_hi:[0,0,1]
v_exp_f32 v40, v40
v_exp_f32 v41, v41
v_exp_f32 v42, v42
v_exp_f32 v43, v43
v_exp_f32 v60, v60
v_exp_f32 v61, v61
v_exp_f32 v62, v62
v_exp_f32 v63, v63
v_pk_add_f32 v[224:225], v[40:41], v[42:43]
v_pk_add_f32 v[226:227], v[60:61], v[62:63]
v_cvt_pk_bf16_f32 v40, v40, v41
v_cvt_pk_bf16_f32 v41, v42, v43
v_cvt_pk_bf16_f32 v42, v60, v61
v_cvt_pk_bf16_f32 v43, v62, v63
v_pk_add_f32 v[224:225], v[224:225], v[226:227]
v_add_f32 v192, v192, v224
v_add_f32 v192, v192, v225
ds_write_b128 v197, v[40:43] offset:5120
v_pk_fma_f32 v[44:45], v[44:45], s[6:7], v[246:247] op_sel:[0,0,1] op_sel_hi:[1,0,1] neg_lo:[0,0,1] neg_hi:[0,0,1]
v_pk_fma_f32 v[46:47], v[46:47], s[6:7], v[246:247] op_sel:[0,0,1] op_sel_hi:[1,0,1] neg_lo:[0,0,1] neg_hi:[0,0,1]
v_pk_fma_f32 v[64:65], v[64:65], s[6:7], v[246:247] op_sel:[0,0,1] op_sel_hi:[1,0,1] neg_lo:[0,0,1] neg_hi:[0,0,1]
v_pk_fma_f32 v[66:67], v[66:67], s[6:7], v[246:247] op_sel:[0,0,1] op_sel_hi:[1,0,1] neg_lo:[0,0,1] neg_hi:[0,0,1]
v_exp_f32 v44, v44
v_exp_f32 v45, v45
v_exp_f32 v46, v46
v_exp_f32 v47, v47
v_exp_f32 v64, v64
v_exp_f32 v65, v65
v_exp_f32 v66, v66
v_exp_f32 v67, v67
v_pk_add_f32 v[220:221], v[44:45], v[46:47]
v_pk_add_f32 v[222:223], v[64:65], v[66:67]
v_cvt_pk_bf16_f32 v44, v44, v45
v_cvt_pk_bf16_f32 v45, v46, v47
v_cvt_pk_bf16_f32 v46, v64, v65
v_cvt_pk_bf16_f32 v47, v66, v67
v_pk_add_f32 v[220:221], v[220:221], v[222:223]
v_add_f32 v193, v193, v220
v_add_f32 v193, v193, v221
ds_write_b128 v197, v[44:47] offset:6144
v_pk_fma_f32 v[48:49], v[48:49], s[6:7], v[248:249] op_sel:[0,0,0] op_sel_hi:[1,0,0] neg_lo:[0,0,1] neg_hi:[0,0,1]
v_pk_fma_f32 v[50:51], v[50:51], s[6:7], v[248:249] op_sel:[0,0,0] op_sel_hi:[1,0,0] neg_lo:[0,0,1] neg_hi:[0,0,1]
v_pk_fma_f32 v[68:69], v[68:69], s[6:7], v[248:249] op_sel:[0,0,0] op_sel_hi:[1,0,0] neg_lo:[0,0,1] neg_hi:[0,0,1]
v_pk_fma_f32 v[70:71], v[70:71], s[6:7], v[248:249] op_sel:[0,0,0] op_sel_hi:[1,0,0] neg_lo:[0,0,1] neg_hi:[0,0,1]
v_exp_f32 v48, v48
v_exp_f32 v49, v49
v_exp_f32 v50, v50
v_exp_f32 v51, v51
v_exp_f32 v68, v68
v_exp_f32 v69, v69
v_exp_f32 v70, v70
v_exp_f32 v71, v71
v_pk_add_f32 v[224:225], v[48:49], v[50:51]
v_pk_add_f32 v[226:227], v[68:69], v[70:71]
v_cvt_pk_bf16_f32 v48, v48, v49
v_cvt_pk_bf16_f32 v49, v50, v51
v_cvt_pk_bf16_f32 v50, v68, v69
v_cvt_pk_bf16_f32 v51, v70, v71
v_pk_add_f32 v[224:225], v[224:225], v[226:227]
v_add_f32 v194, v194, v224
v_add_f32 v194, v194, v225
ds_write_b128 v197, v[48:51] offset:7168
v_pk_fma_f32 v[52:53], v[52:53], s[6:7], v[248:249] op_sel:[0,0,1] op_sel_hi:[1,0,1] neg_lo:[0,0,1] neg_hi:[0,0,1]
v_pk_fma_f32 v[54:55], v[54:55], s[6:7], v[248:249] op_sel:[0,0,1] op_sel_hi:[1,0,1] neg_lo:[0,0,1] neg_hi:[0,0,1]
v_pk_fma_f32 v[72:73], v[72:73], s[6:7], v[248:249] op_sel:[0,0,1] op_sel_hi:[1,0,1] neg_lo:[0,0,1] neg_hi:[0,0,1]
v_pk_fma_f32 v[74:75], v[74:75], s[6:7], v[248:249] op_sel:[0,0,1] op_sel_hi:[1,0,1] neg_lo:[0,0,1] neg_hi:[0,0,1]
v_exp_f32 v52, v52
v_exp_f32 v53, v53
v_exp_f32 v54, v54
v_exp_f32 v55, v55
v_exp_f32 v72, v72
v_exp_f32 v73, v73
v_exp_f32 v74, v74
v_exp_f32 v75, v75
v_pk_add_f32 v[220:221], v[52:53], v[54:55]
v_pk_add_f32 v[222:223], v[72:73], v[74:75]
v_cvt_pk_bf16_f32 v52, v52, v53
v_cvt_pk_bf16_f32 v53, v54, v55
v_cvt_pk_bf16_f32 v54, v72, v73
v_cvt_pk_bf16_f32 v55, v74, v75
v_pk_add_f32 v[220:221], v[220:221], v[222:223]
v_add_f32 v195, v195, v220
v_add_f32 v195, v195, v221
ds_write_b128 v197, v[52:55] offset:8192
v_pk_fma_f32 v[56:57], v[56:57], s[6:7], v[250:251] op_sel:[0,0,0] op_sel_hi:[1,0,0] neg_lo:[0,0,1] neg_hi:[0,0,1]
v_pk_fma_f32 v[58:59], v[58:59], s[6:7], v[250:251] op_sel:[0,0,0] op_sel_hi:[1,0,0] neg_lo:[0,0,1] neg_hi:[0,0,1]
v_pk_fma_f32 v[76:77], v[76:77], s[6:7], v[250:251] op_sel:[0,0,0] op_sel_hi:[1,0,0] neg_lo:[0,0,1] neg_hi:[0,0,1]
v_pk_fma_f32 v[78:79], v[78:79], s[6:7], v[250:251] op_sel:[0,0,0] op_sel_hi:[1,0,0] neg_lo:[0,0,1] neg_hi:[0,0,1]
v_exp_f32 v56, v56
v_exp_f32 v57, v57
v_exp_f32 v58, v58
v_exp_f32 v59, v59
v_exp_f32 v76, v76
v_exp_f32 v77, v77
v_exp_f32 v78, v78
v_exp_f32 v79, v79
v_pk_add_f32 v[224:225], v[56:57], v[58:59]
v_pk_add_f32 v[226:227], v[76:77], v[78:79]
v_cvt_pk_bf16_f32 v56, v56, v57
v_cvt_pk_bf16_f32 v57, v58, v59
v_cvt_pk_bf16_f32 v58, v76, v77
v_cvt_pk_bf16_f32 v59, v78, v79
v_pk_add_f32 v[224:225], v[224:225], v[226:227]
v_add_f32 v196, v196, v224
v_add_f32 v196, v196, v225
ds_write_b128 v197, v[56:59] offset:9216
v_pk_fma_f32 v[80:81], v[80:81], s[6:7], v[246:247] op_sel:[0,0,0] op_sel_hi:[1,0,0] neg_lo:[0,0,1] neg_hi:[0,0,1]
v_pk_fma_f32 v[82:83], v[82:83], s[6:7], v[246:247] op_sel:[0,0,0] op_sel_hi:[1,0,0] neg_lo:[0,0,1] neg_hi:[0,0,1]
v_pk_fma_f32 v[100:101], v[100:101], s[6:7], v[246:247] op_sel:[0,0,0] op_sel_hi:[1,0,0] neg_lo:[0,0,1] neg_hi:[0,0,1]
v_pk_fma_f32 v[102:103], v[102:103], s[6:7], v[246:247] op_sel:[0,0,0] op_sel_hi:[1,0,0] neg_lo:[0,0,1] neg_hi:[0,0,1]
v_exp_f32 v80, v80
v_exp_f32 v81, v81
v_exp_f32 v82, v82
v_exp_f32 v83, v83
v_exp_f32 v100, v100
v_exp_f32 v101, v101
v_exp_f32 v102, v102
v_exp_f32 v103, v103
v_pk_add_f32 v[220:221], v[80:81], v[82:83]
v_pk_add_f32 v[222:223], v[100:101], v[102:103]
v_cvt_pk_bf16_f32 v80, v80, v81
v_cvt_pk_bf16_f32 v81, v82, v83
v_cvt_pk_bf16_f32 v82, v100, v101
v_cvt_pk_bf16_f32 v83, v102, v103
v_pk_add_f32 v[220:221], v[220:221], v[222:223]
v_add_f32 v192, v192, v220
v_add_f32 v192, v192, v221
v_pk_fma_f32 v[84:85], v[84:85], s[6:7], v[246:247] op_sel:[0,0,1] op_sel_hi:[1,0,1] neg_lo:[0,0,1] neg_hi:[0,0,1]
v_pk_fma_f32 v[86:87], v[86:87], s[6:7], v[246:247] op_sel:[0,0,1] op_sel_hi:[1,0,1] neg_lo:[0,0,1] neg_hi:[0,0,1]
v_pk_fma_f32 v[104:105], v[104:105], s[6:7], v[246:247] op_sel:[0,0,1] op_sel_hi:[1,0,1] neg_lo:[0,0,1] neg_hi:[0,0,1]
v_pk_fma_f32 v[106:107], v[106:107], s[6:7], v[246:247] op_sel:[0,0,1] op_sel_hi:[1,0,1] neg_lo:[0,0,1] neg_hi:[0,0,1]
v_exp_f32 v84, v84
v_exp_f32 v85, v85
v_exp_f32 v86, v86
v_exp_f32 v87, v87
v_exp_f32 v104, v104
v_exp_f32 v105, v105
v_exp_f32 v106, v106
v_exp_f32 v107, v107
v_pk_add_f32 v[224:225], v[84:85], v[86:87]
v_pk_add_f32 v[226:227], v[104:105], v[106:107]
v_cvt_pk_bf16_f32 v84, v84, v85
v_cvt_pk_bf16_f32 v85, v86, v87
v_cvt_pk_bf16_f32 v86, v104, v105
v_cvt_pk_bf16_f32 v87, v106, v107
v_pk_add_f32 v[224:225], v[224:225], v[226:227]
v_add_f32 v193, v193, v224
v_add_f32 v193, v193, v225
v_pk_fma_f32 v[88:89], v[88:89], s[6:7], v[248:249] op_sel:[0,0,0] op_sel_hi:[1,0,0] neg_lo:[0,0,1] neg_hi:[0,0,1]
v_pk_fma_f32 v[90:91], v[90:91], s[6:7], v[248:249] op_sel:[0,0,0] op_sel_hi:[1,0,0] neg_lo:[0,0,1] neg_hi:[0,0,1]
v_pk_fma_f32 v[108:109], v[108:109], s[6:7], v[248:249] op_sel:[0,0,0] op_sel_hi:[1,0,0] neg_lo:[0,0,1] neg_hi:[0,0,1]
v_pk_fma_f32 v[110:111], v[110:111], s[6:7], v[248:249] op_sel:[0,0,0] op_sel_hi:[1,0,0] neg_lo:[0,0,1] neg_hi:[0,0,1]
v_exp_f32 v88, v88
v_exp_f32 v89, v89
v_exp_f32 v90, v90
v_exp_f32 v91, v91
v_exp_f32 v108, v108
v_exp_f32 v109, v109
v_exp_f32 v110, v110
v_exp_f32 v111, v111
v_pk_add_f32 v[220:221], v[88:89], v[90:91]
v_pk_add_f32 v[222:223], v[108:109], v[110:111]
v_cvt_pk_bf16_f32 v88, v88, v89
v_cvt_pk_bf16_f32 v89, v90, v91
v_cvt_pk_bf16_f32 v90, v108, v109
v_cvt_pk_bf16_f32 v91, v110, v111
v_pk_add_f32 v[220:221], v[220:221], v[222:223]
v_add_f32 v194, v194, v220
v_add_f32 v194, v194, v221
v_pk_fma_f32 v[92:93], v[92:93], s[6:7], v[248:249] op_sel:[0,0,1] op_sel_hi:[1,0,1] neg_lo:[0,0,1] neg_hi:[0,0,1]
v_pk_fma_f32 v[94:95], v[94:95], s[6:7], v[248:249] op_sel:[0,0,1] op_sel_hi:[1,0,1] neg_lo:[0,0,1] neg_hi:[0,0,1]
v_pk_fma_f32 v[112:113], v[112:113], s[6:7], v[248:249] op_sel:[0,0,1] op_sel_hi:[1,0,1] neg_lo:[0,0,1] neg_hi:[0,0,1]
v_pk_fma_f32 v[114:115], v[114:115], s[6:7], v[248:249] op_sel:[0,0,1] op_sel_hi:[1,0,1] neg_lo:[0,0,1] neg_hi:[0,0,1]
v_exp_f32 v92, v92
v_exp_f32 v93, v93
v_exp_f32 v94, v94
v_exp_f32 v95, v95
v_exp_f32 v112, v112
v_exp_f32 v113, v113
v_exp_f32 v114, v114
v_exp_f32 v115, v115
v_pk_add_f32 v[224:225], v[92:93], v[94:95]
v_pk_add_f32 v[226:227], v[112:113], v[114:115]
v_cvt_pk_bf16_f32 v92, v92, v93
v_cvt_pk_bf16_f32 v93, v94, v95
v_cvt_pk_bf16_f32 v94, v112, v113
v_cvt_pk_bf16_f32 v95, v114, v115
v_pk_add_f32 v[224:225], v[224:225], v[226:227]
v_add_f32 v195, v195, v224
v_add_f32 v195, v195, v225
v_pk_fma_f32 v[96:97], v[96:97], s[6:7], v[250:251] op_sel:[0,0,0] op_sel_hi:[1,0,0] neg_lo:[0,0,1] neg_hi:[0,0,1]
v_pk_fma_f32 v[98:99], v[98:99], s[6:7], v[250:251] op_sel:[0,0,0] op_sel_hi:[1,0,0] neg_lo:[0,0,1] neg_hi:[0,0,1]
v_pk_fma_f32 v[116:117], v[116:117], s[6:7], v[250:251] op_sel:[0,0,0] op_sel_hi:[1,0,0] neg_lo:[0,0,1] neg_hi:[0,0,1]
v_pk_fma_f32 v[118:119], v[118:119], s[6:7], v[250:251] op_sel:[0,0,0] op_sel_hi:[1,0,0] neg_lo:[0,0,1] neg_hi:[0,0,1]
v_exp_f32 v96, v96
v_exp_f32 v97, v97
v_exp_f32 v98, v98
v_exp_f32 v99, v99
v_exp_f32 v116, v116
v_exp_f32 v117, v117
v_exp_f32 v118, v118
v_exp_f32 v119, v119
v_pk_add_f32 v[220:221], v[96:97], v[98:99]
v_pk_add_f32 v[222:223], v[116:117], v[118:119]
v_cvt_pk_bf16_f32 v96, v96, v97
v_cvt_pk_bf16_f32 v97, v98, v99
v_cvt_pk_bf16_f32 v98, v116, v117
v_cvt_pk_bf16_f32 v99, v118, v119
v_pk_add_f32 v[220:221], v[220:221], v[222:223]
v_add_f32 v196, v196, v220
v_add_f32 v196, v196, v221
s_waitcnt lgkmcnt(0)
s_barrier
ds_read_b128 v[160:163], v244 offset:0
ds_read_b128 v[164:167], v244 offset:1024
ds_read_b128 v[168:171], v244 offset:2048
ds_read_b128 v[172:175], v244 offset:3072
ds_read_b128 v[176:179], v244 offset:4096
ds_read_b128 v[180:183], v244 offset:5120
ds_read_b128 v[184:187], v244 offset:6144
ds_read_b128 v[188:191], v244 offset:7168
s_waitcnt lgkmcnt(7)
v_mfma_f32_16x16x32_bf16 v[0:3], v[200:203], v[160:163], 0
v_mfma_f32_16x16x32_bf16 v[20:23], v[204:207], v[160:163], 0
v_mfma_f32_16x16x32_bf16 v[40:43], v[208:211], v[160:163], 0
v_fma_f32 v120, v120, s6, -v246
v_fma_f32 v121, v121, s6, -v246
v_mfma_f32_16x16x32_bf16 v[60:63], v[212:215], v[160:163], 0
v_fma_f32 v122, v122, s6, -v246
ds_read_b128 v[160:163], v244 offset:8192
s_waitcnt lgkmcnt(7)
v_mfma_f32_16x16x32_bf16 v[4:7], v[200:203], v[164:167], 0
v_fma_f32 v123, v123, s6, -v246
s_waitcnt vmcnt(6)
s_barrier
v_mfma_f32_16x16x32_bf16 v[24:27], v[204:207], v[164:167], 0
v_fma_f32 v140, v140, s6, -v246
ds_read_b64_tr_b16 v[216:217], v236 offset:2048
ds_read_b64_tr_b16 v[220:221], v237 offset:2048
ds_read_b64_tr_b16 v[224:225], v238 offset:2048
ds_read_b64_tr_b16 v[228:229], v239 offset:2048
v_mfma_f32_16x16x32_bf16 v[44:47], v[208:211], v[164:167], 0
v_fma_f32 v141, v141, s6, -v246
v_mfma_f32_16x16x32_bf16 v[64:67], v[212:215], v[164:167], 0
v_fma_f32 v142, v142, s6, -v246
ds_read_b128 v[164:167], v244 offset:9216
ds_read_b64_tr_b16 v[218:219], v236 offset:34816
ds_read_b64_tr_b16 v[222:223], v237 offset:34816
ds_read_b64_tr_b16 v[226:227], v238 offset:34816
ds_read_b64_tr_b16 v[230:231], v239 offset:34816
s_waitcnt lgkmcnt(15)
v_mfma_f32_16x16x32_bf16 v[8:11], v[200:203], v[168:171], 0
v_fma_f32 v143, v143, s6, -v246
v_mfma_f32_16x16x32_bf16 v[28:31], v[204:207], v[168:171], 0
v_exp_f32 v120, v120
v_mfma_f32_16x16x32_bf16 v[48:51], v[208:211], v[168:171], 0
v_exp_f32 v121, v121
v_mfma_f32_16x16x32_bf16 v[68:71], v[212:215], v[168:171], 0
v_exp_f32 v122, v122
ds_read_b128 v[168:171], v244 offset:10240
s_waitcnt lgkmcnt(15)
v_mfma_f32_16x16x32_bf16 v[12:15], v[200:203], v[172:175], 0
v_exp_f32 v123, v123
v_mfma_f32_16x16x32_bf16 v[32:35], v[204:207], v[172:175], 0
v_exp_f32 v140, v140
v_mfma_f32_16x16x32_bf16 v[52:55], v[208:211], v[172:175], 0
v_exp_f32 v141, v141
v_mfma_f32_16x16x32_bf16 v[72:75], v[212:215], v[172:175], 0
v_exp_f32 v142, v142
ds_read_b128 v[172:175], v244 offset:11264
s_waitcnt lgkmcnt(15)
v_mfma_f32_16x16x32_bf16 v[16:19], v[200:203], v[176:179], 0
v_exp_f32 v143, v143
v_mfma_f32_16x16x32_bf16 v[36:39], v[204:207], v[176:179], 0
v_pk_add_f32 v[100:101], v[120:121], v[122:123]
v_mfma_f32_16x16x32_bf16 v[56:59], v[208:211], v[176:179], 0
v_pk_add_f32 v[102:103], v[140:141], v[142:143]
v_mfma_f32_16x16x32_bf16 v[76:79], v[212:215], v[176:179], 0
v_cvt_pk_bf16_f32 v120, v120, v121
ds_read_b128 v[176:179], v244 offset:12288
s_waitcnt lgkmcnt(6)
v_mfma_f32_16x16x32_bf16 v[0:3], v[216:219], v[180:183], v[0:3]
v_cvt_pk_bf16_f32 v121, v122, v123
s_waitcnt lgkmcnt(5)
v_mfma_f32_16x16x32_bf16 v[20:23], v[220:223], v[180:183], v[20:23]
v_cvt_pk_bf16_f32 v122, v140, v141
s_waitcnt lgkmcnt(4)
v_mfma_f32_16x16x32_bf16 v[40:43], v[224:227], v[180:183], v[40:43]
v_cvt_pk_bf16_f32 v123, v142, v143
s_waitcnt lgkmcnt(3)
v_mfma_f32_16x16x32_bf16 v[60:63], v[228:231], v[180:183], v[60:63]
v_pk_add_f32 v[100:101], v[100:101], v[102:103]
ds_read_b128 v[180:183], v244 offset:13312
v_mfma_f32_16x16x32_bf16 v[4:7], v[216:219], v[184:187], v[4:7]
v_add_f32 v192, v192, v100
s_waitcnt vmcnt(4)
s_barrier
v_mfma_f32_16x16x32_bf16 v[24:27], v[220:223], v[184:187], v[24:27]
v_add_f32 v192, v192, v101
ds_read_b64_tr_b16 v[200:201], v236 offset:4096
ds_read_b64_tr_b16 v[204:205], v237 offset:4096
ds_read_b64_tr_b16 v[208:209], v238 offset:4096
ds_read_b64_tr_b16 v[212:213], v239 offset:4096
v_mfma_f32_16x16x32_bf16 v[44:47], v[224:227], v[184:187], v[44:47]
v_fma_f32 v124, v124, s6, -v247
v_fma_f32 v125, v125, s6, -v247
v_mfma_f32_16x16x32_bf16 v[64:67], v[228:231], v[184:187], v[64:67]
v_fma_f32 v126, v126, s6, -v247
ds_read_b128 v[184:187], v244 offset:14336
ds_read_b64_tr_b16 v[202:203], v236 offset:36864
ds_read_b64_tr_b16 v[206:207], v237 offset:36864
ds_read_b64_tr_b16 v[210:211], v238 offset:36864
ds_read_b64_tr_b16 v[214:215], v239 offset:36864
v_mfma_f32_16x16x32_bf16 v[8:11], v[216:219], v[188:191], v[8:11]
v_fma_f32 v127, v127, s6, -v247
v_mfma_f32_16x16x32_bf16 v[28:31], v[220:223], v[188:191], v[28:31]
v_fma_f32 v144, v144, s6, -v247
s_mov_b32 m0, s4
s_mov_b32 s9, 79872
buffer_load_dwordx4 v232, s[28:31], s9 offen offset:2048 nt lds
s_mov_b32 s8, 82944
buffer_load_dwordx4 v232, s[28:31], s8 offen offset:3072 nt lds
v_mfma_f32_16x16x32_bf16 v[48:51], v[224:227], v[188:191], v[48:51]
v_fma_f32 v145, v145, s6, -v247
v_mfma_f32_16x16x32_bf16 v[68:71], v[228:231], v[188:191], v[68:71]
v_fma_f32 v146, v146, s6, -v247
ds_read_b128 v[188:191], v244 offset:15360
v_mfma_f32_16x16x32_bf16 v[12:15], v[216:219], v[160:163], v[12:15]
v_fma_f32 v147, v147, s6, -v247
v_mfma_f32_16x16x32_bf16 v[32:35], v[220:223], v[160:163], v[32:35]
v_exp_f32 v124, v124
v_mfma_f32_16x16x32_bf16 v[52:55], v[224:227], v[160:163], v[52:55]
v_exp_f32 v125, v125
v_mfma_f32_16x16x32_bf16 v[72:75], v[228:231], v[160:163], v[72:75]
v_exp_f32 v126, v126
ds_read_b128 v[160:163], v244 offset:16384
v_mfma_f32_16x16x32_bf16 v[16:19], v[216:219], v[164:167], v[16:19]
v_exp_f32 v127, v127
v_mfma_f32_16x16x32_bf16 v[36:39], v[220:223], v[164:167], v[36:39]
v_exp_f32 v144, v144
v_mfma_f32_16x16x32_bf16 v[56:59], v[224:227], v[164:167], v[56:59]
v_exp_f32 v145, v145
v_mfma_f32_16x16x32_bf16 v[76:79], v[228:231], v[164:167], v[76:79]
v_exp_f32 v146, v146
ds_read_b128 v[164:167], v244 offset:17408
s_waitcnt lgkmcnt(6)
v_mfma_f32_16x16x32_bf16 v[0:3], v[200:203], v[168:171], v[0:3]
v_exp_f32 v147, v147
s_waitcnt lgkmcnt(5)
v_mfma_f32_16x16x32_bf16 v[20:23], v[204:207], v[168:171], v[20:23]
v_pk_add_f32 v[100:101], v[124:125], v[126:127]
s_waitcnt lgkmcnt(4)
v_mfma_f32_16x16x32_bf16 v[40:43], v[208:211], v[168:171], v[40:43]
v_pk_add_f32 v[102:103], v[144:145], v[146:147]
s_waitcnt lgkmcnt(3)
v_mfma_f32_16x16x32_bf16 v[60:63], v[212:215], v[168:171], v[60:63]
v_cvt_pk_bf16_f32 v124, v124, v125
ds_read_b128 v[168:171], v244 offset:18432
v_mfma_f32_16x16x32_bf16 v[4:7], v[200:203], v[172:175], v[4:7]
v_cvt_pk_bf16_f32 v125, v126, v127
s_waitcnt vmcnt(4)
s_barrier
v_mfma_f32_16x16x32_bf16 v[24:27], v[204:207], v[172:175], v[24:27]
v_cvt_pk_bf16_f32 v126, v144, v145
ds_read_b64_tr_b16 v[216:217], v236 offset:6144
ds_read_b64_tr_b16 v[220:221], v237 offset:6144
ds_read_b64_tr_b16 v[224:225], v238 offset:6144
ds_read_b64_tr_b16 v[228:229], v239 offset:6144
v_mfma_f32_16x16x32_bf16 v[44:47], v[208:211], v[172:175], v[44:47]
v_cvt_pk_bf16_f32 v127, v146, v147
v_mfma_f32_16x16x32_bf16 v[64:67], v[212:215], v[172:175], v[64:67]
v_pk_add_f32 v[100:101], v[100:101], v[102:103]
ds_read_b128 v[172:175], v244 offset:19456
ds_read_b64_tr_b16 v[218:219], v236 offset:38912
ds_read_b64_tr_b16 v[222:223], v237 offset:38912
ds_read_b64_tr_b16 v[226:227], v238 offset:38912
ds_read_b64_tr_b16 v[230:231], v239 offset:38912
v_mfma_f32_16x16x32_bf16 v[8:11], v[200:203], v[176:179], v[8:11]
v_add_f32 v193, v193, v100
v_mfma_f32_16x16x32_bf16 v[28:31], v[204:207], v[176:179], v[28:31]
v_add_f32 v193, v193, v101
s_mov_b32 m0, s5
s_mov_b32 s9, 98304
buffer_load_dwordx4 v232, s[28:31], s9 offen nt lds
s_mov_b32 s8, 101376
buffer_load_dwordx4 v232, s[28:31], s8 offen offset:1024 nt lds
v_mfma_f32_16x16x32_bf16 v[48:51], v[208:211], v[176:179], v[48:51]
v_fma_f32 v128, v128, s6, -v248
v_fma_f32 v129, v129, s6, -v248
v_mfma_f32_16x16x32_bf16 v[68:71], v[212:215], v[176:179], v[68:71]
v_fma_f32 v130, v130, s6, -v248
ds_read_b128 v[176:179], v244 offset:20480
v_mfma_f32_16x16x32_bf16 v[12:15], v[200:203], v[180:183], v[12:15]
v_fma_f32 v131, v131, s6, -v248
v_mfma_f32_16x16x32_bf16 v[32:35], v[204:207], v[180:183], v[32:35]
v_fma_f32 v148, v148, s6, -v248
v_mfma_f32_16x16x32_bf16 v[52:55], v[208:211], v[180:183], v[52:55]
v_fma_f32 v149, v149, s6, -v248
v_mfma_f32_16x16x32_bf16 v[72:75], v[212:215], v[180:183], v[72:75]
v_fma_f32 v150, v150, s6, -v248
ds_read_b128 v[180:183], v244 offset:21504
v_mfma_f32_16x16x32_bf16 v[16:19], v[200:203], v[184:187], v[16:19]
v_fma_f32 v151, v151, s6, -v248
v_mfma_f32_16x16x32_bf16 v[36:39], v[204:207], v[184:187], v[36:39]
v_exp_f32 v128, v128
v_mfma_f32_16x16x32_bf16 v[56:59], v[208:211], v[184:187], v[56:59]
v_exp_f32 v129, v129
v_mfma_f32_16x16x32_bf16 v[76:79], v[212:215], v[184:187], v[76:79]
v_exp_f32 v130, v130
ds_read_b128 v[184:187], v244 offset:22528
s_waitcnt lgkmcnt(6)
v_mfma_f32_16x16x32_bf16 v[0:3], v[216:219], v[188:191], v[0:3]
v_exp_f32 v131, v131
s_waitcnt lgkmcnt(5)
v_mfma_f32_16x16x32_bf16 v[20:23], v[220:223], v[188:191], v[20:23]
v_exp_f32 v148, v148
s_waitcnt lgkmcnt(4)
v_mfma_f32_16x16x32_bf16 v[40:43], v[224:227], v[188:191], v[40:43]
v_exp_f32 v149, v149
s_waitcnt lgkmcnt(3)
v_mfma_f32_16x16x32_bf16 v[60:63], v[228:231], v[188:191], v[60:63]
v_exp_f32 v150, v150
ds_read_b128 v[188:191], v244 offset:23552
v_mfma_f32_16x16x32_bf16 v[4:7], v[216:219], v[160:163], v[4:7]
v_exp_f32 v151, v151
s_waitcnt vmcnt(4)
s_barrier
v_mfma_f32_16x16x32_bf16 v[24:27], v[220:223], v[160:163], v[24:27]
v_pk_add_f32 v[100:101], v[128:129], v[130:131]
ds_read_b64_tr_b16 v[200:201], v236 offset:0
ds_read_b64_tr_b16 v[204:205], v237 offset:0
ds_read_b64_tr_b16 v[208:209], v238 offset:0
ds_read_b64_tr_b16 v[212:213], v239 offset:0
v_mfma_f32_16x16x32_bf16 v[44:47], v[224:227], v[160:163], v[44:47]
v_pk_add_f32 v[102:103], v[148:149], v[150:151]
v_mfma_f32_16x16x32_bf16 v[64:67], v[228:231], v[160:163], v[64:67]
v_cvt_pk_bf16_f32 v128, v128, v129
ds_read_b128 v[160:163], v244 offset:24576
ds_read_b64_tr_b16 v[202:203], v236 offset:32768
ds_read_b64_tr_b16 v[206:207], v237 offset:32768
ds_read_b64_tr_b16 v[210:211], v238 offset:32768
ds_read_b64_tr_b16 v[214:215], v239 offset:32768
v_mfma_f32_16x16x32_bf16 v[8:11], v[216:219], v[164:167], v[8:11]
v_cvt_pk_bf16_f32 v129, v130, v131
v_mfma_f32_16x16x32_bf16 v[28:31], v[220:223], v[164:167], v[28:31]
v_cvt_pk_bf16_f32 v130, v148, v149
s_mov_b32 m0, s5
s_mov_b32 s9, 112640
buffer_load_dwordx4 v232, s[28:31], s9 offen offset:2048 nt lds
s_mov_b32 s8, 115712
buffer_load_dwordx4 v232, s[28:31], s8 offen offset:3072 nt lds
v_mfma_f32_16x16x32_bf16 v[48:51], v[224:227], v[164:167], v[48:51]
v_cvt_pk_bf16_f32 v131, v150, v151
v_mfma_f32_16x16x32_bf16 v[68:71], v[228:231], v[164:167], v[68:71]
v_pk_add_f32 v[100:101], v[100:101], v[102:103]
ds_read_b128 v[164:167], v244 offset:25600
v_mfma_f32_16x16x32_bf16 v[12:15], v[216:219], v[168:171], v[12:15]
v_add_f32 v194, v194, v100
v_mfma_f32_16x16x32_bf16 v[32:35], v[220:223], v[168:171], v[32:35]
v_add_f32 v194, v194, v101
v_mfma_f32_16x16x32_bf16 v[52:55], v[224:227], v[168:171], v[52:55]
v_fma_f32 v132, v132, s6, -v249
v_fma_f32 v133, v133, s6, -v249
v_mfma_f32_16x16x32_bf16 v[72:75], v[228:231], v[168:171], v[72:75]
v_fma_f32 v134, v134, s6, -v249
ds_read_b128 v[168:171], v244 offset:26624
v_mfma_f32_16x16x32_bf16 v[16:19], v[216:219], v[172:175], v[16:19]
v_fma_f32 v135, v135, s6, -v249
v_mfma_f32_16x16x32_bf16 v[36:39], v[220:223], v[172:175], v[36:39]
v_fma_f32 v152, v152, s6, -v249
v_mfma_f32_16x16x32_bf16 v[56:59], v[224:227], v[172:175], v[56:59]
v_fma_f32 v153, v153, s6, -v249
v_mfma_f32_16x16x32_bf16 v[76:79], v[228:231], v[172:175], v[76:79]
v_fma_f32 v154, v154, s6, -v249
ds_read_b128 v[172:175], v244 offset:27648
s_waitcnt lgkmcnt(6)
v_mfma_f32_16x16x32_bf16 v[0:3], v[200:203], v[176:179], v[0:3]
v_fma_f32 v155, v155, s6, -v249
s_waitcnt lgkmcnt(5)
v_mfma_f32_16x16x32_bf16 v[20:23], v[204:207], v[176:179], v[20:23]
v_exp_f32 v132, v132
s_waitcnt lgkmcnt(4)
v_mfma_f32_16x16x32_bf16 v[40:43], v[208:211], v[176:179], v[40:43]
v_exp_f32 v133, v133
s_waitcnt lgkmcnt(3)
v_mfma_f32_16x16x32_bf16 v[60:63], v[212:215], v[176:179], v[60:63]
v_exp_f32 v134, v134
ds_read_b128 v[176:179], v244 offset:28672
v_mfma_f32_16x16x32_bf16 v[4:7], v[200:203], v[180:183], v[4:7]
v_exp_f32 v135, v135
s_waitcnt vmcnt(4)
s_barrier
v_mfma_f32_16x16x32_bf16 v[24:27], v[204:207], v[180:183], v[24:27]
v_exp_f32 v152, v152
ds_read_b64_tr_b16 v[216:217], v236 offset:2048
ds_read_b64_tr_b16 v[220:221], v237 offset:2048
ds_read_b64_tr_b16 v[224:225], v238 offset:2048
ds_read_b64_tr_b16 v[228:229], v239 offset:2048
v_mfma_f32_16x16x32_bf16 v[44:47], v[208:211], v[180:183], v[44:47]
v_exp_f32 v153, v153
v_mfma_f32_16x16x32_bf16 v[64:67], v[212:215], v[180:183], v[64:67]
v_exp_f32 v154, v154
ds_read_b128 v[180:183], v244 offset:29696
ds_read_b64_tr_b16 v[218:219], v236 offset:34816
ds_read_b64_tr_b16 v[222:223], v237 offset:34816
ds_read_b64_tr_b16 v[226:227], v238 offset:34816
ds_read_b64_tr_b16 v[230:231], v239 offset:34816
v_mfma_f32_16x16x32_bf16 v[8:11], v[200:203], v[184:187], v[8:11]
v_exp_f32 v155, v155
v_mfma_f32_16x16x32_bf16 v[28:31], v[204:207], v[184:187], v[28:31]
v_pk_add_f32 v[100:101], v[132:133], v[134:135]
s_mov_b32 m0, s4
s_mov_b32 s9, 131072
buffer_load_dwordx4 v232, s[28:31], s9 offen nt lds
s_mov_b32 s8, 134144
buffer_load_dwordx4 v232, s[28:31], s8 offen offset:1024 nt lds
v_mfma_f32_16x16x32_bf16 v[48:51], v[208:211], v[184:187], v[48:51]
v_pk_add_f32 v[102:103], v[152:153], v[154:155]
v_mfma_f32_16x16x32_bf16 v[68:71], v[212:215], v[184:187], v[68:71]
v_cvt_pk_bf16_f32 v132, v132, v133
ds_read_b128 v[184:187], v244 offset:30720
v_mfma_f32_16x16x32_bf16 v[12:15], v[200:203], v[188:191], v[12:15]
v_cvt_pk_bf16_f32 v133, v134, v135
v_mfma_f32_16x16x32_bf16 v[32:35], v[204:207], v[188:191], v[32:35]
v_cvt_pk_bf16_f32 v134, v152, v153
v_mfma_f32_16x16x32_bf16 v[52:55], v[208:211], v[188:191], v[52:55]
v_cvt_pk_bf16_f32 v135, v154, v155
v_mfma_f32_16x16x32_bf16 v[72:75], v[212:215], v[188:191], v[72:75]
v_pk_add_f32 v[100:101], v[100:101], v[102:103]
ds_read_b128 v[188:191], v244 offset:31744
v_mfma_f32_16x16x32_bf16 v[16:19], v[200:203], v[160:163], v[16:19]
v_add_f32 v195, v195, v100
v_mfma_f32_16x16x32_bf16 v[36:39], v[204:207], v[160:163], v[36:39]
v_add_f32 v195, v195, v101
v_mfma_f32_16x16x32_bf16 v[56:59], v[208:211], v[160:163], v[56:59]
v_fma_f32 v136, v136, s6, -v250
v_fma_f32 v137, v137, s6, -v250
v_mfma_f32_16x16x32_bf16 v[76:79], v[212:215], v[160:163], v[76:79]
v_fma_f32 v138, v138, s6, -v250
ds_read_b128 v[160:163], v244 offset:32768
s_waitcnt lgkmcnt(6)
v_mfma_f32_16x16x32_bf16 v[0:3], v[216:219], v[164:167], v[0:3]
v_fma_f32 v139, v139, s6, -v250
s_waitcnt lgkmcnt(5)
v_mfma_f32_16x16x32_bf16 v[20:23], v[220:223], v[164:167], v[20:23]
v_fma_f32 v156, v156, s6, -v250
s_waitcnt lgkmcnt(4)
v_mfma_f32_16x16x32_bf16 v[40:43], v[224:227], v[164:167], v[40:43]
v_fma_f32 v157, v157, s6, -v250
s_waitcnt lgkmcnt(3)
v_mfma_f32_16x16x32_bf16 v[60:63], v[228:231], v[164:167], v[60:63]
v_fma_f32 v158, v158, s6, -v250
ds_read_b128 v[164:167], v244 offset:33792
v_mfma_f32_16x16x32_bf16 v[4:7], v[216:219], v[168:171], v[4:7]
v_fma_f32 v159, v159, s6, -v250
s_waitcnt vmcnt(4)
s_barrier
v_mfma_f32_16x16x32_bf16 v[24:27], v[220:223], v[168:171], v[24:27]
v_exp_f32 v136, v136
ds_read_b64_tr_b16 v[200:201], v236 offset:4096
ds_read_b64_tr_b16 v[204:205], v237 offset:4096
ds_read_b64_tr_b16 v[208:209], v238 offset:4096
ds_read_b64_tr_b16 v[212:213], v239 offset:4096
v_mfma_f32_16x16x32_bf16 v[44:47], v[224:227], v[168:171], v[44:47]
v_exp_f32 v137, v137
v_mfma_f32_16x16x32_bf16 v[64:67], v[228:231], v[168:171], v[64:67]
v_exp_f32 v138, v138
ds_read_b128 v[168:171], v244 offset:34816
ds_read_b64_tr_b16 v[202:203], v236 offset:36864
ds_read_b64_tr_b16 v[206:207], v237 offset:36864
ds_read_b64_tr_b16 v[210:211], v238 offset:36864
ds_read_b64_tr_b16 v[214:215], v239 offset:36864
v_mfma_f32_16x16x32_bf16 v[8:11], v[216:219], v[172:175], v[8:11]
v_exp_f32 v139, v139
v_mfma_f32_16x16x32_bf16 v[28:31], v[220:223], v[172:175], v[28:31]
v_exp_f32 v156, v156
s_mov_b32 m0, s4
s_mov_b32 s9, 145408
buffer_load_dwordx4 v232, s[28:31], s9 offen offset:2048 nt lds
s_mov_b32 s8, 148480
buffer_load_dwordx4 v232, s[28:31], s8 offen offset:3072 nt lds
v_mfma_f32_16x16x32_bf16 v[48:51], v[224:227], v[172:175], v[48:51]
v_exp_f32 v157, v157
v_mfma_f32_16x16x32_bf16 v[68:71], v[228:231], v[172:175], v[68:71]
v_exp_f32 v158, v158
ds_read_b128 v[172:175], v244 offset:35840
v_mfma_f32_16x16x32_bf16 v[12:15], v[216:219], v[176:179], v[12:15]
v_exp_f32 v159, v159
v_mfma_f32_16x16x32_bf16 v[32:35], v[220:223], v[176:179], v[32:35]
v_pk_add_f32 v[100:101], v[136:137], v[138:139]
v_mfma_f32_16x16x32_bf16 v[52:55], v[224:227], v[176:179], v[52:55]
v_pk_add_f32 v[102:103], v[156:157], v[158:159]
v_mfma_f32_16x16x32_bf16 v[72:75], v[228:231], v[176:179], v[72:75]
v_cvt_pk_bf16_f32 v136, v136, v137
ds_read_b128 v[176:179], v244 offset:36864
v_mfma_f32_16x16x32_bf16 v[16:19], v[216:219], v[180:183], v[16:19]
v_cvt_pk_bf16_f32 v137, v138, v139
v_mfma_f32_16x16x32_bf16 v[36:39], v[220:223], v[180:183], v[36:39]
v_cvt_pk_bf16_f32 v138, v156, v157
v_mfma_f32_16x16x32_bf16 v[56:59], v[224:227], v[180:183], v[56:59]
v_cvt_pk_bf16_f32 v139, v158, v159
v_mfma_f32_16x16x32_bf16 v[76:79], v[228:231], v[180:183], v[76:79]
v_pk_add_f32 v[100:101], v[100:101], v[102:103]
ds_read_b128 v[180:183], v244 offset:37888
s_waitcnt lgkmcnt(6)
v_mfma_f32_16x16x32_bf16 v[0:3], v[200:203], v[184:187], v[0:3]
v_add_f32 v196, v196, v100
s_waitcnt lgkmcnt(5)
v_mfma_f32_16x16x32_bf16 v[20:23], v[204:207], v[184:187], v[20:23]
v_add_f32 v196, v196, v101
s_waitcnt lgkmcnt(4)
v_mfma_f32_16x16x32_bf16 v[40:43], v[208:211], v[184:187], v[40:43]
s_waitcnt lgkmcnt(3)
v_mfma_f32_16x16x32_bf16 v[60:63], v[212:215], v[184:187], v[60:63]
ds_read_b128 v[184:187], v244 offset:38912
v_mfma_f32_16x16x32_bf16 v[4:7], v[200:203], v[188:191], v[4:7]
v_lshlrev_b32 v199, 4, v235
s_lshl_b32 s10, s14, 11
s_lshl_b32 s11, s15, 2
s_add_u32 s10, s10, s11
s_add_u32 s10, s10, 151552
v_add_u32 v199, s10, v199
v_mov_b32 v198, v196
s_nop 1
v_permlane32_swap_b32 v192, v194
v_permlane32_swap_b32 v193, v195
v_permlane32_swap_b32 v196, v198
v_add_f32 v192, v192, v194
v_add_f32 v193, v193, v195
v_add_f32 v196, v196, v198
v_mov_b32 v198, v196
s_nop 1
v_permlane16_swap_b32 v192, v193
v_permlane16_swap_b32 v196, v198
v_add_f32 v192, v192, v193
v_add_f32 v196, v196, v198
ds_write_b32 v199, v192 offset:0
ds_write_b32 v199, v196 offset:1024
s_waitcnt vmcnt(4)
s_barrier
v_mfma_f32_16x16x32_bf16 v[24:27], v[204:207], v[188:191], v[24:27]
ds_read_b64_tr_b16 v[216:217], v236 offset:6144
ds_read_b64_tr_b16 v[220:221], v237 offset:6144
ds_read_b64_tr_b16 v[224:225], v238 offset:6144
ds_read_b64_tr_b16 v[228:229], v239 offset:6144
v_mfma_f32_16x16x32_bf16 v[44:47], v[208:211], v[188:191], v[44:47]
v_mfma_f32_16x16x32_bf16 v[64:67], v[212:215], v[188:191], v[64:67]
ds_read_b128 v[188:191], v244 offset:39936
ds_read_b64_tr_b16 v[218:219], v236 offset:38912
ds_read_b64_tr_b16 v[222:223], v237 offset:38912
ds_read_b64_tr_b16 v[226:227], v238 offset:38912
ds_read_b64_tr_b16 v[230:231], v239 offset:38912
v_mfma_f32_16x16x32_bf16 v[8:11], v[200:203], v[160:163], v[8:11]
v_mfma_f32_16x16x32_bf16 v[28:31], v[204:207], v[160:163], v[28:31]
s_mov_b32 m0, s5
s_mov_b32 s9, 163840
buffer_load_dwordx4 v232, s[28:31], s9 offen nt lds
s_mov_b32 s8, 166912
buffer_load_dwordx4 v232, s[28:31], s8 offen offset:1024 nt lds
v_mfma_f32_16x16x32_bf16 v[48:51], v[208:211], v[160:163], v[48:51]
v_mfma_f32_16x16x32_bf16 v[68:71], v[212:215], v[160:163], v[68:71]
v_mfma_f32_16x16x32_bf16 v[12:15], v[200:203], v[164:167], v[12:15]
v_mfma_f32_16x16x32_bf16 v[32:35], v[204:207], v[164:167], v[32:35]
v_mfma_f32_16x16x32_bf16 v[52:55], v[208:211], v[164:167], v[52:55]
v_mfma_f32_16x16x32_bf16 v[72:75], v[212:215], v[164:167], v[72:75]
v_mfma_f32_16x16x32_bf16 v[16:19], v[200:203], v[168:171], v[16:19]
s_waitcnt lgkmcnt(4)
s_barrier
ds_write_b128 v197, v[80:83] offset:0
v_mfma_f32_16x16x32_bf16 v[36:39], v[204:207], v[168:171], v[36:39]
ds_write_b128 v197, v[84:87] offset:1024
v_mfma_f32_16x16x32_bf16 v[56:59], v[208:211], v[168:171], v[56:59]
ds_write_b128 v197, v[88:91] offset:2048
v_mfma_f32_16x16x32_bf16 v[76:79], v[212:215], v[168:171], v[76:79]
ds_write_b128 v197, v[92:95] offset:3072
s_waitcnt lgkmcnt(7)
v_mfma_f32_16x16x32_bf16 v[0:3], v[216:219], v[172:175], v[0:3]
ds_write_b128 v197, v[96:99] offset:4096
s_waitcnt lgkmcnt(7)
v_mfma_f32_16x16x32_bf16 v[20:23], v[220:223], v[172:175], v[20:23]
ds_write_b128 v197, v[120:123] offset:5120
s_waitcnt lgkmcnt(7)
v_mfma_f32_16x16x32_bf16 v[40:43], v[224:227], v[172:175], v[40:43]
ds_write_b128 v197, v[124:127] offset:6144
s_waitcnt lgkmcnt(7)
v_mfma_f32_16x16x32_bf16 v[60:63], v[228:231], v[172:175], v[60:63]
ds_write_b128 v197, v[128:131] offset:7168
v_mfma_f32_16x16x32_bf16 v[4:7], v[216:219], v[176:179], v[4:7]
ds_write_b128 v197, v[132:135] offset:8192
s_waitcnt vmcnt(4)
s_barrier
v_mfma_f32_16x16x32_bf16 v[24:27], v[220:223], v[176:179], v[24:27]
ds_write_b128 v197, v[136:139] offset:9216
ds_read_b64_tr_b16 v[200:201], v236 offset:0
ds_read_b64_tr_b16 v[204:205], v237 offset:0
ds_read_b64_tr_b16 v[208:209], v238 offset:0
ds_read_b64_tr_b16 v[212:213], v239 offset:0
v_mfma_f32_16x16x32_bf16 v[44:47], v[224:227], v[176:179], v[44:47]
v_mfma_f32_16x16x32_bf16 v[64:67], v[228:231], v[176:179], v[64:67]
ds_read_b64_tr_b16 v[202:203], v236 offset:32768
ds_read_b64_tr_b16 v[206:207], v237 offset:32768
ds_read_b64_tr_b16 v[210:211], v238 offset:32768
ds_read_b64_tr_b16 v[214:215], v239 offset:32768
v_mfma_f32_16x16x32_bf16 v[8:11], v[216:219], v[180:183], v[8:11]
v_mfma_f32_16x16x32_bf16 v[28:31], v[220:223], v[180:183], v[28:31]
s_mov_b32 m0, s5
s_mov_b32 s9, 178176
buffer_load_dwordx4 v232, s[28:31], s9 offen offset:2048 nt lds
s_mov_b32 s8, 181248
buffer_load_dwordx4 v232, s[28:31], s8 offen offset:3072 nt lds
v_mfma_f32_16x16x32_bf16 v[48:51], v[224:227], v[180:183], v[48:51]
v_mfma_f32_16x16x32_bf16 v[68:71], v[228:231], v[180:183], v[68:71]
v_mfma_f32_16x16x32_bf16 v[12:15], v[216:219], v[184:187], v[12:15]
v_mfma_f32_16x16x32_bf16 v[32:35], v[220:223], v[184:187], v[32:35]
v_mfma_f32_16x16x32_bf16 v[52:55], v[224:227], v[184:187], v[52:55]
v_mfma_f32_16x16x32_bf16 v[72:75], v[228:231], v[184:187], v[72:75]
v_mfma_f32_16x16x32_bf16 v[16:19], v[216:219], v[188:191], v[16:19]
v_mfma_f32_16x16x32_bf16 v[36:39], v[220:223], v[188:191], v[36:39]
v_mfma_f32_16x16x32_bf16 v[56:59], v[224:227], v[188:191], v[56:59]
s_waitcnt lgkmcnt(8)
s_barrier
ds_read_b128 v[160:163], v244 offset:0
ds_read_b128 v[164:167], v244 offset:1024
ds_read_b128 v[168:171], v244 offset:2048
v_mfma_f32_16x16x32_bf16 v[76:79], v[228:231], v[188:191], v[76:79]
ds_read_b128 v[172:175], v244 offset:3072
ds_read_b128 v[176:179], v244 offset:4096
ds_read_b128 v[180:183], v244 offset:5120
s_waitcnt lgkmcnt(5)
v_mfma_f32_16x16x32_bf16 v[0:3], v[200:203], v[160:163], v[0:3]
ds_read_b128 v[184:187], v244 offset:6144
ds_read_b128 v[188:191], v244 offset:7168
v_mfma_f32_16x16x32_bf16 v[20:23], v[204:207], v[160:163], v[20:23]
v_mfma_f32_16x16x32_bf16 v[40:43], v[208:211], v[160:163], v[40:43]
v_mfma_f32_16x16x32_bf16 v[60:63], v[212:215], v[160:163], v[60:63]
ds_read_b128 v[160:163], v244 offset:8192
s_waitcnt lgkmcnt(7)
v_mfma_f32_16x16x32_bf16 v[4:7], v[200:203], v[164:167], v[4:7]
s_waitcnt vmcnt(4)
s_barrier
v_mfma_f32_16x16x32_bf16 v[24:27], v[204:207], v[164:167], v[24:27]
ds_read_b64_tr_b16 v[216:217], v236 offset:2048
ds_read_b64_tr_b16 v[220:221], v237 offset:2048
ds_read_b64_tr_b16 v[224:225], v238 offset:2048
ds_read_b64_tr_b16 v[228:229], v239 offset:2048
v_mfma_f32_16x16x32_bf16 v[44:47], v[208:211], v[164:167], v[44:47]
v_mfma_f32_16x16x32_bf16 v[64:67], v[212:215], v[164:167], v[64:67]
ds_read_b128 v[164:167], v244 offset:9216
ds_read_b64_tr_b16 v[218:219], v236 offset:34816
ds_read_b64_tr_b16 v[222:223], v237 offset:34816
ds_read_b64_tr_b16 v[226:227], v238 offset:34816
ds_read_b64_tr_b16 v[230:231], v239 offset:34816
s_waitcnt lgkmcnt(15)
v_mfma_f32_16x16x32_bf16 v[8:11], v[200:203], v[168:171], v[8:11]
v_mfma_f32_16x16x32_bf16 v[28:31], v[204:207], v[168:171], v[28:31]
s_mov_b32 m0, s4
s_mov_b32 s9, 196608
buffer_load_dwordx4 v232, s[28:31], s9 offen nt lds
s_mov_b32 s8, 199680
buffer_load_dwordx4 v232, s[28:31], s8 offen offset:1024 nt lds
v_mfma_f32_16x16x32_bf16 v[48:51], v[208:211], v[168:171], v[48:51]
v_mfma_f32_16x16x32_bf16 v[68:71], v[212:215], v[168:171], v[68:71]
ds_read_b128 v[168:171], v244 offset:10240
s_waitcnt lgkmcnt(15)
v_mfma_f32_16x16x32_bf16 v[12:15], v[200:203], v[172:175], v[12:15]
v_mfma_f32_16x16x32_bf16 v[32:35], v[204:207], v[172:175], v[32:35]
v_mfma_f32_16x16x32_bf16 v[52:55], v[208:211], v[172:175], v[52:55]
v_mfma_f32_16x16x32_bf16 v[72:75], v[212:215], v[172:175], v[72:75]
ds_read_b128 v[172:175], v244 offset:11264
s_waitcnt lgkmcnt(15)
v_mfma_f32_16x16x32_bf16 v[16:19], v[200:203], v[176:179], v[16:19]
v_mfma_f32_16x16x32_bf16 v[36:39], v[204:207], v[176:179], v[36:39]
v_mfma_f32_16x16x32_bf16 v[56:59], v[208:211], v[176:179], v[56:59]
v_mfma_f32_16x16x32_bf16 v[76:79], v[212:215], v[176:179], v[76:79]
ds_read_b128 v[176:179], v244 offset:12288
s_waitcnt lgkmcnt(6)
v_mfma_f32_16x16x32_bf16 v[0:3], v[216:219], v[180:183], v[0:3]
s_waitcnt lgkmcnt(5)
v_mfma_f32_16x16x32_bf16 v[20:23], v[220:223], v[180:183], v[20:23]
s_waitcnt lgkmcnt(4)
v_mfma_f32_16x16x32_bf16 v[40:43], v[224:227], v[180:183], v[40:43]
s_waitcnt lgkmcnt(3)
v_mfma_f32_16x16x32_bf16 v[60:63], v[228:231], v[180:183], v[60:63]
ds_read_b128 v[180:183], v244 offset:13312
v_mfma_f32_16x16x32_bf16 v[4:7], v[216:219], v[184:187], v[4:7]
s_waitcnt vmcnt(4)
s_barrier
v_mfma_f32_16x16x32_bf16 v[24:27], v[220:223], v[184:187], v[24:27]
ds_read_b64_tr_b16 v[200:201], v236 offset:4096
ds_read_b64_tr_b16 v[204:205], v237 offset:4096
ds_read_b64_tr_b16 v[208:209], v238 offset:4096
ds_read_b64_tr_b16 v[212:213], v239 offset:4096
v_mfma_f32_16x16x32_bf16 v[44:47], v[224:227], v[184:187], v[44:47]
v_mfma_f32_16x16x32_bf16 v[64:67], v[228:231], v[184:187], v[64:67]
ds_read_b128 v[184:187], v244 offset:14336
ds_read_b64_tr_b16 v[202:203], v236 offset:36864
ds_read_b64_tr_b16 v[206:207], v237 offset:36864
ds_read_b64_tr_b16 v[210:211], v238 offset:36864
ds_read_b64_tr_b16 v[214:215], v239 offset:36864
v_mfma_f32_16x16x32_bf16 v[8:11], v[216:219], v[188:191], v[8:11]
v_mfma_f32_16x16x32_bf16 v[28:31], v[220:223], v[188:191], v[28:31]
s_mov_b32 m0, s4
s_mov_b32 s9, 210944
buffer_load_dwordx4 v232, s[28:31], s9 offen offset:2048 nt lds
s_mov_b32 s8, 214016
buffer_load_dwordx4 v232, s[28:31], s8 offen offset:3072 nt lds
v_mfma_f32_16x16x32_bf16 v[48:51], v[224:227], v[188:191], v[48:51]
v_mfma_f32_16x16x32_bf16 v[68:71], v[228:231], v[188:191], v[68:71]
ds_read_b128 v[188:191], v244 offset:15360
v_mfma_f32_16x16x32_bf16 v[12:15], v[216:219], v[160:163], v[12:15]
v_mfma_f32_16x16x32_bf16 v[32:35], v[220:223], v[160:163], v[32:35]
v_mfma_f32_16x16x32_bf16 v[52:55], v[224:227], v[160:163], v[52:55]
v_mfma_f32_16x16x32_bf16 v[72:75], v[228:231], v[160:163], v[72:75]
ds_read_b128 v[160:163], v244 offset:16384
v_mfma_f32_16x16x32_bf16 v[16:19], v[216:219], v[164:167], v[16:19]
v_mfma_f32_16x16x32_bf16 v[36:39], v[220:223], v[164:167], v[36:39]
v_mfma_f32_16x16x32_bf16 v[56:59], v[224:227], v[164:167], v[56:59]
v_mfma_f32_16x16x32_bf16 v[76:79], v[228:231], v[164:167], v[76:79]
ds_read_b128 v[164:167], v244 offset:17408
s_waitcnt lgkmcnt(6)
v_mfma_f32_16x16x32_bf16 v[0:3], v[200:203], v[168:171], v[0:3]
s_waitcnt lgkmcnt(5)
v_mfma_f32_16x16x32_bf16 v[20:23], v[204:207], v[168:171], v[20:23]
s_waitcnt lgkmcnt(4)
v_mfma_f32_16x16x32_bf16 v[40:43], v[208:211], v[168:171], v[40:43]
s_waitcnt lgkmcnt(3)
v_mfma_f32_16x16x32_bf16 v[60:63], v[212:215], v[168:171], v[60:63]
ds_read_b128 v[168:171], v244 offset:18432
v_mfma_f32_16x16x32_bf16 v[4:7], v[200:203], v[172:175], v[4:7]
s_waitcnt vmcnt(4)
s_barrier
v_mfma_f32_16x16x32_bf16 v[24:27], v[204:207], v[172:175], v[24:27]
ds_read_b64_tr_b16 v[216:217], v236 offset:6144
ds_read_b64_tr_b16 v[220:221], v237 offset:6144
ds_read_b64_tr_b16 v[224:225], v238 offset:6144
ds_read_b64_tr_b16 v[228:229], v239 offset:6144
v_mfma_f32_16x16x32_bf16 v[44:47], v[208:211], v[172:175], v[44:47]
v_mfma_f32_16x16x32_bf16 v[64:67], v[212:215], v[172:175], v[64:67]
ds_read_b128 v[172:175], v244 offset:19456
ds_read_b64_tr_b16 v[218:219], v236 offset:38912
ds_read_b64_tr_b16 v[222:223], v237 offset:38912
ds_read_b64_tr_b16 v[226:227], v238 offset:38912
ds_read_b64_tr_b16 v[230:231], v239 offset:38912
v_mfma_f32_16x16x32_bf16 v[8:11], v[200:203], v[176:179], v[8:11]
v_mfma_f32_16x16x32_bf16 v[28:31], v[204:207], v[176:179], v[28:31]
s_mov_b32 m0, s5
s_mov_b32 s9, 229376
buffer_load_dwordx4 v232, s[28:31], s9 offen nt lds
s_mov_b32 s8, 232448
buffer_load_dwordx4 v232, s[28:31], s8 offen offset:1024 nt lds
v_mfma_f32_16x16x32_bf16 v[48:51], v[208:211], v[176:179], v[48:51]
v_mfma_f32_16x16x32_bf16 v[68:71], v[212:215], v[176:179], v[68:71]
ds_read_b128 v[176:179], v244 offset:20480
v_mfma_f32_16x16x32_bf16 v[12:15], v[200:203], v[180:183], v[12:15]
v_mfma_f32_16x16x32_bf16 v[32:35], v[204:207], v[180:183], v[32:35]
v_mfma_f32_16x16x32_bf16 v[52:55], v[208:211], v[180:183], v[52:55]
v_mfma_f32_16x16x32_bf16 v[72:75], v[212:215], v[180:183], v[72:75]
ds_read_b128 v[180:183], v244 offset:21504
v_mfma_f32_16x16x32_bf16 v[16:19], v[200:203], v[184:187], v[16:19]
v_mfma_f32_16x16x32_bf16 v[36:39], v[204:207], v[184:187], v[36:39]
v_mfma_f32_16x16x32_bf16 v[56:59], v[208:211], v[184:187], v[56:59]
v_mfma_f32_16x16x32_bf16 v[76:79], v[212:215], v[184:187], v[76:79]
ds_read_b128 v[184:187], v244 offset:22528
s_waitcnt lgkmcnt(6)
v_mfma_f32_16x16x32_bf16 v[0:3], v[216:219], v[188:191], v[0:3]
v_and_b32 v253, 15, v235
v_lshlrev_b32 v253, 4, v253
s_lshl_b32 s10, s14, 11
s_add_u32 s10, s10, 151552
v_add_u32 v253, s10, v253
ds_read_b128 v[140:143], v253 offset:0
ds_read_b128 v[144:147], v253 offset:256
ds_read_b128 v[148:151], v253 offset:512
ds_read_b128 v[152:155], v253 offset:768
ds_read_b128 v[156:159], v253 offset:1024
s_waitcnt lgkmcnt(4)
v_pk_add_f32 v[140:141], v[140:141], v[142:143]
v_add_f32 v246, v140, v141
s_waitcnt lgkmcnt(3)
v_pk_add_f32 v[144:145], v[144:145], v[146:147]
v_add_f32 v247, v144, v145
s_waitcnt lgkmcnt(2)
v_pk_add_f32 v[148:149], v[148:149], v[150:151]
v_add_f32 v248, v148, v149
s_waitcnt lgkmcnt(1)
v_pk_add_f32 v[152:153], v[152:153], v[154:155]
v_add_f32 v249, v152, v153
s_waitcnt lgkmcnt(0)
v_pk_add_f32 v[156:157], v[156:157], v[158:159]
v_add_f32 v250, v156, v157
v_rcp_f32 v246, v246
v_rcp_f32 v247, v247
v_rcp_f32 v248, v248
v_rcp_f32 v249, v249
v_rcp_f32 v250, v250
v_mfma_f32_16x16x32_bf16 v[20:23], v[220:223], v[188:191], v[20:23]
v_mfma_f32_16x16x32_bf16 v[40:43], v[224:227], v[188:191], v[40:43]
v_mfma_f32_16x16x32_bf16 v[60:63], v[228:231], v[188:191], v[60:63]
ds_read_b128 v[188:191], v244 offset:23552
v_mfma_f32_16x16x32_bf16 v[4:7], v[216:219], v[160:163], v[4:7]
s_waitcnt vmcnt(4)
s_barrier
v_mfma_f32_16x16x32_bf16 v[24:27], v[220:223], v[160:163], v[24:27]
ds_read_b64_tr_b16 v[200:201], v236 offset:0
ds_read_b64_tr_b16 v[204:205], v237 offset:0
ds_read_b64_tr_b16 v[208:209], v238 offset:0
ds_read_b64_tr_b16 v[212:213], v239 offset:0
v_mfma_f32_16x16x32_bf16 v[44:47], v[224:227], v[160:163], v[44:47]
v_mfma_f32_16x16x32_bf16 v[64:67], v[228:231], v[160:163], v[64:67]
ds_read_b128 v[160:163], v244 offset:24576
ds_read_b64_tr_b16 v[202:203], v236 offset:32768
ds_read_b64_tr_b16 v[206:207], v237 offset:32768
ds_read_b64_tr_b16 v[210:211], v238 offset:32768
ds_read_b64_tr_b16 v[214:215], v239 offset:32768
v_mfma_f32_16x16x32_bf16 v[8:11], v[216:219], v[164:167], v[8:11]
v_mfma_f32_16x16x32_bf16 v[28:31], v[220:223], v[164:167], v[28:31]
s_mov_b32 m0, s5
s_mov_b32 s9, 243712
buffer_load_dwordx4 v232, s[28:31], s9 offen offset:2048 nt lds
s_mov_b32 s8, 246784
buffer_load_dwordx4 v232, s[28:31], s8 offen offset:3072 nt lds
v_mfma_f32_16x16x32_bf16 v[48:51], v[224:227], v[164:167], v[48:51]
v_mfma_f32_16x16x32_bf16 v[68:71], v[228:231], v[164:167], v[68:71]
ds_read_b128 v[164:167], v244 offset:25600
v_mfma_f32_16x16x32_bf16 v[12:15], v[216:219], v[168:171], v[12:15]
v_mfma_f32_16x16x32_bf16 v[32:35], v[220:223], v[168:171], v[32:35]
v_mfma_f32_16x16x32_bf16 v[52:55], v[224:227], v[168:171], v[52:55]
v_mfma_f32_16x16x32_bf16 v[72:75], v[228:231], v[168:171], v[72:75]
ds_read_b128 v[168:171], v244 offset:26624
v_mfma_f32_16x16x32_bf16 v[16:19], v[216:219], v[172:175], v[16:19]
v_mfma_f32_16x16x32_bf16 v[36:39], v[220:223], v[172:175], v[36:39]
v_mfma_f32_16x16x32_bf16 v[56:59], v[224:227], v[172:175], v[56:59]
v_mfma_f32_16x16x32_bf16 v[76:79], v[228:231], v[172:175], v[76:79]
ds_read_b128 v[172:175], v244 offset:27648
s_waitcnt lgkmcnt(6)
v_mfma_f32_16x16x32_bf16 v[0:3], v[200:203], v[176:179], v[0:3]
s_waitcnt lgkmcnt(5)
v_mfma_f32_16x16x32_bf16 v[20:23], v[204:207], v[176:179], v[20:23]
s_waitcnt lgkmcnt(4)
v_mfma_f32_16x16x32_bf16 v[40:43], v[208:211], v[176:179], v[40:43]
s_waitcnt lgkmcnt(3)
v_mfma_f32_16x16x32_bf16 v[60:63], v[212:215], v[176:179], v[60:63]
ds_read_b128 v[176:179], v244 offset:28672
v_mfma_f32_16x16x32_bf16 v[4:7], v[200:203], v[180:183], v[4:7]
s_waitcnt vmcnt(4)
s_barrier
v_mfma_f32_16x16x32_bf16 v[24:27], v[204:207], v[180:183], v[24:27]
ds_read_b64_tr_b16 v[216:217], v236 offset:2048
ds_read_b64_tr_b16 v[220:221], v237 offset:2048
ds_read_b64_tr_b16 v[224:225], v238 offset:2048
ds_read_b64_tr_b16 v[228:229], v239 offset:2048
v_mfma_f32_16x16x32_bf16 v[44:47], v[208:211], v[180:183], v[44:47]
v_mfma_f32_16x16x32_bf16 v[64:67], v[212:215], v[180:183], v[64:67]
ds_read_b128 v[180:183], v244 offset:29696
ds_read_b64_tr_b16 v[218:219], v236 offset:34816
ds_read_b64_tr_b16 v[222:223], v237 offset:34816
ds_read_b64_tr_b16 v[226:227], v238 offset:34816
ds_read_b64_tr_b16 v[230:231], v239 offset:34816
v_mfma_f32_16x16x32_bf16 v[8:11], v[200:203], v[184:187], v[8:11]
v_mfma_f32_16x16x32_bf16 v[28:31], v[204:207], v[184:187], v[28:31]
s_mov_b32 m0, s4
s_add_u32 s9, s76, 0
buffer_load_dwordx4 v234, s[32:35], s9 offen lds
s_add_u32 s8, s76, 6144
buffer_load_dwordx4 v234, s[32:35], s8 offen offset:1024 lds
v_mfma_f32_16x16x32_bf16 v[48:51], v[208:211], v[184:187], v[48:51]
v_mfma_f32_16x16x32_bf16 v[68:71], v[212:215], v[184:187], v[68:71]
ds_read_b128 v[184:187], v244 offset:30720
v_mfma_f32_16x16x32_bf16 v[12:15], v[200:203], v[188:191], v[12:15]
v_mfma_f32_16x16x32_bf16 v[32:35], v[204:207], v[188:191], v[32:35]
v_mfma_f32_16x16x32_bf16 v[52:55], v[208:211], v[188:191], v[52:55]
v_mfma_f32_16x16x32_bf16 v[72:75], v[212:215], v[188:191], v[72:75]
ds_read_b128 v[188:191], v244 offset:31744
v_mfma_f32_16x16x32_bf16 v[16:19], v[200:203], v[160:163], v[16:19]
v_mfma_f32_16x16x32_bf16 v[36:39], v[204:207], v[160:163], v[36:39]
v_mfma_f32_16x16x32_bf16 v[56:59], v[208:211], v[160:163], v[56:59]
v_mfma_f32_16x16x32_bf16 v[76:79], v[212:215], v[160:163], v[76:79]
ds_read_b128 v[160:163], v244 offset:32768
s_waitcnt lgkmcnt(6)
v_mfma_f32_16x16x32_bf16 v[0:3], v[216:219], v[164:167], v[0:3]
s_waitcnt lgkmcnt(5)
v_mfma_f32_16x16x32_bf16 v[20:23], v[220:223], v[164:167], v[20:23]
s_waitcnt lgkmcnt(4)
v_mfma_f32_16x16x32_bf16 v[40:43], v[224:227], v[164:167], v[40:43]
s_waitcnt lgkmcnt(3)
v_mfma_f32_16x16x32_bf16 v[60:63], v[228:231], v[164:167], v[60:63]
ds_read_b128 v[164:167], v244 offset:33792
v_mfma_f32_16x16x32_bf16 v[4:7], v[216:219], v[168:171], v[4:7]
s_waitcnt vmcnt(4)
s_barrier
v_mfma_f32_16x16x32_bf16 v[24:27], v[220:223], v[168:171], v[24:27]
ds_read_b64_tr_b16 v[200:201], v236 offset:4096
ds_read_b64_tr_b16 v[204:205], v237 offset:4096
ds_read_b64_tr_b16 v[208:209], v238 offset:4096
ds_read_b64_tr_b16 v[212:213], v239 offset:4096
v_mfma_f32_16x16x32_bf16 v[44:47], v[224:227], v[168:171], v[44:47]
v_mfma_f32_16x16x32_bf16 v[64:67], v[228:231], v[168:171], v[64:67]
ds_read_b128 v[168:171], v244 offset:34816
ds_read_b64_tr_b16 v[202:203], v236 offset:36864
ds_read_b64_tr_b16 v[206:207], v237 offset:36864
ds_read_b64_tr_b16 v[210:211], v238 offset:36864
ds_read_b64_tr_b16 v[214:215], v239 offset:36864
v_mfma_f32_16x16x32_bf16 v[8:11], v[216:219], v[172:175], v[8:11]
v_mfma_f32_16x16x32_bf16 v[28:31], v[220:223], v[172:175], v[28:31]
s_mov_b32 m0, s4
s_add_u32 s9, s76, 12288
buffer_load_dwordx4 v234, s[32:35], s9 offen offset:2048 lds
s_add_u32 s8, s76, 18432
buffer_load_dwordx4 v234, s[32:35], s8 offen offset:3072 lds
v_mfma_f32_16x16x32_bf16 v[48:51], v[224:227], v[172:175], v[48:51]
v_mfma_f32_16x16x32_bf16 v[68:71], v[228:231], v[172:175], v[68:71]
ds_read_b128 v[172:175], v244 offset:35840
v_mfma_f32_16x16x32_bf16 v[12:15], v[216:219], v[176:179], v[12:15]
v_mfma_f32_16x16x32_bf16 v[32:35], v[220:223], v[176:179], v[32:35]
v_mfma_f32_16x16x32_bf16 v[52:55], v[224:227], v[176:179], v[52:55]
v_mfma_f32_16x16x32_bf16 v[72:75], v[228:231], v[176:179], v[72:75]
ds_read_b128 v[176:179], v244 offset:36864
v_mfma_f32_16x16x32_bf16 v[16:19], v[216:219], v[180:183], v[16:19]
v_mfma_f32_16x16x32_bf16 v[36:39], v[220:223], v[180:183], v[36:39]
v_mfma_f32_16x16x32_bf16 v[56:59], v[224:227], v[180:183], v[56:59]
v_mfma_f32_16x16x32_bf16 v[76:79], v[228:231], v[180:183], v[76:79]
ds_read_b128 v[180:183], v244 offset:37888
s_waitcnt lgkmcnt(6)
v_mfma_f32_16x16x32_bf16 v[0:3], v[200:203], v[184:187], v[0:3]
s_waitcnt lgkmcnt(5)
v_mfma_f32_16x16x32_bf16 v[20:23], v[204:207], v[184:187], v[20:23]
s_waitcnt lgkmcnt(4)
v_mfma_f32_16x16x32_bf16 v[40:43], v[208:211], v[184:187], v[40:43]
s_waitcnt lgkmcnt(3)
v_mfma_f32_16x16x32_bf16 v[60:63], v[212:215], v[184:187], v[60:63]
ds_read_b128 v[184:187], v244 offset:38912
v_mfma_f32_16x16x32_bf16 v[4:7], v[200:203], v[188:191], v[4:7]
s_waitcnt vmcnt(4)
s_barrier
v_mfma_f32_16x16x32_bf16 v[24:27], v[204:207], v[188:191], v[24:27]
ds_read_b64_tr_b16 v[216:217], v236 offset:6144
ds_read_b64_tr_b16 v[220:221], v237 offset:6144
ds_read_b64_tr_b16 v[224:225], v238 offset:6144
ds_read_b64_tr_b16 v[228:229], v239 offset:6144
v_mfma_f32_16x16x32_bf16 v[44:47], v[208:211], v[188:191], v[44:47]
v_mfma_f32_16x16x32_bf16 v[64:67], v[212:215], v[188:191], v[64:67]
ds_read_b128 v[188:191], v244 offset:39936
ds_read_b64_tr_b16 v[218:219], v236 offset:38912
ds_read_b64_tr_b16 v[222:223], v237 offset:38912
ds_read_b64_tr_b16 v[226:227], v238 offset:38912
ds_read_b64_tr_b16 v[230:231], v239 offset:38912
v_mfma_f32_16x16x32_bf16 v[8:11], v[200:203], v[160:163], v[8:11]
v_mfma_f32_16x16x32_bf16 v[28:31], v[204:207], v[160:163], v[28:31]
s_mov_b32 m0, s5
s_add_u32 s9, s76, 28672
buffer_load_dwordx4 v234, s[32:35], s9 offen lds
s_add_u32 s8, s76, 34816
buffer_load_dwordx4 v234, s[32:35], s8 offen offset:1024 lds
v_mfma_f32_16x16x32_bf16 v[48:51], v[208:211], v[160:163], v[48:51]
v_mfma_f32_16x16x32_bf16 v[68:71], v[212:215], v[160:163], v[68:71]
v_mfma_f32_16x16x32_bf16 v[12:15], v[200:203], v[164:167], v[12:15]
v_mfma_f32_16x16x32_bf16 v[32:35], v[204:207], v[164:167], v[32:35]
v_mfma_f32_16x16x32_bf16 v[52:55], v[208:211], v[164:167], v[52:55]
v_mfma_f32_16x16x32_bf16 v[72:75], v[212:215], v[164:167], v[72:75]
v_mfma_f32_16x16x32_bf16 v[16:19], v[200:203], v[168:171], v[16:19]
s_waitcnt lgkmcnt(4)
s_barrier
v_mfma_f32_16x16x32_bf16 v[36:39], v[204:207], v[168:171], v[36:39]
v_mfma_f32_16x16x32_bf16 v[56:59], v[208:211], v[168:171], v[56:59]
v_mfma_f32_16x16x32_bf16 v[76:79], v[212:215], v[168:171], v[76:79]
s_waitcnt lgkmcnt(3)
v_mfma_f32_16x16x32_bf16 v[0:3], v[216:219], v[172:175], v[0:3]
s_waitcnt lgkmcnt(2)
v_mfma_f32_16x16x32_bf16 v[20:23], v[220:223], v[172:175], v[20:23]
s_waitcnt lgkmcnt(0)
s_barrier
s_mov_b32 m0, s5
s_add_u32 s9, s76, 40960
buffer_load_dwordx4 v234, s[32:35], s9 offen offset:2048 lds
s_add_u32 s8, s76, 47104
buffer_load_dwordx4 v234, s[32:35], s8 offen offset:3072 lds
s_waitcnt vmcnt(6)
v_add_u32 v236, s13, v236
v_add_u32 v237, s13, v237
v_add_u32 v238, s13, v238
v_add_u32 v239, s13, v239
v_add_u32 v240, s13, v240
v_add_u32 v241, s13, v241
ds_read_b64_tr_b16 v[200:201], v236 offset:0
ds_read_b64_tr_b16 v[204:205], v237 offset:0
ds_read_b64_tr_b16 v[208:209], v238 offset:0
ds_read_b64_tr_b16 v[212:213], v239 offset:0
v_mfma_f32_16x16x32_bf16 v[40:43], v[224:227], v[172:175], v[40:43]
v_mfma_f32_16x16x32_bf16 v[60:63], v[228:231], v[172:175], v[60:63]
v_mfma_f32_16x16x32_bf16 v[4:7], v[216:219], v[176:179], v[4:7]
v_mfma_f32_16x16x32_bf16 v[24:27], v[220:223], v[176:179], v[24:27]
v_mfma_f32_16x16x32_bf16 v[44:47], v[224:227], v[176:179], v[44:47]
s_waitcnt lgkmcnt(0)
s_mov_b32 m0, s4
s_add_u32 s9, s77, 0
buffer_load_dwordx4 v234, s[32:35], s9 offen lds
s_add_u32 s8, s77, 6144
buffer_load_dwordx4 v234, s[32:35], s8 offen offset:1024 lds
v_mfma_f32_16x16x32_bf16 v[64:67], v[228:231], v[176:179], v[64:67]
v_mfma_f32_16x16x32_bf16 v[8:11], v[216:219], v[180:183], v[8:11]
s_waitcnt vmcnt(6)
ds_read_b64_tr_b16 v[202:203], v236 offset:2048
ds_read_b64_tr_b16 v[206:207], v237 offset:2048
ds_read_b64_tr_b16 v[210:211], v238 offset:2048
ds_read_b64_tr_b16 v[214:215], v239 offset:2048
v_mfma_f32_16x16x32_bf16 v[28:31], v[220:223], v[180:183], v[28:31]
v_mfma_f32_16x16x32_bf16 v[48:51], v[224:227], v[180:183], v[48:51]
v_mfma_f32_16x16x32_bf16 v[68:71], v[228:231], v[180:183], v[68:71]
v_mfma_f32_16x16x32_bf16 v[12:15], v[216:219], v[184:187], v[12:15]
v_mfma_f32_16x16x32_bf16 v[32:35], v[220:223], v[184:187], v[32:35]
s_waitcnt lgkmcnt(0)
s_mov_b32 m0, s4
s_add_u32 s9, s77, 12288
buffer_load_dwordx4 v234, s[32:35], s9 offen offset:2048 lds
s_add_u32 s8, s77, 18432
buffer_load_dwordx4 v234, s[32:35], s8 offen offset:3072 lds
v_mfma_f32_16x16x32_bf16 v[52:55], v[224:227], v[184:187], v[52:55]
v_mfma_f32_16x16x32_bf16 v[72:75], v[228:231], v[184:187], v[72:75]
v_mfma_f32_16x16x32_bf16 v[16:19], v[216:219], v[188:191], v[16:19]
v_mfma_f32_16x16x32_bf16 v[36:39], v[220:223], v[188:191], v[36:39]
v_mfma_f32_16x16x32_bf16 v[56:59], v[224:227], v[188:191], v[56:59]
v_mfma_f32_16x16x32_bf16 v[76:79], v[228:231], v[188:191], v[76:79]
s_nop 7
v_add_u32 v252, s71, v242
v_mul_f32 v0, v0, v246
v_mul_f32 v1, v1, v246
v_mul_f32 v2, v2, v246
v_mul_f32 v3, v3, v246
v_mul_f32 v20, v20, v246
v_mul_f32 v21, v21, v246
v_mul_f32 v22, v22, v246
v_mul_f32 v23, v23, v246
v_cvt_pk_bf16_f32 v0, v0, v1
v_cvt_pk_bf16_f32 v1, v2, v3
v_cvt_pk_bf16_f32 v2, v20, v21
v_cvt_pk_bf16_f32 v3, v22, v23
ds_write_b128 v252, v[0:3] offset:0
v_mul_f32 v40, v40, v246
v_mul_f32 v41, v41, v246
v_mul_f32 v42, v42, v246
v_mul_f32 v43, v43, v246
v_mul_f32 v60, v60, v246
v_mul_f32 v61, v61, v246
v_mul_f32 v62, v62, v246
v_mul_f32 v63, v63, v246
v_cvt_pk_bf16_f32 v40, v40, v41
v_cvt_pk_bf16_f32 v41, v42, v43
v_cvt_pk_bf16_f32 v42, v60, v61
v_cvt_pk_bf16_f32 v43, v62, v63
ds_write_b128 v252, v[40:43] offset:5120
v_mul_f32 v4, v4, v247
v_mul_f32 v5, v5, v247
v_mul_f32 v6, v6, v247
v_mul_f32 v7, v7, v247
v_mul_f32 v24, v24, v247
v_mul_f32 v25, v25, v247
v_mul_f32 v26, v26, v247
v_mul_f32 v27, v27, v247
v_cvt_pk_bf16_f32 v4, v4, v5
v_cvt_pk_bf16_f32 v5, v6, v7
v_cvt_pk_bf16_f32 v6, v24, v25
v_cvt_pk_bf16_f32 v7, v26, v27
ds_write_b128 v252, v[4:7] offset:1024
v_mul_f32 v44, v44, v247
v_mul_f32 v45, v45, v247
v_mul_f32 v46, v46, v247
v_mul_f32 v47, v47, v247
v_mul_f32 v64, v64, v247
v_mul_f32 v65, v65, v247
v_mul_f32 v66, v66, v247
v_mul_f32 v67, v67, v247
v_cvt_pk_bf16_f32 v44, v44, v45
v_cvt_pk_bf16_f32 v45, v46, v47
v_cvt_pk_bf16_f32 v46, v64, v65
v_cvt_pk_bf16_f32 v47, v66, v67
ds_write_b128 v252, v[44:47] offset:6144
v_mul_f32 v8, v8, v248
v_mul_f32 v9, v9, v248
v_mul_f32 v10, v10, v248
v_mul_f32 v11, v11, v248
v_mul_f32 v28, v28, v248
v_mul_f32 v29, v29, v248
v_mul_f32 v30, v30, v248
v_mul_f32 v31, v31, v248
v_cvt_pk_bf16_f32 v8, v8, v9
v_cvt_pk_bf16_f32 v9, v10, v11
v_cvt_pk_bf16_f32 v10, v28, v29
v_cvt_pk_bf16_f32 v11, v30, v31
ds_write_b128 v252, v[8:11] offset:2048
v_mul_f32 v48, v48, v248
v_mul_f32 v49, v49, v248
v_mul_f32 v50, v50, v248
v_mul_f32 v51, v51, v248
v_mul_f32 v68, v68, v248
v_mul_f32 v69, v69, v248
v_mul_f32 v70, v70, v248
v_mul_f32 v71, v71, v248
v_cvt_pk_bf16_f32 v48, v48, v49
v_cvt_pk_bf16_f32 v49, v50, v51
v_cvt_pk_bf16_f32 v50, v68, v69
v_cvt_pk_bf16_f32 v51, v70, v71
ds_write_b128 v252, v[48:51] offset:7168
v_mul_f32 v12, v12, v249
v_mul_f32 v13, v13, v249
v_mul_f32 v14, v14, v249
v_mul_f32 v15, v15, v249
v_mul_f32 v32, v32, v249
v_mul_f32 v33, v33, v249
v_mul_f32 v34, v34, v249
v_mul_f32 v35, v35, v249
v_cvt_pk_bf16_f32 v12, v12, v13
v_cvt_pk_bf16_f32 v13, v14, v15
v_cvt_pk_bf16_f32 v14, v32, v33
v_cvt_pk_bf16_f32 v15, v34, v35
ds_write_b128 v252, v[12:15] offset:3072
v_mul_f32 v52, v52, v249
v_mul_f32 v53, v53, v249
v_mul_f32 v54, v54, v249
v_mul_f32 v55, v55, v249
v_mul_f32 v72, v72, v249
v_mul_f32 v73, v73, v249
v_mul_f32 v74, v74, v249
v_mul_f32 v75, v75, v249
v_cvt_pk_bf16_f32 v52, v52, v53
v_cvt_pk_bf16_f32 v53, v54, v55
v_cvt_pk_bf16_f32 v54, v72, v73
v_cvt_pk_bf16_f32 v55, v74, v75
ds_write_b128 v252, v[52:55] offset:8192
v_mul_f32 v16, v16, v250
v_mul_f32 v17, v17, v250
v_mul_f32 v18, v18, v250
v_mul_f32 v19, v19, v250
v_mul_f32 v36, v36, v250
v_mul_f32 v37, v37, v250
v_mul_f32 v38, v38, v250
v_mul_f32 v39, v39, v250
v_cvt_pk_bf16_f32 v16, v16, v17
v_cvt_pk_bf16_f32 v17, v18, v19
v_cvt_pk_bf16_f32 v18, v36, v37
v_cvt_pk_bf16_f32 v19, v38, v39
ds_write_b128 v252, v[16:19] offset:4096
v_mul_f32 v56, v56, v250
v_mul_f32 v57, v57, v250
v_mul_f32 v58, v58, v250
v_mul_f32 v59, v59, v250
v_mul_f32 v76, v76, v250
v_mul_f32 v77, v77, v250
v_mul_f32 v78, v78, v250
v_mul_f32 v79, v79, v250
v_cvt_pk_bf16_f32 v56, v56, v57
v_cvt_pk_bf16_f32 v57, v58, v59
v_cvt_pk_bf16_f32 v58, v76, v77
v_cvt_pk_bf16_f32 v59, v78, v79
ds_write_b128 v252, v[56:59] offset:9216
s_waitcnt lgkmcnt(0)
s_barrier
ds_read_b128 v[160:163], v242 offset:0
ds_read_b128 v[164:167], v242 offset:1024
ds_read_b128 v[168:171], v242 offset:2048
ds_read_b128 v[172:175], v242 offset:3072
ds_read_b128 v[176:179], v242 offset:4096
ds_read_b128 v[180:183], v242 offset:5120
ds_read_b128 v[184:187], v242 offset:6144
ds_read_b128 v[188:191], v242 offset:7168
ds_read_b128 v[192:195], v242 offset:8192
ds_read_b128 v[196:199], v242 offset:9216
s_waitcnt lgkmcnt(9)
v_mfma_f32_16x16x32_bf16 v[0:3], v[200:203], v[160:163], 0
v_mfma_f32_16x16x32_bf16 v[20:23], v[204:207], v[160:163], 0
s_waitcnt vmcnt(6)
ds_read_b64_tr_b16 v[216:217], v236 offset:4096
ds_read_b64_tr_b16 v[220:221], v237 offset:4096
ds_read_b64_tr_b16 v[224:225], v238 offset:4096
ds_read_b64_tr_b16 v[228:229], v239 offset:4096
v_mfma_f32_16x16x32_bf16 v[40:43], v[208:211], v[160:163], 0
v_mfma_f32_16x16x32_bf16 v[60:63], v[212:215], v[160:163], 0
ds_read_b128 v[160:163], v242 offset:10240
s_waitcnt lgkmcnt(13)
v_mfma_f32_16x16x32_bf16 v[4:7], v[200:203], v[164:167], 0
v_mfma_f32_16x16x32_bf16 v[24:27], v[204:207], v[164:167], 0
v_mfma_f32_16x16x32_bf16 v[44:47], v[208:211], v[164:167], 0
s_waitcnt lgkmcnt(1)
s_mov_b32 m0, s5
s_add_u32 s9, s77, 28672
buffer_load_dwordx4 v234, s[32:35], s9 offen lds
s_add_u32 s8, s77, 34816
buffer_load_dwordx4 v234, s[32:35], s8 offen offset:1024 lds
v_mfma_f32_16x16x32_bf16 v[64:67], v[212:215], v[164:167], 0
ds_read_b128 v[164:167], v242 offset:11264
v_mfma_f32_16x16x32_bf16 v[8:11], v[200:203], v[168:171], 0
s_waitcnt vmcnt(6)
ds_read_b64_tr_b16 v[218:219], v236 offset:6144
ds_read_b64_tr_b16 v[222:223], v237 offset:6144
ds_read_b64_tr_b16 v[226:227], v238 offset:6144
ds_read_b64_tr_b16 v[230:231], v239 offset:6144
v_mfma_f32_16x16x32_bf16 v[28:31], v[204:207], v[168:171], 0
v_mfma_f32_16x16x32_bf16 v[48:51], v[208:211], v[168:171], 0
v_mfma_f32_16x16x32_bf16 v[68:71], v[212:215], v[168:171], 0
ds_read_b128 v[168:171], v242 offset:12288
v_mfma_f32_16x16x32_bf16 v[12:15], v[200:203], v[172:175], 0
v_mfma_f32_16x16x32_bf16 v[32:35], v[204:207], v[172:175], 0
s_waitcnt lgkmcnt(1)
s_mov_b32 m0, s5
s_add_u32 s9, s77, 40960
buffer_load_dwordx4 v234, s[32:35], s9 offen offset:2048 lds
s_add_u32 s8, s77, 47104
buffer_load_dwordx4 v234, s[32:35], s8 offen offset:3072 lds
v_mfma_f32_16x16x32_bf16 v[52:55], v[208:211], v[172:175], 0
v_mfma_f32_16x16x32_bf16 v[72:75], v[212:215], v[172:175], 0
v_lshrrev_b32 v251, 3, v235
v_bfe_u32 v252, v235, 2, 1
v_xor_b32 v251, v251, v252
v_mul_u32_u24 v251, 896, v251
v_and_b32 v252, 7, v235
v_lshl_add_u32 v251, v252, 4, v251
s_mov_b32 s9, 0
buffer_load_dwordx4 v[80:83], v251, s[40:43], s9 offen
s_mov_b32 s8, 7168
buffer_load_dwordx4 v[84:87], v251, s[40:43], s8 offen
ds_read_b128 v[172:175], v242 offset:13312
v_mfma_f32_16x16x32_bf16 v[16:19], v[200:203], v[176:179], 0
v_mfma_f32_16x16x32_bf16 v[36:39], v[204:207], v[176:179], 0
v_mfma_f32_16x16x32_bf16 v[56:59], v[208:211], v[176:179], 0
v_mfma_f32_16x16x32_bf16 v[76:79], v[212:215], v[176:179], 0
ds_read_b128 v[176:179], v242 offset:14336
v_mfma_f32_16x16x32_bf16 v[0:3], v[216:219], v[180:183], v[0:3]
v_mfma_f32_16x16x32_bf16 v[20:23], v[220:223], v[180:183], v[20:23]
s_waitcnt vmcnt(8)
ds_read_b64_tr_b16 v[200:201], v236 offset:0
ds_read_b64_tr_b16 v[204:205], v237 offset:0
ds_read_b64_tr_b16 v[208:209], v238 offset:0
ds_read_b64_tr_b16 v[212:213], v239 offset:0
v_mfma_f32_16x16x32_bf16 v[40:43], v[224:227], v[180:183], v[40:43]
v_mfma_f32_16x16x32_bf16 v[60:63], v[228:231], v[180:183], v[60:63]
ds_read_b128 v[180:183], v242 offset:15360
v_mfma_f32_16x16x32_bf16 v[4:7], v[216:219], v[184:187], v[4:7]
v_mfma_f32_16x16x32_bf16 v[24:27], v[220:223], v[184:187], v[24:27]
v_mfma_f32_16x16x32_bf16 v[44:47], v[224:227], v[184:187], v[44:47]
s_waitcnt lgkmcnt(1)
s_mov_b32 m0, s4
s_add_u32 s9, s78, 0
buffer_load_dwordx4 v234, s[32:35], s9 offen lds
s_add_u32 s8, s78, 6144
buffer_load_dwordx4 v234, s[32:35], s8 offen offset:1024 lds
v_mfma_f32_16x16x32_bf16 v[64:67], v[228:231], v[184:187], v[64:67]
ds_read_b128 v[184:187], v242 offset:16384
v_mfma_f32_16x16x32_bf16 v[8:11], v[216:219], v[188:191], v[8:11]
s_waitcnt vmcnt(8)
ds_read_b64_tr_b16 v[202:203], v236 offset:2048
ds_read_b64_tr_b16 v[206:207], v237 offset:2048
ds_read_b64_tr_b16 v[210:211], v238 offset:2048
ds_read_b64_tr_b16 v[214:215], v239 offset:2048
v_mfma_f32_16x16x32_bf16 v[28:31], v[220:223], v[188:191], v[28:31]
v_mfma_f32_16x16x32_bf16 v[48:51], v[224:227], v[188:191], v[48:51]
v_mfma_f32_16x16x32_bf16 v[68:71], v[228:231], v[188:191], v[68:71]
ds_read_b128 v[188:191], v242 offset:17408
v_mfma_f32_16x16x32_bf16 v[12:15], v[216:219], v[192:195], v[12:15]
v_mfma_f32_16x16x32_bf16 v[32:35], v[220:223], v[192:195], v[32:35]
s_waitcnt lgkmcnt(1)
s_mov_b32 m0, s4
s_add_u32 s9, s78, 12288
buffer_load_dwordx4 v234, s[32:35], s9 offen offset:2048 lds
s_add_u32 s8, s78, 18432
buffer_load_dwordx4 v234, s[32:35], s8 offen offset:3072 lds
v_mfma_f32_16x16x32_bf16 v[52:55], v[224:227], v[192:195], v[52:55]
v_mfma_f32_16x16x32_bf16 v[72:75], v[228:231], v[192:195], v[72:75]
ds_read_b128 v[192:195], v242 offset:18432
v_mfma_f32_16x16x32_bf16 v[16:19], v[216:219], v[196:199], v[16:19]
v_mfma_f32_16x16x32_bf16 v[36:39], v[220:223], v[196:199], v[36:39]
v_mfma_f32_16x16x32_bf16 v[56:59], v[224:227], v[196:199], v[56:59]
v_mfma_f32_16x16x32_bf16 v[76:79], v[228:231], v[196:199], v[76:79]
ds_read_b128 v[196:199], v242 offset:19456
v_mfma_f32_16x16x32_bf16 v[0:3], v[200:203], v[160:163], v[0:3]
v_mfma_f32_16x16x32_bf16 v[20:23], v[204:207], v[160:163], v[20:23]
s_waitcnt vmcnt(8)
ds_read_b64_tr_b16 v[216:217], v236 offset:4096
ds_read_b64_tr_b16 v[220:221], v237 offset:4096
ds_read_b64_tr_b16 v[224:225], v238 offset:4096
ds_read_b64_tr_b16 v[228:229], v239 offset:4096
v_mfma_f32_16x16x32_bf16 v[40:43], v[208:211], v[160:163], v[40:43]
v_mfma_f32_16x16x32_bf16 v[60:63], v[212:215], v[160:163], v[60:63]
ds_read_b128 v[160:163], v242 offset:20480
v_mfma_f32_16x16x32_bf16 v[4:7], v[200:203], v[164:167], v[4:7]
v_mfma_f32_16x16x32_bf16 v[24:27], v[204:207], v[164:167], v[24:27]
v_mfma_f32_16x16x32_bf16 v[44:47], v[208:211], v[164:167], v[44:47]
s_waitcnt lgkmcnt(1)
s_mov_b32 m0, s5
s_add_u32 s9, s78, 28672
buffer_load_dwordx4 v234, s[32:35], s9 offen lds
s_add_u32 s8, s78, 34816
buffer_load_dwordx4 v234, s[32:35], s8 offen offset:1024 lds
v_mfma_f32_16x16x32_bf16 v[64:67], v[212:215], v[164:167], v[64:67]
ds_read_b128 v[164:167], v242 offset:21504
v_mfma_f32_16x16x32_bf16 v[8:11], v[200:203], v[168:171], v[8:11]
s_waitcnt vmcnt(8)
ds_read_b64_tr_b16 v[218:219], v236 offset:6144
ds_read_b64_tr_b16 v[222:223], v237 offset:6144
ds_read_b64_tr_b16 v[226:227], v238 offset:6144
ds_read_b64_tr_b16 v[230:231], v239 offset:6144
v_mfma_f32_16x16x32_bf16 v[28:31], v[204:207], v[168:171], v[28:31]
v_mfma_f32_16x16x32_bf16 v[48:51], v[208:211], v[168:171], v[48:51]
v_mfma_f32_16x16x32_bf16 v[68:71], v[212:215], v[168:171], v[68:71]
ds_read_b128 v[168:171], v242 offset:22528
v_mfma_f32_16x16x32_bf16 v[12:15], v[200:203], v[172:175], v[12:15]
v_mfma_f32_16x16x32_bf16 v[32:35], v[204:207], v[172:175], v[32:35]
s_waitcnt lgkmcnt(1)
s_mov_b32 m0, s5
s_add_u32 s9, s78, 40960
buffer_load_dwordx4 v234, s[32:35], s9 offen offset:2048 lds
s_add_u32 s8, s78, 47104
buffer_load_dwordx4 v234, s[32:35], s8 offen offset:3072 lds
v_mfma_f32_16x16x32_bf16 v[52:55], v[208:211], v[172:175], v[52:55]
v_mfma_f32_16x16x32_bf16 v[72:75], v[212:215], v[172:175], v[72:75]
v_lshrrev_b32 v251, 3, v235
v_bfe_u32 v252, v235, 2, 1
v_xor_b32 v251, v251, v252
v_mul_u32_u24 v251, 896, v251
v_and_b32 v252, 7, v235
v_lshl_add_u32 v251, v252, 4, v251
s_mov_b32 s9, 14336
buffer_load_dwordx4 v[88:91], v251, s[40:43], s9 offen
s_mov_b32 s8, 21504
buffer_load_dwordx4 v[92:95], v251, s[40:43], s8 offen
ds_read_b128 v[172:175], v242 offset:23552
v_mfma_f32_16x16x32_bf16 v[16:19], v[200:203], v[176:179], v[16:19]
v_mfma_f32_16x16x32_bf16 v[36:39], v[204:207], v[176:179], v[36:39]
v_mfma_f32_16x16x32_bf16 v[56:59], v[208:211], v[176:179], v[56:59]
v_mfma_f32_16x16x32_bf16 v[76:79], v[212:215], v[176:179], v[76:79]
ds_read_b128 v[176:179], v242 offset:24576
v_mfma_f32_16x16x32_bf16 v[0:3], v[216:219], v[180:183], v[0:3]
v_mfma_f32_16x16x32_bf16 v[20:23], v[220:223], v[180:183], v[20:23]
s_waitcnt vmcnt(8)
ds_read_b64_tr_b16 v[200:201], v236 offset:0
ds_read_b64_tr_b16 v[204:205], v237 offset:0
ds_read_b64_tr_b16 v[208:209], v238 offset:0
ds_read_b64_tr_b16 v[212:213], v239 offset:0
v_mfma_f32_16x16x32_bf16 v[40:43], v[224:227], v[180:183], v[40:43]
v_mfma_f32_16x16x32_bf16 v[60:63], v[228:231], v[180:183], v[60:63]
ds_read_b128 v[180:183], v242 offset:25600
v_mfma_f32_16x16x32_bf16 v[4:7], v[216:219], v[184:187], v[4:7]
v_mfma_f32_16x16x32_bf16 v[24:27], v[220:223], v[184:187], v[24:27]
v_mfma_f32_16x16x32_bf16 v[44:47], v[224:227], v[184:187], v[44:47]
s_waitcnt lgkmcnt(1)
s_mov_b32 m0, s4
s_add_u32 s9, s79, 0
buffer_load_dwordx4 v234, s[32:35], s9 offen lds
s_add_u32 s8, s79, 6144
buffer_load_dwordx4 v234, s[32:35], s8 offen offset:1024 lds
v_mfma_f32_16x16x32_bf16 v[64:67], v[228:231], v[184:187], v[64:67]
ds_read_b128 v[184:187], v242 offset:26624
v_mfma_f32_16x16x32_bf16 v[8:11], v[216:219], v[188:191], v[8:11]
s_waitcnt vmcnt(8)
ds_read_b64_tr_b16 v[202:203], v236 offset:2048
ds_read_b64_tr_b16 v[206:207], v237 offset:2048
ds_read_b64_tr_b16 v[210:211], v238 offset:2048
ds_read_b64_tr_b16 v[214:215], v239 offset:2048
v_mfma_f32_16x16x32_bf16 v[28:31], v[220:223], v[188:191], v[28:31]
v_mfma_f32_16x16x32_bf16 v[48:51], v[224:227], v[188:191], v[48:51]
v_mfma_f32_16x16x32_bf16 v[68:71], v[228:231], v[188:191], v[68:71]
ds_read_b128 v[188:191], v242 offset:27648
v_mfma_f32_16x16x32_bf16 v[12:15], v[216:219], v[192:195], v[12:15]
v_mfma_f32_16x16x32_bf16 v[32:35], v[220:223], v[192:195], v[32:35]
s_waitcnt lgkmcnt(1)
s_mov_b32 m0, s4
s_add_u32 s9, s79, 12288
buffer_load_dwordx4 v234, s[32:35], s9 offen offset:2048 lds
s_add_u32 s8, s79, 18432
buffer_load_dwordx4 v234, s[32:35], s8 offen offset:3072 lds
v_mfma_f32_16x16x32_bf16 v[52:55], v[224:227], v[192:195], v[52:55]
v_mfma_f32_16x16x32_bf16 v[72:75], v[228:231], v[192:195], v[72:75]
ds_read_b128 v[192:195], v242 offset:28672
v_mfma_f32_16x16x32_bf16 v[16:19], v[216:219], v[196:199], v[16:19]
v_mfma_f32_16x16x32_bf16 v[36:39], v[220:223], v[196:199], v[36:39]
v_mfma_f32_16x16x32_bf16 v[56:59], v[224:227], v[196:199], v[56:59]
v_mfma_f32_16x16x32_bf16 v[76:79], v[228:231], v[196:199], v[76:79]
ds_read_b128 v[196:199], v242 offset:29696
v_mfma_f32_16x16x32_bf16 v[0:3], v[200:203], v[160:163], v[0:3]
v_mfma_f32_16x16x32_bf16 v[20:23], v[204:207], v[160:163], v[20:23]
s_waitcnt vmcnt(8)
ds_read_b64_tr_b16 v[216:217], v236 offset:4096
ds_read_b64_tr_b16 v[220:221], v237 offset:4096
ds_read_b64_tr_b16 v[224:225], v238 offset:4096
ds_read_b64_tr_b16 v[228:229], v239 offset:4096
v_mfma_f32_16x16x32_bf16 v[40:43], v[208:211], v[160:163], v[40:43]
v_mfma_f32_16x16x32_bf16 v[60:63], v[212:215], v[160:163], v[60:63]
ds_read_b128 v[160:163], v242 offset:30720
v_mfma_f32_16x16x32_bf16 v[4:7], v[200:203], v[164:167], v[4:7]
v_mfma_f32_16x16x32_bf16 v[24:27], v[204:207], v[164:167], v[24:27]
v_mfma_f32_16x16x32_bf16 v[44:47], v[208:211], v[164:167], v[44:47]
s_waitcnt lgkmcnt(1)
s_mov_b32 m0, s5
s_add_u32 s9, s79, 28672
buffer_load_dwordx4 v234, s[32:35], s9 offen lds
s_add_u32 s8, s79, 34816
buffer_load_dwordx4 v234, s[32:35], s8 offen offset:1024 lds
v_mfma_f32_16x16x32_bf16 v[64:67], v[212:215], v[164:167], v[64:67]
ds_read_b128 v[164:167], v242 offset:31744
v_mfma_f32_16x16x32_bf16 v[8:11], v[200:203], v[168:171], v[8:11]
s_waitcnt vmcnt(8)
ds_read_b64_tr_b16 v[218:219], v236 offset:6144
ds_read_b64_tr_b16 v[222:223], v237 offset:6144
ds_read_b64_tr_b16 v[226:227], v238 offset:6144
ds_read_b64_tr_b16 v[230:231], v239 offset:6144
v_mfma_f32_16x16x32_bf16 v[28:31], v[204:207], v[168:171], v[28:31]
v_mfma_f32_16x16x32_bf16 v[48:51], v[208:211], v[168:171], v[48:51]
v_mfma_f32_16x16x32_bf16 v[68:71], v[212:215], v[168:171], v[68:71]
ds_read_b128 v[168:171], v242 offset:32768
v_mfma_f32_16x16x32_bf16 v[12:15], v[200:203], v[172:175], v[12:15]
v_mfma_f32_16x16x32_bf16 v[32:35], v[204:207], v[172:175], v[32:35]
s_waitcnt lgkmcnt(1)
s_mov_b32 m0, s5
s_add_u32 s9, s79, 40960
buffer_load_dwordx4 v234, s[32:35], s9 offen offset:2048 lds
s_add_u32 s8, s79, 47104
buffer_load_dwordx4 v234, s[32:35], s8 offen offset:3072 lds
v_mfma_f32_16x16x32_bf16 v[52:55], v[208:211], v[172:175], v[52:55]
v_mfma_f32_16x16x32_bf16 v[72:75], v[212:215], v[172:175], v[72:75]
v_lshrrev_b32 v251, 3, v235
v_bfe_u32 v252, v235, 2, 1
v_xor_b32 v251, v251, v252
v_mul_u32_u24 v251, 896, v251
v_and_b32 v252, 7, v235
v_lshl_add_u32 v251, v252, 4, v251
s_mov_b32 s9, 28672
buffer_load_dwordx4 v[96:99], v251, s[40:43], s9 offen
s_mov_b32 s8, 35840
buffer_load_dwordx4 v[100:103], v251, s[40:43], s8 offen
ds_read_b128 v[172:175], v242 offset:33792
v_mfma_f32_16x16x32_bf16 v[16:19], v[200:203], v[176:179], v[16:19]
v_mfma_f32_16x16x32_bf16 v[36:39], v[204:207], v[176:179], v[36:39]
v_mfma_f32_16x16x32_bf16 v[56:59], v[208:211], v[176:179], v[56:59]
v_mfma_f32_16x16x32_bf16 v[76:79], v[212:215], v[176:179], v[76:79]
ds_read_b128 v[176:179], v242 offset:34816
v_mfma_f32_16x16x32_bf16 v[0:3], v[216:219], v[180:183], v[0:3]
v_mfma_f32_16x16x32_bf16 v[20:23], v[220:223], v[180:183], v[20:23]
s_waitcnt vmcnt(8)
ds_read_b64_tr_b16 v[200:201], v236 offset:0
ds_read_b64_tr_b16 v[204:205], v237 offset:0
ds_read_b64_tr_b16 v[208:209], v238 offset:0
ds_read_b64_tr_b16 v[212:213], v239 offset:0
v_mfma_f32_16x16x32_bf16 v[40:43], v[224:227], v[180:183], v[40:43]
v_mfma_f32_16x16x32_bf16 v[60:63], v[228:231], v[180:183], v[60:63]
ds_read_b128 v[180:183], v242 offset:35840
v_mfma_f32_16x16x32_bf16 v[4:7], v[216:219], v[184:187], v[4:7]
v_mfma_f32_16x16x32_bf16 v[24:27], v[220:223], v[184:187], v[24:27]
v_mfma_f32_16x16x32_bf16 v[44:47], v[224:227], v[184:187], v[44:47]
s_waitcnt lgkmcnt(1)
s_mov_b32 m0, s4
s_add_u32 s9, s80, 0
buffer_load_dwordx4 v234, s[32:35], s9 offen lds
s_add_u32 s8, s80, 6144
buffer_load_dwordx4 v234, s[32:35], s8 offen offset:1024 lds
v_mfma_f32_16x16x32_bf16 v[64:67], v[228:231], v[184:187], v[64:67]
ds_read_b128 v[184:187], v242 offset:36864
v_mfma_f32_16x16x32_bf16 v[8:11], v[216:219], v[188:191], v[8:11]
s_waitcnt vmcnt(8)
ds_read_b64_tr_b16 v[202:203], v236 offset:2048
ds_read_b64_tr_b16 v[206:207], v237 offset:2048
ds_read_b64_tr_b16 v[210:211], v238 offset:2048
ds_read_b64_tr_b16 v[214:215], v239 offset:2048
v_mfma_f32_16x16x32_bf16 v[28:31], v[220:223], v[188:191], v[28:31]
v_mfma_f32_16x16x32_bf16 v[48:51], v[224:227], v[188:191], v[48:51]
v_mfma_f32_16x16x32_bf16 v[68:71], v[228:231], v[188:191], v[68:71]
ds_read_b128 v[188:191], v242 offset:37888
v_mfma_f32_16x16x32_bf16 v[12:15], v[216:219], v[192:195], v[12:15]
v_mfma_f32_16x16x32_bf16 v[32:35], v[220:223], v[192:195], v[32:35]
s_waitcnt lgkmcnt(1)
s_mov_b32 m0, s4
s_add_u32 s9, s80, 12288
buffer_load_dwordx4 v234, s[32:35], s9 offen offset:2048 lds
s_add_u32 s8, s80, 18432
buffer_load_dwordx4 v234, s[32:35], s8 offen offset:3072 lds
v_mfma_f32_16x16x32_bf16 v[52:55], v[224:227], v[192:195], v[52:55]
v_mfma_f32_16x16x32_bf16 v[72:75], v[228:231], v[192:195], v[72:75]
ds_read_b128 v[192:195], v242 offset:38912
v_mfma_f32_16x16x32_bf16 v[16:19], v[216:219], v[196:199], v[16:19]
v_mfma_f32_16x16x32_bf16 v[36:39], v[220:223], v[196:199], v[36:39]
v_mfma_f32_16x16x32_bf16 v[56:59], v[224:227], v[196:199], v[56:59]
v_mfma_f32_16x16x32_bf16 v[76:79], v[228:231], v[196:199], v[76:79]
ds_read_b128 v[196:199], v242 offset:39936
v_mfma_f32_16x16x32_bf16 v[0:3], v[200:203], v[160:163], v[0:3]
v_mfma_f32_16x16x32_bf16 v[20:23], v[204:207], v[160:163], v[20:23]
s_waitcnt vmcnt(8)
ds_read_b64_tr_b16 v[216:217], v236 offset:4096
ds_read_b64_tr_b16 v[220:221], v237 offset:4096
ds_read_b64_tr_b16 v[224:225], v238 offset:4096
ds_read_b64_tr_b16 v[228:229], v239 offset:4096
v_mfma_f32_16x16x32_bf16 v[40:43], v[208:211], v[160:163], v[40:43]
v_mfma_f32_16x16x32_bf16 v[60:63], v[212:215], v[160:163], v[60:63]
ds_read_b128 v[160:163], v243 offset:0
v_mfma_f32_16x16x32_bf16 v[4:7], v[200:203], v[164:167], v[4:7]
v_mfma_f32_16x16x32_bf16 v[24:27], v[204:207], v[164:167], v[24:27]
v_mfma_f32_16x16x32_bf16 v[44:47], v[208:211], v[164:167], v[44:47]
s_waitcnt lgkmcnt(1)
s_mov_b32 m0, s5
s_add_u32 s9, s80, 28672
buffer_load_dwordx4 v234, s[32:35], s9 offen lds
s_add_u32 s8, s80, 34816
buffer_load_dwordx4 v234, s[32:35], s8 offen offset:1024 lds
v_mfma_f32_16x16x32_bf16 v[64:67], v[212:215], v[164:167], v[64:67]
ds_read_b128 v[164:167], v243 offset:1024
v_mfma_f32_16x16x32_bf16 v[8:11], v[200:203], v[168:171], v[8:11]
s_waitcnt vmcnt(8)
ds_read_b64_tr_b16 v[218:219], v236 offset:6144
ds_read_b64_tr_b16 v[222:223], v237 offset:6144
ds_read_b64_tr_b16 v[226:227], v238 offset:6144
ds_read_b64_tr_b16 v[230:231], v239 offset:6144
v_mfma_f32_16x16x32_bf16 v[28:31], v[204:207], v[168:171], v[28:31]
v_mfma_f32_16x16x32_bf16 v[48:51], v[208:211], v[168:171], v[48:51]
v_mfma_f32_16x16x32_bf16 v[68:71], v[212:215], v[168:171], v[68:71]
ds_read_b128 v[168:171], v243 offset:2048
v_mfma_f32_16x16x32_bf16 v[12:15], v[200:203], v[172:175], v[12:15]
v_mfma_f32_16x16x32_bf16 v[32:35], v[204:207], v[172:175], v[32:35]
s_waitcnt lgkmcnt(1)
s_mov_b32 m0, s5
s_add_u32 s9, s80, 40960
buffer_load_dwordx4 v234, s[32:35], s9 offen offset:2048 lds
s_add_u32 s8, s80, 47104
buffer_load_dwordx4 v234, s[32:35], s8 offen offset:3072 lds
v_mfma_f32_16x16x32_bf16 v[52:55], v[208:211], v[172:175], v[52:55]
v_mfma_f32_16x16x32_bf16 v[72:75], v[212:215], v[172:175], v[72:75]
v_lshrrev_b32 v251, 3, v235
v_bfe_u32 v252, v235, 2, 1
v_xor_b32 v251, v251, v252
v_mul_u32_u24 v251, 896, v251
v_and_b32 v252, 7, v235
v_lshl_add_u32 v251, v252, 4, v251
s_mov_b32 s9, 43008
buffer_load_dwordx4 v[104:107], v251, s[40:43], s9 offen
s_mov_b32 s8, 50176
buffer_load_dwordx4 v[108:111], v251, s[40:43], s8 offen
ds_read_b128 v[172:175], v243 offset:3072
v_mfma_f32_16x16x32_bf16 v[16:19], v[200:203], v[176:179], v[16:19]
v_mfma_f32_16x16x32_bf16 v[36:39], v[204:207], v[176:179], v[36:39]
v_mfma_f32_16x16x32_bf16 v[56:59], v[208:211], v[176:179], v[56:59]
v_mfma_f32_16x16x32_bf16 v[76:79], v[212:215], v[176:179], v[76:79]
ds_read_b128 v[176:179], v243 offset:4096
v_mfma_f32_16x16x32_bf16 v[0:3], v[216:219], v[180:183], v[0:3]
v_mfma_f32_16x16x32_bf16 v[20:23], v[220:223], v[180:183], v[20:23]
s_waitcnt vmcnt(8)
ds_read_b64_tr_b16 v[200:201], v236 offset:0
ds_read_b64_tr_b16 v[204:205], v237 offset:0
ds_read_b64_tr_b16 v[208:209], v238 offset:0
ds_read_b64_tr_b16 v[212:213], v239 offset:0
v_mfma_f32_16x16x32_bf16 v[40:43], v[224:227], v[180:183], v[40:43]
v_mfma_f32_16x16x32_bf16 v[60:63], v[228:231], v[180:183], v[60:63]
ds_read_b128 v[180:183], v243 offset:5120
v_mfma_f32_16x16x32_bf16 v[4:7], v[216:219], v[184:187], v[4:7]
v_mfma_f32_16x16x32_bf16 v[24:27], v[220:223], v[184:187], v[24:27]
v_mfma_f32_16x16x32_bf16 v[44:47], v[224:227], v[184:187], v[44:47]
s_waitcnt lgkmcnt(1)
s_mov_b32 m0, s4
s_add_u32 s9, s81, 0
buffer_load_dwordx4 v234, s[32:35], s9 offen lds
s_add_u32 s8, s81, 6144
buffer_load_dwordx4 v234, s[32:35], s8 offen offset:1024 lds
v_mfma_f32_16x16x32_bf16 v[64:67], v[228:231], v[184:187], v[64:67]
ds_read_b128 v[184:187], v243 offset:6144
v_mfma_f32_16x16x32_bf16 v[8:11], v[216:219], v[188:191], v[8:11]
s_waitcnt vmcnt(8)
ds_read_b64_tr_b16 v[202:203], v236 offset:2048
ds_read_b64_tr_b16 v[206:207], v237 offset:2048
ds_read_b64_tr_b16 v[210:211], v238 offset:2048
ds_read_b64_tr_b16 v[214:215], v239 offset:2048
v_mfma_f32_16x16x32_bf16 v[28:31], v[220:223], v[188:191], v[28:31]
v_mfma_f32_16x16x32_bf16 v[48:51], v[224:227], v[188:191], v[48:51]
v_mfma_f32_16x16x32_bf16 v[68:71], v[228:231], v[188:191], v[68:71]
ds_read_b128 v[188:191], v243 offset:7168
v_mfma_f32_16x16x32_bf16 v[12:15], v[216:219], v[192:195], v[12:15]
v_mfma_f32_16x16x32_bf16 v[32:35], v[220:223], v[192:195], v[32:35]
s_waitcnt lgkmcnt(1)
s_mov_b32 m0, s4
s_add_u32 s9, s81, 12288
buffer_load_dwordx4 v234, s[32:35], s9 offen offset:2048 lds
s_add_u32 s8, s81, 18432
buffer_load_dwordx4 v234, s[32:35], s8 offen offset:3072 lds
v_mfma_f32_16x16x32_bf16 v[52:55], v[224:227], v[192:195], v[52:55]
v_mfma_f32_16x16x32_bf16 v[72:75], v[228:231], v[192:195], v[72:75]
ds_read_b128 v[192:195], v243 offset:8192
v_mfma_f32_16x16x32_bf16 v[16:19], v[216:219], v[196:199], v[16:19]
v_mfma_f32_16x16x32_bf16 v[36:39], v[220:223], v[196:199], v[36:39]
v_mfma_f32_16x16x32_bf16 v[56:59], v[224:227], v[196:199], v[56:59]
v_mfma_f32_16x16x32_bf16 v[76:79], v[228:231], v[196:199], v[76:79]
ds_read_b128 v[196:199], v243 offset:9216
v_mfma_f32_16x16x32_bf16 v[0:3], v[200:203], v[160:163], v[0:3]
v_mfma_f32_16x16x32_bf16 v[20:23], v[204:207], v[160:163], v[20:23]
s_waitcnt vmcnt(8)
ds_read_b64_tr_b16 v[216:217], v236 offset:4096
ds_read_b64_tr_b16 v[220:221], v237 offset:4096
ds_read_b64_tr_b16 v[224:225], v238 offset:4096
ds_read_b64_tr_b16 v[228:229], v239 offset:4096
v_mfma_f32_16x16x32_bf16 v[40:43], v[208:211], v[160:163], v[40:43]
v_mfma_f32_16x16x32_bf16 v[60:63], v[212:215], v[160:163], v[60:63]
ds_read_b128 v[160:163], v243 offset:10240
v_mfma_f32_16x16x32_bf16 v[4:7], v[200:203], v[164:167], v[4:7]
v_mfma_f32_16x16x32_bf16 v[24:27], v[204:207], v[164:167], v[24:27]
v_mfma_f32_16x16x32_bf16 v[44:47], v[208:211], v[164:167], v[44:47]
s_waitcnt lgkmcnt(1)
s_mov_b32 m0, s5
s_add_u32 s9, s81, 28672
buffer_load_dwordx4 v234, s[32:35], s9 offen lds
s_add_u32 s8, s81, 34816
buffer_load_dwordx4 v234, s[32:35], s8 offen offset:1024 lds
v_mfma_f32_16x16x32_bf16 v[64:67], v[212:215], v[164:167], v[64:67]
ds_read_b128 v[164:167], v243 offset:11264
v_mfma_f32_16x16x32_bf16 v[8:11], v[200:203], v[168:171], v[8:11]
s_waitcnt vmcnt(8)
ds_read_b64_tr_b16 v[218:219], v236 offset:6144
ds_read_b64_tr_b16 v[222:223], v237 offset:6144
ds_read_b64_tr_b16 v[226:227], v238 offset:6144
ds_read_b64_tr_b16 v[230:231], v239 offset:6144
v_mfma_f32_16x16x32_bf16 v[28:31], v[204:207], v[168:171], v[28:31]
v_mfma_f32_16x16x32_bf16 v[48:51], v[208:211], v[168:171], v[48:51]
v_mfma_f32_16x16x32_bf16 v[68:71], v[212:215], v[168:171], v[68:71]
ds_read_b128 v[168:171], v243 offset:12288
v_mfma_f32_16x16x32_bf16 v[12:15], v[200:203], v[172:175], v[12:15]
v_mfma_f32_16x16x32_bf16 v[32:35], v[204:207], v[172:175], v[32:35]
s_waitcnt lgkmcnt(1)
s_mov_b32 m0, s5
s_add_u32 s9, s81, 40960
buffer_load_dwordx4 v234, s[32:35], s9 offen offset:2048 lds
s_add_u32 s8, s81, 47104
buffer_load_dwordx4 v234, s[32:35], s8 offen offset:3072 lds
v_mfma_f32_16x16x32_bf16 v[52:55], v[208:211], v[172:175], v[52:55]
v_mfma_f32_16x16x32_bf16 v[72:75], v[212:215], v[172:175], v[72:75]
v_lshrrev_b32 v251, 3, v235
v_bfe_u32 v252, v235, 2, 1
v_xor_b32 v251, v251, v252
v_mul_u32_u24 v251, 896, v251
v_and_b32 v252, 7, v235
v_lshl_add_u32 v251, v252, 4, v251
s_mov_b32 s9, 57344
buffer_load_dwordx4 v[112:115], v251, s[40:43], s9 offen
s_mov_b32 s8, 64512
buffer_load_dwordx4 v[116:119], v251, s[40:43], s8 offen
ds_read_b128 v[172:175], v243 offset:13312
v_mfma_f32_16x16x32_bf16 v[16:19], v[200:203], v[176:179], v[16:19]
v_mfma_f32_16x16x32_bf16 v[36:39], v[204:207], v[176:179], v[36:39]
v_mfma_f32_16x16x32_bf16 v[56:59], v[208:211], v[176:179], v[56:59]
v_mfma_f32_16x16x32_bf16 v[76:79], v[212:215], v[176:179], v[76:79]
ds_read_b128 v[176:179], v243 offset:14336
v_mfma_f32_16x16x32_bf16 v[0:3], v[216:219], v[180:183], v[0:3]
v_mfma_f32_16x16x32_bf16 v[20:23], v[220:223], v[180:183], v[20:23]
s_waitcnt vmcnt(8)
ds_read_b64_tr_b16 v[200:201], v236 offset:0
ds_read_b64_tr_b16 v[204:205], v237 offset:0
ds_read_b64_tr_b16 v[208:209], v238 offset:0
ds_read_b64_tr_b16 v[212:213], v239 offset:0
v_mfma_f32_16x16x32_bf16 v[40:43], v[224:227], v[180:183], v[40:43]
v_mfma_f32_16x16x32_bf16 v[60:63], v[228:231], v[180:183], v[60:63]
ds_read_b128 v[180:183], v243 offset:15360
v_mfma_f32_16x16x32_bf16 v[4:7], v[216:219], v[184:187], v[4:7]
v_mfma_f32_16x16x32_bf16 v[24:27], v[220:223], v[184:187], v[24:27]
v_mfma_f32_16x16x32_bf16 v[44:47], v[224:227], v[184:187], v[44:47]
s_waitcnt lgkmcnt(1)
s_mov_b32 m0, s4
s_add_u32 s9, s82, 0
buffer_load_dwordx4 v234, s[32:35], s9 offen lds
s_add_u32 s8, s82, 6144
buffer_load_dwordx4 v234, s[32:35], s8 offen offset:1024 lds
v_mfma_f32_16x16x32_bf16 v[64:67], v[228:231], v[184:187], v[64:67]
ds_read_b128 v[184:187], v243 offset:16384
v_mfma_f32_16x16x32_bf16 v[8:11], v[216:219], v[188:191], v[8:11]
s_waitcnt vmcnt(8)
ds_read_b64_tr_b16 v[202:203], v236 offset:2048
ds_read_b64_tr_b16 v[206:207], v237 offset:2048
ds_read_b64_tr_b16 v[210:211], v238 offset:2048
ds_read_b64_tr_b16 v[214:215], v239 offset:2048
v_mfma_f32_16x16x32_bf16 v[28:31], v[220:223], v[188:191], v[28:31]
v_mfma_f32_16x16x32_bf16 v[48:51], v[224:227], v[188:191], v[48:51]
v_mfma_f32_16x16x32_bf16 v[68:71], v[228:231], v[188:191], v[68:71]
ds_read_b128 v[188:191], v243 offset:17408
v_mfma_f32_16x16x32_bf16 v[12:15], v[216:219], v[192:195], v[12:15]
v_mfma_f32_16x16x32_bf16 v[32:35], v[220:223], v[192:195], v[32:35]
s_waitcnt lgkmcnt(1)
s_mov_b32 m0, s4
s_add_u32 s9, s82, 12288
buffer_load_dwordx4 v234, s[32:35], s9 offen offset:2048 lds
s_add_u32 s8, s82, 18432
buffer_load_dwordx4 v234, s[32:35], s8 offen offset:3072 lds
v_mfma_f32_16x16x32_bf16 v[52:55], v[224:227], v[192:195], v[52:55]
v_mfma_f32_16x16x32_bf16 v[72:75], v[228:231], v[192:195], v[72:75]
ds_read_b128 v[192:195], v243 offset:18432
v_mfma_f32_16x16x32_bf16 v[16:19], v[216:219], v[196:199], v[16:19]
v_mfma_f32_16x16x32_bf16 v[36:39], v[220:223], v[196:199], v[36:39]
v_mfma_f32_16x16x32_bf16 v[56:59], v[224:227], v[196:199], v[56:59]
v_mfma_f32_16x16x32_bf16 v[76:79], v[228:231], v[196:199], v[76:79]
ds_read_b128 v[196:199], v243 offset:19456
v_mfma_f32_16x16x32_bf16 v[0:3], v[200:203], v[160:163], v[0:3]
v_mfma_f32_16x16x32_bf16 v[20:23], v[204:207], v[160:163], v[20:23]
s_waitcnt vmcnt(8)
ds_read_b64_tr_b16 v[216:217], v236 offset:4096
ds_read_b64_tr_b16 v[220:221], v237 offset:4096
ds_read_b64_tr_b16 v[224:225], v238 offset:4096
ds_read_b64_tr_b16 v[228:229], v239 offset:4096
v_mfma_f32_16x16x32_bf16 v[40:43], v[208:211], v[160:163], v[40:43]
v_mfma_f32_16x16x32_bf16 v[60:63], v[212:215], v[160:163], v[60:63]
ds_read_b128 v[160:163], v243 offset:20480
v_mfma_f32_16x16x32_bf16 v[4:7], v[200:203], v[164:167], v[4:7]
v_mfma_f32_16x16x32_bf16 v[24:27], v[204:207], v[164:167], v[24:27]
v_mfma_f32_16x16x32_bf16 v[44:47], v[208:211], v[164:167], v[44:47]
s_waitcnt lgkmcnt(1)
s_mov_b32 m0, s5
s_add_u32 s9, s82, 28672
buffer_load_dwordx4 v234, s[32:35], s9 offen lds
s_add_u32 s8, s82, 34816
buffer_load_dwordx4 v234, s[32:35], s8 offen offset:1024 lds
v_mfma_f32_16x16x32_bf16 v[64:67], v[212:215], v[164:167], v[64:67]
ds_read_b128 v[164:167], v243 offset:21504
v_mfma_f32_16x16x32_bf16 v[8:11], v[200:203], v[168:171], v[8:11]
s_waitcnt vmcnt(8)
ds_read_b64_tr_b16 v[218:219], v236 offset:6144
ds_read_b64_tr_b16 v[222:223], v237 offset:6144
ds_read_b64_tr_b16 v[226:227], v238 offset:6144
ds_read_b64_tr_b16 v[230:231], v239 offset:6144
v_mfma_f32_16x16x32_bf16 v[28:31], v[204:207], v[168:171], v[28:31]
v_mfma_f32_16x16x32_bf16 v[48:51], v[208:211], v[168:171], v[48:51]
v_mfma_f32_16x16x32_bf16 v[68:71], v[212:215], v[168:171], v[68:71]
ds_read_b128 v[168:171], v243 offset:22528
v_mfma_f32_16x16x32_bf16 v[12:15], v[200:203], v[172:175], v[12:15]
v_mfma_f32_16x16x32_bf16 v[32:35], v[204:207], v[172:175], v[32:35]
s_waitcnt lgkmcnt(1)
s_mov_b32 m0, s5
s_add_u32 s9, s82, 40960
buffer_load_dwordx4 v234, s[32:35], s9 offen offset:2048 lds
s_add_u32 s8, s82, 47104
buffer_load_dwordx4 v234, s[32:35], s8 offen offset:3072 lds
v_mfma_f32_16x16x32_bf16 v[52:55], v[208:211], v[172:175], v[52:55]
v_mfma_f32_16x16x32_bf16 v[72:75], v[212:215], v[172:175], v[72:75]
ds_read_b128 v[172:175], v243 offset:23552
v_mfma_f32_16x16x32_bf16 v[16:19], v[200:203], v[176:179], v[16:19]
v_mfma_f32_16x16x32_bf16 v[36:39], v[204:207], v[176:179], v[36:39]
v_mfma_f32_16x16x32_bf16 v[56:59], v[208:211], v[176:179], v[56:59]
v_mfma_f32_16x16x32_bf16 v[76:79], v[212:215], v[176:179], v[76:79]
ds_read_b128 v[176:179], v243 offset:24576
v_mfma_f32_16x16x32_bf16 v[0:3], v[216:219], v[180:183], v[0:3]
v_mfma_f32_16x16x32_bf16 v[20:23], v[220:223], v[180:183], v[20:23]
s_waitcnt vmcnt(6)
ds_read_b64_tr_b16 v[200:201], v236 offset:0
ds_read_b64_tr_b16 v[204:205], v237 offset:0
ds_read_b64_tr_b16 v[208:209], v238 offset:0
ds_read_b64_tr_b16 v[212:213], v239 offset:0
v_mfma_f32_16x16x32_bf16 v[40:43], v[224:227], v[180:183], v[40:43]
v_mfma_f32_16x16x32_bf16 v[60:63], v[228:231], v[180:183], v[60:63]
ds_read_b128 v[180:183], v243 offset:25600
v_mfma_f32_16x16x32_bf16 v[4:7], v[216:219], v[184:187], v[4:7]
v_mfma_f32_16x16x32_bf16 v[24:27], v[220:223], v[184:187], v[24:27]
v_mfma_f32_16x16x32_bf16 v[44:47], v[224:227], v[184:187], v[44:47]
s_waitcnt lgkmcnt(1)
s_mov_b32 m0, s4
s_add_u32 s9, s83, 0
buffer_load_dwordx4 v234, s[32:35], s9 offen lds
s_add_u32 s8, s83, 6144
buffer_load_dwordx4 v234, s[32:35], s8 offen offset:1024 lds
v_mfma_f32_16x16x32_bf16 v[64:67], v[228:231], v[184:187], v[64:67]
ds_read_b128 v[184:187], v243 offset:26624
v_mfma_f32_16x16x32_bf16 v[8:11], v[216:219], v[188:191], v[8:11]
s_waitcnt vmcnt(6)
ds_read_b64_tr_b16 v[202:203], v236 offset:2048
ds_read_b64_tr_b16 v[206:207], v237 offset:2048
ds_read_b64_tr_b16 v[210:211], v238 offset:2048
ds_read_b64_tr_b16 v[214:215], v239 offset:2048
v_mfma_f32_16x16x32_bf16 v[28:31], v[220:223], v[188:191], v[28:31]
v_mfma_f32_16x16x32_bf16 v[48:51], v[224:227], v[188:191], v[48:51]
v_mfma_f32_16x16x32_bf16 v[68:71], v[228:231], v[188:191], v[68:71]
ds_read_b128 v[188:191], v243 offset:27648
v_mfma_f32_16x16x32_bf16 v[12:15], v[216:219], v[192:195], v[12:15]
v_mfma_f32_16x16x32_bf16 v[32:35], v[220:223], v[192:195], v[32:35]
s_waitcnt lgkmcnt(1)
s_mov_b32 m0, s4
s_add_u32 s9, s83, 12288
buffer_load_dwordx4 v234, s[32:35], s9 offen offset:2048 lds
s_add_u32 s8, s83, 18432
buffer_load_dwordx4 v234, s[32:35], s8 offen offset:3072 lds
v_mfma_f32_16x16x32_bf16 v[52:55], v[224:227], v[192:195], v[52:55]
v_mfma_f32_16x16x32_bf16 v[72:75], v[228:231], v[192:195], v[72:75]
ds_read_b128 v[192:195], v243 offset:28672
v_mfma_f32_16x16x32_bf16 v[16:19], v[216:219], v[196:199], v[16:19]
v_mfma_f32_16x16x32_bf16 v[36:39], v[220:223], v[196:199], v[36:39]
v_mfma_f32_16x16x32_bf16 v[56:59], v[224:227], v[196:199], v[56:59]
v_mfma_f32_16x16x32_bf16 v[76:79], v[228:231], v[196:199], v[76:79]
ds_read_b128 v[196:199], v243 offset:29696
v_mfma_f32_16x16x32_bf16 v[0:3], v[200:203], v[160:163], v[0:3]
v_mfma_f32_16x16x32_bf16 v[20:23], v[204:207], v[160:163], v[20:23]
s_waitcnt vmcnt(6)
ds_read_b64_tr_b16 v[216:217], v236 offset:4096
ds_read_b64_tr_b16 v[220:221], v237 offset:4096
ds_read_b64_tr_b16 v[224:225], v238 offset:4096
ds_read_b64_tr_b16 v[228:229], v239 offset:4096
v_mfma_f32_16x16x32_bf16 v[40:43], v[208:211], v[160:163], v[40:43]
v_mfma_f32_16x16x32_bf16 v[60:63], v[212:215], v[160:163], v[60:63]
ds_read_b128 v[160:163], v243 offset:30720
v_mfma_f32_16x16x32_bf16 v[4:7], v[200:203], v[164:167], v[4:7]
v_mfma_f32_16x16x32_bf16 v[24:27], v[204:207], v[164:167], v[24:27]
v_mfma_f32_16x16x32_bf16 v[44:47], v[208:211], v[164:167], v[44:47]
s_waitcnt lgkmcnt(1)
s_mov_b32 m0, s5
s_add_u32 s9, s83, 28672
buffer_load_dwordx4 v234, s[32:35], s9 offen lds
s_add_u32 s8, s83, 34816
buffer_load_dwordx4 v234, s[32:35], s8 offen offset:1024 lds
v_mfma_f32_16x16x32_bf16 v[64:67], v[212:215], v[164:167], v[64:67]
ds_read_b128 v[164:167], v243 offset:31744
v_mfma_f32_16x16x32_bf16 v[8:11], v[200:203], v[168:171], v[8:11]
s_waitcnt vmcnt(6)
ds_read_b64_tr_b16 v[218:219], v236 offset:6144
ds_read_b64_tr_b16 v[222:223], v237 offset:6144
ds_read_b64_tr_b16 v[226:227], v238 offset:6144
ds_read_b64_tr_b16 v[230:231], v239 offset:6144
v_mfma_f32_16x16x32_bf16 v[28:31], v[204:207], v[168:171], v[28:31]
v_mfma_f32_16x16x32_bf16 v[48:51], v[208:211], v[168:171], v[48:51]
v_mfma_f32_16x16x32_bf16 v[68:71], v[212:215], v[168:171], v[68:71]
ds_read_b128 v[168:171], v243 offset:32768
v_mfma_f32_16x16x32_bf16 v[12:15], v[200:203], v[172:175], v[12:15]
v_mfma_f32_16x16x32_bf16 v[32:35], v[204:207], v[172:175], v[32:35]
s_waitcnt lgkmcnt(1)
s_mov_b32 m0, s5
s_add_u32 s9, s83, 40960
buffer_load_dwordx4 v234, s[32:35], s9 offen offset:2048 lds
s_add_u32 s8, s83, 47104
buffer_load_dwordx4 v234, s[32:35], s8 offen offset:3072 lds
v_mfma_f32_16x16x32_bf16 v[52:55], v[208:211], v[172:175], v[52:55]
v_mfma_f32_16x16x32_bf16 v[72:75], v[212:215], v[172:175], v[72:75]
ds_read_b128 v[172:175], v243 offset:33792
v_mfma_f32_16x16x32_bf16 v[16:19], v[200:203], v[176:179], v[16:19]
v_mfma_f32_16x16x32_bf16 v[36:39], v[204:207], v[176:179], v[36:39]
v_mfma_f32_16x16x32_bf16 v[56:59], v[208:211], v[176:179], v[56:59]
v_mfma_f32_16x16x32_bf16 v[76:79], v[212:215], v[176:179], v[76:79]
ds_read_b128 v[176:179], v243 offset:34816
v_mfma_f32_16x16x32_bf16 v[0:3], v[216:219], v[180:183], v[0:3]
v_lshrrev_b32 v251, 3, v235
v_bfe_u32 v252, v235, 2, 1
v_xor_b32 v251, v251, v252
v_and_b32 v253, 3, v235
v_lshl_add_u32 v251, v253, 4, v251
v_lshlrev_b32 v253, 1, v253
v_xor_b32 v251, v251, v253
v_lshlrev_b32 v251, 4, v251
v_mul_u32_u24 v252, 5120, v252
v_add3_u32 v251, v251, v252, s12
v_mfma_f32_16x16x32_bf16 v[20:23], v[220:223], v[180:183], v[20:23]
s_waitcnt vmcnt(6)
ds_read_b64_tr_b16 v[200:201], v236 offset:0
ds_read_b64_tr_b16 v[204:205], v237 offset:0
ds_read_b64_tr_b16 v[208:209], v238 offset:0
ds_read_b64_tr_b16 v[212:213], v239 offset:0
v_mfma_f32_16x16x32_bf16 v[40:43], v[224:227], v[180:183], v[40:43]
v_mfma_f32_16x16x32_bf16 v[60:63], v[228:231], v[180:183], v[60:63]
ds_read_b128 v[180:183], v243 offset:35840
v_mfma_f32_16x16x32_bf16 v[4:7], v[216:219], v[184:187], v[4:7]
v_mfma_f32_16x16x32_bf16 v[24:27], v[220:223], v[184:187], v[24:27]
v_mfma_f32_16x16x32_bf16 v[44:47], v[224:227], v[184:187], v[44:47]
s_waitcnt lgkmcnt(1)
s_mov_b32 m0, s4
s_add_u32 s9, s90, 0
buffer_load_dwordx4 v233, s[44:47], s9 offen lds
s_add_u32 s8, s90, 130048
buffer_load_dwordx4 v233, s[44:47], s8 offen offset:1024 lds
v_mfma_f32_16x16x32_bf16 v[64:67], v[228:231], v[184:187], v[64:67]
ds_read_b128 v[184:187], v243 offset:36864
v_mfma_f32_16x16x32_bf16 v[8:11], v[216:219], v[188:191], v[8:11]
s_waitcnt vmcnt(6)
ds_read_b64_tr_b16 v[202:203], v236 offset:2048
ds_read_b64_tr_b16 v[206:207], v237 offset:2048
ds_read_b64_tr_b16 v[210:211], v238 offset:2048
ds_read_b64_tr_b16 v[214:215], v239 offset:2048
v_mfma_f32_16x16x32_bf16 v[28:31], v[220:223], v[188:191], v[28:31]
v_mfma_f32_16x16x32_bf16 v[48:51], v[224:227], v[188:191], v[48:51]
v_mfma_f32_16x16x32_bf16 v[68:71], v[228:231], v[188:191], v[68:71]
ds_read_b128 v[188:191], v243 offset:37888
v_mfma_f32_16x16x32_bf16 v[12:15], v[216:219], v[192:195], v[12:15]
v_mfma_f32_16x16x32_bf16 v[32:35], v[220:223], v[192:195], v[32:35]
s_waitcnt lgkmcnt(1)
s_mov_b32 m0, s4
s_add_u32 s9, s90, 30720
buffer_load_dwordx4 v233, s[44:47], s9 offen offset:2048 lds
s_add_u32 s8, s90, 160768
buffer_load_dwordx4 v233, s[44:47], s8 offen offset:3072 lds
v_mfma_f32_16x16x32_bf16 v[52:55], v[224:227], v[192:195], v[52:55]
v_mfma_f32_16x16x32_bf16 v[72:75], v[228:231], v[192:195], v[72:75]
ds_read_b128 v[192:195], v243 offset:38912
v_mfma_f32_16x16x32_bf16 v[16:19], v[216:219], v[196:199], v[16:19]
v_mfma_f32_16x16x32_bf16 v[36:39], v[220:223], v[196:199], v[36:39]
v_mfma_f32_16x16x32_bf16 v[56:59], v[224:227], v[196:199], v[56:59]
v_mfma_f32_16x16x32_bf16 v[76:79], v[228:231], v[196:199], v[76:79]
ds_read_b128 v[196:199], v243 offset:39936
v_mfma_f32_16x16x32_bf16 v[0:3], v[200:203], v[160:163], v[0:3]
v_mfma_f32_16x16x32_bf16 v[20:23], v[204:207], v[160:163], v[20:23]
s_waitcnt vmcnt(6)
ds_read_b64_tr_b16 v[216:217], v236 offset:4096
ds_read_b64_tr_b16 v[220:221], v237 offset:4096
ds_read_b64_tr_b16 v[224:225], v238 offset:4096
ds_read_b64_tr_b16 v[228:229], v239 offset:4096
v_mfma_f32_16x16x32_bf16 v[40:43], v[208:211], v[160:163], v[40:43]
v_mfma_f32_16x16x32_bf16 v[60:63], v[212:215], v[160:163], v[60:63]
v_mfma_f32_16x16x32_bf16 v[4:7], v[200:203], v[164:167], v[4:7]
v_mfma_f32_16x16x32_bf16 v[24:27], v[204:207], v[164:167], v[24:27]
v_mfma_f32_16x16x32_bf16 v[44:47], v[208:211], v[164:167], v[44:47]
s_waitcnt lgkmcnt(0)
s_mov_b32 m0, s5
s_add_u32 s9, s90, 262144
buffer_load_dwordx4 v233, s[44:47], s9 offen lds
s_add_u32 s8, s90, 392192
buffer_load_dwordx4 v233, s[44:47], s8 offen offset:1024 lds
v_mfma_f32_16x16x32_bf16 v[64:67], v[212:215], v[164:167], v[64:67]
v_mfma_f32_16x16x32_bf16 v[8:11], v[200:203], v[168:171], v[8:11]
s_waitcnt vmcnt(6)
ds_read_b64_tr_b16 v[218:219], v236 offset:6144
ds_read_b64_tr_b16 v[222:223], v237 offset:6144
ds_read_b64_tr_b16 v[226:227], v238 offset:6144
ds_read_b64_tr_b16 v[230:231], v239 offset:6144
v_mfma_f32_16x16x32_bf16 v[28:31], v[204:207], v[168:171], v[28:31]
v_mfma_f32_16x16x32_bf16 v[48:51], v[208:211], v[168:171], v[48:51]
s_barrier
ds_write_b128 v251, v[80:83] offset:0
v_mfma_f32_16x16x32_bf16 v[68:71], v[212:215], v[168:171], v[68:71]
ds_write_b128 v251, v[84:87] offset:128
v_mfma_f32_16x16x32_bf16 v[12:15], v[200:203], v[172:175], v[12:15]
ds_write_b128 v251, v[88:91] offset:1024
v_mfma_f32_16x16x32_bf16 v[32:35], v[204:207], v[172:175], v[32:35]
ds_write_b128 v251, v[92:95] offset:1152
s_waitcnt lgkmcnt(4)
s_mov_b32 m0, s5
s_add_u32 s9, s90, 292864
buffer_load_dwordx4 v233, s[44:47], s9 offen offset:2048 lds
s_add_u32 s8, s90, 422912
buffer_load_dwordx4 v233, s[44:47], s8 offen offset:3072 lds
v_mfma_f32_16x16x32_bf16 v[52:55], v[208:211], v[172:175], v[52:55]
ds_write_b128 v251, v[96:99] offset:2048
v_mfma_f32_16x16x32_bf16 v[72:75], v[212:215], v[172:175], v[72:75]
ds_write_b128 v251, v[100:103] offset:2176
v_mfma_f32_16x16x32_bf16 v[16:19], v[200:203], v[176:179], v[16:19]
ds_write_b128 v251, v[104:107] offset:3072
v_mfma_f32_16x16x32_bf16 v[36:39], v[204:207], v[176:179], v[36:39]
ds_write_b128 v251, v[108:111] offset:3200
v_mfma_f32_16x16x32_bf16 v[56:59], v[208:211], v[176:179], v[56:59]
ds_write_b128 v251, v[112:115] offset:4096
v_mfma_f32_16x16x32_bf16 v[76:79], v[212:215], v[176:179], v[76:79]
ds_write_b128 v251, v[116:119] offset:4224
v_mfma_f32_16x16x32_bf16 v[0:3], v[216:219], v[180:183], v[0:3]
v_mfma_f32_16x16x32_bf16 v[20:23], v[220:223], v[180:183], v[20:23]
s_waitcnt vmcnt(6)
ds_read_b64_tr_b16 v[200:201], v236 offset:0
ds_read_b64_tr_b16 v[204:205], v237 offset:0
ds_read_b64_tr_b16 v[208:209], v238 offset:0
ds_read_b64_tr_b16 v[212:213], v239 offset:0
v_mfma_f32_16x16x32_bf16 v[40:43], v[224:227], v[180:183], v[40:43]
v_mfma_f32_16x16x32_bf16 v[60:63], v[228:231], v[180:183], v[60:63]
v_mfma_f32_16x16x32_bf16 v[4:7], v[216:219], v[184:187], v[4:7]
v_mfma_f32_16x16x32_bf16 v[24:27], v[220:223], v[184:187], v[24:27]
v_mfma_f32_16x16x32_bf16 v[44:47], v[224:227], v[184:187], v[44:47]
s_waitcnt lgkmcnt(0)
s_mov_b32 m0, s4
s_add_u32 s9, s91, 0
buffer_load_dwordx4 v233, s[44:47], s9 offen lds
s_add_u32 s8, s91, 130048
buffer_load_dwordx4 v233, s[44:47], s8 offen offset:1024 lds
v_mfma_f32_16x16x32_bf16 v[64:67], v[228:231], v[184:187], v[64:67]
v_mfma_f32_16x16x32_bf16 v[8:11], v[216:219], v[188:191], v[8:11]
s_waitcnt vmcnt(6)
ds_read_b64_tr_b16 v[202:203], v236 offset:2048
ds_read_b64_tr_b16 v[206:207], v237 offset:2048
ds_read_b64_tr_b16 v[210:211], v238 offset:2048
ds_read_b64_tr_b16 v[214:215], v239 offset:2048
v_mfma_f32_16x16x32_bf16 v[28:31], v[220:223], v[188:191], v[28:31]
v_mfma_f32_16x16x32_bf16 v[48:51], v[224:227], v[188:191], v[48:51]
v_mfma_f32_16x16x32_bf16 v[68:71], v[228:231], v[188:191], v[68:71]
v_mfma_f32_16x16x32_bf16 v[12:15], v[216:219], v[192:195], v[12:15]
v_mfma_f32_16x16x32_bf16 v[32:35], v[220:223], v[192:195], v[32:35]
s_waitcnt lgkmcnt(0)
s_mov_b32 m0, s4
s_add_u32 s9, s91, 30720
buffer_load_dwordx4 v233, s[44:47], s9 offen offset:2048 lds
s_add_u32 s8, s91, 160768
buffer_load_dwordx4 v233, s[44:47], s8 offen offset:3072 lds
v_mfma_f32_16x16x32_bf16 v[52:55], v[224:227], v[192:195], v[52:55]
v_mfma_f32_16x16x32_bf16 v[72:75], v[228:231], v[192:195], v[72:75]
v_mfma_f32_16x16x32_bf16 v[16:19], v[216:219], v[196:199], v[16:19]
v_mfma_f32_16x16x32_bf16 v[36:39], v[220:223], v[196:199], v[36:39]
v_mfma_f32_16x16x32_bf16 v[56:59], v[224:227], v[196:199], v[56:59]
v_mfma_f32_16x16x32_bf16 v[76:79], v[228:231], v[196:199], v[76:79]
s_nop 7
s_waitcnt lgkmcnt(0)
s_barrier
ds_read_b128 v[160:163], v242 offset:0
ds_read_b128 v[164:167], v242 offset:1024
ds_read_b128 v[168:171], v242 offset:2048
ds_read_b128 v[172:175], v242 offset:3072
ds_read_b128 v[176:179], v242 offset:4096
ds_read_b128 v[180:183], v242 offset:5120
ds_read_b128 v[184:187], v242 offset:6144
ds_read_b128 v[188:191], v242 offset:7168
ds_read_b128 v[192:195], v242 offset:8192
ds_read_b128 v[196:199], v242 offset:9216
v_lshlrev_b32 v254, 4, v235
v_cvt_pk_bf16_f32 v0, v0, v1
v_cvt_pk_bf16_f32 v1, v2, v3
v_cvt_pk_bf16_f32 v2, v20, v21
v_cvt_pk_bf16_f32 v3, v22, v23
s_mov_b32 s9, 0
buffer_store_dwordx4 v[0:3], v254, s[36:39], s9 offen sc1
v_cvt_pk_bf16_f32 v4, v4, v5
v_cvt_pk_bf16_f32 v5, v6, v7
v_cvt_pk_bf16_f32 v6, v24, v25
v_cvt_pk_bf16_f32 v7, v26, v27
s_mov_b32 s8, 1024
buffer_store_dwordx4 v[4:7], v254, s[36:39], s8 offen sc1
v_cvt_pk_bf16_f32 v8, v8, v9
v_cvt_pk_bf16_f32 v9, v10, v11
v_cvt_pk_bf16_f32 v10, v28, v29
v_cvt_pk_bf16_f32 v11, v30, v31
s_mov_b32 s9, 2048
buffer_store_dwordx4 v[8:11], v254, s[36:39], s9 offen sc1
v_cvt_pk_bf16_f32 v12, v12, v13
v_cvt_pk_bf16_f32 v13, v14, v15
v_cvt_pk_bf16_f32 v14, v32, v33
v_cvt_pk_bf16_f32 v15, v34, v35
s_mov_b32 s8, 3072
buffer_store_dwordx4 v[12:15], v254, s[36:39], s8 offen sc1
v_cvt_pk_bf16_f32 v16, v16, v17
v_cvt_pk_bf16_f32 v17, v18, v19
v_cvt_pk_bf16_f32 v18, v36, v37
v_cvt_pk_bf16_f32 v19, v38, v39
s_mov_b32 s9, 4096
buffer_store_dwordx4 v[16:19], v254, s[36:39], s9 offen sc1
v_cvt_pk_bf16_f32 v40, v40, v41
v_cvt_pk_bf16_f32 v41, v42, v43
v_cvt_pk_bf16_f32 v42, v60, v61
v_cvt_pk_bf16_f32 v43, v62, v63
s_mov_b32 s8, 5120
buffer_store_dwordx4 v[40:43], v254, s[36:39], s8 offen sc1
v_cvt_pk_bf16_f32 v44, v44, v45
v_cvt_pk_bf16_f32 v45, v46, v47
v_cvt_pk_bf16_f32 v46, v64, v65
v_cvt_pk_bf16_f32 v47, v66, v67
s_mov_b32 s9, 6144
buffer_store_dwordx4 v[44:47], v254, s[36:39], s9 offen sc1
v_cvt_pk_bf16_f32 v48, v48, v49
v_cvt_pk_bf16_f32 v49, v50, v51
v_cvt_pk_bf16_f32 v50, v68, v69
v_cvt_pk_bf16_f32 v51, v70, v71
s_mov_b32 s8, 7168
buffer_store_dwordx4 v[48:51], v254, s[36:39], s8 offen sc1
v_cvt_pk_bf16_f32 v52, v52, v53
v_cvt_pk_bf16_f32 v53, v54, v55
v_cvt_pk_bf16_f32 v54, v72, v73
v_cvt_pk_bf16_f32 v55, v74, v75
s_mov_b32 s9, 8192
buffer_store_dwordx4 v[52:55], v254, s[36:39], s9 offen sc1
v_cvt_pk_bf16_f32 v56, v56, v57
v_cvt_pk_bf16_f32 v57, v58, v59
v_cvt_pk_bf16_f32 v58, v76, v77
v_cvt_pk_bf16_f32 v59, v78, v79
s_mov_b32 s8, 9216
buffer_store_dwordx4 v[56:59], v254, s[36:39], s8 offen sc1
s_nop 1
s_waitcnt lgkmcnt(9)
v_mfma_f32_16x16x32_bf16 v[0:3], v[200:203], v[160:163], 0
v_mfma_f32_16x16x32_bf16 v[20:23], v[204:207], v[160:163], 0
s_waitcnt vmcnt(16)
ds_read_b64_tr_b16 v[216:217], v236 offset:4096
ds_read_b64_tr_b16 v[220:221], v237 offset:4096
ds_read_b64_tr_b16 v[224:225], v238 offset:4096
ds_read_b64_tr_b16 v[228:229], v239 offset:4096
v_mfma_f32_16x16x32_bf16 v[40:43], v[208:211], v[160:163], 0
v_mfma_f32_16x16x32_bf16 v[60:63], v[212:215], v[160:163], 0
ds_read_b128 v[160:163], v242 offset:10240
s_waitcnt lgkmcnt(13)
v_mfma_f32_16x16x32_bf16 v[4:7], v[200:203], v[164:167], 0
v_mfma_f32_16x16x32_bf16 v[24:27], v[204:207], v[164:167], 0
v_mfma_f32_16x16x32_bf16 v[44:47], v[208:211], v[164:167], 0
s_waitcnt lgkmcnt(1)
s_mov_b32 m0, s5
s_add_u32 s9, s91, 262144
buffer_load_dwordx4 v233, s[44:47], s9 offen lds
s_add_u32 s8, s91, 392192
buffer_load_dwordx4 v233, s[44:47], s8 offen offset:1024 lds
v_mfma_f32_16x16x32_bf16 v[64:67], v[212:215], v[164:167], 0
ds_read_b128 v[164:167], v242 offset:11264
v_mfma_f32_16x16x32_bf16 v[8:11], v[200:203], v[168:171], 0
s_waitcnt vmcnt(16)
ds_read_b64_tr_b16 v[218:219], v236 offset:6144
ds_read_b64_tr_b16 v[222:223], v237 offset:6144
ds_read_b64_tr_b16 v[226:227], v238 offset:6144
ds_read_b64_tr_b16 v[230:231], v239 offset:6144
v_mfma_f32_16x16x32_bf16 v[28:31], v[204:207], v[168:171], 0
v_mfma_f32_16x16x32_bf16 v[48:51], v[208:211], v[168:171], 0
v_mfma_f32_16x16x32_bf16 v[68:71], v[212:215], v[168:171], 0
ds_read_b128 v[168:171], v242 offset:12288
v_mfma_f32_16x16x32_bf16 v[12:15], v[200:203], v[172:175], 0
v_mfma_f32_16x16x32_bf16 v[32:35], v[204:207], v[172:175], 0
s_waitcnt lgkmcnt(1)
s_mov_b32 m0, s5
s_add_u32 s9, s91, 292864
buffer_load_dwordx4 v233, s[44:47], s9 offen offset:2048 lds
s_add_u32 s8, s91, 422912
buffer_load_dwordx4 v233, s[44:47], s8 offen offset:3072 lds
v_mfma_f32_16x16x32_bf16 v[52:55], v[208:211], v[172:175], 0
v_mfma_f32_16x16x32_bf16 v[72:75], v[212:215], v[172:175], 0
ds_read_b128 v[172:175], v242 offset:13312
v_mfma_f32_16x16x32_bf16 v[16:19], v[200:203], v[176:179], 0
v_mfma_f32_16x16x32_bf16 v[36:39], v[204:207], v[176:179], 0
v_mfma_f32_16x16x32_bf16 v[56:59], v[208:211], v[176:179], 0
v_mfma_f32_16x16x32_bf16 v[76:79], v[212:215], v[176:179], 0
ds_read_b128 v[176:179], v242 offset:14336
v_mfma_f32_16x16x32_bf16 v[0:3], v[216:219], v[180:183], v[0:3]
v_mfma_f32_16x16x32_bf16 v[20:23], v[220:223], v[180:183], v[20:23]
s_waitcnt vmcnt(16)
ds_read_b64_tr_b16 v[200:201], v236 offset:0
ds_read_b64_tr_b16 v[204:205], v237 offset:0
ds_read_b64_tr_b16 v[208:209], v238 offset:0
ds_read_b64_tr_b16 v[212:213], v239 offset:0
v_mfma_f32_16x16x32_bf16 v[40:43], v[224:227], v[180:183], v[40:43]
v_mfma_f32_16x16x32_bf16 v[60:63], v[228:231], v[180:183], v[60:63]
ds_read_b128 v[180:183], v242 offset:15360
v_mfma_f32_16x16x32_bf16 v[4:7], v[216:219], v[184:187], v[4:7]
v_mfma_f32_16x16x32_bf16 v[24:27], v[220:223], v[184:187], v[24:27]
v_mfma_f32_16x16x32_bf16 v[44:47], v[224:227], v[184:187], v[44:47]
s_waitcnt lgkmcnt(1)
s_mov_b32 m0, s4
s_add_u32 s9, s92, 0
buffer_load_dwordx4 v233, s[44:47], s9 offen lds
s_add_u32 s8, s92, 130048
buffer_load_dwordx4 v233, s[44:47], s8 offen offset:1024 lds
v_mfma_f32_16x16x32_bf16 v[64:67], v[228:231], v[184:187], v[64:67]
ds_read_b128 v[184:187], v242 offset:16384
v_mfma_f32_16x16x32_bf16 v[8:11], v[216:219], v[188:191], v[8:11]
s_waitcnt vmcnt(16)
ds_read_b64_tr_b16 v[202:203], v236 offset:2048
ds_read_b64_tr_b16 v[206:207], v237 offset:2048
ds_read_b64_tr_b16 v[210:211], v238 offset:2048
ds_read_b64_tr_b16 v[214:215], v239 offset:2048
v_mfma_f32_16x16x32_bf16 v[28:31], v[220:223], v[188:191], v[28:31]
v_mfma_f32_16x16x32_bf16 v[48:51], v[224:227], v[188:191], v[48:51]
v_mfma_f32_16x16x32_bf16 v[68:71], v[228:231], v[188:191], v[68:71]
ds_read_b128 v[188:191], v242 offset:17408
v_mfma_f32_16x16x32_bf16 v[12:15], v[216:219], v[192:195], v[12:15]
v_mfma_f32_16x16x32_bf16 v[32:35], v[220:223], v[192:195], v[32:35]
s_waitcnt lgkmcnt(1)
s_mov_b32 m0, s4
s_add_u32 s9, s92, 30720
buffer_load_dwordx4 v233, s[44:47], s9 offen offset:2048 lds
s_add_u32 s8, s92, 160768
buffer_load_dwordx4 v233, s[44:47], s8 offen offset:3072 lds
v_mfma_f32_16x16x32_bf16 v[52:55], v[224:227], v[192:195], v[52:55]
v_mfma_f32_16x16x32_bf16 v[72:75], v[228:231], v[192:195], v[72:75]
ds_read_b128 v[192:195], v242 offset:18432
v_mfma_f32_16x16x32_bf16 v[16:19], v[216:219], v[196:199], v[16:19]
v_mfma_f32_16x16x32_bf16 v[36:39], v[220:223], v[196:199], v[36:39]
v_mfma_f32_16x16x32_bf16 v[56:59], v[224:227], v[196:199], v[56:59]
v_mfma_f32_16x16x32_bf16 v[76:79], v[228:231], v[196:199], v[76:79]
ds_read_b128 v[196:199], v242 offset:19456
v_mfma_f32_16x16x32_bf16 v[0:3], v[200:203], v[160:163], v[0:3]
v_mfma_f32_16x16x32_bf16 v[20:23], v[204:207], v[160:163], v[20:23]
s_waitcnt vmcnt(6)
ds_read_b64_tr_b16 v[216:217], v236 offset:4096
ds_read_b64_tr_b16 v[220:221], v237 offset:4096
ds_read_b64_tr_b16 v[224:225], v238 offset:4096
ds_read_b64_tr_b16 v[228:229], v239 offset:4096
v_mfma_f32_16x16x32_bf16 v[40:43], v[208:211], v[160:163], v[40:43]
v_mfma_f32_16x16x32_bf16 v[60:63], v[212:215], v[160:163], v[60:63]
ds_read_b128 v[160:163], v242 offset:20480
v_mfma_f32_16x16x32_bf16 v[4:7], v[200:203], v[164:167], v[4:7]
v_mfma_f32_16x16x32_bf16 v[24:27], v[204:207], v[164:167], v[24:27]
v_mfma_f32_16x16x32_bf16 v[44:47], v[208:211], v[164:167], v[44:47]
s_waitcnt lgkmcnt(1)
s_mov_b32 m0, s5
s_add_u32 s9, s92, 262144
buffer_load_dwordx4 v233, s[44:47], s9 offen lds
s_add_u32 s8, s92, 392192
buffer_load_dwordx4 v233, s[44:47], s8 offen offset:1024 lds
v_mfma_f32_16x16x32_bf16 v[64:67], v[212:215], v[164:167], v[64:67]
ds_read_b128 v[164:167], v242 offset:21504
v_mfma_f32_16x16x32_bf16 v[8:11], v[200:203], v[168:171], v[8:11]
s_waitcnt vmcnt(6)
ds_read_b64_tr_b16 v[218:219], v236 offset:6144
ds_read_b64_tr_b16 v[222:223], v237 offset:6144
ds_read_b64_tr_b16 v[226:227], v238 offset:6144
ds_read_b64_tr_b16 v[230:231], v239 offset:6144
v_mfma_f32_16x16x32_bf16 v[28:31], v[204:207], v[168:171], v[28:31]
v_mfma_f32_16x16x32_bf16 v[48:51], v[208:211], v[168:171], v[48:51]
v_mfma_f32_16x16x32_bf16 v[68:71], v[212:215], v[168:171], v[68:71]
ds_read_b128 v[168:171], v242 offset:22528
v_mfma_f32_16x16x32_bf16 v[12:15], v[200:203], v[172:175], v[12:15]
v_mfma_f32_16x16x32_bf16 v[32:35], v[204:207], v[172:175], v[32:35]
s_waitcnt lgkmcnt(1)
s_mov_b32 m0, s5
s_add_u32 s9, s92, 292864
buffer_load_dwordx4 v233, s[44:47], s9 offen offset:2048 lds
s_add_u32 s8, s92, 422912
buffer_load_dwordx4 v233, s[44:47], s8 offen offset:3072 lds
v_mfma_f32_16x16x32_bf16 v[52:55], v[208:211], v[172:175], v[52:55]
v_mfma_f32_16x16x32_bf16 v[72:75], v[212:215], v[172:175], v[72:75]
ds_read_b128 v[172:175], v242 offset:23552
v_mfma_f32_16x16x32_bf16 v[16:19], v[200:203], v[176:179], v[16:19]
v_mfma_f32_16x16x32_bf16 v[36:39], v[204:207], v[176:179], v[36:39]
v_mfma_f32_16x16x32_bf16 v[56:59], v[208:211], v[176:179], v[56:59]
v_mfma_f32_16x16x32_bf16 v[76:79], v[212:215], v[176:179], v[76:79]
ds_read_b128 v[176:179], v242 offset:24576
v_mfma_f32_16x16x32_bf16 v[0:3], v[216:219], v[180:183], v[0:3]
v_mfma_f32_16x16x32_bf16 v[20:23], v[220:223], v[180:183], v[20:23]
s_waitcnt vmcnt(6)
ds_read_b64_tr_b16 v[200:201], v236 offset:0
ds_read_b64_tr_b16 v[204:205], v237 offset:0
ds_read_b64_tr_b16 v[208:209], v238 offset:0
ds_read_b64_tr_b16 v[212:213], v239 offset:0
v_mfma_f32_16x16x32_bf16 v[40:43], v[224:227], v[180:183], v[40:43]
v_mfma_f32_16x16x32_bf16 v[60:63], v[228:231], v[180:183], v[60:63]
ds_read_b128 v[180:183], v242 offset:25600
v_mfma_f32_16x16x32_bf16 v[4:7], v[216:219], v[184:187], v[4:7]
v_mfma_f32_16x16x32_bf16 v[24:27], v[220:223], v[184:187], v[24:27]
v_mfma_f32_16x16x32_bf16 v[44:47], v[224:227], v[184:187], v[44:47]
s_waitcnt lgkmcnt(1)
s_mov_b32 m0, s4
s_add_u32 s9, s93, 0
buffer_load_dwordx4 v233, s[44:47], s9 offen lds
s_add_u32 s8, s93, 130048
buffer_load_dwordx4 v233, s[44:47], s8 offen offset:1024 lds
v_mfma_f32_16x16x32_bf16 v[64:67], v[228:231], v[184:187], v[64:67]
ds_read_b128 v[184:187], v242 offset:26624
v_mfma_f32_16x16x32_bf16 v[8:11], v[216:219], v[188:191], v[8:11]
s_waitcnt vmcnt(6)
ds_read_b64_tr_b16 v[202:203], v236 offset:2048
ds_read_b64_tr_b16 v[206:207], v237 offset:2048
ds_read_b64_tr_b16 v[210:211], v238 offset:2048
ds_read_b64_tr_b16 v[214:215], v239 offset:2048
v_mfma_f32_16x16x32_bf16 v[28:31], v[220:223], v[188:191], v[28:31]
v_mfma_f32_16x16x32_bf16 v[48:51], v[224:227], v[188:191], v[48:51]
v_mfma_f32_16x16x32_bf16 v[68:71], v[228:231], v[188:191], v[68:71]
ds_read_b128 v[188:191], v242 offset:27648
v_mfma_f32_16x16x32_bf16 v[12:15], v[216:219], v[192:195], v[12:15]
v_mfma_f32_16x16x32_bf16 v[32:35], v[220:223], v[192:195], v[32:35]
s_waitcnt lgkmcnt(1)
s_mov_b32 m0, s4
s_add_u32 s9, s93, 30720
buffer_load_dwordx4 v233, s[44:47], s9 offen offset:2048 lds
s_add_u32 s8, s93, 160768
buffer_load_dwordx4 v233, s[44:47], s8 offen offset:3072 lds
v_mfma_f32_16x16x32_bf16 v[52:55], v[224:227], v[192:195], v[52:55]
v_mfma_f32_16x16x32_bf16 v[72:75], v[228:231], v[192:195], v[72:75]
ds_read_b128 v[192:195], v242 offset:28672
v_mfma_f32_16x16x32_bf16 v[16:19], v[216:219], v[196:199], v[16:19]
v_mfma_f32_16x16x32_bf16 v[36:39], v[220:223], v[196:199], v[36:39]
v_mfma_f32_16x16x32_bf16 v[56:59], v[224:227], v[196:199], v[56:59]
v_mfma_f32_16x16x32_bf16 v[76:79], v[228:231], v[196:199], v[76:79]
ds_read_b128 v[196:199], v242 offset:29696
v_mfma_f32_16x16x32_bf16 v[0:3], v[200:203], v[160:163], v[0:3]
v_mfma_f32_16x16x32_bf16 v[20:23], v[204:207], v[160:163], v[20:23]
s_waitcnt vmcnt(6)
ds_read_b64_tr_b16 v[216:217], v236 offset:4096
ds_read_b64_tr_b16 v[220:221], v237 offset:4096
ds_read_b64_tr_b16 v[224:225], v238 offset:4096
ds_read_b64_tr_b16 v[228:229], v239 offset:4096
v_mfma_f32_16x16x32_bf16 v[40:43], v[208:211], v[160:163], v[40:43]
v_mfma_f32_16x16x32_bf16 v[60:63], v[212:215], v[160:163], v[60:63]
ds_read_b128 v[160:163], v242 offset:30720
v_mfma_f32_16x16x32_bf16 v[4:7], v[200:203], v[164:167], v[4:7]
v_mfma_f32_16x16x32_bf16 v[24:27], v[204:207], v[164:167], v[24:27]
v_mfma_f32_16x16x32_bf16 v[44:47], v[208:211], v[164:167], v[44:47]
s_waitcnt lgkmcnt(1)
s_mov_b32 m0, s5
s_add_u32 s9, s93, 262144
buffer_load_dwordx4 v233, s[44:47], s9 offen lds
s_add_u32 s8, s93, 392192
buffer_load_dwordx4 v233, s[44:47], s8 offen offset:1024 lds
v_mfma_f32_16x16x32_bf16 v[64:67], v[212:215], v[164:167], v[64:67]
ds_read_b128 v[164:167], v242 offset:31744
v_mfma_f32_16x16x32_bf16 v[8:11], v[200:203], v[168:171], v[8:11]
s_waitcnt vmcnt(6)
ds_read_b64_tr_b16 v[218:219], v236 offset:6144
ds_read_b64_tr_b16 v[222:223], v237 offset:6144
ds_read_b64_tr_b16 v[226:227], v238 offset:6144
ds_read_b64_tr_b16 v[230:231], v239 offset:6144
v_mfma_f32_16x16x32_bf16 v[28:31], v[204:207], v[168:171], v[28:31]
v_mfma_f32_16x16x32_bf16 v[48:51], v[208:211], v[168:171], v[48:51]
v_mfma_f32_16x16x32_bf16 v[68:71], v[212:215], v[168:171], v[68:71]
ds_read_b128 v[168:171], v242 offset:32768
v_mfma_f32_16x16x32_bf16 v[12:15], v[200:203], v[172:175], v[12:15]
v_mfma_f32_16x16x32_bf16 v[32:35], v[204:207], v[172:175], v[32:35]
s_waitcnt lgkmcnt(1)
s_mov_b32 m0, s5
s_add_u32 s9, s93, 292864
buffer_load_dwordx4 v233, s[44:47], s9 offen offset:2048 lds
s_add_u32 s8, s93, 422912
buffer_load_dwordx4 v233, s[44:47], s8 offen offset:3072 lds
v_mfma_f32_16x16x32_bf16 v[52:55], v[208:211], v[172:175], v[52:55]
v_mfma_f32_16x16x32_bf16 v[72:75], v[212:215], v[172:175], v[72:75]
ds_read_b128 v[172:175], v242 offset:33792
v_mfma_f32_16x16x32_bf16 v[16:19], v[200:203], v[176:179], v[16:19]
v_mfma_f32_16x16x32_bf16 v[36:39], v[204:207], v[176:179], v[36:39]
v_mfma_f32_16x16x32_bf16 v[56:59], v[208:211], v[176:179], v[56:59]
v_mfma_f32_16x16x32_bf16 v[76:79], v[212:215], v[176:179], v[76:79]
ds_read_b128 v[176:179], v242 offset:34816
v_mfma_f32_16x16x32_bf16 v[0:3], v[216:219], v[180:183], v[0:3]
v_mfma_f32_16x16x32_bf16 v[20:23], v[220:223], v[180:183], v[20:23]
s_waitcnt vmcnt(6)
ds_read_b64_tr_b16 v[200:201], v236 offset:0
ds_read_b64_tr_b16 v[204:205], v237 offset:0
ds_read_b64_tr_b16 v[208:209], v238 offset:0
ds_read_b64_tr_b16 v[212:213], v239 offset:0
v_mfma_f32_16x16x32_bf16 v[40:43], v[224:227], v[180:183], v[40:43]
v_mfma_f32_16x16x32_bf16 v[60:63], v[228:231], v[180:183], v[60:63]
ds_read_b128 v[180:183], v242 offset:35840
v_mfma_f32_16x16x32_bf16 v[4:7], v[216:219], v[184:187], v[4:7]
v_mfma_f32_16x16x32_bf16 v[24:27], v[220:223], v[184:187], v[24:27]
v_mfma_f32_16x16x32_bf16 v[44:47], v[224:227], v[184:187], v[44:47]
s_waitcnt lgkmcnt(1)
s_mov_b32 m0, s4
s_add_u32 s9, s94, 0
buffer_load_dwordx4 v233, s[44:47], s9 offen lds
s_add_u32 s8, s94, 130048
buffer_load_dwordx4 v233, s[44:47], s8 offen offset:1024 lds
v_mfma_f32_16x16x32_bf16 v[64:67], v[228:231], v[184:187], v[64:67]
ds_read_b128 v[184:187], v242 offset:36864
v_mfma_f32_16x16x32_bf16 v[8:11], v[216:219], v[188:191], v[8:11]
s_waitcnt vmcnt(6)
ds_read_b64_tr_b16 v[202:203], v236 offset:2048
ds_read_b64_tr_b16 v[206:207], v237 offset:2048
ds_read_b64_tr_b16 v[210:211], v238 offset:2048
ds_read_b64_tr_b16 v[214:215], v239 offset:2048
v_mfma_f32_16x16x32_bf16 v[28:31], v[220:223], v[188:191], v[28:31]
v_mfma_f32_16x16x32_bf16 v[48:51], v[224:227], v[188:191], v[48:51]
v_mfma_f32_16x16x32_bf16 v[68:71], v[228:231], v[188:191], v[68:71]
ds_read_b128 v[188:191], v242 offset:37888
v_mfma_f32_16x16x32_bf16 v[12:15], v[216:219], v[192:195], v[12:15]
v_mfma_f32_16x16x32_bf16 v[32:35], v[220:223], v[192:195], v[32:35]
s_waitcnt lgkmcnt(1)
s_mov_b32 m0, s4
s_add_u32 s9, s94, 30720
buffer_load_dwordx4 v233, s[44:47], s9 offen offset:2048 lds
s_add_u32 s8, s94, 160768
buffer_load_dwordx4 v233, s[44:47], s8 offen offset:3072 lds
v_mfma_f32_16x16x32_bf16 v[52:55], v[224:227], v[192:195], v[52:55]
v_mfma_f32_16x16x32_bf16 v[72:75], v[228:231], v[192:195], v[72:75]
ds_read_b128 v[192:195], v242 offset:38912
v_mfma_f32_16x16x32_bf16 v[16:19], v[216:219], v[196:199], v[16:19]
v_mfma_f32_16x16x32_bf16 v[36:39], v[220:223], v[196:199], v[36:39]
v_mfma_f32_16x16x32_bf16 v[56:59], v[224:227], v[196:199], v[56:59]
v_mfma_f32_16x16x32_bf16 v[76:79], v[228:231], v[196:199], v[76:79]
ds_read_b128 v[196:199], v242 offset:39936
v_mfma_f32_16x16x32_bf16 v[0:3], v[200:203], v[160:163], v[0:3]
v_mfma_f32_16x16x32_bf16 v[20:23], v[204:207], v[160:163], v[20:23]
s_waitcnt vmcnt(6)
ds_read_b64_tr_b16 v[216:217], v236 offset:4096
ds_read_b64_tr_b16 v[220:221], v237 offset:4096
ds_read_b64_tr_b16 v[224:225], v238 offset:4096
ds_read_b64_tr_b16 v[228:229], v239 offset:4096
v_mfma_f32_16x16x32_bf16 v[40:43], v[208:211], v[160:163], v[40:43]
v_mfma_f32_16x16x32_bf16 v[60:63], v[212:215], v[160:163], v[60:63]
ds_read_b128 v[160:163], v243 offset:0
v_mfma_f32_16x16x32_bf16 v[4:7], v[200:203], v[164:167], v[4:7]
v_mfma_f32_16x16x32_bf16 v[24:27], v[204:207], v[164:167], v[24:27]
v_mfma_f32_16x16x32_bf16 v[44:47], v[208:211], v[164:167], v[44:47]
s_waitcnt lgkmcnt(1)
s_mov_b32 m0, s5
s_add_u32 s9, s94, 262144
buffer_load_dwordx4 v233, s[44:47], s9 offen lds
s_add_u32 s8, s94, 392192
buffer_load_dwordx4 v233, s[44:47], s8 offen offset:1024 lds
v_mfma_f32_16x16x32_bf16 v[64:67], v[212:215], v[164:167], v[64:67]
ds_read_b128 v[164:167], v243 offset:1024
v_mfma_f32_16x16x32_bf16 v[8:11], v[200:203], v[168:171], v[8:11]
s_waitcnt vmcnt(6)
ds_read_b64_tr_b16 v[218:219], v236 offset:6144
ds_read_b64_tr_b16 v[222:223], v237 offset:6144
ds_read_b64_tr_b16 v[226:227], v238 offset:6144
ds_read_b64_tr_b16 v[230:231], v239 offset:6144
v_mfma_f32_16x16x32_bf16 v[28:31], v[204:207], v[168:171], v[28:31]
v_mfma_f32_16x16x32_bf16 v[48:51], v[208:211], v[168:171], v[48:51]
v_mfma_f32_16x16x32_bf16 v[68:71], v[212:215], v[168:171], v[68:71]
ds_read_b128 v[168:171], v243 offset:2048
v_mfma_f32_16x16x32_bf16 v[12:15], v[200:203], v[172:175], v[12:15]
v_mfma_f32_16x16x32_bf16 v[32:35], v[204:207], v[172:175], v[32:35]
s_waitcnt lgkmcnt(1)
s_mov_b32 m0, s5
s_add_u32 s9, s94, 292864
buffer_load_dwordx4 v233, s[44:47], s9 offen offset:2048 lds
s_add_u32 s8, s94, 422912
buffer_load_dwordx4 v233, s[44:47], s8 offen offset:3072 lds
v_mfma_f32_16x16x32_bf16 v[52:55], v[208:211], v[172:175], v[52:55]
v_mfma_f32_16x16x32_bf16 v[72:75], v[212:215], v[172:175], v[72:75]
ds_read_b128 v[172:175], v243 offset:3072
v_mfma_f32_16x16x32_bf16 v[16:19], v[200:203], v[176:179], v[16:19]
v_mfma_f32_16x16x32_bf16 v[36:39], v[204:207], v[176:179], v[36:39]
v_mfma_f32_16x16x32_bf16 v[56:59], v[208:211], v[176:179], v[56:59]
v_mfma_f32_16x16x32_bf16 v[76:79], v[212:215], v[176:179], v[76:79]
ds_read_b128 v[176:179], v243 offset:4096
v_mfma_f32_16x16x32_bf16 v[0:3], v[216:219], v[180:183], v[0:3]
v_mfma_f32_16x16x32_bf16 v[20:23], v[220:223], v[180:183], v[20:23]
s_waitcnt vmcnt(6)
ds_read_b64_tr_b16 v[200:201], v236 offset:0
ds_read_b64_tr_b16 v[204:205], v237 offset:0
ds_read_b64_tr_b16 v[208:209], v238 offset:0
ds_read_b64_tr_b16 v[212:213], v239 offset:0
v_mfma_f32_16x16x32_bf16 v[40:43], v[224:227], v[180:183], v[40:43]
v_mfma_f32_16x16x32_bf16 v[60:63], v[228:231], v[180:183], v[60:63]
ds_read_b128 v[180:183], v243 offset:5120
v_mfma_f32_16x16x32_bf16 v[4:7], v[216:219], v[184:187], v[4:7]
v_mfma_f32_16x16x32_bf16 v[24:27], v[220:223], v[184:187], v[24:27]
v_mfma_f32_16x16x32_bf16 v[44:47], v[224:227], v[184:187], v[44:47]
s_waitcnt lgkmcnt(1)
s_mov_b32 m0, s4
s_add_u32 s9, s95, 0
buffer_load_dwordx4 v233, s[44:47], s9 offen lds
s_add_u32 s8, s95, 130048
buffer_load_dwordx4 v233, s[44:47], s8 offen offset:1024 lds
v_mfma_f32_16x16x32_bf16 v[64:67], v[228:231], v[184:187], v[64:67]
ds_read_b128 v[184:187], v243 offset:6144
v_mfma_f32_16x16x32_bf16 v[8:11], v[216:219], v[188:191], v[8:11]
s_waitcnt vmcnt(6)
ds_read_b64_tr_b16 v[202:203], v236 offset:2048
ds_read_b64_tr_b16 v[206:207], v237 offset:2048
ds_read_b64_tr_b16 v[210:211], v238 offset:2048
ds_read_b64_tr_b16 v[214:215], v239 offset:2048
v_mfma_f32_16x16x32_bf16 v[28:31], v[220:223], v[188:191], v[28:31]
v_mfma_f32_16x16x32_bf16 v[48:51], v[224:227], v[188:191], v[48:51]
v_mfma_f32_16x16x32_bf16 v[68:71], v[228:231], v[188:191], v[68:71]
ds_read_b128 v[188:191], v243 offset:7168
v_mfma_f32_16x16x32_bf16 v[12:15], v[216:219], v[192:195], v[12:15]
v_mfma_f32_16x16x32_bf16 v[32:35], v[220:223], v[192:195], v[32:35]
s_waitcnt lgkmcnt(1)
s_mov_b32 m0, s4
s_add_u32 s9, s95, 30720
buffer_load_dwordx4 v233, s[44:47], s9 offen offset:2048 lds
s_add_u32 s8, s95, 160768
buffer_load_dwordx4 v233, s[44:47], s8 offen offset:3072 lds
v_mfma_f32_16x16x32_bf16 v[52:55], v[224:227], v[192:195], v[52:55]
v_mfma_f32_16x16x32_bf16 v[72:75], v[228:231], v[192:195], v[72:75]
ds_read_b128 v[192:195], v243 offset:8192
v_mfma_f32_16x16x32_bf16 v[16:19], v[216:219], v[196:199], v[16:19]
v_mfma_f32_16x16x32_bf16 v[36:39], v[220:223], v[196:199], v[36:39]
v_mfma_f32_16x16x32_bf16 v[56:59], v[224:227], v[196:199], v[56:59]
v_mfma_f32_16x16x32_bf16 v[76:79], v[228:231], v[196:199], v[76:79]
ds_read_b128 v[196:199], v243 offset:9216
v_mfma_f32_16x16x32_bf16 v[0:3], v[200:203], v[160:163], v[0:3]
v_mfma_f32_16x16x32_bf16 v[20:23], v[204:207], v[160:163], v[20:23]
s_waitcnt vmcnt(6)
ds_read_b64_tr_b16 v[216:217], v236 offset:4096
ds_read_b64_tr_b16 v[220:221], v237 offset:4096
ds_read_b64_tr_b16 v[224:225], v238 offset:4096
ds_read_b64_tr_b16 v[228:229], v239 offset:4096
v_mfma_f32_16x16x32_bf16 v[40:43], v[208:211], v[160:163], v[40:43]
v_mfma_f32_16x16x32_bf16 v[60:63], v[212:215], v[160:163], v[60:63]
ds_read_b128 v[160:163], v243 offset:10240
v_mfma_f32_16x16x32_bf16 v[4:7], v[200:203], v[164:167], v[4:7]
v_mfma_f32_16x16x32_bf16 v[24:27], v[204:207], v[164:167], v[24:27]
v_mfma_f32_16x16x32_bf16 v[44:47], v[208:211], v[164:167], v[44:47]
s_waitcnt lgkmcnt(1)
s_mov_b32 m0, s5
s_add_u32 s9, s95, 262144
buffer_load_dwordx4 v233, s[44:47], s9 offen lds
s_add_u32 s8, s95, 392192
buffer_load_dwordx4 v233, s[44:47], s8 offen offset:1024 lds
v_mfma_f32_16x16x32_bf16 v[64:67], v[212:215], v[164:167], v[64:67]
ds_read_b128 v[164:167], v243 offset:11264
v_mfma_f32_16x16x32_bf16 v[8:11], v[200:203], v[168:171], v[8:11]
s_waitcnt vmcnt(6)
ds_read_b64_tr_b16 v[218:219], v236 offset:6144
ds_read_b64_tr_b16 v[222:223], v237 offset:6144
ds_read_b64_tr_b16 v[226:227], v238 offset:6144
ds_read_b64_tr_b16 v[230:231], v239 offset:6144
v_mfma_f32_16x16x32_bf16 v[28:31], v[204:207], v[168:171], v[28:31]
v_mfma_f32_16x16x32_bf16 v[48:51], v[208:211], v[168:171], v[48:51]
v_mfma_f32_16x16x32_bf16 v[68:71], v[212:215], v[168:171], v[68:71]
ds_read_b128 v[168:171], v243 offset:12288
v_mfma_f32_16x16x32_bf16 v[12:15], v[200:203], v[172:175], v[12:15]
v_mfma_f32_16x16x32_bf16 v[32:35], v[204:207], v[172:175], v[32:35]
s_waitcnt lgkmcnt(1)
s_mov_b32 m0, s5
s_add_u32 s9, s95, 292864
buffer_load_dwordx4 v233, s[44:47], s9 offen offset:2048 lds
s_add_u32 s8, s95, 422912
buffer_load_dwordx4 v233, s[44:47], s8 offen offset:3072 lds
v_mfma_f32_16x16x32_bf16 v[52:55], v[208:211], v[172:175], v[52:55]
v_mfma_f32_16x16x32_bf16 v[72:75], v[212:215], v[172:175], v[72:75]
ds_read_b128 v[172:175], v243 offset:13312
v_mfma_f32_16x16x32_bf16 v[16:19], v[200:203], v[176:179], v[16:19]
v_mfma_f32_16x16x32_bf16 v[36:39], v[204:207], v[176:179], v[36:39]
v_mfma_f32_16x16x32_bf16 v[56:59], v[208:211], v[176:179], v[56:59]
v_mfma_f32_16x16x32_bf16 v[76:79], v[212:215], v[176:179], v[76:79]
ds_read_b128 v[176:179], v243 offset:14336
v_mfma_f32_16x16x32_bf16 v[0:3], v[216:219], v[180:183], v[0:3]
v_mfma_f32_16x16x32_bf16 v[20:23], v[220:223], v[180:183], v[20:23]
s_waitcnt vmcnt(6)
ds_read_b64_tr_b16 v[200:201], v236 offset:0
ds_read_b64_tr_b16 v[204:205], v237 offset:0
ds_read_b64_tr_b16 v[208:209], v238 offset:0
ds_read_b64_tr_b16 v[212:213], v239 offset:0
v_mfma_f32_16x16x32_bf16 v[40:43], v[224:227], v[180:183], v[40:43]
v_mfma_f32_16x16x32_bf16 v[60:63], v[228:231], v[180:183], v[60:63]
ds_read_b128 v[180:183], v243 offset:15360
v_mfma_f32_16x16x32_bf16 v[4:7], v[216:219], v[184:187], v[4:7]
v_mfma_f32_16x16x32_bf16 v[24:27], v[220:223], v[184:187], v[24:27]
v_mfma_f32_16x16x32_bf16 v[44:47], v[224:227], v[184:187], v[44:47]
s_waitcnt lgkmcnt(1)
s_mov_b32 m0, s4
s_add_u32 s9, s96, 0
buffer_load_dwordx4 v233, s[44:47], s9 offen lds
s_add_u32 s8, s96, 130048
buffer_load_dwordx4 v233, s[44:47], s8 offen offset:1024 lds
v_mfma_f32_16x16x32_bf16 v[64:67], v[228:231], v[184:187], v[64:67]
ds_read_b128 v[184:187], v243 offset:16384
v_mfma_f32_16x16x32_bf16 v[8:11], v[216:219], v[188:191], v[8:11]
s_waitcnt vmcnt(6)
ds_read_b64_tr_b16 v[202:203], v236 offset:2048
ds_read_b64_tr_b16 v[206:207], v237 offset:2048
ds_read_b64_tr_b16 v[210:211], v238 offset:2048
ds_read_b64_tr_b16 v[214:215], v239 offset:2048
v_mfma_f32_16x16x32_bf16 v[28:31], v[220:223], v[188:191], v[28:31]
v_mfma_f32_16x16x32_bf16 v[48:51], v[224:227], v[188:191], v[48:51]
v_mfma_f32_16x16x32_bf16 v[68:71], v[228:231], v[188:191], v[68:71]
ds_read_b128 v[188:191], v243 offset:17408
v_mfma_f32_16x16x32_bf16 v[12:15], v[216:219], v[192:195], v[12:15]
v_mfma_f32_16x16x32_bf16 v[32:35], v[220:223], v[192:195], v[32:35]
s_waitcnt lgkmcnt(1)
s_mov_b32 m0, s4
s_add_u32 s9, s96, 30720
buffer_load_dwordx4 v233, s[44:47], s9 offen offset:2048 lds
s_add_u32 s8, s96, 160768
buffer_load_dwordx4 v233, s[44:47], s8 offen offset:3072 lds
v_mfma_f32_16x16x32_bf16 v[52:55], v[224:227], v[192:195], v[52:55]
v_mfma_f32_16x16x32_bf16 v[72:75], v[228:231], v[192:195], v[72:75]
ds_read_b128 v[192:195], v243 offset:18432
v_mfma_f32_16x16x32_bf16 v[16:19], v[216:219], v[196:199], v[16:19]
v_mfma_f32_16x16x32_bf16 v[36:39], v[220:223], v[196:199], v[36:39]
v_mfma_f32_16x16x32_bf16 v[56:59], v[224:227], v[196:199], v[56:59]
v_mfma_f32_16x16x32_bf16 v[76:79], v[228:231], v[196:199], v[76:79]
ds_read_b128 v[196:199], v243 offset:19456
v_mfma_f32_16x16x32_bf16 v[0:3], v[200:203], v[160:163], v[0:3]
v_mfma_f32_16x16x32_bf16 v[20:23], v[204:207], v[160:163], v[20:23]
s_waitcnt vmcnt(6)
ds_read_b64_tr_b16 v[216:217], v236 offset:4096
ds_read_b64_tr_b16 v[220:221], v237 offset:4096
ds_read_b64_tr_b16 v[224:225], v238 offset:4096
ds_read_b64_tr_b16 v[228:229], v239 offset:4096
v_mfma_f32_16x16x32_bf16 v[40:43], v[208:211], v[160:163], v[40:43]
v_mfma_f32_16x16x32_bf16 v[60:63], v[212:215], v[160:163], v[60:63]
ds_read_b128 v[160:163], v243 offset:20480
v_mfma_f32_16x16x32_bf16 v[4:7], v[200:203], v[164:167], v[4:7]
v_mfma_f32_16x16x32_bf16 v[24:27], v[204:207], v[164:167], v[24:27]
v_mfma_f32_16x16x32_bf16 v[44:47], v[208:211], v[164:167], v[44:47]
s_waitcnt lgkmcnt(1)
s_mov_b32 m0, s5
s_add_u32 s9, s96, 262144
buffer_load_dwordx4 v233, s[44:47], s9 offen lds
s_add_u32 s8, s96, 392192
buffer_load_dwordx4 v233, s[44:47], s8 offen offset:1024 lds
v_mfma_f32_16x16x32_bf16 v[64:67], v[212:215], v[164:167], v[64:67]
ds_read_b128 v[164:167], v243 offset:21504
v_mfma_f32_16x16x32_bf16 v[8:11], v[200:203], v[168:171], v[8:11]
s_waitcnt vmcnt(6)
ds_read_b64_tr_b16 v[218:219], v236 offset:6144
ds_read_b64_tr_b16 v[222:223], v237 offset:6144
ds_read_b64_tr_b16 v[226:227], v238 offset:6144
ds_read_b64_tr_b16 v[230:231], v239 offset:6144
v_mfma_f32_16x16x32_bf16 v[28:31], v[204:207], v[168:171], v[28:31]
v_mfma_f32_16x16x32_bf16 v[48:51], v[208:211], v[168:171], v[48:51]
v_mfma_f32_16x16x32_bf16 v[68:71], v[212:215], v[168:171], v[68:71]
ds_read_b128 v[168:171], v243 offset:22528
v_mfma_f32_16x16x32_bf16 v[12:15], v[200:203], v[172:175], v[12:15]
v_mfma_f32_16x16x32_bf16 v[32:35], v[204:207], v[172:175], v[32:35]
s_waitcnt lgkmcnt(1)
s_mov_b32 m0, s5
s_add_u32 s9, s96, 292864
buffer_load_dwordx4 v233, s[44:47], s9 offen offset:2048 lds
s_add_u32 s8, s96, 422912
buffer_load_dwordx4 v233, s[44:47], s8 offen offset:3072 lds
v_mfma_f32_16x16x32_bf16 v[52:55], v[208:211], v[172:175], v[52:55]
v_mfma_f32_16x16x32_bf16 v[72:75], v[212:215], v[172:175], v[72:75]
ds_read_b128 v[172:175], v243 offset:23552
v_mfma_f32_16x16x32_bf16 v[16:19], v[200:203], v[176:179], v[16:19]
v_mfma_f32_16x16x32_bf16 v[36:39], v[204:207], v[176:179], v[36:39]
v_mfma_f32_16x16x32_bf16 v[56:59], v[208:211], v[176:179], v[56:59]
v_mfma_f32_16x16x32_bf16 v[76:79], v[212:215], v[176:179], v[76:79]
ds_read_b128 v[176:179], v243 offset:24576
v_mfma_f32_16x16x32_bf16 v[0:3], v[216:219], v[180:183], v[0:3]
v_lshrrev_b32 v246, 5, v235
v_add_u32 v246, 0, v246
v_lshlrev_b32 v247, 1, v246
v_and_b32 v248, 15, v235
v_xor_b32 v247, v248, v247
v_lshl_add_u32 v247, v246, 4, v247
v_lshlrev_b32 v247, 4, v247
v_bfe_u32 v248, v235, 4, 1
v_lshl_add_u32 v247, v248, 3, v247
v_add_u32 v251, s70, v247
v_lshrrev_b32 v246, 5, v235
v_add_u32 v246, 2, v246
v_lshlrev_b32 v247, 1, v246
v_and_b32 v248, 15, v235
v_xor_b32 v247, v248, v247
v_lshl_add_u32 v247, v246, 4, v247
v_lshlrev_b32 v247, 4, v247
v_bfe_u32 v248, v235, 4, 1
v_lshl_add_u32 v247, v248, 3, v247
v_add_u32 v252, s70, v247
v_mfma_f32_16x16x32_bf16 v[20:23], v[220:223], v[180:183], v[20:23]
s_waitcnt vmcnt(6)
ds_read_b64_tr_b16 v[200:201], v236 offset:0
ds_read_b64_tr_b16 v[204:205], v237 offset:0
ds_read_b64_tr_b16 v[208:209], v238 offset:0
ds_read_b64_tr_b16 v[212:213], v239 offset:0
v_mfma_f32_16x16x32_bf16 v[40:43], v[224:227], v[180:183], v[40:43]
v_mfma_f32_16x16x32_bf16 v[60:63], v[228:231], v[180:183], v[60:63]
ds_read_b128 v[180:183], v243 offset:25600
v_mfma_f32_16x16x32_bf16 v[4:7], v[216:219], v[184:187], v[4:7]
v_mfma_f32_16x16x32_bf16 v[24:27], v[220:223], v[184:187], v[24:27]
v_mfma_f32_16x16x32_bf16 v[44:47], v[224:227], v[184:187], v[44:47]
s_waitcnt lgkmcnt(1)
s_mov_b32 m0, s4
s_add_u32 s9, s66, 0
buffer_load_dwordx4 v232, s[48:51], s9 offen nt lds
s_add_u32 s8, s66, 3072
buffer_load_dwordx4 v232, s[48:51], s8 offen offset:1024 nt lds
v_mfma_f32_16x16x32_bf16 v[64:67], v[228:231], v[184:187], v[64:67]
ds_read_b128 v[184:187], v243 offset:26624
v_mfma_f32_16x16x32_bf16 v[8:11], v[216:219], v[188:191], v[8:11]
s_waitcnt vmcnt(6)
ds_read_b64_tr_b16 v[202:203], v236 offset:2048
ds_read_b64_tr_b16 v[206:207], v237 offset:2048
ds_read_b64_tr_b16 v[210:211], v238 offset:2048
ds_read_b64_tr_b16 v[214:215], v239 offset:2048
v_mfma_f32_16x16x32_bf16 v[28:31], v[220:223], v[188:191], v[28:31]
v_mfma_f32_16x16x32_bf16 v[48:51], v[224:227], v[188:191], v[48:51]
v_mfma_f32_16x16x32_bf16 v[68:71], v[228:231], v[188:191], v[68:71]
ds_read_b128 v[188:191], v243 offset:27648
v_mfma_f32_16x16x32_bf16 v[12:15], v[216:219], v[192:195], v[12:15]
v_mfma_f32_16x16x32_bf16 v[32:35], v[220:223], v[192:195], v[32:35]
s_waitcnt lgkmcnt(1)
s_mov_b32 m0, s4
s_add_u32 s9, s66, 6144
buffer_load_dwordx4 v232, s[48:51], s9 offen offset:2048 nt lds
s_add_u32 s8, s66, 9216
buffer_load_dwordx4 v232, s[48:51], s8 offen offset:3072 nt lds
v_mfma_f32_16x16x32_bf16 v[52:55], v[224:227], v[192:195], v[52:55]
v_mfma_f32_16x16x32_bf16 v[72:75], v[228:231], v[192:195], v[72:75]
ds_read_b128 v[192:195], v243 offset:28672
v_mfma_f32_16x16x32_bf16 v[16:19], v[216:219], v[196:199], v[16:19]
v_mfma_f32_16x16x32_bf16 v[36:39], v[220:223], v[196:199], v[36:39]
v_mfma_f32_16x16x32_bf16 v[56:59], v[224:227], v[196:199], v[56:59]
v_mfma_f32_16x16x32_bf16 v[76:79], v[228:231], v[196:199], v[76:79]
ds_read_b128 v[196:199], v243 offset:29696
v_mfma_f32_16x16x32_bf16 v[0:3], v[200:203], v[160:163], v[0:3]
v_mfma_f32_16x16x32_bf16 v[20:23], v[204:207], v[160:163], v[20:23]
s_waitcnt vmcnt(6)
ds_read_b64_tr_b16 v[216:217], v236 offset:4096
ds_read_b64_tr_b16 v[220:221], v237 offset:4096
ds_read_b64_tr_b16 v[224:225], v238 offset:4096
ds_read_b64_tr_b16 v[228:229], v239 offset:4096
v_mfma_f32_16x16x32_bf16 v[40:43], v[208:211], v[160:163], v[40:43]
v_mfma_f32_16x16x32_bf16 v[60:63], v[212:215], v[160:163], v[60:63]
v_mfma_f32_16x16x32_bf16 v[4:7], v[200:203], v[164:167], v[4:7]
v_mfma_f32_16x16x32_bf16 v[24:27], v[204:207], v[164:167], v[24:27]
v_mfma_f32_16x16x32_bf16 v[44:47], v[208:211], v[164:167], v[44:47]
s_waitcnt lgkmcnt(0)
s_mov_b32 m0, s5
s_add_u32 s9, s66, 16384
buffer_load_dwordx4 v232, s[48:51], s9 offen nt lds
s_add_u32 s8, s66, 19456
buffer_load_dwordx4 v232, s[48:51], s8 offen offset:1024 nt lds
v_mfma_f32_16x16x32_bf16 v[64:67], v[212:215], v[164:167], v[64:67]
v_mfma_f32_16x16x32_bf16 v[8:11], v[200:203], v[168:171], v[8:11]
s_waitcnt vmcnt(6)
ds_read_b64_tr_b16 v[218:219], v236 offset:6144
ds_read_b64_tr_b16 v[222:223], v237 offset:6144
ds_read_b64_tr_b16 v[226:227], v238 offset:6144
ds_read_b64_tr_b16 v[230:231], v239 offset:6144
v_mfma_f32_16x16x32_bf16 v[28:31], v[204:207], v[168:171], v[28:31]
v_mfma_f32_16x16x32_bf16 v[48:51], v[208:211], v[168:171], v[48:51]
v_mfma_f32_16x16x32_bf16 v[68:71], v[212:215], v[168:171], v[68:71]
v_mfma_f32_16x16x32_bf16 v[12:15], v[200:203], v[172:175], v[12:15]
s_barrier
v_mfma_f32_16x16x32_bf16 v[32:35], v[204:207], v[172:175], v[32:35]
s_waitcnt lgkmcnt(0)
s_mov_b32 m0, s5
s_add_u32 s9, s66, 22528
buffer_load_dwordx4 v232, s[48:51], s9 offen offset:2048 nt lds
s_add_u32 s8, s66, 25600
buffer_load_dwordx4 v232, s[48:51], s8 offen offset:3072 nt lds
v_mfma_f32_16x16x32_bf16 v[52:55], v[208:211], v[172:175], v[52:55]
v_mfma_f32_16x16x32_bf16 v[72:75], v[212:215], v[172:175], v[72:75]
v_mfma_f32_16x16x32_bf16 v[16:19], v[200:203], v[176:179], v[16:19]
v_mfma_f32_16x16x32_bf16 v[36:39], v[204:207], v[176:179], v[36:39]
v_mfma_f32_16x16x32_bf16 v[56:59], v[208:211], v[176:179], v[56:59]
v_mfma_f32_16x16x32_bf16 v[76:79], v[212:215], v[176:179], v[76:79]
v_mfma_f32_16x16x32_bf16 v[0:3], v[216:219], v[180:183], v[0:3]
v_mfma_f32_16x16x32_bf16 v[20:23], v[220:223], v[180:183], v[20:23]
s_waitcnt vmcnt(6)
ds_read_b128 v[200:203], v240 offset:0
ds_read_b128 v[204:207], v241 offset:0
v_mfma_f32_16x16x32_bf16 v[40:43], v[224:227], v[180:183], v[40:43]
v_mfma_f32_16x16x32_bf16 v[60:63], v[228:231], v[180:183], v[60:63]
v_mfma_f32_16x16x32_bf16 v[4:7], v[216:219], v[184:187], v[4:7]
v_mfma_f32_16x16x32_bf16 v[24:27], v[220:223], v[184:187], v[24:27]
v_mfma_f32_16x16x32_bf16 v[44:47], v[224:227], v[184:187], v[44:47]
s_waitcnt lgkmcnt(0)
s_mov_b32 m0, s4
s_add_u32 s9, s67, 0
buffer_load_dwordx4 v232, s[48:51], s9 offen nt lds
s_add_u32 s8, s67, 3072
buffer_load_dwordx4 v232, s[48:51], s8 offen offset:1024 nt lds
v_mfma_f32_16x16x32_bf16 v[64:67], v[228:231], v[184:187], v[64:67]
v_mfma_f32_16x16x32_bf16 v[8:11], v[216:219], v[188:191], v[8:11]
s_waitcnt vmcnt(6)
ds_read_b128 v[208:211], v240 offset:2048
ds_read_b128 v[212:215], v241 offset:2048
v_mfma_f32_16x16x32_bf16 v[28:31], v[220:223], v[188:191], v[28:31]
v_mfma_f32_16x16x32_bf16 v[48:51], v[224:227], v[188:191], v[48:51]
v_mfma_f32_16x16x32_bf16 v[68:71], v[228:231], v[188:191], v[68:71]
v_mfma_f32_16x16x32_bf16 v[12:15], v[216:219], v[192:195], v[12:15]
v_cvt_pk_bf16_f32 v0, v0, v1
v_cvt_pk_bf16_f32 v1, v2, v3
ds_write_b64 v251, v[0:1] offset:0
v_cvt_pk_bf16_f32 v20, v20, v21
v_cvt_pk_bf16_f32 v21, v22, v23
ds_write_b64 v252, v[20:21] offset:0
v_cvt_pk_bf16_f32 v40, v40, v41
v_cvt_pk_bf16_f32 v41, v42, v43
ds_write_b64 v251, v[40:41] offset:5120
v_cvt_pk_bf16_f32 v60, v60, v61
v_cvt_pk_bf16_f32 v61, v62, v63
ds_write_b64 v252, v[60:61] offset:5120
v_mfma_f32_16x16x32_bf16 v[32:35], v[220:223], v[192:195], v[32:35]
s_waitcnt lgkmcnt(4)
s_mov_b32 m0, s4
s_add_u32 s9, s67, 6144
buffer_load_dwordx4 v232, s[48:51], s9 offen offset:2048 nt lds
s_add_u32 s8, s67, 9216
buffer_load_dwordx4 v232, s[48:51], s8 offen offset:3072 nt lds
v_mfma_f32_16x16x32_bf16 v[52:55], v[224:227], v[192:195], v[52:55]
v_mfma_f32_16x16x32_bf16 v[72:75], v[228:231], v[192:195], v[72:75]
v_mfma_f32_16x16x32_bf16 v[16:19], v[216:219], v[196:199], v[16:19]
v_cvt_pk_bf16_f32 v4, v4, v5
v_cvt_pk_bf16_f32 v5, v6, v7
ds_write_b64 v251, v[4:5] offset:1024
v_cvt_pk_bf16_f32 v24, v24, v25
v_cvt_pk_bf16_f32 v25, v26, v27
ds_write_b64 v252, v[24:25] offset:1024
v_cvt_pk_bf16_f32 v44, v44, v45
v_cvt_pk_bf16_f32 v45, v46, v47
ds_write_b64 v251, v[44:45] offset:6144
v_cvt_pk_bf16_f32 v64, v64, v65
v_cvt_pk_bf16_f32 v65, v66, v67
ds_write_b64 v252, v[64:65] offset:6144
v_mfma_f32_16x16x32_bf16 v[36:39], v[220:223], v[196:199], v[36:39]
v_mfma_f32_16x16x32_bf16 v[56:59], v[224:227], v[196:199], v[56:59]
v_mfma_f32_16x16x32_bf16 v[76:79], v[228:231], v[196:199], v[76:79]
s_nop 7
v_cvt_pk_bf16_f32 v8, v8, v9
v_cvt_pk_bf16_f32 v9, v10, v11
ds_write_b64 v251, v[8:9] offset:2048
v_cvt_pk_bf16_f32 v28, v28, v29
v_cvt_pk_bf16_f32 v29, v30, v31
ds_write_b64 v252, v[28:29] offset:2048
v_cvt_pk_bf16_f32 v48, v48, v49
v_cvt_pk_bf16_f32 v49, v50, v51
ds_write_b64 v251, v[48:49] offset:7168
v_cvt_pk_bf16_f32 v68, v68, v69
v_cvt_pk_bf16_f32 v69, v70, v71
ds_write_b64 v252, v[68:69] offset:7168
v_cvt_pk_bf16_f32 v12, v12, v13
v_cvt_pk_bf16_f32 v13, v14, v15
ds_write_b64 v251, v[12:13] offset:3072
v_cvt_pk_bf16_f32 v32, v32, v33
v_cvt_pk_bf16_f32 v33, v34, v35
ds_write_b64 v252, v[32:33] offset:3072
v_cvt_pk_bf16_f32 v52, v52, v53
v_cvt_pk_bf16_f32 v53, v54, v55
ds_write_b64 v251, v[52:53] offset:8192
v_cvt_pk_bf16_f32 v72, v72, v73
v_cvt_pk_bf16_f32 v73, v74, v75
ds_write_b64 v252, v[72:73] offset:8192
v_cvt_pk_bf16_f32 v16, v16, v17
v_cvt_pk_bf16_f32 v17, v18, v19
ds_write_b64 v251, v[16:17] offset:4096
v_cvt_pk_bf16_f32 v36, v36, v37
v_cvt_pk_bf16_f32 v37, v38, v39
ds_write_b64 v252, v[36:37] offset:4096
v_cvt_pk_bf16_f32 v56, v56, v57
v_cvt_pk_bf16_f32 v57, v58, v59
ds_write_b64 v251, v[56:57] offset:9216
v_cvt_pk_bf16_f32 v76, v76, v77
v_cvt_pk_bf16_f32 v77, v78, v79
ds_write_b64 v252, v[76:77] offset:9216
s_waitcnt lgkmcnt(0)
s_barrier
s_cmp_lg_u32 s3, 0
s_cbranch_scc1 L_sigABa
s_lshl_b32 s10, s98, 2
v_mov_b32 v253, s10
v_mov_b32 v254, 1
s_mov_b64 exec, 1
global_atomic_add v253, v254, s[86:87] offset:0 sc1
s_mov_b64 exec, -1
L_sigABa:
ds_read_b128 v[160:163], v244 offset:0
ds_read_b128 v[164:167], v244 offset:1024
ds_read_b128 v[168:171], v244 offset:2048
ds_read_b128 v[172:175], v244 offset:3072
ds_read_b128 v[176:179], v244 offset:4096
ds_read_b128 v[180:183], v244 offset:5120
ds_read_b128 v[184:187], v244 offset:6144
ds_read_b128 v[188:191], v244 offset:7168
ds_read_b128 v[192:195], v244 offset:8192
ds_read_b128 v[196:199], v244 offset:9216
s_waitcnt lgkmcnt(9)
v_mfma_f32_16x16x32_bf16 v[0:3], v[200:203], v[160:163], 0
v_mfma_f32_16x16x32_bf16 v[20:23], v[208:211], v[160:163], 0
s_waitcnt vmcnt(6)
ds_read_b128 v[216:219], v240 offset:4096
ds_read_b128 v[220:223], v241 offset:4096
s_waitcnt lgkmcnt(10)
v_mfma_f32_16x16x32_bf16 v[4:7], v[200:203], v[164:167], 0
v_mfma_f32_16x16x32_bf16 v[24:27], v[208:211], v[164:167], 0
s_waitcnt lgkmcnt(9)
v_mfma_f32_16x16x32_bf16 v[8:11], v[200:203], v[168:171], 0
v_mfma_f32_16x16x32_bf16 v[28:31], v[208:211], v[168:171], 0
s_waitcnt lgkmcnt(8)
v_mfma_f32_16x16x32_bf16 v[12:15], v[200:203], v[172:175], 0
s_waitcnt lgkmcnt(0)
s_mov_b32 m0, s5
s_add_u32 s9, s67, 16384
buffer_load_dwordx4 v232, s[48:51], s9 offen nt lds
s_add_u32 s8, s67, 19456
buffer_load_dwordx4 v232, s[48:51], s8 offen offset:1024 nt lds
v_mfma_f32_16x16x32_bf16 v[32:35], v[208:211], v[172:175], 0
v_mfma_f32_16x16x32_bf16 v[16:19], v[200:203], v[176:179], 0
s_waitcnt vmcnt(6)
ds_read_b128 v[224:227], v240 offset:6144
ds_read_b128 v[228:231], v241 offset:6144
v_mfma_f32_16x16x32_bf16 v[36:39], v[208:211], v[176:179], 0
v_mfma_f32_16x16x32_bf16 v[0:3], v[204:207], v[180:183], v[0:3]
v_mfma_f32_16x16x32_bf16 v[20:23], v[212:215], v[180:183], v[20:23]
v_mfma_f32_16x16x32_bf16 v[4:7], v[204:207], v[184:187], v[4:7]
v_mfma_f32_16x16x32_bf16 v[24:27], v[212:215], v[184:187], v[24:27]
s_waitcnt lgkmcnt(0)
s_mov_b32 m0, s5
s_add_u32 s9, s67, 22528
buffer_load_dwordx4 v232, s[48:51], s9 offen offset:2048 nt lds
s_add_u32 s8, s67, 25600
buffer_load_dwordx4 v232, s[48:51], s8 offen offset:3072 nt lds
v_mfma_f32_16x16x32_bf16 v[8:11], v[204:207], v[188:191], v[8:11]
v_mfma_f32_16x16x32_bf16 v[28:31], v[212:215], v[188:191], v[28:31]
v_mfma_f32_16x16x32_bf16 v[12:15], v[204:207], v[192:195], v[12:15]
v_mfma_f32_16x16x32_bf16 v[32:35], v[212:215], v[192:195], v[32:35]
v_mfma_f32_16x16x32_bf16 v[16:19], v[204:207], v[196:199], v[16:19]
v_mfma_f32_16x16x32_bf16 v[36:39], v[212:215], v[196:199], v[36:39]
v_mfma_f32_16x16x32_bf16 v[40:43], v[216:219], v[160:163], 0
v_mfma_f32_16x16x32_bf16 v[60:63], v[224:227], v[160:163], 0
ds_read_b128 v[160:163], v244 offset:10240
s_waitcnt vmcnt(6)
ds_read_b128 v[200:203], v240 offset:0
ds_read_b128 v[204:207], v241 offset:0
v_mfma_f32_16x16x32_bf16 v[44:47], v[216:219], v[164:167], 0
v_mfma_f32_16x16x32_bf16 v[64:67], v[224:227], v[164:167], 0
ds_read_b128 v[164:167], v244 offset:11264
v_mfma_f32_16x16x32_bf16 v[48:51], v[216:219], v[168:171], 0
v_mfma_f32_16x16x32_bf16 v[68:71], v[224:227], v[168:171], 0
ds_read_b128 v[168:171], v244 offset:12288
v_mfma_f32_16x16x32_bf16 v[52:55], v[216:219], v[172:175], 0
s_waitcnt lgkmcnt(2)
s_mov_b32 m0, s4
s_add_u32 s9, s68, 0
buffer_load_dwordx4 v232, s[48:51], s9 offen nt lds
s_add_u32 s8, s68, 3072
buffer_load_dwordx4 v232, s[48:51], s8 offen offset:1024 nt lds
v_mfma_f32_16x16x32_bf16 v[72:75], v[224:227], v[172:175], 0
ds_read_b128 v[172:175], v244 offset:13312
v_mfma_f32_16x16x32_bf16 v[56:59], v[216:219], v[176:179], 0
s_waitcnt vmcnt(6)
ds_read_b128 v[208:211], v240 offset:2048
ds_read_b128 v[212:215], v241 offset:2048
v_mfma_f32_16x16x32_bf16 v[76:79], v[224:227], v[176:179], 0
ds_read_b128 v[176:179], v244 offset:14336
v_mfma_f32_16x16x32_bf16 v[40:43], v[220:223], v[180:183], v[40:43]
v_mfma_f32_16x16x32_bf16 v[60:63], v[228:231], v[180:183], v[60:63]
ds_read_b128 v[180:183], v244 offset:15360
v_mfma_f32_16x16x32_bf16 v[44:47], v[220:223], v[184:187], v[44:47]
v_mfma_f32_16x16x32_bf16 v[64:67], v[228:231], v[184:187], v[64:67]
ds_read_b128 v[184:187], v244 offset:16384
s_waitcnt lgkmcnt(3)
s_mov_b32 m0, s4
s_add_u32 s9, s68, 6144
buffer_load_dwordx4 v232, s[48:51], s9 offen offset:2048 nt lds
s_add_u32 s8, s68, 9216
buffer_load_dwordx4 v232, s[48:51], s8 offen offset:3072 nt lds
v_mfma_f32_16x16x32_bf16 v[48:51], v[220:223], v[188:191], v[48:51]
v_mfma_f32_16x16x32_bf16 v[68:71], v[228:231], v[188:191], v[68:71]
ds_read_b128 v[188:191], v244 offset:17408
v_mfma_f32_16x16x32_bf16 v[52:55], v[220:223], v[192:195], v[52:55]
v_mfma_f32_16x16x32_bf16 v[72:75], v[228:231], v[192:195], v[72:75]
ds_read_b128 v[192:195], v244 offset:18432
v_mfma_f32_16x16x32_bf16 v[56:59], v[220:223], v[196:199], v[56:59]
v_mfma_f32_16x16x32_bf16 v[76:79], v[228:231], v[196:199], v[76:79]
ds_read_b128 v[196:199], v244 offset:19456
v_mfma_f32_16x16x32_bf16 v[0:3], v[200:203], v[160:163], v[0:3]
v_mfma_f32_16x16x32_bf16 v[20:23], v[208:211], v[160:163], v[20:23]
s_waitcnt vmcnt(6)
ds_read_b128 v[216:219], v240 offset:4096
ds_read_b128 v[220:223], v241 offset:4096
v_mfma_f32_16x16x32_bf16 v[4:7], v[200:203], v[164:167], v[4:7]
v_mfma_f32_16x16x32_bf16 v[24:27], v[208:211], v[164:167], v[24:27]
v_mfma_f32_16x16x32_bf16 v[8:11], v[200:203], v[168:171], v[8:11]
v_mfma_f32_16x16x32_bf16 v[28:31], v[208:211], v[168:171], v[28:31]
v_mfma_f32_16x16x32_bf16 v[12:15], v[200:203], v[172:175], v[12:15]
s_waitcnt lgkmcnt(0)
s_mov_b32 m0, s5
s_add_u32 s9, s68, 16384
buffer_load_dwordx4 v232, s[48:51], s9 offen nt lds
s_add_u32 s8, s68, 19456
buffer_load_dwordx4 v232, s[48:51], s8 offen offset:1024 nt lds
v_mfma_f32_16x16x32_bf16 v[32:35], v[208:211], v[172:175], v[32:35]
v_mfma_f32_16x16x32_bf16 v[16:19], v[200:203], v[176:179], v[16:19]
s_waitcnt vmcnt(6)
ds_read_b128 v[224:227], v240 offset:6144
ds_read_b128 v[228:231], v241 offset:6144
v_mfma_f32_16x16x32_bf16 v[36:39], v[208:211], v[176:179], v[36:39]
v_mfma_f32_16x16x32_bf16 v[0:3], v[204:207], v[180:183], v[0:3]
v_mfma_f32_16x16x32_bf16 v[20:23], v[212:215], v[180:183], v[20:23]
v_mfma_f32_16x16x32_bf16 v[4:7], v[204:207], v[184:187], v[4:7]
v_mfma_f32_16x16x32_bf16 v[24:27], v[212:215], v[184:187], v[24:27]
s_waitcnt lgkmcnt(0)
s_mov_b32 m0, s5
s_add_u32 s9, s68, 22528
buffer_load_dwordx4 v232, s[48:51], s9 offen offset:2048 nt lds
s_add_u32 s8, s68, 25600
buffer_load_dwordx4 v232, s[48:51], s8 offen offset:3072 nt lds
v_mfma_f32_16x16x32_bf16 v[8:11], v[204:207], v[188:191], v[8:11]
v_mfma_f32_16x16x32_bf16 v[28:31], v[212:215], v[188:191], v[28:31]
v_mfma_f32_16x16x32_bf16 v[12:15], v[204:207], v[192:195], v[12:15]
v_mfma_f32_16x16x32_bf16 v[32:35], v[212:215], v[192:195], v[32:35]
v_mfma_f32_16x16x32_bf16 v[16:19], v[204:207], v[196:199], v[16:19]
v_mfma_f32_16x16x32_bf16 v[36:39], v[212:215], v[196:199], v[36:39]
v_mfma_f32_16x16x32_bf16 v[40:43], v[216:219], v[160:163], v[40:43]
v_mfma_f32_16x16x32_bf16 v[60:63], v[224:227], v[160:163], v[60:63]
ds_read_b128 v[160:163], v244 offset:20480
s_waitcnt vmcnt(6)
ds_read_b128 v[200:203], v240 offset:0
ds_read_b128 v[204:207], v241 offset:0
v_mfma_f32_16x16x32_bf16 v[44:47], v[216:219], v[164:167], v[44:47]
v_mfma_f32_16x16x32_bf16 v[64:67], v[224:227], v[164:167], v[64:67]
ds_read_b128 v[164:167], v244 offset:21504
v_mfma_f32_16x16x32_bf16 v[48:51], v[216:219], v[168:171], v[48:51]
v_mfma_f32_16x16x32_bf16 v[68:71], v[224:227], v[168:171], v[68:71]
ds_read_b128 v[168:171], v244 offset:22528
v_mfma_f32_16x16x32_bf16 v[52:55], v[216:219], v[172:175], v[52:55]
s_waitcnt lgkmcnt(2)
s_mov_b32 m0, s4
s_add_u32 s9, s69, 0
buffer_load_dwordx4 v232, s[48:51], s9 offen nt lds
s_add_u32 s8, s69, 3072
buffer_load_dwordx4 v232, s[48:51], s8 offen offset:1024 nt lds
v_mfma_f32_16x16x32_bf16 v[72:75], v[224:227], v[172:175], v[72:75]
ds_read_b128 v[172:175], v244 offset:23552
v_mfma_f32_16x16x32_bf16 v[56:59], v[216:219], v[176:179], v[56:59]
s_waitcnt vmcnt(6)
ds_read_b128 v[208:211], v240 offset:2048
ds_read_b128 v[212:215], v241 offset:2048
v_mfma_f32_16x16x32_bf16 v[76:79], v[224:227], v[176:179], v[76:79]
ds_read_b128 v[176:179], v244 offset:24576
v_mfma_f32_16x16x32_bf16 v[40:43], v[220:223], v[180:183], v[40:43]
v_mfma_f32_16x16x32_bf16 v[60:63], v[228:231], v[180:183], v[60:63]
ds_read_b128 v[180:183], v244 offset:25600
v_mfma_f32_16x16x32_bf16 v[44:47], v[220:223], v[184:187], v[44:47]
v_mfma_f32_16x16x32_bf16 v[64:67], v[228:231], v[184:187], v[64:67]
ds_read_b128 v[184:187], v244 offset:26624
s_waitcnt lgkmcnt(3)
s_mov_b32 m0, s4
s_add_u32 s9, s69, 6144
buffer_load_dwordx4 v232, s[48:51], s9 offen offset:2048 nt lds
s_add_u32 s8, s69, 9216
buffer_load_dwordx4 v232, s[48:51], s8 offen offset:3072 nt lds
v_mfma_f32_16x16x32_bf16 v[48:51], v[220:223], v[188:191], v[48:51]
v_mfma_f32_16x16x32_bf16 v[68:71], v[228:231], v[188:191], v[68:71]
ds_read_b128 v[188:191], v244 offset:27648
v_mfma_f32_16x16x32_bf16 v[52:55], v[220:223], v[192:195], v[52:55]
v_mfma_f32_16x16x32_bf16 v[72:75], v[228:231], v[192:195], v[72:75]
ds_read_b128 v[192:195], v244 offset:28672
v_mfma_f32_16x16x32_bf16 v[56:59], v[220:223], v[196:199], v[56:59]
v_mfma_f32_16x16x32_bf16 v[76:79], v[228:231], v[196:199], v[76:79]
ds_read_b128 v[196:199], v244 offset:29696
v_mfma_f32_16x16x32_bf16 v[0:3], v[200:203], v[160:163], v[0:3]
v_mfma_f32_16x16x32_bf16 v[20:23], v[208:211], v[160:163], v[20:23]
s_waitcnt vmcnt(6)
ds_read_b128 v[216:219], v240 offset:4096
ds_read_b128 v[220:223], v241 offset:4096
v_mfma_f32_16x16x32_bf16 v[4:7], v[200:203], v[164:167], v[4:7]
v_mfma_f32_16x16x32_bf16 v[24:27], v[208:211], v[164:167], v[24:27]
v_mfma_f32_16x16x32_bf16 v[8:11], v[200:203], v[168:171], v[8:11]
v_mfma_f32_16x16x32_bf16 v[28:31], v[208:211], v[168:171], v[28:31]
v_mfma_f32_16x16x32_bf16 v[12:15], v[200:203], v[172:175], v[12:15]
s_waitcnt lgkmcnt(0)
s_mov_b32 m0, s5
s_add_u32 s9, s69, 16384
buffer_load_dwordx4 v232, s[48:51], s9 offen nt lds
s_add_u32 s8, s69, 19456
buffer_load_dwordx4 v232, s[48:51], s8 offen offset:1024 nt lds
v_mfma_f32_16x16x32_bf16 v[32:35], v[208:211], v[172:175], v[32:35]
v_mfma_f32_16x16x32_bf16 v[16:19], v[200:203], v[176:179], v[16:19]
s_waitcnt vmcnt(6)
ds_read_b128 v[224:227], v240 offset:6144
ds_read_b128 v[228:231], v241 offset:6144
v_mfma_f32_16x16x32_bf16 v[36:39], v[208:211], v[176:179], v[36:39]
v_mfma_f32_16x16x32_bf16 v[0:3], v[204:207], v[180:183], v[0:3]
v_mfma_f32_16x16x32_bf16 v[20:23], v[212:215], v[180:183], v[20:23]
v_mfma_f32_16x16x32_bf16 v[4:7], v[204:207], v[184:187], v[4:7]
v_mfma_f32_16x16x32_bf16 v[24:27], v[212:215], v[184:187], v[24:27]
s_waitcnt lgkmcnt(0)
s_mov_b32 m0, s5
s_add_u32 s9, s69, 22528
buffer_load_dwordx4 v232, s[48:51], s9 offen offset:2048 nt lds
s_add_u32 s8, s69, 25600
buffer_load_dwordx4 v232, s[48:51], s8 offen offset:3072 nt lds
v_mfma_f32_16x16x32_bf16 v[8:11], v[204:207], v[188:191], v[8:11]
v_mfma_f32_16x16x32_bf16 v[28:31], v[212:215], v[188:191], v[28:31]
v_mfma_f32_16x16x32_bf16 v[12:15], v[204:207], v[192:195], v[12:15]
v_mfma_f32_16x16x32_bf16 v[32:35], v[212:215], v[192:195], v[32:35]
v_mfma_f32_16x16x32_bf16 v[16:19], v[204:207], v[196:199], v[16:19]
v_mfma_f32_16x16x32_bf16 v[36:39], v[212:215], v[196:199], v[36:39]
v_mfma_f32_16x16x32_bf16 v[40:43], v[216:219], v[160:163], v[40:43]
v_mfma_f32_16x16x32_bf16 v[60:63], v[224:227], v[160:163], v[60:63]
ds_read_b128 v[160:163], v244 offset:30720
s_waitcnt vmcnt(6)
ds_read_b128 v[200:203], v240 offset:0
ds_read_b128 v[204:207], v241 offset:0
v_mfma_f32_16x16x32_bf16 v[44:47], v[216:219], v[164:167], v[44:47]
v_mfma_f32_16x16x32_bf16 v[64:67], v[224:227], v[164:167], v[64:67]
ds_read_b128 v[164:167], v244 offset:31744
v_mfma_f32_16x16x32_bf16 v[48:51], v[216:219], v[168:171], v[48:51]
v_mfma_f32_16x16x32_bf16 v[68:71], v[224:227], v[168:171], v[68:71]
ds_read_b128 v[168:171], v244 offset:32768
v_mfma_f32_16x16x32_bf16 v[52:55], v[216:219], v[172:175], v[52:55]
s_waitcnt lgkmcnt(2)
s_mov_b32 m0, s4
s_add_u32 s9, s66, 131072
buffer_load_dwordx4 v232, s[48:51], s9 offen nt lds
s_add_u32 s8, s66, 134144
buffer_load_dwordx4 v232, s[48:51], s8 offen offset:1024 nt lds
v_mfma_f32_16x16x32_bf16 v[72:75], v[224:227], v[172:175], v[72:75]
ds_read_b128 v[172:175], v244 offset:33792
v_mfma_f32_16x16x32_bf16 v[56:59], v[216:219], v[176:179], v[56:59]
s_waitcnt vmcnt(6)
ds_read_b128 v[208:211], v240 offset:2048
ds_read_b128 v[212:215], v241 offset:2048
v_mfma_f32_16x16x32_bf16 v[76:79], v[224:227], v[176:179], v[76:79]
ds_read_b128 v[176:179], v244 offset:34816
v_mfma_f32_16x16x32_bf16 v[40:43], v[220:223], v[180:183], v[40:43]
v_mfma_f32_16x16x32_bf16 v[60:63], v[228:231], v[180:183], v[60:63]
ds_read_b128 v[180:183], v244 offset:35840
v_mfma_f32_16x16x32_bf16 v[44:47], v[220:223], v[184:187], v[44:47]
v_mfma_f32_16x16x32_bf16 v[64:67], v[228:231], v[184:187], v[64:67]
ds_read_b128 v[184:187], v244 offset:36864
s_waitcnt lgkmcnt(3)
s_mov_b32 m0, s4
s_add_u32 s9, s66, 137216
buffer_load_dwordx4 v232, s[48:51], s9 offen offset:2048 nt lds
s_add_u32 s8, s66, 140288
buffer_load_dwordx4 v232, s[48:51], s8 offen offset:3072 nt lds
v_mfma_f32_16x16x32_bf16 v[48:51], v[220:223], v[188:191], v[48:51]
v_mfma_f32_16x16x32_bf16 v[68:71], v[228:231], v[188:191], v[68:71]
ds_read_b128 v[188:191], v244 offset:37888
v_mfma_f32_16x16x32_bf16 v[52:55], v[220:223], v[192:195], v[52:55]
v_mfma_f32_16x16x32_bf16 v[72:75], v[228:231], v[192:195], v[72:75]
ds_read_b128 v[192:195], v244 offset:38912
v_mfma_f32_16x16x32_bf16 v[56:59], v[220:223], v[196:199], v[56:59]
v_mfma_f32_16x16x32_bf16 v[76:79], v[228:231], v[196:199], v[76:79]
ds_read_b128 v[196:199], v244 offset:39936
v_mfma_f32_16x16x32_bf16 v[0:3], v[200:203], v[160:163], v[0:3]
v_mfma_f32_16x16x32_bf16 v[20:23], v[208:211], v[160:163], v[20:23]
s_waitcnt vmcnt(6)
ds_read_b128 v[216:219], v240 offset:4096
ds_read_b128 v[220:223], v241 offset:4096
v_mfma_f32_16x16x32_bf16 v[4:7], v[200:203], v[164:167], v[4:7]
v_mfma_f32_16x16x32_bf16 v[24:27], v[208:211], v[164:167], v[24:27]
v_mfma_f32_16x16x32_bf16 v[8:11], v[200:203], v[168:171], v[8:11]
v_mfma_f32_16x16x32_bf16 v[28:31], v[208:211], v[168:171], v[28:31]
v_mfma_f32_16x16x32_bf16 v[12:15], v[200:203], v[172:175], v[12:15]
s_waitcnt lgkmcnt(0)
s_mov_b32 m0, s5
s_add_u32 s9, s66, 147456
buffer_load_dwordx4 v232, s[48:51], s9 offen nt lds
s_add_u32 s8, s66, 150528
buffer_load_dwordx4 v232, s[48:51], s8 offen offset:1024 nt lds
v_mfma_f32_16x16x32_bf16 v[32:35], v[208:211], v[172:175], v[32:35]
v_mfma_f32_16x16x32_bf16 v[16:19], v[200:203], v[176:179], v[16:19]
s_waitcnt vmcnt(6)
ds_read_b128 v[224:227], v240 offset:6144
ds_read_b128 v[228:231], v241 offset:6144
v_mfma_f32_16x16x32_bf16 v[36:39], v[208:211], v[176:179], v[36:39]
v_mfma_f32_16x16x32_bf16 v[0:3], v[204:207], v[180:183], v[0:3]
v_mfma_f32_16x16x32_bf16 v[20:23], v[212:215], v[180:183], v[20:23]
v_mfma_f32_16x16x32_bf16 v[4:7], v[204:207], v[184:187], v[4:7]
v_mfma_f32_16x16x32_bf16 v[24:27], v[212:215], v[184:187], v[24:27]
s_waitcnt lgkmcnt(0)
s_mov_b32 m0, s5
s_add_u32 s9, s66, 153600
buffer_load_dwordx4 v232, s[48:51], s9 offen offset:2048 nt lds
s_add_u32 s8, s66, 156672
buffer_load_dwordx4 v232, s[48:51], s8 offen offset:3072 nt lds
v_mfma_f32_16x16x32_bf16 v[8:11], v[204:207], v[188:191], v[8:11]
v_mfma_f32_16x16x32_bf16 v[28:31], v[212:215], v[188:191], v[28:31]
v_mfma_f32_16x16x32_bf16 v[12:15], v[204:207], v[192:195], v[12:15]
v_mfma_f32_16x16x32_bf16 v[32:35], v[212:215], v[192:195], v[32:35]
v_mfma_f32_16x16x32_bf16 v[16:19], v[204:207], v[196:199], v[16:19]
v_mfma_f32_16x16x32_bf16 v[36:39], v[212:215], v[196:199], v[36:39]
v_mfma_f32_16x16x32_bf16 v[40:43], v[216:219], v[160:163], v[40:43]
v_mfma_f32_16x16x32_bf16 v[60:63], v[224:227], v[160:163], v[60:63]
ds_read_b128 v[160:163], v244 offset:0
s_waitcnt vmcnt(6)
ds_read_b128 v[200:203], v240 offset:0
ds_read_b128 v[204:207], v241 offset:0
v_mfma_f32_16x16x32_bf16 v[44:47], v[216:219], v[164:167], v[44:47]
v_mfma_f32_16x16x32_bf16 v[64:67], v[224:227], v[164:167], v[64:67]
ds_read_b128 v[164:167], v244 offset:1024
v_mfma_f32_16x16x32_bf16 v[48:51], v[216:219], v[168:171], v[48:51]
v_mfma_f32_16x16x32_bf16 v[68:71], v[224:227], v[168:171], v[68:71]
ds_read_b128 v[168:171], v244 offset:2048
v_mfma_f32_16x16x32_bf16 v[52:55], v[216:219], v[172:175], v[52:55]
s_waitcnt lgkmcnt(2)
s_mov_b32 m0, s4
s_add_u32 s9, s67, 131072
buffer_load_dwordx4 v232, s[48:51], s9 offen nt lds
s_add_u32 s8, s67, 134144
buffer_load_dwordx4 v232, s[48:51], s8 offen offset:1024 nt lds
v_mfma_f32_16x16x32_bf16 v[72:75], v[224:227], v[172:175], v[72:75]
ds_read_b128 v[172:175], v244 offset:3072
v_mfma_f32_16x16x32_bf16 v[56:59], v[216:219], v[176:179], v[56:59]
s_waitcnt vmcnt(6)
ds_read_b128 v[208:211], v240 offset:2048
ds_read_b128 v[212:215], v241 offset:2048
v_mfma_f32_16x16x32_bf16 v[76:79], v[224:227], v[176:179], v[76:79]
ds_read_b128 v[176:179], v244 offset:4096
v_mfma_f32_16x16x32_bf16 v[40:43], v[220:223], v[180:183], v[40:43]
v_mfma_f32_16x16x32_bf16 v[60:63], v[228:231], v[180:183], v[60:63]
ds_read_b128 v[180:183], v244 offset:5120
v_mfma_f32_16x16x32_bf16 v[44:47], v[220:223], v[184:187], v[44:47]
v_mfma_f32_16x16x32_bf16 v[64:67], v[228:231], v[184:187], v[64:67]
ds_read_b128 v[184:187], v244 offset:6144
s_waitcnt lgkmcnt(3)
s_mov_b32 m0, s4
s_add_u32 s9, s67, 137216
buffer_load_dwordx4 v232, s[48:51], s9 offen offset:2048 nt lds
s_add_u32 s8, s67, 140288
buffer_load_dwordx4 v232, s[48:51], s8 offen offset:3072 nt lds
v_mfma_f32_16x16x32_bf16 v[48:51], v[220:223], v[188:191], v[48:51]
v_mfma_f32_16x16x32_bf16 v[68:71], v[228:231], v[188:191], v[68:71]
ds_read_b128 v[188:191], v244 offset:7168
v_mfma_f32_16x16x32_bf16 v[52:55], v[220:223], v[192:195], v[52:55]
v_mfma_f32_16x16x32_bf16 v[72:75], v[228:231], v[192:195], v[72:75]
ds_read_b128 v[192:195], v244 offset:8192
v_mfma_f32_16x16x32_bf16 v[56:59], v[220:223], v[196:199], v[56:59]
v_mfma_f32_16x16x32_bf16 v[76:79], v[228:231], v[196:199], v[76:79]
ds_read_b128 v[196:199], v244 offset:9216
v_mfma_f32_16x16x32_bf16 v[80:83], v[200:203], v[160:163], 0
v_mfma_f32_16x16x32_bf16 v[100:103], v[208:211], v[160:163], 0
s_waitcnt vmcnt(6)
ds_read_b128 v[216:219], v240 offset:4096
ds_read_b128 v[220:223], v241 offset:4096
v_mfma_f32_16x16x32_bf16 v[84:87], v[200:203], v[164:167], 0
v_mfma_f32_16x16x32_bf16 v[104:107], v[208:211], v[164:167], 0
v_mfma_f32_16x16x32_bf16 v[88:91], v[200:203], v[168:171], 0
v_mfma_f32_16x16x32_bf16 v[108:111], v[208:211], v[168:171], 0
v_mfma_f32_16x16x32_bf16 v[92:95], v[200:203], v[172:175], 0
s_waitcnt lgkmcnt(0)
s_mov_b32 m0, s5
s_add_u32 s9, s67, 147456
buffer_load_dwordx4 v232, s[48:51], s9 offen nt lds
s_add_u32 s8, s67, 150528
buffer_load_dwordx4 v232, s[48:51], s8 offen offset:1024 nt lds
v_mfma_f32_16x16x32_bf16 v[112:115], v[208:211], v[172:175], 0
v_mfma_f32_16x16x32_bf16 v[96:99], v[200:203], v[176:179], 0
s_waitcnt vmcnt(6)
ds_read_b128 v[224:227], v240 offset:6144
ds_read_b128 v[228:231], v241 offset:6144
v_mfma_f32_16x16x32_bf16 v[116:119], v[208:211], v[176:179], 0
v_mfma_f32_16x16x32_bf16 v[80:83], v[204:207], v[180:183], v[80:83]
v_mfma_f32_16x16x32_bf16 v[100:103], v[212:215], v[180:183], v[100:103]
v_mfma_f32_16x16x32_bf16 v[84:87], v[204:207], v[184:187], v[84:87]
v_mfma_f32_16x16x32_bf16 v[104:107], v[212:215], v[184:187], v[104:107]
s_waitcnt lgkmcnt(0)
s_mov_b32 m0, s5
s_add_u32 s9, s67, 153600
buffer_load_dwordx4 v232, s[48:51], s9 offen offset:2048 nt lds
s_add_u32 s8, s67, 156672
buffer_load_dwordx4 v232, s[48:51], s8 offen offset:3072 nt lds
v_mfma_f32_16x16x32_bf16 v[88:91], v[204:207], v[188:191], v[88:91]
v_mfma_f32_16x16x32_bf16 v[108:111], v[212:215], v[188:191], v[108:111]
v_max_f32 v246, v0, v1
v_mfma_f32_16x16x32_bf16 v[92:95], v[204:207], v[192:195], v[92:95]
v_mfma_f32_16x16x32_bf16 v[112:115], v[212:215], v[192:195], v[112:115]
v_max_f32 v247, v4, v5
v_mfma_f32_16x16x32_bf16 v[96:99], v[204:207], v[196:199], v[96:99]
v_mfma_f32_16x16x32_bf16 v[116:119], v[212:215], v[196:199], v[116:119]
v_max_f32 v248, v8, v9
v_mfma_f32_16x16x32_bf16 v[120:123], v[216:219], v[160:163], 0
v_mfma_f32_16x16x32_bf16 v[140:143], v[224:227], v[160:163], 0
v_max_f32 v249, v12, v13
ds_read_b128 v[160:163], v244 offset:10240
s_waitcnt vmcnt(6)
ds_read_b128 v[200:203], v240 offset:0
ds_read_b128 v[204:207], v241 offset:0
v_mfma_f32_16x16x32_bf16 v[124:127], v[216:219], v[164:167], 0
v_mfma_f32_16x16x32_bf16 v[144:147], v[224:227], v[164:167], 0
v_max_f32 v250, v16, v17
ds_read_b128 v[164:167], v244 offset:11264
v_mfma_f32_16x16x32_bf16 v[128:131], v[216:219], v[168:171], 0
v_mfma_f32_16x16x32_bf16 v[148:151], v[224:227], v[168:171], 0
v_max3_f32 v246, v246, v2, v3
ds_read_b128 v[168:171], v244 offset:12288
v_mfma_f32_16x16x32_bf16 v[132:135], v[216:219], v[172:175], 0
s_waitcnt lgkmcnt(2)
s_mov_b32 m0, s4
s_add_u32 s9, s68, 131072
buffer_load_dwordx4 v232, s[48:51], s9 offen nt lds
s_add_u32 s8, s68, 134144
buffer_load_dwordx4 v232, s[48:51], s8 offen offset:1024 nt lds
v_mfma_f32_16x16x32_bf16 v[152:155], v[224:227], v[172:175], 0
v_max3_f32 v247, v247, v6, v7
ds_read_b128 v[172:175], v244 offset:13312
v_mfma_f32_16x16x32_bf16 v[136:139], v[216:219], v[176:179], 0
s_waitcnt vmcnt(6)
ds_read_b128 v[208:211], v240 offset:2048
ds_read_b128 v[212:215], v241 offset:2048
v_mfma_f32_16x16x32_bf16 v[156:159], v[224:227], v[176:179], 0
v_max3_f32 v248, v248, v10, v11
ds_read_b128 v[176:179], v244 offset:14336
v_mfma_f32_16x16x32_bf16 v[120:123], v[220:223], v[180:183], v[120:123]
v_mfma_f32_16x16x32_bf16 v[140:143], v[228:231], v[180:183], v[140:143]
v_max3_f32 v249, v249, v14, v15
ds_read_b128 v[180:183], v244 offset:15360
v_mfma_f32_16x16x32_bf16 v[124:127], v[220:223], v[184:187], v[124:127]
v_mfma_f32_16x16x32_bf16 v[144:147], v[228:231], v[184:187], v[144:147]
v_max3_f32 v250, v250, v18, v19
ds_read_b128 v[184:187], v244 offset:16384
s_waitcnt lgkmcnt(3)
s_mov_b32 m0, s4
s_add_u32 s9, s68, 137216
buffer_load_dwordx4 v232, s[48:51], s9 offen offset:2048 nt lds
s_add_u32 s8, s68, 140288
buffer_load_dwordx4 v232, s[48:51], s8 offen offset:3072 nt lds
v_mfma_f32_16x16x32_bf16 v[128:131], v[220:223], v[188:191], v[128:131]
v_mfma_f32_16x16x32_bf16 v[148:151], v[228:231], v[188:191], v[148:151]
v_max3_f32 v246, v246, v20, v21
ds_read_b128 v[188:191], v244 offset:17408
v_mfma_f32_16x16x32_bf16 v[132:135], v[220:223], v[192:195], v[132:135]
v_mfma_f32_16x16x32_bf16 v[152:155], v[228:231], v[192:195], v[152:155]
v_max3_f32 v247, v247, v24, v25
ds_read_b128 v[192:195], v244 offset:18432
v_mfma_f32_16x16x32_bf16 v[136:139], v[220:223], v[196:199], v[136:139]
v_mfma_f32_16x16x32_bf16 v[156:159], v[228:231], v[196:199], v[156:159]
v_max3_f32 v248, v248, v28, v29
ds_read_b128 v[196:199], v244 offset:19456
v_mfma_f32_16x16x32_bf16 v[80:83], v[200:203], v[160:163], v[80:83]
v_mfma_f32_16x16x32_bf16 v[100:103], v[208:211], v[160:163], v[100:103]
v_max3_f32 v249, v249, v32, v33
s_waitcnt vmcnt(6)
ds_read_b128 v[216:219], v240 offset:4096
ds_read_b128 v[220:223], v241 offset:4096
v_mfma_f32_16x16x32_bf16 v[84:87], v[200:203], v[164:167], v[84:87]
v_mfma_f32_16x16x32_bf16 v[104:107], v[208:211], v[164:167], v[104:107]
v_max3_f32 v250, v250, v36, v37
v_mfma_f32_16x16x32_bf16 v[88:91], v[200:203], v[168:171], v[88:91]
v_mfma_f32_16x16x32_bf16 v[108:111], v[208:211], v[168:171], v[108:111]
v_max3_f32 v246, v246, v22, v23
v_mfma_f32_16x16x32_bf16 v[92:95], v[200:203], v[172:175], v[92:95]
s_waitcnt lgkmcnt(0)
s_mov_b32 m0, s5
s_add_u32 s9, s68, 147456
buffer_load_dwordx4 v232, s[48:51], s9 offen nt lds
s_add_u32 s8, s68, 150528
buffer_load_dwordx4 v232, s[48:51], s8 offen offset:1024 nt lds
v_mfma_f32_16x16x32_bf16 v[112:115], v[208:211], v[172:175], v[112:115]
v_max3_f32 v247, v247, v26, v27
v_mfma_f32_16x16x32_bf16 v[96:99], v[200:203], v[176:179], v[96:99]
s_waitcnt vmcnt(6)
ds_read_b128 v[224:227], v240 offset:6144
ds_read_b128 v[228:231], v241 offset:6144
v_mfma_f32_16x16x32_bf16 v[116:119], v[208:211], v[176:179], v[116:119]
v_max3_f32 v248, v248, v30, v31
v_mfma_f32_16x16x32_bf16 v[80:83], v[204:207], v[180:183], v[80:83]
v_mfma_f32_16x16x32_bf16 v[100:103], v[212:215], v[180:183], v[100:103]
v_max3_f32 v249, v249, v34, v35
v_mfma_f32_16x16x32_bf16 v[84:87], v[204:207], v[184:187], v[84:87]
v_mfma_f32_16x16x32_bf16 v[104:107], v[212:215], v[184:187], v[104:107]
v_max3_f32 v250, v250, v38, v39
s_waitcnt lgkmcnt(0)
s_mov_b32 m0, s5
s_add_u32 s9, s68, 153600
buffer_load_dwordx4 v232, s[48:51], s9 offen offset:2048 nt lds
s_add_u32 s8, s68, 156672
buffer_load_dwordx4 v232, s[48:51], s8 offen offset:3072 nt lds
v_mfma_f32_16x16x32_bf16 v[88:91], v[204:207], v[188:191], v[88:91]
v_mfma_f32_16x16x32_bf16 v[108:111], v[212:215], v[188:191], v[108:111]
v_max3_f32 v246, v246, v40, v41
v_mfma_f32_16x16x32_bf16 v[92:95], v[204:207], v[192:195], v[92:95]
v_mfma_f32_16x16x32_bf16 v[112:115], v[212:215], v[192:195], v[112:115]
v_max3_f32 v247, v247, v44, v45
v_mfma_f32_16x16x32_bf16 v[96:99], v[204:207], v[196:199], v[96:99]
v_mfma_f32_16x16x32_bf16 v[116:119], v[212:215], v[196:199], v[116:119]
v_max3_f32 v248, v248, v48, v49
v_mfma_f32_16x16x32_bf16 v[120:123], v[216:219], v[160:163], v[120:123]
v_mfma_f32_16x16x32_bf16 v[140:143], v[224:227], v[160:163], v[140:143]
v_max3_f32 v249, v249, v52, v53
ds_read_b128 v[160:163], v244 offset:20480
s_waitcnt vmcnt(6)
ds_read_b128 v[200:203], v240 offset:0
ds_read_b128 v[204:207], v241 offset:0
v_mfma_f32_16x16x32_bf16 v[124:127], v[216:219], v[164:167], v[124:127]
v_mfma_f32_16x16x32_bf16 v[144:147], v[224:227], v[164:167], v[144:147]
v_max3_f32 v250, v250, v56, v57
ds_read_b128 v[164:167], v244 offset:21504
v_mfma_f32_16x16x32_bf16 v[128:131], v[216:219], v[168:171], v[128:131]
v_mfma_f32_16x16x32_bf16 v[148:151], v[224:227], v[168:171], v[148:151]
v_max3_f32 v246, v246, v42, v43
ds_read_b128 v[168:171], v244 offset:22528
v_mfma_f32_16x16x32_bf16 v[132:135], v[216:219], v[172:175], v[132:135]
s_waitcnt lgkmcnt(2)
s_mov_b32 m0, s4
s_add_u32 s9, s69, 131072
buffer_load_dwordx4 v232, s[48:51], s9 offen nt lds
s_add_u32 s8, s69, 134144
buffer_load_dwordx4 v232, s[48:51], s8 offen offset:1024 nt lds
v_mfma_f32_16x16x32_bf16 v[152:155], v[224:227], v[172:175], v[152:155]
v_max3_f32 v247, v247, v46, v47
ds_read_b128 v[172:175], v244 offset:23552
v_mfma_f32_16x16x32_bf16 v[136:139], v[216:219], v[176:179], v[136:139]
s_waitcnt vmcnt(6)
ds_read_b128 v[208:211], v240 offset:2048
ds_read_b128 v[212:215], v241 offset:2048
v_mfma_f32_16x16x32_bf16 v[156:159], v[224:227], v[176:179], v[156:159]
v_max3_f32 v248, v248, v50, v51
ds_read_b128 v[176:179], v244 offset:24576
v_mfma_f32_16x16x32_bf16 v[120:123], v[220:223], v[180:183], v[120:123]
v_mfma_f32_16x16x32_bf16 v[140:143], v[228:231], v[180:183], v[140:143]
v_max3_f32 v249, v249, v54, v55
ds_read_b128 v[180:183], v244 offset:25600
v_mfma_f32_16x16x32_bf16 v[124:127], v[220:223], v[184:187], v[124:127]
v_mfma_f32_16x16x32_bf16 v[144:147], v[228:231], v[184:187], v[144:147]
v_max3_f32 v250, v250, v58, v59
ds_read_b128 v[184:187], v244 offset:26624
s_waitcnt lgkmcnt(3)
s_mov_b32 m0, s4
s_add_u32 s9, s69, 137216
buffer_load_dwordx4 v232, s[48:51], s9 offen offset:2048 nt lds
s_add_u32 s8, s69, 140288
buffer_load_dwordx4 v232, s[48:51], s8 offen offset:3072 nt lds
v_mfma_f32_16x16x32_bf16 v[128:131], v[220:223], v[188:191], v[128:131]
v_mfma_f32_16x16x32_bf16 v[148:151], v[228:231], v[188:191], v[148:151]
v_max3_f32 v246, v246, v60, v61
ds_read_b128 v[188:191], v244 offset:27648
v_mfma_f32_16x16x32_bf16 v[132:135], v[220:223], v[192:195], v[132:135]
v_mfma_f32_16x16x32_bf16 v[152:155], v[228:231], v[192:195], v[152:155]
v_max3_f32 v247, v247, v64, v65
ds_read_b128 v[192:195], v244 offset:28672
v_mfma_f32_16x16x32_bf16 v[136:139], v[220:223], v[196:199], v[136:139]
v_mfma_f32_16x16x32_bf16 v[156:159], v[228:231], v[196:199], v[156:159]
v_max3_f32 v248, v248, v68, v69
ds_read_b128 v[196:199], v244 offset:29696
v_mfma_f32_16x16x32_bf16 v[80:83], v[200:203], v[160:163], v[80:83]
v_mfma_f32_16x16x32_bf16 v[100:103], v[208:211], v[160:163], v[100:103]
v_max3_f32 v249, v249, v72, v73
s_waitcnt vmcnt(6)
ds_read_b128 v[216:219], v240 offset:4096
ds_read_b128 v[220:223], v241 offset:4096
v_mfma_f32_16x16x32_bf16 v[84:87], v[200:203], v[164:167], v[84:87]
v_mfma_f32_16x16x32_bf16 v[104:107], v[208:211], v[164:167], v[104:107]
v_max3_f32 v250, v250, v76, v77
v_mfma_f32_16x16x32_bf16 v[88:91], v[200:203], v[168:171], v[88:91]
v_mfma_f32_16x16x32_bf16 v[108:111], v[208:211], v[168:171], v[108:111]
v_max3_f32 v246, v246, v62, v63
v_mfma_f32_16x16x32_bf16 v[92:95], v[200:203], v[172:175], v[92:95]
s_waitcnt lgkmcnt(0)
s_mov_b32 m0, s5
s_add_u32 s9, s69, 147456
buffer_load_dwordx4 v232, s[48:51], s9 offen nt lds
s_add_u32 s8, s69, 150528
buffer_load_dwordx4 v232, s[48:51], s8 offen offset:1024 nt lds
v_mfma_f32_16x16x32_bf16 v[112:115], v[208:211], v[172:175], v[112:115]
v_max3_f32 v247, v247, v66, v67
v_mfma_f32_16x16x32_bf16 v[96:99], v[200:203], v[176:179], v[96:99]
s_waitcnt vmcnt(6)
ds_read_b128 v[224:227], v240 offset:6144
ds_read_b128 v[228:231], v241 offset:6144
v_mfma_f32_16x16x32_bf16 v[116:119], v[208:211], v[176:179], v[116:119]
v_max3_f32 v248, v248, v70, v71
v_mfma_f32_16x16x32_bf16 v[80:83], v[204:207], v[180:183], v[80:83]
v_mfma_f32_16x16x32_bf16 v[100:103], v[212:215], v[180:183], v[100:103]
v_max3_f32 v249, v249, v74, v75
v_mfma_f32_16x16x32_bf16 v[84:87], v[204:207], v[184:187], v[84:87]
v_mfma_f32_16x16x32_bf16 v[104:107], v[212:215], v[184:187], v[104:107]
v_max3_f32 v250, v250, v78, v79
s_waitcnt lgkmcnt(0)
s_mov_b32 m0, s5
s_add_u32 s9, s69, 153600
buffer_load_dwordx4 v232, s[48:51], s9 offen offset:2048 nt lds
s_add_u32 s8, s69, 156672
buffer_load_dwordx4 v232, s[48:51], s8 offen offset:3072 nt lds
v_mfma_f32_16x16x32_bf16 v[88:91], v[204:207], v[188:191], v[88:91]
v_mfma_f32_16x16x32_bf16 v[108:111], v[212:215], v[188:191], v[108:111]
v_mfma_f32_16x16x32_bf16 v[92:95], v[204:207], v[192:195], v[92:95]
v_mfma_f32_16x16x32_bf16 v[112:115], v[212:215], v[192:195], v[112:115]
v_mfma_f32_16x16x32_bf16 v[96:99], v[204:207], v[196:199], v[96:99]
v_mfma_f32_16x16x32_bf16 v[116:119], v[212:215], v[196:199], v[116:119]
v_mfma_f32_16x16x32_bf16 v[120:123], v[216:219], v[160:163], v[120:123]
v_mfma_f32_16x16x32_bf16 v[140:143], v[224:227], v[160:163], v[140:143]
ds_read_b128 v[160:163], v244 offset:30720
s_waitcnt vmcnt(6)
ds_read_b128 v[200:203], v240 offset:0
ds_read_b128 v[204:207], v241 offset:0
v_mfma_f32_16x16x32_bf16 v[124:127], v[216:219], v[164:167], v[124:127]
v_mfma_f32_16x16x32_bf16 v[144:147], v[224:227], v[164:167], v[144:147]
ds_read_b128 v[164:167], v244 offset:31744
v_mfma_f32_16x16x32_bf16 v[128:131], v[216:219], v[168:171], v[128:131]
v_mfma_f32_16x16x32_bf16 v[148:151], v[224:227], v[168:171], v[148:151]
ds_read_b128 v[168:171], v244 offset:32768
v_mfma_f32_16x16x32_bf16 v[132:135], v[216:219], v[172:175], v[132:135]
s_waitcnt lgkmcnt(2)
s_mov_b32 m0, s4
s_mov_b32 s9, 0
buffer_load_dwordx4 v232, s[52:55], s9 offen nt lds
s_mov_b32 s8, 3072
buffer_load_dwordx4 v232, s[52:55], s8 offen offset:1024 nt lds
v_mfma_f32_16x16x32_bf16 v[152:155], v[224:227], v[172:175], v[152:155]
ds_read_b128 v[172:175], v244 offset:33792
v_mfma_f32_16x16x32_bf16 v[136:139], v[216:219], v[176:179], v[136:139]
s_waitcnt vmcnt(6)
ds_read_b128 v[208:211], v240 offset:2048
ds_read_b128 v[212:215], v241 offset:2048
v_mfma_f32_16x16x32_bf16 v[156:159], v[224:227], v[176:179], v[156:159]
ds_read_b128 v[176:179], v244 offset:34816
v_mfma_f32_16x16x32_bf16 v[120:123], v[220:223], v[180:183], v[120:123]
v_mfma_f32_16x16x32_bf16 v[140:143], v[228:231], v[180:183], v[140:143]
ds_read_b128 v[180:183], v244 offset:35840
v_mfma_f32_16x16x32_bf16 v[124:127], v[220:223], v[184:187], v[124:127]
v_mfma_f32_16x16x32_bf16 v[144:147], v[228:231], v[184:187], v[144:147]
ds_read_b128 v[184:187], v244 offset:36864
s_waitcnt lgkmcnt(3)
s_mov_b32 m0, s4
s_mov_b32 s9, 6144
buffer_load_dwordx4 v232, s[52:55], s9 offen offset:2048 nt lds
s_mov_b32 s8, 9216
buffer_load_dwordx4 v232, s[52:55], s8 offen offset:3072 nt lds
v_mfma_f32_16x16x32_bf16 v[128:131], v[220:223], v[188:191], v[128:131]
v_mfma_f32_16x16x32_bf16 v[148:151], v[228:231], v[188:191], v[148:151]
ds_read_b128 v[188:191], v244 offset:37888
v_mfma_f32_16x16x32_bf16 v[132:135], v[220:223], v[192:195], v[132:135]
v_mfma_f32_16x16x32_bf16 v[152:155], v[228:231], v[192:195], v[152:155]
ds_read_b128 v[192:195], v244 offset:38912
v_mfma_f32_16x16x32_bf16 v[136:139], v[220:223], v[196:199], v[136:139]
v_mfma_f32_16x16x32_bf16 v[156:159], v[228:231], v[196:199], v[156:159]
ds_read_b128 v[196:199], v244 offset:39936
v_mfma_f32_16x16x32_bf16 v[80:83], v[200:203], v[160:163], v[80:83]
v_mfma_f32_16x16x32_bf16 v[100:103], v[208:211], v[160:163], v[100:103]
s_waitcnt vmcnt(6)
ds_read_b128 v[216:219], v240 offset:4096
ds_read_b128 v[220:223], v241 offset:4096
v_mfma_f32_16x16x32_bf16 v[84:87], v[200:203], v[164:167], v[84:87]
v_mfma_f32_16x16x32_bf16 v[104:107], v[208:211], v[164:167], v[104:107]
v_mfma_f32_16x16x32_bf16 v[88:91], v[200:203], v[168:171], v[88:91]
v_mfma_f32_16x16x32_bf16 v[108:111], v[208:211], v[168:171], v[108:111]
v_mfma_f32_16x16x32_bf16 v[92:95], v[200:203], v[172:175], v[92:95]
s_waitcnt lgkmcnt(0)
s_mov_b32 m0, s5
s_mov_b32 s9, 16384
buffer_load_dwordx4 v232, s[52:55], s9 offen nt lds
s_mov_b32 s8, 19456
buffer_load_dwordx4 v232, s[52:55], s8 offen offset:1024 nt lds
v_mfma_f32_16x16x32_bf16 v[112:115], v[208:211], v[172:175], v[112:115]
v_mfma_f32_16x16x32_bf16 v[96:99], v[200:203], v[176:179], v[96:99]
s_waitcnt vmcnt(6)
ds_read_b128 v[224:227], v240 offset:6144
ds_read_b128 v[228:231], v241 offset:6144
v_mfma_f32_16x16x32_bf16 v[116:119], v[208:211], v[176:179], v[116:119]
v_mfma_f32_16x16x32_bf16 v[80:83], v[204:207], v[180:183], v[80:83]
v_mfma_f32_16x16x32_bf16 v[100:103], v[212:215], v[180:183], v[100:103]
v_mfma_f32_16x16x32_bf16 v[84:87], v[204:207], v[184:187], v[84:87]
v_mfma_f32_16x16x32_bf16 v[104:107], v[212:215], v[184:187], v[104:107]
s_waitcnt lgkmcnt(0)
s_mov_b32 m0, s5
s_mov_b32 s9, 22528
buffer_load_dwordx4 v232, s[52:55], s9 offen offset:2048 nt lds
s_mov_b32 s8, 25600
buffer_load_dwordx4 v232, s[52:55], s8 offen offset:3072 nt lds
v_mfma_f32_16x16x32_bf16 v[88:91], v[204:207], v[188:191], v[88:91]
v_mfma_f32_16x16x32_bf16 v[108:111], v[212:215], v[188:191], v[108:111]
v_mfma_f32_16x16x32_bf16 v[92:95], v[204:207], v[192:195], v[92:95]
v_mfma_f32_16x16x32_bf16 v[112:115], v[212:215], v[192:195], v[112:115]
v_mfma_f32_16x16x32_bf16 v[96:99], v[204:207], v[196:199], v[96:99]
v_mfma_f32_16x16x32_bf16 v[116:119], v[212:215], v[196:199], v[116:119]
v_mfma_f32_16x16x32_bf16 v[120:123], v[216:219], v[160:163], v[120:123]
v_mfma_f32_16x16x32_bf16 v[140:143], v[224:227], v[160:163], v[140:143]
s_waitcnt vmcnt(6)
ds_read_b64_tr_b16 v[200:201], v236 offset:0
ds_read_b64_tr_b16 v[204:205], v237 offset:0
ds_read_b64_tr_b16 v[208:209], v238 offset:0
ds_read_b64_tr_b16 v[212:213], v239 offset:0
v_mfma_f32_16x16x32_bf16 v[124:127], v[216:219], v[164:167], v[124:127]
v_mfma_f32_16x16x32_bf16 v[144:147], v[224:227], v[164:167], v[144:147]
v_mfma_f32_16x16x32_bf16 v[128:131], v[216:219], v[168:171], v[128:131]
v_mfma_f32_16x16x32_bf16 v[148:151], v[224:227], v[168:171], v[148:151]
v_mfma_f32_16x16x32_bf16 v[132:135], v[216:219], v[172:175], v[132:135]
s_waitcnt lgkmcnt(0)
s_mov_b32 m0, s4
s_mov_b32 s9, 32768
buffer_load_dwordx4 v232, s[52:55], s9 offen nt lds
s_mov_b32 s8, 35840
buffer_load_dwordx4 v232, s[52:55], s8 offen offset:1024 nt lds
v_mfma_f32_16x16x32_bf16 v[152:155], v[224:227], v[172:175], v[152:155]
v_mfma_f32_16x16x32_bf16 v[136:139], v[216:219], v[176:179], v[136:139]
s_waitcnt vmcnt(6)
ds_read_b64_tr_b16 v[202:203], v236 offset:2048
ds_read_b64_tr_b16 v[206:207], v237 offset:2048
ds_read_b64_tr_b16 v[210:211], v238 offset:2048
ds_read_b64_tr_b16 v[214:215], v239 offset:2048
v_mfma_f32_16x16x32_bf16 v[156:159], v[224:227], v[176:179], v[156:159]
v_mfma_f32_16x16x32_bf16 v[120:123], v[220:223], v[180:183], v[120:123]
v_mfma_f32_16x16x32_bf16 v[140:143], v[228:231], v[180:183], v[140:143]
v_mfma_f32_16x16x32_bf16 v[124:127], v[220:223], v[184:187], v[124:127]
v_mfma_f32_16x16x32_bf16 v[144:147], v[228:231], v[184:187], v[144:147]
s_waitcnt lgkmcnt(0)
s_mov_b32 m0, s4
s_mov_b32 s9, 38912
buffer_load_dwordx4 v232, s[52:55], s9 offen offset:2048 nt lds
s_mov_b32 s8, 41984
buffer_load_dwordx4 v232, s[52:55], s8 offen offset:3072 nt lds
v_mfma_f32_16x16x32_bf16 v[128:131], v[220:223], v[188:191], v[128:131]
v_mfma_f32_16x16x32_bf16 v[148:151], v[228:231], v[188:191], v[148:151]
v_mfma_f32_16x16x32_bf16 v[132:135], v[220:223], v[192:195], v[132:135]
v_mfma_f32_16x16x32_bf16 v[152:155], v[228:231], v[192:195], v[152:155]
v_mfma_f32_16x16x32_bf16 v[136:139], v[220:223], v[196:199], v[136:139]
v_mfma_f32_16x16x32_bf16 v[156:159], v[228:231], v[196:199], v[156:159]
s_nop 7
s_cmp_lg_u32 s3, 0
s_cbranch_scc1 L_flAB
s_lshl_b32 s10, s98, 2
v_mov_b32 v228, s10
s_mov_b64 exec, 1
global_load_dword v255, v228, s[86:87] offset:0 sc1
s_mov_b64 exec, -1
L_flAB:
v_max3_f32 v246, v246, v80, v81
v_max3_f32 v247, v247, v84, v85
v_max3_f32 v248, v248, v88, v89
v_max3_f32 v249, v249, v92, v93
v_max3_f32 v250, v250, v96, v97
v_max3_f32 v246, v246, v82, v83
v_max3_f32 v247, v247, v86, v87
v_max3_f32 v248, v248, v90, v91
v_max3_f32 v249, v249, v94, v95
v_max3_f32 v250, v250, v98, v99
v_max3_f32 v246, v246, v100, v101
v_max3_f32 v247, v247, v104, v105
v_max3_f32 v248, v248, v108, v109
v_max3_f32 v249, v249, v112, v113
v_max3_f32 v250, v250, v116, v117
v_max3_f32 v246, v246, v102, v103
v_max3_f32 v247, v247, v106, v107
v_max3_f32 v248, v248, v110, v111
v_max3_f32 v249, v249, v114, v115
v_max3_f32 v250, v250, v118, v119
v_max3_f32 v246, v246, v120, v121
v_max3_f32 v247, v247, v124, v125
v_max3_f32 v248, v248, v128, v129
v_max3_f32 v249, v249, v132, v133
v_max3_f32 v250, v250, v136, v137
v_max3_f32 v246, v246, v122, v123
v_max3_f32 v247, v247, v126, v127
v_max3_f32 v248, v248, v130, v131
v_max3_f32 v249, v249, v134, v135
v_max3_f32 v250, v250, v138, v139
v_max3_f32 v246, v246, v140, v141
v_max3_f32 v247, v247, v144, v145
v_max3_f32 v248, v248, v148, v149
v_max3_f32 v249, v249, v152, v153
v_max3_f32 v250, v250, v156, v157
v_max3_f32 v246, v246, v142, v143
v_max3_f32 v247, v247, v146, v147
v_max3_f32 v248, v248, v150, v151
v_max3_f32 v249, v249, v154, v155
v_max3_f32 v250, v250, v158, v159
v_lshlrev_b32 v217, 4, v235
s_lshl_b32 s10, s14, 11
s_lshl_b32 s11, s15, 2
s_add_u32 s10, s10, s11
s_add_u32 s10, s10, 147456
v_add_u32 v217, s10, v217
v_mov_b32 v216, v250
s_nop 1
v_permlane32_swap_b32 v246, v248
v_permlane32_swap_b32 v247, v249
v_permlane32_swap_b32 v250, v216
v_max_f32 v246, v246, v248
v_max_f32 v247, v247, v249
v_max_f32 v250, v250, v216
v_mov_b32 v216, v250
s_nop 1
v_permlane16_swap_b32 v246, v247
v_permlane16_swap_b32 v250, v216
v_max_f32 v246, v246, v247
v_max_f32 v250, v250, v216
ds_write_b32 v217, v246 offset:0
ds_write_b32 v217, v250 offset:1024
s_waitcnt lgkmcnt(0)
s_barrier
v_and_b32 v217, 15, v235
v_lshlrev_b32 v217, 4, v217
s_lshl_b32 s10, s14, 11
s_add_u32 s10, s10, 147456
v_add_u32 v217, s10, v217
ds_read_b128 v[160:163], v217 offset:0
ds_read_b128 v[164:167], v217 offset:256
ds_read_b128 v[168:171], v217 offset:512
ds_read_b128 v[172:175], v217 offset:768
ds_read_b128 v[176:179], v217 offset:1024
s_waitcnt lgkmcnt(4)
v_max_f32 v246, v160, v161
v_max3_f32 v246, v246, v162, v163
s_waitcnt lgkmcnt(3)
v_max_f32 v247, v164, v165
v_max3_f32 v247, v247, v166, v167
s_waitcnt lgkmcnt(2)
v_max_f32 v248, v168, v169
v_max3_f32 v248, v248, v170, v171
s_waitcnt lgkmcnt(1)
v_max_f32 v249, v172, v173
v_max3_f32 v249, v249, v174, v175
s_waitcnt lgkmcnt(0)
v_max_f32 v250, v176, v177
v_max3_f32 v250, v250, v178, v179
v_mul_f32 v246, s6, v246
v_mul_f32 v247, s6, v247
v_mul_f32 v248, s6, v248
v_mul_f32 v249, s6, v249
v_mul_f32 v250, s6, v250
v_add_u32 v197, s12, v242
v_pk_fma_f32 v[0:1], v[0:1], s[6:7], v[246:247] op_sel:[0,0,0] op_sel_hi:[1,0,0] neg_lo:[0,0,1] neg_hi:[0,0,1]
v_pk_fma_f32 v[2:3], v[2:3], s[6:7], v[246:247] op_sel:[0,0,0] op_sel_hi:[1,0,0] neg_lo:[0,0,1] neg_hi:[0,0,1]
v_pk_fma_f32 v[20:21], v[20:21], s[6:7], v[246:247] op_sel:[0,0,0] op_sel_hi:[1,0,0] neg_lo:[0,0,1] neg_hi:[0,0,1]
v_pk_fma_f32 v[22:23], v[22:23], s[6:7], v[246:247] op_sel:[0,0,0] op_sel_hi:[1,0,0] neg_lo:[0,0,1] neg_hi:[0,0,1]
v_exp_f32 v0, v0
v_exp_f32 v1, v1
v_exp_f32 v2, v2
v_exp_f32 v3, v3
v_exp_f32 v20, v20
v_exp_f32 v21, v21
v_exp_f32 v22, v22
v_exp_f32 v23, v23
v_pk_add_f32 v[220:221], v[0:1], v[2:3]
v_pk_add_f32 v[222:223], v[20:21], v[22:23]
v_cvt_pk_bf16_f32 v0, v0, v1
v_cvt_pk_bf16_f32 v1, v2, v3
v_cvt_pk_bf16_f32 v2, v20, v21
v_cvt_pk_bf16_f32 v3, v22, v23
v_pk_add_f32 v[220:221], v[220:221], v[222:223]
v_add_f32 v192, v220, v221
ds_write_b128 v197, v[0:3] offset:0
v_pk_fma_f32 v[4:5], v[4:5], s[6:7], v[246:247] op_sel:[0,0,1] op_sel_hi:[1,0,1] neg_lo:[0,0,1] neg_hi:[0,0,1]
v_pk_fma_f32 v[6:7], v[6:7], s[6:7], v[246:247] op_sel:[0,0,1] op_sel_hi:[1,0,1] neg_lo:[0,0,1] neg_hi:[0,0,1]
v_pk_fma_f32 v[24:25], v[24:25], s[6:7], v[246:247] op_sel:[0,0,1] op_sel_hi:[1,0,1] neg_lo:[0,0,1] neg_hi:[0,0,1]
v_pk_fma_f32 v[26:27], v[26:27], s[6:7], v[246:247] op_sel:[0,0,1] op_sel_hi:[1,0,1] neg_lo:[0,0,1] neg_hi:[0,0,1]
v_exp_f32 v4, v4
v_exp_f32 v5, v5
v_exp_f32 v6, v6
v_exp_f32 v7, v7
v_exp_f32 v24, v24
v_exp_f32 v25, v25
v_exp_f32 v26, v26
v_exp_f32 v27, v27
v_pk_add_f32 v[224:225], v[4:5], v[6:7]
v_pk_add_f32 v[226:227], v[24:25], v[26:27]
v_cvt_pk_bf16_f32 v4, v4, v5
v_cvt_pk_bf16_f32 v5, v6, v7
v_cvt_pk_bf16_f32 v6, v24, v25
v_cvt_pk_bf16_f32 v7, v26, v27
v_pk_add_f32 v[224:225], v[224:225], v[226:227]
v_add_f32 v193, v224, v225
ds_write_b128 v197, v[4:7] offset:1024
v_pk_fma_f32 v[8:9], v[8:9], s[6:7], v[248:249] op_sel:[0,0,0] op_sel_hi:[1,0,0] neg_lo:[0,0,1] neg_hi:[0,0,1]
v_pk_fma_f32 v[10:11], v[10:11], s[6:7], v[248:249] op_sel:[0,0,0] op_sel_hi:[1,0,0] neg_lo:[0,0,1] neg_hi:[0,0,1]
v_pk_fma_f32 v[28:29], v[28:29], s[6:7], v[248:249] op_sel:[0,0,0] op_sel_hi:[1,0,0] neg_lo:[0,0,1] neg_hi:[0,0,1]
v_pk_fma_f32 v[30:31], v[30:31], s[6:7], v[248:249] op_sel:[0,0,0] op_sel_hi:[1,0,0] neg_lo:[0,0,1] neg_hi:[0,0,1]
v_exp_f32 v8, v8
v_exp_f32 v9, v9
v_exp_f32 v10, v10
v_exp_f32 v11, v11
v_exp_f32 v28, v28
v_exp_f32 v29, v29
v_exp_f32 v30, v30
v_exp_f32 v31, v31
v_pk_add_f32 v[220:221], v[8:9], v[10:11]
v_pk_add_f32 v[222:223], v[28:29], v[30:31]
v_cvt_pk_bf16_f32 v8, v8, v9
v_cvt_pk_bf16_f32 v9, v10, v11
v_cvt_pk_bf16_f32 v10, v28, v29
v_cvt_pk_bf16_f32 v11, v30, v31
v_pk_add_f32 v[220:221], v[220:221], v[222:223]
v_add_f32 v194, v220, v221
ds_write_b128 v197, v[8:11] offset:2048
v_pk_fma_f32 v[12:13], v[12:13], s[6:7], v[248:249] op_sel:[0,0,1] op_sel_hi:[1,0,1] neg_lo:[0,0,1] neg_hi:[0,0,1]
v_pk_fma_f32 v[14:15], v[14:15], s[6:7], v[248:249] op_sel:[0,0,1] op_sel_hi:[1,0,1] neg_lo:[0,0,1] neg_hi:[0,0,1]
v_pk_fma_f32 v[32:33], v[32:33], s[6:7], v[248:249] op_sel:[0,0,1] op_sel_hi:[1,0,1] neg_lo:[0,0,1] neg_hi:[0,0,1]
v_pk_fma_f32 v[34:35], v[34:35], s[6:7], v[248:249] op_sel:[0,0,1] op_sel_hi:[1,0,1] neg_lo:[0,0,1] neg_hi:[0,0,1]
v_exp_f32 v12, v12
v_exp_f32 v13, v13
v_exp_f32 v14, v14
v_exp_f32 v15, v15
v_exp_f32 v32, v32
v_exp_f32 v33, v33
v_exp_f32 v34, v34
v_exp_f32 v35, v35
v_pk_add_f32 v[224:225], v[12:13], v[14:15]
v_pk_add_f32 v[226:227], v[32:33], v[34:35]
v_cvt_pk_bf16_f32 v12, v12, v13
v_cvt_pk_bf16_f32 v13, v14, v15
v_cvt_pk_bf16_f32 v14, v32, v33
v_cvt_pk_bf16_f32 v15, v34, v35
v_pk_add_f32 v[224:225], v[224:225], v[226:227]
v_add_f32 v195, v224, v225
ds_write_b128 v197, v[12:15] offset:3072
v_pk_fma_f32 v[16:17], v[16:17], s[6:7], v[250:251] op_sel:[0,0,0] op_sel_hi:[1,0,0] neg_lo:[0,0,1] neg_hi:[0,0,1]
v_pk_fma_f32 v[18:19], v[18:19], s[6:7], v[250:251] op_sel:[0,0,0] op_sel_hi:[1,0,0] neg_lo:[0,0,1] neg_hi:[0,0,1]
v_pk_fma_f32 v[36:37], v[36:37], s[6:7], v[250:251] op_sel:[0,0,0] op_sel_hi:[1,0,0] neg_lo:[0,0,1] neg_hi:[0,0,1]
v_pk_fma_f32 v[38:39], v[38:39], s[6:7], v[250:251] op_sel:[0,0,0] op_sel_hi:[1,0,0] neg_lo:[0,0,1] neg_hi:[0,0,1]
v_exp_f32 v16, v16
v_exp_f32 v17, v17
v_exp_f32 v18, v18
v_exp_f32 v19, v19
v_exp_f32 v36, v36
v_exp_f32 v37, v37
v_exp_f32 v38, v38
v_exp_f32 v39, v39
v_pk_add_f32 v[220:221], v[16:17], v[18:19]
v_pk_add_f32 v[222:223], v[36:37], v[38:39]
v_cvt_pk_bf16_f32 v16, v16, v17
v_cvt_pk_bf16_f32 v17, v18, v19
v_cvt_pk_bf16_f32 v18, v36, v37
v_cvt_pk_bf16_f32 v19, v38, v39
v_pk_add_f32 v[220:221], v[220:221], v[222:223]
v_add_f32 v196, v220, v221
ds_write_b128 v197, v[16:19] offset:4096
v_pk_fma_f32 v[40:41], v[40:41], s[6:7], v[246:247] op_sel:[0,0,0] op_sel_hi:[1,0,0] neg_lo:[0,0,1] neg_hi:[0,0,1]
v_pk_fma_f32 v[42:43], v[42:43], s[6:7], v[246:247] op_sel:[0,0,0] op_sel_hi:[1,0,0] neg_lo:[0,0,1] neg_hi:[0,0,1]
v_pk_fma_f32 v[60:61], v[60:61], s[6:7], v[246:247] op_sel:[0,0,0] op_sel_hi:[1,0,0] neg_lo:[0,0,1] neg_hi:[0,0,1]
v_pk_fma_f32 v[62:63], v[62:63], s[6:7], v[246:247] op_sel:[0,0,0] op_sel_hi:[1,0,0] neg_lo:[0,0,1] neg_hi:[0,0,1]
v_exp_f32 v40, v40
v_exp_f32 v41, v41
v_exp_f32 v42, v42
v_exp_f32 v43, v43
v_exp_f32 v60, v60
v_exp_f32 v61, v61
v_exp_f32 v62, v62
v_exp_f32 v63, v63
v_pk_add_f32 v[224:225], v[40:41], v[42:43]
v_pk_add_f32 v[226:227], v[60:61], v[62:63]
v_cvt_pk_bf16_f32 v40, v40, v41
v_cvt_pk_bf16_f32 v41, v42, v43
v_cvt_pk_bf16_f32 v42, v60, v61
v_cvt_pk_bf16_f32 v43, v62, v63
v_pk_add_f32 v[224:225], v[224:225], v[226:227]
v_add_f32 v192, v192, v224
v_add_f32 v192, v192, v225
ds_write_b128 v197, v[40:43] offset:5120
v_pk_fma_f32 v[44:45], v[44:45], s[6:7], v[246:247] op_sel:[0,0,1] op_sel_hi:[1,0,1] neg_lo:[0,0,1] neg_hi:[0,0,1]
v_pk_fma_f32 v[46:47], v[46:47], s[6:7], v[246:247] op_sel:[0,0,1] op_sel_hi:[1,0,1] neg_lo:[0,0,1] neg_hi:[0,0,1]
v_pk_fma_f32 v[64:65], v[64:65], s[6:7], v[246:247] op_sel:[0,0,1] op_sel_hi:[1,0,1] neg_lo:[0,0,1] neg_hi:[0,0,1]
v_pk_fma_f32 v[66:67], v[66:67], s[6:7], v[246:247] op_sel:[0,0,1] op_sel_hi:[1,0,1] neg_lo:[0,0,1] neg_hi:[0,0,1]
v_exp_f32 v44, v44
v_exp_f32 v45, v45
v_exp_f32 v46, v46
v_exp_f32 v47, v47
v_exp_f32 v64, v64
v_exp_f32 v65, v65
v_exp_f32 v66, v66
v_exp_f32 v67, v67
v_pk_add_f32 v[220:221], v[44:45], v[46:47]
v_pk_add_f32 v[222:223], v[64:65], v[66:67]
v_cvt_pk_bf16_f32 v44, v44, v45
v_cvt_pk_bf16_f32 v45, v46, v47
v_cvt_pk_bf16_f32 v46, v64, v65
v_cvt_pk_bf16_f32 v47, v66, v67
v_pk_add_f32 v[220:221], v[220:221], v[222:223]
v_add_f32 v193, v193, v220
v_add_f32 v193, v193, v221
ds_write_b128 v197, v[44:47] offset:6144
v_pk_fma_f32 v[48:49], v[48:49], s[6:7], v[248:249] op_sel:[0,0,0] op_sel_hi:[1,0,0] neg_lo:[0,0,1] neg_hi:[0,0,1]
v_pk_fma_f32 v[50:51], v[50:51], s[6:7], v[248:249] op_sel:[0,0,0] op_sel_hi:[1,0,0] neg_lo:[0,0,1] neg_hi:[0,0,1]
v_pk_fma_f32 v[68:69], v[68:69], s[6:7], v[248:249] op_sel:[0,0,0] op_sel_hi:[1,0,0] neg_lo:[0,0,1] neg_hi:[0,0,1]
v_pk_fma_f32 v[70:71], v[70:71], s[6:7], v[248:249] op_sel:[0,0,0] op_sel_hi:[1,0,0] neg_lo:[0,0,1] neg_hi:[0,0,1]
v_exp_f32 v48, v48
v_exp_f32 v49, v49
v_exp_f32 v50, v50
v_exp_f32 v51, v51
v_exp_f32 v68, v68
v_exp_f32 v69, v69
v_exp_f32 v70, v70
v_exp_f32 v71, v71
v_pk_add_f32 v[224:225], v[48:49], v[50:51]
v_pk_add_f32 v[226:227], v[68:69], v[70:71]
v_cvt_pk_bf16_f32 v48, v48, v49
v_cvt_pk_bf16_f32 v49, v50, v51
v_cvt_pk_bf16_f32 v50, v68, v69
v_cvt_pk_bf16_f32 v51, v70, v71
v_pk_add_f32 v[224:225], v[224:225], v[226:227]
v_add_f32 v194, v194, v224
v_add_f32 v194, v194, v225
ds_write_b128 v197, v[48:51] offset:7168
v_pk_fma_f32 v[52:53], v[52:53], s[6:7], v[248:249] op_sel:[0,0,1] op_sel_hi:[1,0,1] neg_lo:[0,0,1] neg_hi:[0,0,1]
v_pk_fma_f32 v[54:55], v[54:55], s[6:7], v[248:249] op_sel:[0,0,1] op_sel_hi:[1,0,1] neg_lo:[0,0,1] neg_hi:[0,0,1]
v_pk_fma_f32 v[72:73], v[72:73], s[6:7], v[248:249] op_sel:[0,0,1] op_sel_hi:[1,0,1] neg_lo:[0,0,1] neg_hi:[0,0,1]
v_pk_fma_f32 v[74:75], v[74:75], s[6:7], v[248:249] op_sel:[0,0,1] op_sel_hi:[1,0,1] neg_lo:[0,0,1] neg_hi:[0,0,1]
v_exp_f32 v52, v52
v_exp_f32 v53, v53
v_exp_f32 v54, v54
v_exp_f32 v55, v55
v_exp_f32 v72, v72
v_exp_f32 v73, v73
v_exp_f32 v74, v74
v_exp_f32 v75, v75
v_pk_add_f32 v[220:221], v[52:53], v[54:55]
v_pk_add_f32 v[222:223], v[72:73], v[74:75]
v_cvt_pk_bf16_f32 v52, v52, v53
v_cvt_pk_bf16_f32 v53, v54, v55
v_cvt_pk_bf16_f32 v54, v72, v73
v_cvt_pk_bf16_f32 v55, v74, v75
v_pk_add_f32 v[220:221], v[220:221], v[222:223]
v_add_f32 v195, v195, v220
v_add_f32 v195, v195, v221
ds_write_b128 v197, v[52:55] offset:8192
v_pk_fma_f32 v[56:57], v[56:57], s[6:7], v[250:251] op_sel:[0,0,0] op_sel_hi:[1,0,0] neg_lo:[0,0,1] neg_hi:[0,0,1]
v_pk_fma_f32 v[58:59], v[58:59], s[6:7], v[250:251] op_sel:[0,0,0] op_sel_hi:[1,0,0] neg_lo:[0,0,1] neg_hi:[0,0,1]
v_pk_fma_f32 v[76:77], v[76:77], s[6:7], v[250:251] op_sel:[0,0,0] op_sel_hi:[1,0,0] neg_lo:[0,0,1] neg_hi:[0,0,1]
v_pk_fma_f32 v[78:79], v[78:79], s[6:7], v[250:251] op_sel:[0,0,0] op_sel_hi:[1,0,0] neg_lo:[0,0,1] neg_hi:[0,0,1]
v_exp_f32 v56, v56
v_exp_f32 v57, v57
v_exp_f32 v58, v58
v_exp_f32 v59, v59
v_exp_f32 v76, v76
v_exp_f32 v77, v77
v_exp_f32 v78, v78
v_exp_f32 v79, v79
v_pk_add_f32 v[224:225], v[56:57], v[58:59]
v_pk_add_f32 v[226:227], v[76:77], v[78:79]
v_cvt_pk_bf16_f32 v56, v56, v57
v_cvt_pk_bf16_f32 v57, v58, v59
v_cvt_pk_bf16_f32 v58, v76, v77
v_cvt_pk_bf16_f32 v59, v78, v79
v_pk_add_f32 v[224:225], v[224:225], v[226:227]
v_add_f32 v196, v196, v224
v_add_f32 v196, v196, v225
ds_write_b128 v197, v[56:59] offset:9216
v_pk_fma_f32 v[80:81], v[80:81], s[6:7], v[246:247] op_sel:[0,0,0] op_sel_hi:[1,0,0] neg_lo:[0,0,1] neg_hi:[0,0,1]
v_pk_fma_f32 v[82:83], v[82:83], s[6:7], v[246:247] op_sel:[0,0,0] op_sel_hi:[1,0,0] neg_lo:[0,0,1] neg_hi:[0,0,1]
v_pk_fma_f32 v[100:101], v[100:101], s[6:7], v[246:247] op_sel:[0,0,0] op_sel_hi:[1,0,0] neg_lo:[0,0,1] neg_hi:[0,0,1]
v_pk_fma_f32 v[102:103], v[102:103], s[6:7], v[246:247] op_sel:[0,0,0] op_sel_hi:[1,0,0] neg_lo:[0,0,1] neg_hi:[0,0,1]
v_exp_f32 v80, v80
v_exp_f32 v81, v81
v_exp_f32 v82, v82
v_exp_f32 v83, v83
v_exp_f32 v100, v100
v_exp_f32 v101, v101
v_exp_f32 v102, v102
v_exp_f32 v103, v103
v_pk_add_f32 v[220:221], v[80:81], v[82:83]
v_pk_add_f32 v[222:223], v[100:101], v[102:103]
v_cvt_pk_bf16_f32 v80, v80, v81
v_cvt_pk_bf16_f32 v81, v82, v83
v_cvt_pk_bf16_f32 v82, v100, v101
v_cvt_pk_bf16_f32 v83, v102, v103
v_pk_add_f32 v[220:221], v[220:221], v[222:223]
v_add_f32 v192, v192, v220
v_add_f32 v192, v192, v221
s_waitcnt lgkmcnt(0)
s_barrier
ds_read_b128 v[160:163], v244 offset:0
ds_read_b128 v[164:167], v244 offset:1024
ds_read_b128 v[168:171], v244 offset:2048
ds_read_b128 v[172:175], v244 offset:3072
ds_read_b128 v[176:179], v244 offset:4096
ds_read_b128 v[180:183], v244 offset:5120
ds_read_b128 v[184:187], v244 offset:6144
ds_read_b128 v[188:191], v244 offset:7168
s_waitcnt lgkmcnt(7)
v_mfma_f32_16x16x32_bf16 v[0:3], v[200:203], v[160:163], 0
v_mfma_f32_16x16x32_bf16 v[20:23], v[204:207], v[160:163], 0
s_waitcnt vmcnt(6)
ds_read_b64_tr_b16 v[216:217], v236 offset:4096
ds_read_b64_tr_b16 v[220:221], v237 offset:4096
ds_read_b64_tr_b16 v[224:225], v238 offset:4096
ds_read_b64_tr_b16 v[228:229], v239 offset:4096
v_mfma_f32_16x16x32_bf16 v[40:43], v[208:211], v[160:163], 0
v_fma_f32 v84, v84, s6, -v247
v_fma_f32 v85, v85, s6, -v247
v_mfma_f32_16x16x32_bf16 v[60:63], v[212:215], v[160:163], 0
v_fma_f32 v86, v86, s6, -v247
v_fma_f32 v87, v87, s6, -v247
ds_read_b128 v[160:163], v244 offset:8192
s_waitcnt lgkmcnt(11)
v_mfma_f32_16x16x32_bf16 v[4:7], v[200:203], v[164:167], 0
v_fma_f32 v104, v104, s6, -v247
v_fma_f32 v105, v105, s6, -v247
v_mfma_f32_16x16x32_bf16 v[24:27], v[204:207], v[164:167], 0
v_fma_f32 v106, v106, s6, -v247
v_fma_f32 v107, v107, s6, -v247
v_mfma_f32_16x16x32_bf16 v[44:47], v[208:211], v[164:167], 0
v_exp_f32 v84, v84
v_exp_f32 v85, v85
s_waitcnt lgkmcnt(1)
s_mov_b32 m0, s5
s_mov_b32 s9, 49152
buffer_load_dwordx4 v232, s[52:55], s9 offen nt lds
s_mov_b32 s8, 52224
buffer_load_dwordx4 v232, s[52:55], s8 offen offset:1024 nt lds
v_mfma_f32_16x16x32_bf16 v[64:67], v[212:215], v[164:167], 0
v_exp_f32 v86, v86
v_exp_f32 v87, v87
ds_read_b128 v[164:167], v244 offset:9216
v_mfma_f32_16x16x32_bf16 v[8:11], v[200:203], v[168:171], 0
v_exp_f32 v104, v104
v_exp_f32 v105, v105
s_waitcnt vmcnt(6)
ds_read_b64_tr_b16 v[218:219], v236 offset:6144
ds_read_b64_tr_b16 v[222:223], v237 offset:6144
ds_read_b64_tr_b16 v[226:227], v238 offset:6144
ds_read_b64_tr_b16 v[230:231], v239 offset:6144
v_mfma_f32_16x16x32_bf16 v[28:31], v[204:207], v[168:171], 0
v_exp_f32 v106, v106
v_mfma_f32_16x16x32_bf16 v[48:51], v[208:211], v[168:171], 0
v_exp_f32 v107, v107
v_pk_add_f32 v[100:101], v[84:85], v[86:87]
v_mfma_f32_16x16x32_bf16 v[68:71], v[212:215], v[168:171], 0
v_pk_add_f32 v[102:103], v[104:105], v[106:107]
v_cvt_pk_bf16_f32 v84, v84, v85
ds_read_b128 v[168:171], v244 offset:10240
v_mfma_f32_16x16x32_bf16 v[12:15], v[200:203], v[172:175], 0
v_cvt_pk_bf16_f32 v85, v86, v87
v_cvt_pk_bf16_f32 v86, v104, v105
v_mfma_f32_16x16x32_bf16 v[32:35], v[204:207], v[172:175], 0
v_cvt_pk_bf16_f32 v87, v106, v107
v_pk_add_f32 v[100:101], v[100:101], v[102:103]
s_waitcnt lgkmcnt(1)
s_mov_b32 m0, s5
s_mov_b32 s9, 55296
buffer_load_dwordx4 v232, s[52:55], s9 offen offset:2048 nt lds
s_mov_b32 s8, 58368
buffer_load_dwordx4 v232, s[52:55], s8 offen offset:3072 nt lds
v_mfma_f32_16x16x32_bf16 v[52:55], v[208:211], v[172:175], 0
v_add_f32 v193, v193, v100
v_add_f32 v193, v193, v101
v_mfma_f32_16x16x32_bf16 v[72:75], v[212:215], v[172:175], 0
v_fma_f32 v88, v88, s6, -v248
v_fma_f32 v89, v89, s6, -v248
ds_read_b128 v[172:175], v244 offset:11264
v_mfma_f32_16x16x32_bf16 v[16:19], v[200:203], v[176:179], 0
v_fma_f32 v90, v90, s6, -v248
v_fma_f32 v91, v91, s6, -v248
v_mfma_f32_16x16x32_bf16 v[36:39], v[204:207], v[176:179], 0
v_fma_f32 v108, v108, s6, -v248
v_mfma_f32_16x16x32_bf16 v[56:59], v[208:211], v[176:179], 0
v_fma_f32 v109, v109, s6, -v248
v_fma_f32 v110, v110, s6, -v248
v_mfma_f32_16x16x32_bf16 v[76:79], v[212:215], v[176:179], 0
v_fma_f32 v111, v111, s6, -v248
v_exp_f32 v88, v88
ds_read_b128 v[176:179], v244 offset:12288
v_mfma_f32_16x16x32_bf16 v[0:3], v[216:219], v[180:183], v[0:3]
v_exp_f32 v89, v89
v_exp_f32 v90, v90
v_mfma_f32_16x16x32_bf16 v[20:23], v[220:223], v[180:183], v[20:23]
v_exp_f32 v91, v91
v_exp_f32 v108, v108
s_waitcnt vmcnt(6)
ds_read_b64_tr_b16 v[200:201], v236 offset:0
ds_read_b64_tr_b16 v[204:205], v237 offset:0
ds_read_b64_tr_b16 v[208:209], v238 offset:0
ds_read_b64_tr_b16 v[212:213], v239 offset:0
v_mfma_f32_16x16x32_bf16 v[40:43], v[224:227], v[180:183], v[40:43]
v_exp_f32 v109, v109
v_exp_f32 v110, v110
v_mfma_f32_16x16x32_bf16 v[60:63], v[228:231], v[180:183], v[60:63]
v_exp_f32 v111, v111
v_pk_add_f32 v[100:101], v[88:89], v[90:91]
ds_read_b128 v[180:183], v244 offset:13312
v_mfma_f32_16x16x32_bf16 v[4:7], v[216:219], v[184:187], v[4:7]
v_pk_add_f32 v[102:103], v[108:109], v[110:111]
v_cvt_pk_bf16_f32 v88, v88, v89
v_mfma_f32_16x16x32_bf16 v[24:27], v[220:223], v[184:187], v[24:27]
v_cvt_pk_bf16_f32 v89, v90, v91
v_mfma_f32_16x16x32_bf16 v[44:47], v[224:227], v[184:187], v[44:47]
v_cvt_pk_bf16_f32 v90, v108, v109
v_cvt_pk_bf16_f32 v91, v110, v111
s_waitcnt lgkmcnt(1)
s_mov_b32 m0, s4
s_mov_b32 s9, 65536
buffer_load_dwordx4 v232, s[52:55], s9 offen nt lds
s_mov_b32 s8, 68608
buffer_load_dwordx4 v232, s[52:55], s8 offen offset:1024 nt lds
v_mfma_f32_16x16x32_bf16 v[64:67], v[228:231], v[184:187], v[64:67]
v_pk_add_f32 v[100:101], v[100:101], v[102:103]
v_add_f32 v194, v194, v100
ds_read_b128 v[184:187], v244 offset:14336
v_mfma_f32_16x16x32_bf16 v[8:11], v[216:219], v[188:191], v[8:11]
v_add_f32 v194, v194, v101
v_fma_f32 v92, v92, s6, -v249
s_waitcnt vmcnt(6)
ds_read_b64_tr_b16 v[202:203], v236 offset:2048
ds_read_b64_tr_b16 v[206:207], v237 offset:2048
ds_read_b64_tr_b16 v[210:211], v238 offset:2048
ds_read_b64_tr_b16 v[214:215], v239 offset:2048
v_mfma_f32_16x16x32_bf16 v[28:31], v[220:223], v[188:191], v[28:31]
v_fma_f32 v93, v93, s6, -v249
v_fma_f32 v94, v94, s6, -v249
v_mfma_f32_16x16x32_bf16 v[48:51], v[224:227], v[188:191], v[48:51]
v_fma_f32 v95, v95, s6, -v249
v_fma_f32 v112, v112, s6, -v249
v_mfma_f32_16x16x32_bf16 v[68:71], v[228:231], v[188:191], v[68:71]
v_fma_f32 v113, v113, s6, -v249
v_fma_f32 v114, v114, s6, -v249
ds_read_b128 v[188:191], v244 offset:15360
v_mfma_f32_16x16x32_bf16 v[12:15], v[216:219], v[160:163], v[12:15]
v_fma_f32 v115, v115, s6, -v249
v_exp_f32 v92, v92
v_mfma_f32_16x16x32_bf16 v[32:35], v[220:223], v[160:163], v[32:35]
v_exp_f32 v93, v93
s_waitcnt lgkmcnt(1)
s_mov_b32 m0, s4
s_mov_b32 s9, 71680
buffer_load_dwordx4 v232, s[52:55], s9 offen offset:2048 nt lds
s_mov_b32 s8, 74752
buffer_load_dwordx4 v232, s[52:55], s8 offen offset:3072 nt lds
v_mfma_f32_16x16x32_bf16 v[52:55], v[224:227], v[160:163], v[52:55]
v_exp_f32 v94, v94
v_exp_f32 v95, v95
v_mfma_f32_16x16x32_bf16 v[72:75], v[228:231], v[160:163], v[72:75]
v_exp_f32 v112, v112
v_exp_f32 v113, v113
ds_read_b128 v[160:163], v244 offset:16384
v_mfma_f32_16x16x32_bf16 v[16:19], v[216:219], v[164:167], v[16:19]
v_exp_f32 v114, v114
v_exp_f32 v115, v115
v_mfma_f32_16x16x32_bf16 v[36:39], v[220:223], v[164:167], v[36:39]
v_pk_add_f32 v[100:101], v[92:93], v[94:95]
v_pk_add_f32 v[102:103], v[112:113], v[114:115]
v_mfma_f32_16x16x32_bf16 v[56:59], v[224:227], v[164:167], v[56:59]
v_cvt_pk_bf16_f32 v92, v92, v93
v_cvt_pk_bf16_f32 v93, v94, v95
v_mfma_f32_16x16x32_bf16 v[76:79], v[228:231], v[164:167], v[76:79]
v_cvt_pk_bf16_f32 v94, v112, v113
v_cvt_pk_bf16_f32 v95, v114, v115
ds_read_b128 v[164:167], v244 offset:17408
v_mfma_f32_16x16x32_bf16 v[0:3], v[200:203], v[168:171], v[0:3]
v_pk_add_f32 v[100:101], v[100:101], v[102:103]
v_add_f32 v195, v195, v100
v_mfma_f32_16x16x32_bf16 v[20:23], v[204:207], v[168:171], v[20:23]
v_add_f32 v195, v195, v101
s_waitcnt vmcnt(6)
ds_read_b64_tr_b16 v[216:217], v236 offset:4096
ds_read_b64_tr_b16 v[220:221], v237 offset:4096
ds_read_b64_tr_b16 v[224:225], v238 offset:4096
ds_read_b64_tr_b16 v[228:229], v239 offset:4096
v_mfma_f32_16x16x32_bf16 v[40:43], v[208:211], v[168:171], v[40:43]
v_fma_f32 v96, v96, s6, -v250
v_fma_f32 v97, v97, s6, -v250
v_mfma_f32_16x16x32_bf16 v[60:63], v[212:215], v[168:171], v[60:63]
v_fma_f32 v98, v98, s6, -v250
v_fma_f32 v99, v99, s6, -v250
ds_read_b128 v[168:171], v244 offset:18432
v_mfma_f32_16x16x32_bf16 v[4:7], v[200:203], v[172:175], v[4:7]
v_fma_f32 v116, v116, s6, -v250
v_fma_f32 v117, v117, s6, -v250
v_mfma_f32_16x16x32_bf16 v[24:27], v[204:207], v[172:175], v[24:27]
v_fma_f32 v118, v118, s6, -v250
v_fma_f32 v119, v119, s6, -v250
v_mfma_f32_16x16x32_bf16 v[44:47], v[208:211], v[172:175], v[44:47]
v_exp_f32 v96, v96
v_exp_f32 v97, v97
s_waitcnt lgkmcnt(1)
s_mov_b32 m0, s5
s_mov_b32 s9, 81920
buffer_load_dwordx4 v232, s[52:55], s9 offen nt lds
s_mov_b32 s8, 84992
buffer_load_dwordx4 v232, s[52:55], s8 offen offset:1024 nt lds
v_mfma_f32_16x16x32_bf16 v[64:67], v[212:215], v[172:175], v[64:67]
v_exp_f32 v98, v98
v_exp_f32 v99, v99
ds_read_b128 v[172:175], v244 offset:19456
v_mfma_f32_16x16x32_bf16 v[8:11], v[200:203], v[176:179], v[8:11]
v_exp_f32 v116, v116
v_exp_f32 v117, v117
s_waitcnt vmcnt(6)
ds_read_b64_tr_b16 v[218:219], v236 offset:6144
ds_read_b64_tr_b16 v[222:223], v237 offset:6144
ds_read_b64_tr_b16 v[226:227], v238 offset:6144
ds_read_b64_tr_b16 v[230:231], v239 offset:6144
v_mfma_f32_16x16x32_bf16 v[28:31], v[204:207], v[176:179], v[28:31]
v_exp_f32 v118, v118
v_mfma_f32_16x16x32_bf16 v[48:51], v[208:211], v[176:179], v[48:51]
v_exp_f32 v119, v119
v_pk_add_f32 v[100:101], v[96:97], v[98:99]
v_mfma_f32_16x16x32_bf16 v[68:71], v[212:215], v[176:179], v[68:71]
v_pk_add_f32 v[102:103], v[116:117], v[118:119]
v_cvt_pk_bf16_f32 v96, v96, v97
ds_read_b128 v[176:179], v244 offset:20480
v_mfma_f32_16x16x32_bf16 v[12:15], v[200:203], v[180:183], v[12:15]
v_cvt_pk_bf16_f32 v97, v98, v99
v_cvt_pk_bf16_f32 v98, v116, v117
v_mfma_f32_16x16x32_bf16 v[32:35], v[204:207], v[180:183], v[32:35]
v_cvt_pk_bf16_f32 v99, v118, v119
v_pk_add_f32 v[100:101], v[100:101], v[102:103]
s_waitcnt lgkmcnt(1)
s_mov_b32 m0, s5
s_mov_b32 s9, 88064
buffer_load_dwordx4 v232, s[52:55], s9 offen offset:2048 nt lds
s_mov_b32 s8, 91136
buffer_load_dwordx4 v232, s[52:55], s8 offen offset:3072 nt lds
v_mfma_f32_16x16x32_bf16 v[52:55], v[208:211], v[180:183], v[52:55]
v_add_f32 v196, v196, v100
v_add_f32 v196, v196, v101
v_mfma_f32_16x16x32_bf16 v[72:75], v[212:215], v[180:183], v[72:75]
v_fma_f32 v120, v120, s6, -v246
v_fma_f32 v121, v121, s6, -v246
ds_read_b128 v[180:183], v244 offset:21504
v_mfma_f32_16x16x32_bf16 v[16:19], v[200:203], v[184:187], v[16:19]
v_fma_f32 v122, v122, s6, -v246
v_fma_f32 v123, v123, s6, -v246
v_mfma_f32_16x16x32_bf16 v[36:39], v[204:207], v[184:187], v[36:39]
v_fma_f32 v140, v140, s6, -v246
v_mfma_f32_16x16x32_bf16 v[56:59], v[208:211], v[184:187], v[56:59]
v_fma_f32 v141, v141, s6, -v246
v_fma_f32 v142, v142, s6, -v246
v_mfma_f32_16x16x32_bf16 v[76:79], v[212:215], v[184:187], v[76:79]
v_fma_f32 v143, v143, s6, -v246
v_exp_f32 v120, v120
ds_read_b128 v[184:187], v244 offset:22528
v_mfma_f32_16x16x32_bf16 v[0:3], v[216:219], v[188:191], v[0:3]
v_exp_f32 v121, v121
v_exp_f32 v122, v122
v_mfma_f32_16x16x32_bf16 v[20:23], v[220:223], v[188:191], v[20:23]
v_exp_f32 v123, v123
v_exp_f32 v140, v140
s_waitcnt vmcnt(6)
ds_read_b64_tr_b16 v[200:201], v236 offset:0
ds_read_b64_tr_b16 v[204:205], v237 offset:0
ds_read_b64_tr_b16 v[208:209], v238 offset:0
ds_read_b64_tr_b16 v[212:213], v239 offset:0
v_mfma_f32_16x16x32_bf16 v[40:43], v[224:227], v[188:191], v[40:43]
v_exp_f32 v141, v141
v_exp_f32 v142, v142
v_mfma_f32_16x16x32_bf16 v[60:63], v[228:231], v[188:191], v[60:63]
v_exp_f32 v143, v143
v_pk_add_f32 v[100:101], v[120:121], v[122:123]
ds_read_b128 v[188:191], v244 offset:23552
v_mfma_f32_16x16x32_bf16 v[4:7], v[216:219], v[160:163], v[4:7]
v_pk_add_f32 v[102:103], v[140:141], v[142:143]
v_cvt_pk_bf16_f32 v120, v120, v121
v_mfma_f32_16x16x32_bf16 v[24:27], v[220:223], v[160:163], v[24:27]
v_cvt_pk_bf16_f32 v121, v122, v123
v_mfma_f32_16x16x32_bf16 v[44:47], v[224:227], v[160:163], v[44:47]
v_cvt_pk_bf16_f32 v122, v140, v141
v_cvt_pk_bf16_f32 v123, v142, v143
s_waitcnt lgkmcnt(1)
s_mov_b32 m0, s4
s_mov_b32 s9, 98304
buffer_load_dwordx4 v232, s[52:55], s9 offen nt lds
s_mov_b32 s8, 101376
buffer_load_dwordx4 v232, s[52:55], s8 offen offset:1024 nt lds
v_mfma_f32_16x16x32_bf16 v[64:67], v[228:231], v[160:163], v[64:67]
v_pk_add_f32 v[100:101], v[100:101], v[102:103]
v_add_f32 v192, v192, v100
ds_read_b128 v[160:163], v244 offset:24576
v_mfma_f32_16x16x32_bf16 v[8:11], v[216:219], v[164:167], v[8:11]
v_add_f32 v192, v192, v101
v_fma_f32 v124, v124, s6, -v247
s_waitcnt vmcnt(6)
ds_read_b64_tr_b16 v[202:203], v236 offset:2048
ds_read_b64_tr_b16 v[206:207], v237 offset:2048
ds_read_b64_tr_b16 v[210:211], v238 offset:2048
ds_read_b64_tr_b16 v[214:215], v239 offset:2048
v_mfma_f32_16x16x32_bf16 v[28:31], v[220:223], v[164:167], v[28:31]
v_fma_f32 v125, v125, s6, -v247
v_fma_f32 v126, v126, s6, -v247
v_mfma_f32_16x16x32_bf16 v[48:51], v[224:227], v[164:167], v[48:51]
v_fma_f32 v127, v127, s6, -v247
v_fma_f32 v144, v144, s6, -v247
v_mfma_f32_16x16x32_bf16 v[68:71], v[228:231], v[164:167], v[68:71]
v_fma_f32 v145, v145, s6, -v247
v_fma_f32 v146, v146, s6, -v247
ds_read_b128 v[164:167], v244 offset:25600
v_mfma_f32_16x16x32_bf16 v[12:15], v[216:219], v[168:171], v[12:15]
v_fma_f32 v147, v147, s6, -v247
v_exp_f32 v124, v124
v_mfma_f32_16x16x32_bf16 v[32:35], v[220:223], v[168:171], v[32:35]
v_exp_f32 v125, v125
s_waitcnt lgkmcnt(1)
s_mov_b32 m0, s4
s_mov_b32 s9, 104448
buffer_load_dwordx4 v232, s[52:55], s9 offen offset:2048 nt lds
s_mov_b32 s8, 107520
buffer_load_dwordx4 v232, s[52:55], s8 offen offset:3072 nt lds
v_mfma_f32_16x16x32_bf16 v[52:55], v[224:227], v[168:171], v[52:55]
v_exp_f32 v126, v126
v_exp_f32 v127, v127
v_mfma_f32_16x16x32_bf16 v[72:75], v[228:231], v[168:171], v[72:75]
v_exp_f32 v144, v144
v_exp_f32 v145, v145
ds_read_b128 v[168:171], v244 offset:26624
v_mfma_f32_16x16x32_bf16 v[16:19], v[216:219], v[172:175], v[16:19]
v_exp_f32 v146, v146
v_exp_f32 v147, v147
v_mfma_f32_16x16x32_bf16 v[36:39], v[220:223], v[172:175], v[36:39]
v_pk_add_f32 v[100:101], v[124:125], v[126:127]
v_pk_add_f32 v[102:103], v[144:145], v[146:147]
v_mfma_f32_16x16x32_bf16 v[56:59], v[224:227], v[172:175], v[56:59]
v_cvt_pk_bf16_f32 v124, v124, v125
v_cvt_pk_bf16_f32 v125, v126, v127
v_mfma_f32_16x16x32_bf16 v[76:79], v[228:231], v[172:175], v[76:79]
v_cvt_pk_bf16_f32 v126, v144, v145
v_cvt_pk_bf16_f32 v127, v146, v147
ds_read_b128 v[172:175], v244 offset:27648
v_mfma_f32_16x16x32_bf16 v[0:3], v[200:203], v[176:179], v[0:3]
v_pk_add_f32 v[100:101], v[100:101], v[102:103]
v_add_f32 v193, v193, v100
v_mfma_f32_16x16x32_bf16 v[20:23], v[204:207], v[176:179], v[20:23]
v_add_f32 v193, v193, v101
s_waitcnt vmcnt(6)
ds_read_b64_tr_b16 v[216:217], v236 offset:4096
ds_read_b64_tr_b16 v[220:221], v237 offset:4096
ds_read_b64_tr_b16 v[224:225], v238 offset:4096
ds_read_b64_tr_b16 v[228:229], v239 offset:4096
v_mfma_f32_16x16x32_bf16 v[40:43], v[208:211], v[176:179], v[40:43]
v_fma_f32 v128, v128, s6, -v248
v_fma_f32 v129, v129, s6, -v248
v_mfma_f32_16x16x32_bf16 v[60:63], v[212:215], v[176:179], v[60:63]
v_fma_f32 v130, v130, s6, -v248
v_fma_f32 v131, v131, s6, -v248
ds_read_b128 v[176:179], v244 offset:28672
v_mfma_f32_16x16x32_bf16 v[4:7], v[200:203], v[180:183], v[4:7]
v_fma_f32 v148, v148, s6, -v248
v_fma_f32 v149, v149, s6, -v248
v_mfma_f32_16x16x32_bf16 v[24:27], v[204:207], v[180:183], v[24:27]
v_fma_f32 v150, v150, s6, -v248
v_fma_f32 v151, v151, s6, -v248
v_mfma_f32_16x16x32_bf16 v[44:47], v[208:211], v[180:183], v[44:47]
v_exp_f32 v128, v128
v_exp_f32 v129, v129
s_waitcnt lgkmcnt(1)
s_mov_b32 m0, s5
s_mov_b32 s9, 114688
buffer_load_dwordx4 v232, s[52:55], s9 offen nt lds
s_mov_b32 s8, 117760
buffer_load_dwordx4 v232, s[52:55], s8 offen offset:1024 nt lds
v_mfma_f32_16x16x32_bf16 v[64:67], v[212:215], v[180:183], v[64:67]
v_exp_f32 v130, v130
v_exp_f32 v131, v131
ds_read_b128 v[180:183], v244 offset:29696
v_mfma_f32_16x16x32_bf16 v[8:11], v[200:203], v[184:187], v[8:11]
v_exp_f32 v148, v148
v_exp_f32 v149, v149
s_waitcnt vmcnt(6)
ds_read_b64_tr_b16 v[218:219], v236 offset:6144
ds_read_b64_tr_b16 v[222:223], v237 offset:6144
ds_read_b64_tr_b16 v[226:227], v238 offset:6144
ds_read_b64_tr_b16 v[230:231], v239 offset:6144
v_mfma_f32_16x16x32_bf16 v[28:31], v[204:207], v[184:187], v[28:31]
v_exp_f32 v150, v150
v_mfma_f32_16x16x32_bf16 v[48:51], v[208:211], v[184:187], v[48:51]
v_exp_f32 v151, v151
v_pk_add_f32 v[100:101], v[128:129], v[130:131]
v_mfma_f32_16x16x32_bf16 v[68:71], v[212:215], v[184:187], v[68:71]
v_pk_add_f32 v[102:103], v[148:149], v[150:151]
v_cvt_pk_bf16_f32 v128, v128, v129
ds_read_b128 v[184:187], v244 offset:30720
v_mfma_f32_16x16x32_bf16 v[12:15], v[200:203], v[188:191], v[12:15]
v_cvt_pk_bf16_f32 v129, v130, v131
v_cvt_pk_bf16_f32 v130, v148, v149
v_mfma_f32_16x16x32_bf16 v[32:35], v[204:207], v[188:191], v[32:35]
v_cvt_pk_bf16_f32 v131, v150, v151
v_pk_add_f32 v[100:101], v[100:101], v[102:103]
s_waitcnt lgkmcnt(1)
s_mov_b32 m0, s5
s_mov_b32 s9, 120832
buffer_load_dwordx4 v232, s[52:55], s9 offen offset:2048 nt lds
s_mov_b32 s8, 123904
buffer_load_dwordx4 v232, s[52:55], s8 offen offset:3072 nt lds
v_mfma_f32_16x16x32_bf16 v[52:55], v[208:211], v[188:191], v[52:55]
v_add_f32 v194, v194, v100
v_add_f32 v194, v194, v101
v_mfma_f32_16x16x32_bf16 v[72:75], v[212:215], v[188:191], v[72:75]
v_fma_f32 v132, v132, s6, -v249
v_fma_f32 v133, v133, s6, -v249
ds_read_b128 v[188:191], v244 offset:31744
v_mfma_f32_16x16x32_bf16 v[16:19], v[200:203], v[160:163], v[16:19]
v_fma_f32 v134, v134, s6, -v249
v_fma_f32 v135, v135, s6, -v249
v_mfma_f32_16x16x32_bf16 v[36:39], v[204:207], v[160:163], v[36:39]
v_fma_f32 v152, v152, s6, -v249
v_mfma_f32_16x16x32_bf16 v[56:59], v[208:211], v[160:163], v[56:59]
v_fma_f32 v153, v153, s6, -v249
v_fma_f32 v154, v154, s6, -v249
v_mfma_f32_16x16x32_bf16 v[76:79], v[212:215], v[160:163], v[76:79]
v_fma_f32 v155, v155, s6, -v249
v_exp_f32 v132, v132
ds_read_b128 v[160:163], v244 offset:32768
v_mfma_f32_16x16x32_bf16 v[0:3], v[216:219], v[164:167], v[0:3]
v_exp_f32 v133, v133
v_exp_f32 v134, v134
v_mfma_f32_16x16x32_bf16 v[20:23], v[220:223], v[164:167], v[20:23]
v_exp_f32 v135, v135
v_exp_f32 v152, v152
s_waitcnt vmcnt(6)
ds_read_b64_tr_b16 v[200:201], v236 offset:0
ds_read_b64_tr_b16 v[204:205], v237 offset:0
ds_read_b64_tr_b16 v[208:209], v238 offset:0
ds_read_b64_tr_b16 v[212:213], v239 offset:0
v_mfma_f32_16x16x32_bf16 v[40:43], v[224:227], v[164:167], v[40:43]
v_exp_f32 v153, v153
v_exp_f32 v154, v154
v_mfma_f32_16x16x32_bf16 v[60:63], v[228:231], v[164:167], v[60:63]
v_exp_f32 v155, v155
v_pk_add_f32 v[100:101], v[132:133], v[134:135]
ds_read_b128 v[164:167], v244 offset:33792
v_mfma_f32_16x16x32_bf16 v[4:7], v[216:219], v[168:171], v[4:7]
v_pk_add_f32 v[102:103], v[152:153], v[154:155]
v_cvt_pk_bf16_f32 v132, v132, v133
v_mfma_f32_16x16x32_bf16 v[24:27], v[220:223], v[168:171], v[24:27]
v_cvt_pk_bf16_f32 v133, v134, v135
v_mfma_f32_16x16x32_bf16 v[44:47], v[224:227], v[168:171], v[44:47]
v_cvt_pk_bf16_f32 v134, v152, v153
v_cvt_pk_bf16_f32 v135, v154, v155
s_waitcnt lgkmcnt(1)
s_mov_b32 m0, s4
s_mov_b32 s9, 131072
buffer_load_dwordx4 v232, s[52:55], s9 offen nt lds
s_mov_b32 s8, 134144
buffer_load_dwordx4 v232, s[52:55], s8 offen offset:1024 nt lds
v_mfma_f32_16x16x32_bf16 v[64:67], v[228:231], v[168:171], v[64:67]
v_pk_add_f32 v[100:101], v[100:101], v[102:103]
v_add_f32 v195, v195, v100
ds_read_b128 v[168:171], v244 offset:34816
v_mfma_f32_16x16x32_bf16 v[8:11], v[216:219], v[172:175], v[8:11]
v_add_f32 v195, v195, v101
v_fma_f32 v136, v136, s6, -v250
s_waitcnt vmcnt(6)
ds_read_b64_tr_b16 v[202:203], v236 offset:2048
ds_read_b64_tr_b16 v[206:207], v237 offset:2048
ds_read_b64_tr_b16 v[210:211], v238 offset:2048
ds_read_b64_tr_b16 v[214:215], v239 offset:2048
v_mfma_f32_16x16x32_bf16 v[28:31], v[220:223], v[172:175], v[28:31]
v_fma_f32 v137, v137, s6, -v250
v_fma_f32 v138, v138, s6, -v250
v_mfma_f32_16x16x32_bf16 v[48:51], v[224:227], v[172:175], v[48:51]
v_fma_f32 v139, v139, s6, -v250
v_fma_f32 v156, v156, s6, -v250
v_mfma_f32_16x16x32_bf16 v[68:71], v[228:231], v[172:175], v[68:71]
v_fma_f32 v157, v157, s6, -v250
v_fma_f32 v158, v158, s6, -v250
ds_read_b128 v[172:175], v244 offset:35840
v_mfma_f32_16x16x32_bf16 v[12:15], v[216:219], v[176:179], v[12:15]
v_fma_f32 v159, v159, s6, -v250
v_exp_f32 v136, v136
v_mfma_f32_16x16x32_bf16 v[32:35], v[220:223], v[176:179], v[32:35]
v_exp_f32 v137, v137
s_waitcnt lgkmcnt(1)
s_mov_b32 m0, s4
s_mov_b32 s9, 137216
buffer_load_dwordx4 v232, s[52:55], s9 offen offset:2048 nt lds
s_mov_b32 s8, 140288
buffer_load_dwordx4 v232, s[52:55], s8 offen offset:3072 nt lds
v_mfma_f32_16x16x32_bf16 v[52:55], v[224:227], v[176:179], v[52:55]
v_exp_f32 v138, v138
v_exp_f32 v139, v139
v_mfma_f32_16x16x32_bf16 v[72:75], v[228:231], v[176:179], v[72:75]
v_exp_f32 v156, v156
v_exp_f32 v157, v157
ds_read_b128 v[176:179], v244 offset:36864
v_mfma_f32_16x16x32_bf16 v[16:19], v[216:219], v[180:183], v[16:19]
v_exp_f32 v158, v158
v_exp_f32 v159, v159
v_mfma_f32_16x16x32_bf16 v[36:39], v[220:223], v[180:183], v[36:39]
v_pk_add_f32 v[100:101], v[136:137], v[138:139]
v_pk_add_f32 v[102:103], v[156:157], v[158:159]
v_mfma_f32_16x16x32_bf16 v[56:59], v[224:227], v[180:183], v[56:59]
v_cvt_pk_bf16_f32 v136, v136, v137
v_cvt_pk_bf16_f32 v137, v138, v139
v_mfma_f32_16x16x32_bf16 v[76:79], v[228:231], v[180:183], v[76:79]
v_cvt_pk_bf16_f32 v138, v156, v157
v_cvt_pk_bf16_f32 v139, v158, v159
ds_read_b128 v[180:183], v244 offset:37888
v_mfma_f32_16x16x32_bf16 v[0:3], v[200:203], v[184:187], v[0:3]
v_pk_add_f32 v[100:101], v[100:101], v[102:103]
v_add_f32 v196, v196, v100
v_mfma_f32_16x16x32_bf16 v[20:23], v[204:207], v[184:187], v[20:23]
v_add_f32 v196, v196, v101
s_waitcnt vmcnt(6)
ds_read_b64_tr_b16 v[216:217], v236 offset:4096
ds_read_b64_tr_b16 v[220:221], v237 offset:4096
ds_read_b64_tr_b16 v[224:225], v238 offset:4096
ds_read_b64_tr_b16 v[228:229], v239 offset:4096
v_mfma_f32_16x16x32_bf16 v[40:43], v[208:211], v[184:187], v[40:43]
v_mfma_f32_16x16x32_bf16 v[60:63], v[212:215], v[184:187], v[60:63]
ds_read_b128 v[184:187], v244 offset:38912
v_mfma_f32_16x16x32_bf16 v[4:7], v[200:203], v[188:191], v[4:7]
v_lshlrev_b32 v199, 4, v235
s_lshl_b32 s10, s14, 11
s_lshl_b32 s11, s15, 2
s_add_u32 s10, s10, s11
s_add_u32 s10, s10, 151552
v_add_u32 v199, s10, v199
v_mov_b32 v198, v196
s_nop 1
v_permlane32_swap_b32 v192, v194
v_permlane32_swap_b32 v193, v195
v_permlane32_swap_b32 v196, v198
v_add_f32 v192, v192, v194
v_add_f32 v193, v193, v195
v_add_f32 v196, v196, v198
v_mov_b32 v198, v196
s_nop 1
v_permlane16_swap_b32 v192, v193
v_permlane16_swap_b32 v196, v198
v_add_f32 v192, v192, v193
v_add_f32 v196, v196, v198
ds_write_b32 v199, v192 offset:0
ds_write_b32 v199, v196 offset:1024
v_mfma_f32_16x16x32_bf16 v[24:27], v[204:207], v[188:191], v[24:27]
v_mfma_f32_16x16x32_bf16 v[44:47], v[208:211], v[188:191], v[44:47]
s_waitcnt lgkmcnt(3)
s_mov_b32 m0, s5
s_mov_b32 s9, 147456
buffer_load_dwordx4 v232, s[52:55], s9 offen nt lds
s_mov_b32 s8, 150528
buffer_load_dwordx4 v232, s[52:55], s8 offen offset:1024 nt lds
v_mfma_f32_16x16x32_bf16 v[64:67], v[212:215], v[188:191], v[64:67]
ds_read_b128 v[188:191], v244 offset:39936
v_mfma_f32_16x16x32_bf16 v[8:11], v[200:203], v[160:163], v[8:11]
s_waitcnt vmcnt(6)
ds_read_b64_tr_b16 v[218:219], v236 offset:6144
ds_read_b64_tr_b16 v[222:223], v237 offset:6144
ds_read_b64_tr_b16 v[226:227], v238 offset:6144
ds_read_b64_tr_b16 v[230:231], v239 offset:6144
v_mfma_f32_16x16x32_bf16 v[28:31], v[204:207], v[160:163], v[28:31]
v_mfma_f32_16x16x32_bf16 v[48:51], v[208:211], v[160:163], v[48:51]
v_mfma_f32_16x16x32_bf16 v[68:71], v[212:215], v[160:163], v[68:71]
v_mfma_f32_16x16x32_bf16 v[12:15], v[200:203], v[164:167], v[12:15]
v_mfma_f32_16x16x32_bf16 v[32:35], v[204:207], v[164:167], v[32:35]
s_waitcnt lgkmcnt(0)
s_mov_b32 m0, s5
s_mov_b32 s9, 153600
buffer_load_dwordx4 v232, s[52:55], s9 offen offset:2048 nt lds
s_mov_b32 s8, 156672
buffer_load_dwordx4 v232, s[52:55], s8 offen offset:3072 nt lds
v_mfma_f32_16x16x32_bf16 v[52:55], v[208:211], v[164:167], v[52:55]
v_mfma_f32_16x16x32_bf16 v[72:75], v[212:215], v[164:167], v[72:75]
v_mfma_f32_16x16x32_bf16 v[16:19], v[200:203], v[168:171], v[16:19]
s_barrier
ds_write_b128 v197, v[80:83] offset:0
v_mfma_f32_16x16x32_bf16 v[36:39], v[204:207], v[168:171], v[36:39]
ds_write_b128 v197, v[84:87] offset:1024
v_mfma_f32_16x16x32_bf16 v[56:59], v[208:211], v[168:171], v[56:59]
ds_write_b128 v197, v[88:91] offset:2048
v_mfma_f32_16x16x32_bf16 v[76:79], v[212:215], v[168:171], v[76:79]
ds_write_b128 v197, v[92:95] offset:3072
v_mfma_f32_16x16x32_bf16 v[0:3], v[216:219], v[172:175], v[0:3]
ds_write_b128 v197, v[96:99] offset:4096
v_mfma_f32_16x16x32_bf16 v[20:23], v[220:223], v[172:175], v[20:23]
ds_write_b128 v197, v[120:123] offset:5120
s_waitcnt vmcnt(6)
ds_read_b64_tr_b16 v[200:201], v236 offset:0
ds_read_b64_tr_b16 v[204:205], v237 offset:0
ds_read_b64_tr_b16 v[208:209], v238 offset:0
ds_read_b64_tr_b16 v[212:213], v239 offset:0
v_mfma_f32_16x16x32_bf16 v[40:43], v[224:227], v[172:175], v[40:43]
ds_write_b128 v197, v[124:127] offset:6144
v_mfma_f32_16x16x32_bf16 v[60:63], v[228:231], v[172:175], v[60:63]
ds_write_b128 v197, v[128:131] offset:7168
v_mfma_f32_16x16x32_bf16 v[4:7], v[216:219], v[176:179], v[4:7]
ds_write_b128 v197, v[132:135] offset:8192
v_mfma_f32_16x16x32_bf16 v[24:27], v[220:223], v[176:179], v[24:27]
ds_write_b128 v197, v[136:139] offset:9216
v_mfma_f32_16x16x32_bf16 v[44:47], v[224:227], v[176:179], v[44:47]
s_waitcnt lgkmcnt(4)
s_mov_b32 m0, s4
s_mov_b32 s9, 163840
buffer_load_dwordx4 v232, s[52:55], s9 offen nt lds
s_mov_b32 s8, 166912
buffer_load_dwordx4 v232, s[52:55], s8 offen offset:1024 nt lds
v_mfma_f32_16x16x32_bf16 v[64:67], v[228:231], v[176:179], v[64:67]
v_mfma_f32_16x16x32_bf16 v[8:11], v[216:219], v[180:183], v[8:11]
s_waitcnt vmcnt(6)
ds_read_b64_tr_b16 v[202:203], v236 offset:2048
ds_read_b64_tr_b16 v[206:207], v237 offset:2048
ds_read_b64_tr_b16 v[210:211], v238 offset:2048
ds_read_b64_tr_b16 v[214:215], v239 offset:2048
v_mfma_f32_16x16x32_bf16 v[28:31], v[220:223], v[180:183], v[28:31]
v_mfma_f32_16x16x32_bf16 v[48:51], v[224:227], v[180:183], v[48:51]
v_mfma_f32_16x16x32_bf16 v[68:71], v[228:231], v[180:183], v[68:71]
v_mfma_f32_16x16x32_bf16 v[12:15], v[216:219], v[184:187], v[12:15]
v_mfma_f32_16x16x32_bf16 v[32:35], v[220:223], v[184:187], v[32:35]
s_waitcnt lgkmcnt(0)
s_mov_b32 m0, s4
s_mov_b32 s9, 169984
buffer_load_dwordx4 v232, s[52:55], s9 offen offset:2048 nt lds
s_mov_b32 s8, 173056
buffer_load_dwordx4 v232, s[52:55], s8 offen offset:3072 nt lds
v_mfma_f32_16x16x32_bf16 v[52:55], v[224:227], v[184:187], v[52:55]
v_mfma_f32_16x16x32_bf16 v[72:75], v[228:231], v[184:187], v[72:75]
v_mfma_f32_16x16x32_bf16 v[16:19], v[216:219], v[188:191], v[16:19]
v_mfma_f32_16x16x32_bf16 v[36:39], v[220:223], v[188:191], v[36:39]
v_mfma_f32_16x16x32_bf16 v[56:59], v[224:227], v[188:191], v[56:59]
s_barrier
ds_read_b128 v[160:163], v244 offset:0
ds_read_b128 v[164:167], v244 offset:1024
ds_read_b128 v[168:171], v244 offset:2048
v_mfma_f32_16x16x32_bf16 v[76:79], v[228:231], v[188:191], v[76:79]
ds_read_b128 v[172:175], v244 offset:3072
ds_read_b128 v[176:179], v244 offset:4096
ds_read_b128 v[180:183], v244 offset:5120
s_waitcnt lgkmcnt(5)
v_mfma_f32_16x16x32_bf16 v[0:3], v[200:203], v[160:163], v[0:3]
ds_read_b128 v[184:187], v244 offset:6144
ds_read_b128 v[188:191], v244 offset:7168
v_mfma_f32_16x16x32_bf16 v[20:23], v[204:207], v[160:163], v[20:23]
s_waitcnt vmcnt(6)
ds_read_b64_tr_b16 v[216:217], v236 offset:4096
ds_read_b64_tr_b16 v[220:221], v237 offset:4096
ds_read_b64_tr_b16 v[224:225], v238 offset:4096
ds_read_b64_tr_b16 v[228:229], v239 offset:4096
v_mfma_f32_16x16x32_bf16 v[40:43], v[208:211], v[160:163], v[40:43]
v_mfma_f32_16x16x32_bf16 v[60:63], v[212:215], v[160:163], v[60:63]
ds_read_b128 v[160:163], v244 offset:8192
s_waitcnt lgkmcnt(11)
v_mfma_f32_16x16x32_bf16 v[4:7], v[200:203], v[164:167], v[4:7]
v_mfma_f32_16x16x32_bf16 v[24:27], v[204:207], v[164:167], v[24:27]
v_mfma_f32_16x16x32_bf16 v[44:47], v[208:211], v[164:167], v[44:47]
s_waitcnt lgkmcnt(1)
s_mov_b32 m0, s5
s_mov_b32 s9, 180224
buffer_load_dwordx4 v232, s[52:55], s9 offen nt lds
s_mov_b32 s8, 183296
buffer_load_dwordx4 v232, s[52:55], s8 offen offset:1024 nt lds
v_mfma_f32_16x16x32_bf16 v[64:67], v[212:215], v[164:167], v[64:67]
ds_read_b128 v[164:167], v244 offset:9216
v_mfma_f32_16x16x32_bf16 v[8:11], v[200:203], v[168:171], v[8:11]
s_waitcnt vmcnt(6)
ds_read_b64_tr_b16 v[218:219], v236 offset:6144
ds_read_b64_tr_b16 v[222:223], v237 offset:6144
ds_read_b64_tr_b16 v[226:227], v238 offset:6144
ds_read_b64_tr_b16 v[230:231], v239 offset:6144
v_mfma_f32_16x16x32_bf16 v[28:31], v[204:207], v[168:171], v[28:31]
v_mfma_f32_16x16x32_bf16 v[48:51], v[208:211], v[168:171], v[48:51]
v_mfma_f32_16x16x32_bf16 v[68:71], v[212:215], v[168:171], v[68:71]
ds_read_b128 v[168:171], v244 offset:10240
v_mfma_f32_16x16x32_bf16 v[12:15], v[200:203], v[172:175], v[12:15]
v_mfma_f32_16x16x32_bf16 v[32:35], v[204:207], v[172:175], v[32:35]
s_waitcnt lgkmcnt(1)
s_mov_b32 m0, s5
s_mov_b32 s9, 186368
buffer_load_dwordx4 v232, s[52:55], s9 offen offset:2048 nt lds
s_mov_b32 s8, 189440
buffer_load_dwordx4 v232, s[52:55], s8 offen offset:3072 nt lds
v_mfma_f32_16x16x32_bf16 v[52:55], v[208:211], v[172:175], v[52:55]
v_mfma_f32_16x16x32_bf16 v[72:75], v[212:215], v[172:175], v[72:75]
ds_read_b128 v[172:175], v244 offset:11264
v_mfma_f32_16x16x32_bf16 v[16:19], v[200:203], v[176:179], v[16:19]
v_mfma_f32_16x16x32_bf16 v[36:39], v[204:207], v[176:179], v[36:39]
v_mfma_f32_16x16x32_bf16 v[56:59], v[208:211], v[176:179], v[56:59]
v_mfma_f32_16x16x32_bf16 v[76:79], v[212:215], v[176:179], v[76:79]
ds_read_b128 v[176:179], v244 offset:12288
v_mfma_f32_16x16x32_bf16 v[0:3], v[216:219], v[180:183], v[0:3]
v_mfma_f32_16x16x32_bf16 v[20:23], v[220:223], v[180:183], v[20:23]
s_waitcnt vmcnt(6)
ds_read_b64_tr_b16 v[200:201], v236 offset:0
ds_read_b64_tr_b16 v[204:205], v237 offset:0
ds_read_b64_tr_b16 v[208:209], v238 offset:0
ds_read_b64_tr_b16 v[212:213], v239 offset:0
v_mfma_f32_16x16x32_bf16 v[40:43], v[224:227], v[180:183], v[40:43]
v_mfma_f32_16x16x32_bf16 v[60:63], v[228:231], v[180:183], v[60:63]
ds_read_b128 v[180:183], v244 offset:13312
v_mfma_f32_16x16x32_bf16 v[4:7], v[216:219], v[184:187], v[4:7]
v_mfma_f32_16x16x32_bf16 v[24:27], v[220:223], v[184:187], v[24:27]
v_mfma_f32_16x16x32_bf16 v[44:47], v[224:227], v[184:187], v[44:47]
s_waitcnt lgkmcnt(1)
s_mov_b32 m0, s4
s_mov_b32 s9, 196608
buffer_load_dwordx4 v232, s[52:55], s9 offen nt lds
s_mov_b32 s8, 199680
buffer_load_dwordx4 v232, s[52:55], s8 offen offset:1024 nt lds
v_mfma_f32_16x16x32_bf16 v[64:67], v[228:231], v[184:187], v[64:67]
ds_read_b128 v[184:187], v244 offset:14336
v_mfma_f32_16x16x32_bf16 v[8:11], v[216:219], v[188:191], v[8:11]
s_waitcnt vmcnt(6)
ds_read_b64_tr_b16 v[202:203], v236 offset:2048
ds_read_b64_tr_b16 v[206:207], v237 offset:2048
ds_read_b64_tr_b16 v[210:211], v238 offset:2048
ds_read_b64_tr_b16 v[214:215], v239 offset:2048
v_mfma_f32_16x16x32_bf16 v[28:31], v[220:223], v[188:191], v[28:31]
v_mfma_f32_16x16x32_bf16 v[48:51], v[224:227], v[188:191], v[48:51]
v_mfma_f32_16x16x32_bf16 v[68:71], v[228:231], v[188:191], v[68:71]
ds_read_b128 v[188:191], v244 offset:15360
v_mfma_f32_16x16x32_bf16 v[12:15], v[216:219], v[160:163], v[12:15]
v_mfma_f32_16x16x32_bf16 v[32:35], v[220:223], v[160:163], v[32:35]
s_waitcnt lgkmcnt(1)
s_mov_b32 m0, s4
s_mov_b32 s9, 202752
buffer_load_dwordx4 v232, s[52:55], s9 offen offset:2048 nt lds
s_mov_b32 s8, 205824
buffer_load_dwordx4 v232, s[52:55], s8 offen offset:3072 nt lds
v_mfma_f32_16x16x32_bf16 v[52:55], v[224:227], v[160:163], v[52:55]
v_mfma_f32_16x16x32_bf16 v[72:75], v[228:231], v[160:163], v[72:75]
ds_read_b128 v[160:163], v244 offset:16384
v_mfma_f32_16x16x32_bf16 v[16:19], v[216:219], v[164:167], v[16:19]
v_mfma_f32_16x16x32_bf16 v[36:39], v[220:223], v[164:167], v[36:39]
v_mfma_f32_16x16x32_bf16 v[56:59], v[224:227], v[164:167], v[56:59]
v_mfma_f32_16x16x32_bf16 v[76:79], v[228:231], v[164:167], v[76:79]
ds_read_b128 v[164:167], v244 offset:17408
v_mfma_f32_16x16x32_bf16 v[0:3], v[200:203], v[168:171], v[0:3]
s_mul_i32 s10, s98, 143360
s_add_u32 s20, s84, s10
s_addc_u32 s21, s85, 0
s_mov_b32 s22, 143360
s_mov_b32 s23, 0x20000
s_mul_i32 s10, s97, 560
s_lshl_b32 s11, s3, 6
s_add_u32 s11, s11, s10
s_add_u32 s10, s10, 512
v_add_u32 v104, s11, v235
v_add_u32 v105, s10, v235
v_lshlrev_b32 v112, 4, v104
v_lshrrev_b32 v106, 6, v104
v_mul_u32_u24 v107, 205, v106
v_lshrrev_b32 v107, 10, v107
v_mul_u32_u24 v108, 5, v107
v_sub_u32 v108, v106, v108
v_and_b32 v109, 15, v104
v_lshl_add_u32 v108, v108, 4, v109
v_mul_u32_u24 v108, 1792, v108
v_lshl_add_u32 v108, v107, 6, v108
v_bfe_u32 v109, v104, 4, 2
v_lshl_add_u32 v114, v109, 3, v108
v_lshlrev_b32 v113, 4, v105
v_lshrrev_b32 v106, 6, v105
v_mul_u32_u24 v107, 205, v106
v_lshrrev_b32 v107, 10, v107
v_mul_u32_u24 v108, 5, v107
v_sub_u32 v108, v106, v108
v_and_b32 v109, 15, v105
v_lshl_add_u32 v108, v108, 4, v109
v_mul_u32_u24 v108, 1792, v108
v_lshl_add_u32 v108, v107, 6, v108
v_bfe_u32 v109, v105, 4, 2
v_lshl_add_u32 v115, v109, 3, v108
v_cmp_gt_u32 vcc, 48, v235
v_mov_b32 v106, 0x7ff00000
s_nop 1
v_cndmask_b32 v113, v106, v113, vcc
v_cndmask_b32 v115, v106, v115, vcc
v_mfma_f32_16x16x32_bf16 v[20:23], v[204:207], v[168:171], v[20:23]
s_waitcnt vmcnt(6)
ds_read_b64_tr_b16 v[216:217], v236 offset:4096
ds_read_b64_tr_b16 v[220:221], v237 offset:4096
ds_read_b64_tr_b16 v[224:225], v238 offset:4096
ds_read_b64_tr_b16 v[228:229], v239 offset:4096
v_mfma_f32_16x16x32_bf16 v[40:43], v[208:211], v[168:171], v[40:43]
v_mfma_f32_16x16x32_bf16 v[60:63], v[212:215], v[168:171], v[60:63]
ds_read_b128 v[168:171], v244 offset:18432
v_mfma_f32_16x16x32_bf16 v[4:7], v[200:203], v[172:175], v[4:7]
v_mfma_f32_16x16x32_bf16 v[24:27], v[204:207], v[172:175], v[24:27]
v_mfma_f32_16x16x32_bf16 v[44:47], v[208:211], v[172:175], v[44:47]
s_waitcnt lgkmcnt(1)
s_mov_b32 m0, s5
s_mov_b32 s9, 212992
buffer_load_dwordx4 v232, s[52:55], s9 offen nt lds
s_mov_b32 s8, 216064
buffer_load_dwordx4 v232, s[52:55], s8 offen offset:1024 nt lds
v_mfma_f32_16x16x32_bf16 v[64:67], v[212:215], v[172:175], v[64:67]
ds_read_b128 v[172:175], v244 offset:19456
v_mfma_f32_16x16x32_bf16 v[8:11], v[200:203], v[176:179], v[8:11]
s_waitcnt vmcnt(6)
ds_read_b64_tr_b16 v[218:219], v236 offset:6144
ds_read_b64_tr_b16 v[222:223], v237 offset:6144
ds_read_b64_tr_b16 v[226:227], v238 offset:6144
ds_read_b64_tr_b16 v[230:231], v239 offset:6144
v_mfma_f32_16x16x32_bf16 v[28:31], v[204:207], v[176:179], v[28:31]
v_mfma_f32_16x16x32_bf16 v[48:51], v[208:211], v[176:179], v[48:51]
v_mfma_f32_16x16x32_bf16 v[68:71], v[212:215], v[176:179], v[68:71]
ds_read_b128 v[176:179], v244 offset:20480
v_mfma_f32_16x16x32_bf16 v[12:15], v[200:203], v[180:183], v[12:15]
v_mfma_f32_16x16x32_bf16 v[32:35], v[204:207], v[180:183], v[32:35]
s_waitcnt lgkmcnt(1)
s_mov_b32 m0, s5
s_mov_b32 s9, 219136
buffer_load_dwordx4 v232, s[52:55], s9 offen offset:2048 nt lds
s_mov_b32 s8, 222208
buffer_load_dwordx4 v232, s[52:55], s8 offen offset:3072 nt lds
v_mfma_f32_16x16x32_bf16 v[52:55], v[208:211], v[180:183], v[52:55]
v_mfma_f32_16x16x32_bf16 v[72:75], v[212:215], v[180:183], v[72:75]
ds_read_b128 v[180:183], v244 offset:21504
v_mfma_f32_16x16x32_bf16 v[16:19], v[200:203], v[184:187], v[16:19]
v_mfma_f32_16x16x32_bf16 v[36:39], v[204:207], v[184:187], v[36:39]
v_mfma_f32_16x16x32_bf16 v[56:59], v[208:211], v[184:187], v[56:59]
v_mfma_f32_16x16x32_bf16 v[76:79], v[212:215], v[184:187], v[76:79]
ds_read_b128 v[184:187], v244 offset:22528
v_mfma_f32_16x16x32_bf16 v[0:3], v[216:219], v[188:191], v[0:3]
v_and_b32 v253, 15, v235
v_lshlrev_b32 v253, 4, v253
s_lshl_b32 s10, s14, 11
s_add_u32 s10, s10, 151552
v_add_u32 v253, s10, v253
ds_read_b128 v[140:143], v253 offset:0
ds_read_b128 v[144:147], v253 offset:256
ds_read_b128 v[148:151], v253 offset:512
ds_read_b128 v[152:155], v253 offset:768
ds_read_b128 v[156:159], v253 offset:1024
s_waitcnt lgkmcnt(4)
v_pk_add_f32 v[140:141], v[140:141], v[142:143]
v_add_f32 v246, v140, v141
s_waitcnt lgkmcnt(3)
v_pk_add_f32 v[144:145], v[144:145], v[146:147]
v_add_f32 v247, v144, v145
s_waitcnt lgkmcnt(2)
v_pk_add_f32 v[148:149], v[148:149], v[150:151]
v_add_f32 v248, v148, v149
s_waitcnt lgkmcnt(1)
v_pk_add_f32 v[152:153], v[152:153], v[154:155]
v_add_f32 v249, v152, v153
s_waitcnt lgkmcnt(0)
v_pk_add_f32 v[156:157], v[156:157], v[158:159]
v_add_f32 v250, v156, v157
v_rcp_f32 v246, v246
v_rcp_f32 v247, v247
v_rcp_f32 v248, v248
v_rcp_f32 v249, v249
v_rcp_f32 v250, v250
v_mfma_f32_16x16x32_bf16 v[20:23], v[220:223], v[188:191], v[20:23]
s_waitcnt vmcnt(6)
ds_read_b64_tr_b16 v[200:201], v236 offset:0
ds_read_b64_tr_b16 v[204:205], v237 offset:0
ds_read_b64_tr_b16 v[208:209], v238 offset:0
ds_read_b64_tr_b16 v[212:213], v239 offset:0
v_mfma_f32_16x16x32_bf16 v[40:43], v[224:227], v[188:191], v[40:43]
v_mfma_f32_16x16x32_bf16 v[60:63], v[228:231], v[188:191], v[60:63]
ds_read_b128 v[188:191], v244 offset:23552
v_mfma_f32_16x16x32_bf16 v[4:7], v[216:219], v[160:163], v[4:7]
v_mfma_f32_16x16x32_bf16 v[24:27], v[220:223], v[160:163], v[24:27]
v_mfma_f32_16x16x32_bf16 v[44:47], v[224:227], v[160:163], v[44:47]
s_waitcnt lgkmcnt(1)
s_mov_b32 m0, s4
s_mov_b32 s9, 229376
buffer_load_dwordx4 v232, s[52:55], s9 offen nt lds
s_mov_b32 s8, 232448
buffer_load_dwordx4 v232, s[52:55], s8 offen offset:1024 nt lds
v_mfma_f32_16x16x32_bf16 v[64:67], v[228:231], v[160:163], v[64:67]
ds_read_b128 v[160:163], v244 offset:24576
v_mfma_f32_16x16x32_bf16 v[8:11], v[216:219], v[164:167], v[8:11]
s_waitcnt vmcnt(6)
ds_read_b64_tr_b16 v[202:203], v236 offset:2048
ds_read_b64_tr_b16 v[206:207], v237 offset:2048
ds_read_b64_tr_b16 v[210:211], v238 offset:2048
ds_read_b64_tr_b16 v[214:215], v239 offset:2048
v_mfma_f32_16x16x32_bf16 v[28:31], v[220:223], v[164:167], v[28:31]
v_mfma_f32_16x16x32_bf16 v[48:51], v[224:227], v[164:167], v[48:51]
v_mfma_f32_16x16x32_bf16 v[68:71], v[228:231], v[164:167], v[68:71]
ds_read_b128 v[164:167], v244 offset:25600
v_mfma_f32_16x16x32_bf16 v[12:15], v[216:219], v[168:171], v[12:15]
v_mfma_f32_16x16x32_bf16 v[32:35], v[220:223], v[168:171], v[32:35]
s_waitcnt lgkmcnt(1)
s_mov_b32 m0, s4
s_mov_b32 s9, 235520
buffer_load_dwordx4 v232, s[52:55], s9 offen offset:2048 nt lds
s_mov_b32 s8, 238592
buffer_load_dwordx4 v232, s[52:55], s8 offen offset:3072 nt lds
v_mfma_f32_16x16x32_bf16 v[52:55], v[224:227], v[168:171], v[52:55]
v_mfma_f32_16x16x32_bf16 v[72:75], v[228:231], v[168:171], v[72:75]
ds_read_b128 v[168:171], v244 offset:26624
v_mfma_f32_16x16x32_bf16 v[16:19], v[216:219], v[172:175], v[16:19]
v_mfma_f32_16x16x32_bf16 v[36:39], v[220:223], v[172:175], v[36:39]
v_mfma_f32_16x16x32_bf16 v[56:59], v[224:227], v[172:175], v[56:59]
v_mfma_f32_16x16x32_bf16 v[76:79], v[228:231], v[172:175], v[76:79]
ds_read_b128 v[172:175], v244 offset:27648
v_mfma_f32_16x16x32_bf16 v[0:3], v[200:203], v[176:179], v[0:3]
v_mfma_f32_16x16x32_bf16 v[20:23], v[204:207], v[176:179], v[20:23]
s_waitcnt vmcnt(6)
ds_read_b64_tr_b16 v[216:217], v236 offset:4096
ds_read_b64_tr_b16 v[220:221], v237 offset:4096
ds_read_b64_tr_b16 v[224:225], v238 offset:4096
ds_read_b64_tr_b16 v[228:229], v239 offset:4096
v_mfma_f32_16x16x32_bf16 v[40:43], v[208:211], v[176:179], v[40:43]
v_mfma_f32_16x16x32_bf16 v[60:63], v[212:215], v[176:179], v[60:63]
ds_read_b128 v[176:179], v244 offset:28672
v_mfma_f32_16x16x32_bf16 v[4:7], v[200:203], v[180:183], v[4:7]
v_mfma_f32_16x16x32_bf16 v[24:27], v[204:207], v[180:183], v[24:27]
v_mfma_f32_16x16x32_bf16 v[44:47], v[208:211], v[180:183], v[44:47]
s_waitcnt lgkmcnt(1)
s_mov_b32 m0, s5
s_mov_b32 s9, 245760
buffer_load_dwordx4 v232, s[52:55], s9 offen nt lds
s_mov_b32 s8, 248832
buffer_load_dwordx4 v232, s[52:55], s8 offen offset:1024 nt lds
v_mfma_f32_16x16x32_bf16 v[64:67], v[212:215], v[180:183], v[64:67]
ds_read_b128 v[180:183], v244 offset:29696
v_mfma_f32_16x16x32_bf16 v[8:11], v[200:203], v[184:187], v[8:11]
s_waitcnt vmcnt(6)
ds_read_b64_tr_b16 v[218:219], v236 offset:6144
ds_read_b64_tr_b16 v[222:223], v237 offset:6144
ds_read_b64_tr_b16 v[226:227], v238 offset:6144
ds_read_b64_tr_b16 v[230:231], v239 offset:6144
v_mfma_f32_16x16x32_bf16 v[28:31], v[204:207], v[184:187], v[28:31]
v_mfma_f32_16x16x32_bf16 v[48:51], v[208:211], v[184:187], v[48:51]
s_cmp_lg_u32 s3, 0
s_cbranch_scc1 L_fABgo
v_readfirstlane_b32 s10, v255
s_nop 3
s_cmp_ge_u32 s10, 8
s_cbranch_scc1 L_fABgo
s_lshl_b32 s10, s98, 2
v_mov_b32 v116, s10
L_fABpoll:
s_mov_b64 exec, 1
global_load_dword v117, v116, s[86:87] offset:0 sc1
s_mov_b64 exec, -1
s_waitcnt vmcnt(0)
v_readfirstlane_b32 s10, v117
s_nop 3
s_cmp_ge_u32 s10, 8
s_cbranch_scc1 L_fABgo
s_sleep 4
s_branch L_fABpoll
L_fABgo:
v_mfma_f32_16x16x32_bf16 v[68:71], v[212:215], v[184:187], v[68:71]
ds_read_b128 v[184:187], v244 offset:30720
v_mfma_f32_16x16x32_bf16 v[12:15], v[200:203], v[188:191], v[12:15]
v_mfma_f32_16x16x32_bf16 v[32:35], v[204:207], v[188:191], v[32:35]
s_waitcnt lgkmcnt(1)
s_mov_b32 m0, s5
s_mov_b32 s9, 251904
buffer_load_dwordx4 v232, s[52:55], s9 offen offset:2048 nt lds
s_mov_b32 s8, 254976
buffer_load_dwordx4 v232, s[52:55], s8 offen offset:3072 nt lds
v_mfma_f32_16x16x32_bf16 v[52:55], v[208:211], v[188:191], v[52:55]
v_mfma_f32_16x16x32_bf16 v[72:75], v[212:215], v[188:191], v[72:75]
ds_read_b128 v[188:191], v244 offset:31744
v_mfma_f32_16x16x32_bf16 v[16:19], v[200:203], v[160:163], v[16:19]
v_mfma_f32_16x16x32_bf16 v[36:39], v[204:207], v[160:163], v[36:39]
v_mfma_f32_16x16x32_bf16 v[56:59], v[208:211], v[160:163], v[56:59]
v_mfma_f32_16x16x32_bf16 v[76:79], v[212:215], v[160:163], v[76:79]
ds_read_b128 v[160:163], v244 offset:32768
v_mfma_f32_16x16x32_bf16 v[0:3], v[216:219], v[164:167], v[0:3]
v_mfma_f32_16x16x32_bf16 v[20:23], v[220:223], v[164:167], v[20:23]
s_waitcnt vmcnt(6)
ds_read_b64_tr_b16 v[200:201], v236 offset:0
ds_read_b64_tr_b16 v[204:205], v237 offset:0
ds_read_b64_tr_b16 v[208:209], v238 offset:0
ds_read_b64_tr_b16 v[212:213], v239 offset:0
v_mfma_f32_16x16x32_bf16 v[40:43], v[224:227], v[164:167], v[40:43]
v_mfma_f32_16x16x32_bf16 v[60:63], v[228:231], v[164:167], v[60:63]
ds_read_b128 v[164:167], v244 offset:33792
v_mfma_f32_16x16x32_bf16 v[4:7], v[216:219], v[168:171], v[4:7]
v_mfma_f32_16x16x32_bf16 v[24:27], v[220:223], v[168:171], v[24:27]
v_mfma_f32_16x16x32_bf16 v[44:47], v[224:227], v[168:171], v[44:47]
s_waitcnt lgkmcnt(1)
s_mov_b32 m0, s4
s_add_u32 s9, s76, 0
buffer_load_dwordx4 v234, s[56:59], s9 offen lds
s_add_u32 s8, s76, 6144
buffer_load_dwordx4 v234, s[56:59], s8 offen offset:1024 lds
v_mfma_f32_16x16x32_bf16 v[64:67], v[228:231], v[168:171], v[64:67]
ds_read_b128 v[168:171], v244 offset:34816
v_mfma_f32_16x16x32_bf16 v[8:11], v[216:219], v[172:175], v[8:11]
s_waitcnt vmcnt(6)
ds_read_b64_tr_b16 v[202:203], v236 offset:2048
ds_read_b64_tr_b16 v[206:207], v237 offset:2048
ds_read_b64_tr_b16 v[210:211], v238 offset:2048
ds_read_b64_tr_b16 v[214:215], v239 offset:2048
v_mfma_f32_16x16x32_bf16 v[28:31], v[220:223], v[172:175], v[28:31]
v_mfma_f32_16x16x32_bf16 v[48:51], v[224:227], v[172:175], v[48:51]
v_mfma_f32_16x16x32_bf16 v[68:71], v[228:231], v[172:175], v[68:71]
ds_read_b128 v[172:175], v244 offset:35840
v_mfma_f32_16x16x32_bf16 v[12:15], v[216:219], v[176:179], v[12:15]
v_mfma_f32_16x16x32_bf16 v[32:35], v[220:223], v[176:179], v[32:35]
s_waitcnt lgkmcnt(1)
s_mov_b32 m0, s4
s_add_u32 s9, s76, 12288
buffer_load_dwordx4 v234, s[56:59], s9 offen offset:2048 lds
s_add_u32 s8, s76, 18432
buffer_load_dwordx4 v234, s[56:59], s8 offen offset:3072 lds
v_mfma_f32_16x16x32_bf16 v[52:55], v[224:227], v[176:179], v[52:55]
v_mfma_f32_16x16x32_bf16 v[72:75], v[228:231], v[176:179], v[72:75]
ds_read_b128 v[176:179], v244 offset:36864
v_mfma_f32_16x16x32_bf16 v[16:19], v[216:219], v[180:183], v[16:19]
v_mfma_f32_16x16x32_bf16 v[36:39], v[220:223], v[180:183], v[36:39]
v_mfma_f32_16x16x32_bf16 v[56:59], v[224:227], v[180:183], v[56:59]
v_mfma_f32_16x16x32_bf16 v[76:79], v[228:231], v[180:183], v[76:79]
ds_read_b128 v[180:183], v244 offset:37888
v_mfma_f32_16x16x32_bf16 v[0:3], v[200:203], v[184:187], v[0:3]
v_mfma_f32_16x16x32_bf16 v[20:23], v[204:207], v[184:187], v[20:23]
s_waitcnt vmcnt(6)
ds_read_b64_tr_b16 v[216:217], v236 offset:4096
ds_read_b64_tr_b16 v[220:221], v237 offset:4096
ds_read_b64_tr_b16 v[224:225], v238 offset:4096
ds_read_b64_tr_b16 v[228:229], v239 offset:4096
v_mfma_f32_16x16x32_bf16 v[40:43], v[208:211], v[184:187], v[40:43]
v_mfma_f32_16x16x32_bf16 v[60:63], v[212:215], v[184:187], v[60:63]
ds_read_b128 v[184:187], v244 offset:38912
v_mfma_f32_16x16x32_bf16 v[4:7], v[200:203], v[188:191], v[4:7]
v_mfma_f32_16x16x32_bf16 v[24:27], v[204:207], v[188:191], v[24:27]
v_mfma_f32_16x16x32_bf16 v[44:47], v[208:211], v[188:191], v[44:47]
s_waitcnt lgkmcnt(1)
s_mov_b32 m0, s5
s_add_u32 s9, s76, 28672
buffer_load_dwordx4 v234, s[56:59], s9 offen lds
s_add_u32 s8, s76, 34816
buffer_load_dwordx4 v234, s[56:59], s8 offen offset:1024 lds
v_mfma_f32_16x16x32_bf16 v[64:67], v[212:215], v[188:191], v[64:67]
ds_read_b128 v[188:191], v244 offset:39936
v_mfma_f32_16x16x32_bf16 v[8:11], v[200:203], v[160:163], v[8:11]
s_waitcnt vmcnt(6)
ds_read_b64_tr_b16 v[218:219], v236 offset:6144
ds_read_b64_tr_b16 v[222:223], v237 offset:6144
ds_read_b64_tr_b16 v[226:227], v238 offset:6144
ds_read_b64_tr_b16 v[230:231], v239 offset:6144
v_mfma_f32_16x16x32_bf16 v[28:31], v[204:207], v[160:163], v[28:31]
v_mfma_f32_16x16x32_bf16 v[48:51], v[208:211], v[160:163], v[48:51]
v_mfma_f32_16x16x32_bf16 v[68:71], v[212:215], v[160:163], v[68:71]
v_mfma_f32_16x16x32_bf16 v[12:15], v[200:203], v[164:167], v[12:15]
v_mfma_f32_16x16x32_bf16 v[32:35], v[204:207], v[164:167], v[32:35]
s_waitcnt lgkmcnt(0)
s_mov_b32 m0, s5
s_add_u32 s9, s76, 40960
buffer_load_dwordx4 v234, s[56:59], s9 offen offset:2048 lds
s_add_u32 s8, s76, 47104
buffer_load_dwordx4 v234, s[56:59], s8 offen offset:3072 lds
v_mfma_f32_16x16x32_bf16 v[52:55], v[208:211], v[164:167], v[52:55]
v_mfma_f32_16x16x32_bf16 v[72:75], v[212:215], v[164:167], v[72:75]
v_mfma_f32_16x16x32_bf16 v[16:19], v[200:203], v[168:171], v[16:19]
s_barrier
v_mfma_f32_16x16x32_bf16 v[36:39], v[204:207], v[168:171], v[36:39]
v_mfma_f32_16x16x32_bf16 v[56:59], v[208:211], v[168:171], v[56:59]
v_mfma_f32_16x16x32_bf16 v[76:79], v[212:215], v[168:171], v[76:79]
v_mfma_f32_16x16x32_bf16 v[0:3], v[216:219], v[172:175], v[0:3]
v_mfma_f32_16x16x32_bf16 v[20:23], v[220:223], v[172:175], v[20:23]
s_waitcnt vmcnt(6)
ds_read_b64_tr_b16 v[200:201], v236 offset:0
ds_read_b64_tr_b16 v[204:205], v237 offset:0
ds_read_b64_tr_b16 v[208:209], v238 offset:0
ds_read_b64_tr_b16 v[212:213], v239 offset:0
v_mfma_f32_16x16x32_bf16 v[40:43], v[224:227], v[172:175], v[40:43]
v_mfma_f32_16x16x32_bf16 v[60:63], v[228:231], v[172:175], v[60:63]
v_mfma_f32_16x16x32_bf16 v[4:7], v[216:219], v[176:179], v[4:7]
v_mfma_f32_16x16x32_bf16 v[24:27], v[220:223], v[176:179], v[24:27]
v_mfma_f32_16x16x32_bf16 v[44:47], v[224:227], v[176:179], v[44:47]
s_waitcnt lgkmcnt(0)
s_mov_b32 m0, s4
s_add_u32 s9, s77, 0
buffer_load_dwordx4 v234, s[56:59], s9 offen lds
s_add_u32 s8, s77, 6144
buffer_load_dwordx4 v234, s[56:59], s8 offen offset:1024 lds
v_mfma_f32_16x16x32_bf16 v[64:67], v[228:231], v[176:179], v[64:67]
v_mfma_f32_16x16x32_bf16 v[8:11], v[216:219], v[180:183], v[8:11]
s_waitcnt vmcnt(6)
ds_read_b64_tr_b16 v[202:203], v236 offset:2048
ds_read_b64_tr_b16 v[206:207], v237 offset:2048
ds_read_b64_tr_b16 v[210:211], v238 offset:2048
ds_read_b64_tr_b16 v[214:215], v239 offset:2048
v_mfma_f32_16x16x32_bf16 v[28:31], v[220:223], v[180:183], v[28:31]
v_mfma_f32_16x16x32_bf16 v[48:51], v[224:227], v[180:183], v[48:51]
v_mfma_f32_16x16x32_bf16 v[68:71], v[228:231], v[180:183], v[68:71]
v_mfma_f32_16x16x32_bf16 v[12:15], v[216:219], v[184:187], v[12:15]
v_mfma_f32_16x16x32_bf16 v[32:35], v[220:223], v[184:187], v[32:35]
s_waitcnt lgkmcnt(0)
s_mov_b32 m0, s4
s_add_u32 s9, s77, 12288
buffer_load_dwordx4 v234, s[56:59], s9 offen offset:2048 lds
s_add_u32 s8, s77, 18432
buffer_load_dwordx4 v234, s[56:59], s8 offen offset:3072 lds
v_mfma_f32_16x16x32_bf16 v[52:55], v[224:227], v[184:187], v[52:55]
v_mfma_f32_16x16x32_bf16 v[72:75], v[228:231], v[184:187], v[72:75]
v_mfma_f32_16x16x32_bf16 v[16:19], v[216:219], v[188:191], v[16:19]
v_mfma_f32_16x16x32_bf16 v[36:39], v[220:223], v[188:191], v[36:39]
v_mfma_f32_16x16x32_bf16 v[56:59], v[224:227], v[188:191], v[56:59]
v_mfma_f32_16x16x32_bf16 v[76:79], v[228:231], v[188:191], v[76:79]
s_nop 7
v_add_u32 v252, s71, v242
v_mul_f32 v0, v0, v246
v_mul_f32 v1, v1, v246
v_mul_f32 v2, v2, v246
v_mul_f32 v3, v3, v246
v_mul_f32 v20, v20, v246
v_mul_f32 v21, v21, v246
v_mul_f32 v22, v22, v246
v_mul_f32 v23, v23, v246
v_cvt_pk_bf16_f32 v0, v0, v1
v_cvt_pk_bf16_f32 v1, v2, v3
v_cvt_pk_bf16_f32 v2, v20, v21
v_cvt_pk_bf16_f32 v3, v22, v23
ds_write_b128 v252, v[0:3] offset:0
v_mul_f32 v40, v40, v246
v_mul_f32 v41, v41, v246
v_mul_f32 v42, v42, v246
v_mul_f32 v43, v43, v246
v_mul_f32 v60, v60, v246
v_mul_f32 v61, v61, v246
v_mul_f32 v62, v62, v246
v_mul_f32 v63, v63, v246
v_cvt_pk_bf16_f32 v40, v40, v41
v_cvt_pk_bf16_f32 v41, v42, v43
v_cvt_pk_bf16_f32 v42, v60, v61
v_cvt_pk_bf16_f32 v43, v62, v63
ds_write_b128 v252, v[40:43] offset:5120
v_mul_f32 v4, v4, v247
v_mul_f32 v5, v5, v247
v_mul_f32 v6, v6, v247
v_mul_f32 v7, v7, v247
v_mul_f32 v24, v24, v247
v_mul_f32 v25, v25, v247
v_mul_f32 v26, v26, v247
v_mul_f32 v27, v27, v247
v_cvt_pk_bf16_f32 v4, v4, v5
v_cvt_pk_bf16_f32 v5, v6, v7
v_cvt_pk_bf16_f32 v6, v24, v25
v_cvt_pk_bf16_f32 v7, v26, v27
ds_write_b128 v252, v[4:7] offset:1024
v_mul_f32 v44, v44, v247
v_mul_f32 v45, v45, v247
v_mul_f32 v46, v46, v247
v_mul_f32 v47, v47, v247
v_mul_f32 v64, v64, v247
v_mul_f32 v65, v65, v247
v_mul_f32 v66, v66, v247
v_mul_f32 v67, v67, v247
v_cvt_pk_bf16_f32 v44, v44, v45
v_cvt_pk_bf16_f32 v45, v46, v47
v_cvt_pk_bf16_f32 v46, v64, v65
v_cvt_pk_bf16_f32 v47, v66, v67
ds_write_b128 v252, v[44:47] offset:6144
v_mul_f32 v8, v8, v248
v_mul_f32 v9, v9, v248
v_mul_f32 v10, v10, v248
v_mul_f32 v11, v11, v248
v_mul_f32 v28, v28, v248
v_mul_f32 v29, v29, v248
v_mul_f32 v30, v30, v248
v_mul_f32 v31, v31, v248
v_cvt_pk_bf16_f32 v8, v8, v9
v_cvt_pk_bf16_f32 v9, v10, v11
v_cvt_pk_bf16_f32 v10, v28, v29
v_cvt_pk_bf16_f32 v11, v30, v31
ds_write_b128 v252, v[8:11] offset:2048
v_mul_f32 v48, v48, v248
v_mul_f32 v49, v49, v248
v_mul_f32 v50, v50, v248
v_mul_f32 v51, v51, v248
v_mul_f32 v68, v68, v248
v_mul_f32 v69, v69, v248
v_mul_f32 v70, v70, v248
v_mul_f32 v71, v71, v248
v_cvt_pk_bf16_f32 v48, v48, v49
v_cvt_pk_bf16_f32 v49, v50, v51
v_cvt_pk_bf16_f32 v50, v68, v69
v_cvt_pk_bf16_f32 v51, v70, v71
ds_write_b128 v252, v[48:51] offset:7168
v_mul_f32 v12, v12, v249
v_mul_f32 v13, v13, v249
v_mul_f32 v14, v14, v249
v_mul_f32 v15, v15, v249
v_mul_f32 v32, v32, v249
v_mul_f32 v33, v33, v249
v_mul_f32 v34, v34, v249
v_mul_f32 v35, v35, v249
v_cvt_pk_bf16_f32 v12, v12, v13
v_cvt_pk_bf16_f32 v13, v14, v15
v_cvt_pk_bf16_f32 v14, v32, v33
v_cvt_pk_bf16_f32 v15, v34, v35
ds_write_b128 v252, v[12:15] offset:3072
v_mul_f32 v52, v52, v249
v_mul_f32 v53, v53, v249
v_mul_f32 v54, v54, v249
v_mul_f32 v55, v55, v249
v_mul_f32 v72, v72, v249
v_mul_f32 v73, v73, v249
v_mul_f32 v74, v74, v249
v_mul_f32 v75, v75, v249
v_cvt_pk_bf16_f32 v52, v52, v53
v_cvt_pk_bf16_f32 v53, v54, v55
v_cvt_pk_bf16_f32 v54, v72, v73
v_cvt_pk_bf16_f32 v55, v74, v75
ds_write_b128 v252, v[52:55] offset:8192
v_mul_f32 v16, v16, v250
v_mul_f32 v17, v17, v250
v_mul_f32 v18, v18, v250
v_mul_f32 v19, v19, v250
v_mul_f32 v36, v36, v250
v_mul_f32 v37, v37, v250
v_mul_f32 v38, v38, v250
v_mul_f32 v39, v39, v250
v_cvt_pk_bf16_f32 v16, v16, v17
v_cvt_pk_bf16_f32 v17, v18, v19
v_cvt_pk_bf16_f32 v18, v36, v37
v_cvt_pk_bf16_f32 v19, v38, v39
ds_write_b128 v252, v[16:19] offset:4096
v_mul_f32 v56, v56, v250
v_mul_f32 v57, v57, v250
v_mul_f32 v58, v58, v250
v_mul_f32 v59, v59, v250
v_mul_f32 v76, v76, v250
v_mul_f32 v77, v77, v250
v_mul_f32 v78, v78, v250
v_mul_f32 v79, v79, v250
v_cvt_pk_bf16_f32 v56, v56, v57
v_cvt_pk_bf16_f32 v57, v58, v59
v_cvt_pk_bf16_f32 v58, v76, v77
v_cvt_pk_bf16_f32 v59, v78, v79
ds_write_b128 v252, v[56:59] offset:9216
s_waitcnt lgkmcnt(0)
s_barrier
ds_read_b128 v[160:163], v242 offset:0
ds_read_b128 v[164:167], v242 offset:1024
ds_read_b128 v[168:171], v242 offset:2048
ds_read_b128 v[172:175], v242 offset:3072
ds_read_b128 v[176:179], v242 offset:4096
ds_read_b128 v[180:183], v242 offset:5120
ds_read_b128 v[184:187], v242 offset:6144
ds_read_b128 v[188:191], v242 offset:7168
ds_read_b128 v[192:195], v242 offset:8192
ds_read_b128 v[196:199], v242 offset:9216
s_waitcnt lgkmcnt(9)
v_mfma_f32_16x16x32_bf16 v[0:3], v[200:203], v[160:163], 0
v_mfma_f32_16x16x32_bf16 v[20:23], v[204:207], v[160:163], 0
s_waitcnt vmcnt(6)
ds_read_b64_tr_b16 v[216:217], v236 offset:4096
ds_read_b64_tr_b16 v[220:221], v237 offset:4096
ds_read_b64_tr_b16 v[224:225], v238 offset:4096
ds_read_b64_tr_b16 v[228:229], v239 offset:4096
v_mfma_f32_16x16x32_bf16 v[40:43], v[208:211], v[160:163], 0
v_mfma_f32_16x16x32_bf16 v[60:63], v[212:215], v[160:163], 0
ds_read_b128 v[160:163], v242 offset:10240
s_waitcnt lgkmcnt(13)
v_mfma_f32_16x16x32_bf16 v[4:7], v[200:203], v[164:167], 0
v_mfma_f32_16x16x32_bf16 v[24:27], v[204:207], v[164:167], 0
v_mfma_f32_16x16x32_bf16 v[44:47], v[208:211], v[164:167], 0
s_waitcnt lgkmcnt(1)
s_mov_b32 m0, s5
s_add_u32 s9, s77, 28672
buffer_load_dwordx4 v234, s[56:59], s9 offen lds
s_add_u32 s8, s77, 34816
buffer_load_dwordx4 v234, s[56:59], s8 offen offset:1024 lds
v_mfma_f32_16x16x32_bf16 v[64:67], v[212:215], v[164:167], 0
ds_read_b128 v[164:167], v242 offset:11264
v_mfma_f32_16x16x32_bf16 v[8:11], v[200:203], v[168:171], 0
s_waitcnt vmcnt(6)
ds_read_b64_tr_b16 v[218:219], v236 offset:6144
ds_read_b64_tr_b16 v[222:223], v237 offset:6144
ds_read_b64_tr_b16 v[226:227], v238 offset:6144
ds_read_b64_tr_b16 v[230:231], v239 offset:6144
v_mfma_f32_16x16x32_bf16 v[28:31], v[204:207], v[168:171], 0
v_mfma_f32_16x16x32_bf16 v[48:51], v[208:211], v[168:171], 0
v_mfma_f32_16x16x32_bf16 v[68:71], v[212:215], v[168:171], 0
ds_read_b128 v[168:171], v242 offset:12288
v_mfma_f32_16x16x32_bf16 v[12:15], v[200:203], v[172:175], 0
v_mfma_f32_16x16x32_bf16 v[32:35], v[204:207], v[172:175], 0
s_waitcnt lgkmcnt(1)
s_mov_b32 m0, s5
s_add_u32 s9, s77, 40960
buffer_load_dwordx4 v234, s[56:59], s9 offen offset:2048 lds
s_add_u32 s8, s77, 47104
buffer_load_dwordx4 v234, s[56:59], s8 offen offset:3072 lds
v_mfma_f32_16x16x32_bf16 v[52:55], v[208:211], v[172:175], 0
v_mfma_f32_16x16x32_bf16 v[72:75], v[212:215], v[172:175], 0
ds_read_b128 v[172:175], v242 offset:13312
v_mfma_f32_16x16x32_bf16 v[16:19], v[200:203], v[176:179], 0
v_mfma_f32_16x16x32_bf16 v[36:39], v[204:207], v[176:179], 0
v_mfma_f32_16x16x32_bf16 v[56:59], v[208:211], v[176:179], 0
v_mfma_f32_16x16x32_bf16 v[76:79], v[212:215], v[176:179], 0
ds_read_b128 v[176:179], v242 offset:14336
v_mfma_f32_16x16x32_bf16 v[0:3], v[216:219], v[180:183], v[0:3]
v_mfma_f32_16x16x32_bf16 v[20:23], v[220:223], v[180:183], v[20:23]
s_waitcnt vmcnt(6)
ds_read_b64_tr_b16 v[200:201], v236 offset:0
ds_read_b64_tr_b16 v[204:205], v237 offset:0
ds_read_b64_tr_b16 v[208:209], v238 offset:0
ds_read_b64_tr_b16 v[212:213], v239 offset:0
v_mfma_f32_16x16x32_bf16 v[40:43], v[224:227], v[180:183], v[40:43]
v_mfma_f32_16x16x32_bf16 v[60:63], v[228:231], v[180:183], v[60:63]
ds_read_b128 v[180:183], v242 offset:15360
v_mfma_f32_16x16x32_bf16 v[4:7], v[216:219], v[184:187], v[4:7]
v_mfma_f32_16x16x32_bf16 v[24:27], v[220:223], v[184:187], v[24:27]
v_mfma_f32_16x16x32_bf16 v[44:47], v[224:227], v[184:187], v[44:47]
s_waitcnt lgkmcnt(1)
s_mov_b32 m0, s4
s_add_u32 s9, s78, 0
buffer_load_dwordx4 v234, s[56:59], s9 offen lds
s_add_u32 s8, s78, 6144
buffer_load_dwordx4 v234, s[56:59], s8 offen offset:1024 lds
v_mfma_f32_16x16x32_bf16 v[64:67], v[228:231], v[184:187], v[64:67]
ds_read_b128 v[184:187], v242 offset:16384
v_mfma_f32_16x16x32_bf16 v[8:11], v[216:219], v[188:191], v[8:11]
s_waitcnt vmcnt(6)
ds_read_b64_tr_b16 v[202:203], v236 offset:2048
ds_read_b64_tr_b16 v[206:207], v237 offset:2048
ds_read_b64_tr_b16 v[210:211], v238 offset:2048
ds_read_b64_tr_b16 v[214:215], v239 offset:2048
v_mfma_f32_16x16x32_bf16 v[28:31], v[220:223], v[188:191], v[28:31]
v_mfma_f32_16x16x32_bf16 v[48:51], v[224:227], v[188:191], v[48:51]
v_mfma_f32_16x16x32_bf16 v[68:71], v[228:231], v[188:191], v[68:71]
ds_read_b128 v[188:191], v242 offset:17408
v_mfma_f32_16x16x32_bf16 v[12:15], v[216:219], v[192:195], v[12:15]
v_mfma_f32_16x16x32_bf16 v[32:35], v[220:223], v[192:195], v[32:35]
s_waitcnt lgkmcnt(1)
s_mov_b32 m0, s4
s_add_u32 s9, s78, 12288
buffer_load_dwordx4 v234, s[56:59], s9 offen offset:2048 lds
s_add_u32 s8, s78, 18432
buffer_load_dwordx4 v234, s[56:59], s8 offen offset:3072 lds
v_mfma_f32_16x16x32_bf16 v[52:55], v[224:227], v[192:195], v[52:55]
v_mfma_f32_16x16x32_bf16 v[72:75], v[228:231], v[192:195], v[72:75]
ds_read_b128 v[192:195], v242 offset:18432
v_mfma_f32_16x16x32_bf16 v[16:19], v[216:219], v[196:199], v[16:19]
v_mfma_f32_16x16x32_bf16 v[36:39], v[220:223], v[196:199], v[36:39]
v_mfma_f32_16x16x32_bf16 v[56:59], v[224:227], v[196:199], v[56:59]
v_mfma_f32_16x16x32_bf16 v[76:79], v[228:231], v[196:199], v[76:79]
ds_read_b128 v[196:199], v242 offset:19456
v_mfma_f32_16x16x32_bf16 v[0:3], v[200:203], v[160:163], v[0:3]
v_mfma_f32_16x16x32_bf16 v[20:23], v[204:207], v[160:163], v[20:23]
s_waitcnt vmcnt(6)
ds_read_b64_tr_b16 v[216:217], v236 offset:4096
ds_read_b64_tr_b16 v[220:221], v237 offset:4096
ds_read_b64_tr_b16 v[224:225], v238 offset:4096
ds_read_b64_tr_b16 v[228:229], v239 offset:4096
v_mfma_f32_16x16x32_bf16 v[40:43], v[208:211], v[160:163], v[40:43]
v_mfma_f32_16x16x32_bf16 v[60:63], v[212:215], v[160:163], v[60:63]
ds_read_b128 v[160:163], v242 offset:20480
v_mfma_f32_16x16x32_bf16 v[4:7], v[200:203], v[164:167], v[4:7]
v_mfma_f32_16x16x32_bf16 v[24:27], v[204:207], v[164:167], v[24:27]
v_mfma_f32_16x16x32_bf16 v[44:47], v[208:211], v[164:167], v[44:47]
s_waitcnt lgkmcnt(1)
s_mov_b32 m0, s5
s_add_u32 s9, s78, 28672
buffer_load_dwordx4 v234, s[56:59], s9 offen lds
s_add_u32 s8, s78, 34816
buffer_load_dwordx4 v234, s[56:59], s8 offen offset:1024 lds
v_mfma_f32_16x16x32_bf16 v[64:67], v[212:215], v[164:167], v[64:67]
ds_read_b128 v[164:167], v242 offset:21504
v_mfma_f32_16x16x32_bf16 v[8:11], v[200:203], v[168:171], v[8:11]
s_waitcnt vmcnt(6)
ds_read_b64_tr_b16 v[218:219], v236 offset:6144
ds_read_b64_tr_b16 v[222:223], v237 offset:6144
ds_read_b64_tr_b16 v[226:227], v238 offset:6144
ds_read_b64_tr_b16 v[230:231], v239 offset:6144
v_mfma_f32_16x16x32_bf16 v[28:31], v[204:207], v[168:171], v[28:31]
v_mfma_f32_16x16x32_bf16 v[48:51], v[208:211], v[168:171], v[48:51]
v_mfma_f32_16x16x32_bf16 v[68:71], v[212:215], v[168:171], v[68:71]
ds_read_b128 v[168:171], v242 offset:22528
v_mfma_f32_16x16x32_bf16 v[12:15], v[200:203], v[172:175], v[12:15]
v_mfma_f32_16x16x32_bf16 v[32:35], v[204:207], v[172:175], v[32:35]
s_waitcnt lgkmcnt(1)
s_mov_b32 m0, s5
s_add_u32 s9, s78, 40960
buffer_load_dwordx4 v234, s[56:59], s9 offen offset:2048 lds
s_add_u32 s8, s78, 47104
buffer_load_dwordx4 v234, s[56:59], s8 offen offset:3072 lds
v_mfma_f32_16x16x32_bf16 v[52:55], v[208:211], v[172:175], v[52:55]
v_mfma_f32_16x16x32_bf16 v[72:75], v[212:215], v[172:175], v[72:75]
ds_read_b128 v[172:175], v242 offset:23552
v_mfma_f32_16x16x32_bf16 v[16:19], v[200:203], v[176:179], v[16:19]
v_mfma_f32_16x16x32_bf16 v[36:39], v[204:207], v[176:179], v[36:39]
v_mfma_f32_16x16x32_bf16 v[56:59], v[208:211], v[176:179], v[56:59]
v_mfma_f32_16x16x32_bf16 v[76:79], v[212:215], v[176:179], v[76:79]
ds_read_b128 v[176:179], v242 offset:24576
v_mfma_f32_16x16x32_bf16 v[0:3], v[216:219], v[180:183], v[0:3]
v_mfma_f32_16x16x32_bf16 v[20:23], v[220:223], v[180:183], v[20:23]
s_waitcnt vmcnt(6)
ds_read_b64_tr_b16 v[200:201], v236 offset:0
ds_read_b64_tr_b16 v[204:205], v237 offset:0
ds_read_b64_tr_b16 v[208:209], v238 offset:0
ds_read_b64_tr_b16 v[212:213], v239 offset:0
v_mfma_f32_16x16x32_bf16 v[40:43], v[224:227], v[180:183], v[40:43]
v_mfma_f32_16x16x32_bf16 v[60:63], v[228:231], v[180:183], v[60:63]
ds_read_b128 v[180:183], v242 offset:25600
v_mfma_f32_16x16x32_bf16 v[4:7], v[216:219], v[184:187], v[4:7]
v_mfma_f32_16x16x32_bf16 v[24:27], v[220:223], v[184:187], v[24:27]
v_mfma_f32_16x16x32_bf16 v[44:47], v[224:227], v[184:187], v[44:47]
s_waitcnt lgkmcnt(1)
s_mov_b32 m0, s4
s_add_u32 s9, s79, 0
buffer_load_dwordx4 v234, s[56:59], s9 offen lds
s_add_u32 s8, s79, 6144
buffer_load_dwordx4 v234, s[56:59], s8 offen offset:1024 lds
v_mfma_f32_16x16x32_bf16 v[64:67], v[228:231], v[184:187], v[64:67]
ds_read_b128 v[184:187], v242 offset:26624
v_mfma_f32_16x16x32_bf16 v[8:11], v[216:219], v[188:191], v[8:11]
s_waitcnt vmcnt(6)
ds_read_b64_tr_b16 v[202:203], v236 offset:2048
ds_read_b64_tr_b16 v[206:207], v237 offset:2048
ds_read_b64_tr_b16 v[210:211], v238 offset:2048
ds_read_b64_tr_b16 v[214:215], v239 offset:2048
v_mfma_f32_16x16x32_bf16 v[28:31], v[220:223], v[188:191], v[28:31]
v_mfma_f32_16x16x32_bf16 v[48:51], v[224:227], v[188:191], v[48:51]
v_mfma_f32_16x16x32_bf16 v[68:71], v[228:231], v[188:191], v[68:71]
ds_read_b128 v[188:191], v242 offset:27648
v_mfma_f32_16x16x32_bf16 v[12:15], v[216:219], v[192:195], v[12:15]
v_mfma_f32_16x16x32_bf16 v[32:35], v[220:223], v[192:195], v[32:35]
s_waitcnt lgkmcnt(1)
s_mov_b32 m0, s4
s_add_u32 s9, s79, 12288
buffer_load_dwordx4 v234, s[56:59], s9 offen offset:2048 lds
s_add_u32 s8, s79, 18432
buffer_load_dwordx4 v234, s[56:59], s8 offen offset:3072 lds
v_mfma_f32_16x16x32_bf16 v[52:55], v[224:227], v[192:195], v[52:55]
v_mfma_f32_16x16x32_bf16 v[72:75], v[228:231], v[192:195], v[72:75]
ds_read_b128 v[192:195], v242 offset:28672
v_mfma_f32_16x16x32_bf16 v[16:19], v[216:219], v[196:199], v[16:19]
v_mfma_f32_16x16x32_bf16 v[36:39], v[220:223], v[196:199], v[36:39]
v_mfma_f32_16x16x32_bf16 v[56:59], v[224:227], v[196:199], v[56:59]
v_mfma_f32_16x16x32_bf16 v[76:79], v[228:231], v[196:199], v[76:79]
ds_read_b128 v[196:199], v242 offset:29696
v_mfma_f32_16x16x32_bf16 v[0:3], v[200:203], v[160:163], v[0:3]
v_mfma_f32_16x16x32_bf16 v[20:23], v[204:207], v[160:163], v[20:23]
s_waitcnt vmcnt(6)
ds_read_b64_tr_b16 v[216:217], v236 offset:4096
ds_read_b64_tr_b16 v[220:221], v237 offset:4096
ds_read_b64_tr_b16 v[224:225], v238 offset:4096
ds_read_b64_tr_b16 v[228:229], v239 offset:4096
v_mfma_f32_16x16x32_bf16 v[40:43], v[208:211], v[160:163], v[40:43]
v_mfma_f32_16x16x32_bf16 v[60:63], v[212:215], v[160:163], v[60:63]
ds_read_b128 v[160:163], v242 offset:30720
v_mfma_f32_16x16x32_bf16 v[4:7], v[200:203], v[164:167], v[4:7]
v_mfma_f32_16x16x32_bf16 v[24:27], v[204:207], v[164:167], v[24:27]
v_mfma_f32_16x16x32_bf16 v[44:47], v[208:211], v[164:167], v[44:47]
s_waitcnt lgkmcnt(1)
s_mov_b32 m0, s5
s_add_u32 s9, s79, 28672
buffer_load_dwordx4 v234, s[56:59], s9 offen lds
s_add_u32 s8, s79, 34816
buffer_load_dwordx4 v234, s[56:59], s8 offen offset:1024 lds
v_mfma_f32_16x16x32_bf16 v[64:67], v[212:215], v[164:167], v[64:67]
ds_read_b128 v[164:167], v242 offset:31744
v_mfma_f32_16x16x32_bf16 v[8:11], v[200:203], v[168:171], v[8:11]
s_waitcnt vmcnt(6)
ds_read_b64_tr_b16 v[218:219], v236 offset:6144
ds_read_b64_tr_b16 v[222:223], v237 offset:6144
ds_read_b64_tr_b16 v[226:227], v238 offset:6144
ds_read_b64_tr_b16 v[230:231], v239 offset:6144
v_mfma_f32_16x16x32_bf16 v[28:31], v[204:207], v[168:171], v[28:31]
v_mfma_f32_16x16x32_bf16 v[48:51], v[208:211], v[168:171], v[48:51]
v_mfma_f32_16x16x32_bf16 v[68:71], v[212:215], v[168:171], v[68:71]
ds_read_b128 v[168:171], v242 offset:32768
v_mfma_f32_16x16x32_bf16 v[12:15], v[200:203], v[172:175], v[12:15]
v_mfma_f32_16x16x32_bf16 v[32:35], v[204:207], v[172:175], v[32:35]
s_waitcnt lgkmcnt(1)
s_mov_b32 m0, s5
s_add_u32 s9, s79, 40960
buffer_load_dwordx4 v234, s[56:59], s9 offen offset:2048 lds
s_add_u32 s8, s79, 47104
buffer_load_dwordx4 v234, s[56:59], s8 offen offset:3072 lds
v_mfma_f32_16x16x32_bf16 v[52:55], v[208:211], v[172:175], v[52:55]
v_mfma_f32_16x16x32_bf16 v[72:75], v[212:215], v[172:175], v[72:75]
ds_read_b128 v[172:175], v242 offset:33792
v_mfma_f32_16x16x32_bf16 v[16:19], v[200:203], v[176:179], v[16:19]
v_mfma_f32_16x16x32_bf16 v[36:39], v[204:207], v[176:179], v[36:39]
v_mfma_f32_16x16x32_bf16 v[56:59], v[208:211], v[176:179], v[56:59]
v_mfma_f32_16x16x32_bf16 v[76:79], v[212:215], v[176:179], v[76:79]
ds_read_b128 v[176:179], v242 offset:34816
v_mfma_f32_16x16x32_bf16 v[0:3], v[216:219], v[180:183], v[0:3]
v_mfma_f32_16x16x32_bf16 v[20:23], v[220:223], v[180:183], v[20:23]
s_waitcnt vmcnt(6)
ds_read_b64_tr_b16 v[200:201], v236 offset:0
ds_read_b64_tr_b16 v[204:205], v237 offset:0
ds_read_b64_tr_b16 v[208:209], v238 offset:0
ds_read_b64_tr_b16 v[212:213], v239 offset:0
v_mfma_f32_16x16x32_bf16 v[40:43], v[224:227], v[180:183], v[40:43]
v_mfma_f32_16x16x32_bf16 v[60:63], v[228:231], v[180:183], v[60:63]
ds_read_b128 v[180:183], v242 offset:35840
v_mfma_f32_16x16x32_bf16 v[4:7], v[216:219], v[184:187], v[4:7]
v_mfma_f32_16x16x32_bf16 v[24:27], v[220:223], v[184:187], v[24:27]
v_mfma_f32_16x16x32_bf16 v[44:47], v[224:227], v[184:187], v[44:47]
s_waitcnt lgkmcnt(1)
s_mov_b32 m0, s4
s_add_u32 s9, s80, 0
buffer_load_dwordx4 v234, s[56:59], s9 offen lds
s_add_u32 s8, s80, 6144
buffer_load_dwordx4 v234, s[56:59], s8 offen offset:1024 lds
v_mfma_f32_16x16x32_bf16 v[64:67], v[228:231], v[184:187], v[64:67]
ds_read_b128 v[184:187], v242 offset:36864
v_mfma_f32_16x16x32_bf16 v[8:11], v[216:219], v[188:191], v[8:11]
s_waitcnt vmcnt(6)
ds_read_b64_tr_b16 v[202:203], v236 offset:2048
ds_read_b64_tr_b16 v[206:207], v237 offset:2048
ds_read_b64_tr_b16 v[210:211], v238 offset:2048
ds_read_b64_tr_b16 v[214:215], v239 offset:2048
v_mfma_f32_16x16x32_bf16 v[28:31], v[220:223], v[188:191], v[28:31]
v_mfma_f32_16x16x32_bf16 v[48:51], v[224:227], v[188:191], v[48:51]
v_mfma_f32_16x16x32_bf16 v[68:71], v[228:231], v[188:191], v[68:71]
ds_read_b128 v[188:191], v242 offset:37888
v_mfma_f32_16x16x32_bf16 v[12:15], v[216:219], v[192:195], v[12:15]
v_mfma_f32_16x16x32_bf16 v[32:35], v[220:223], v[192:195], v[32:35]
s_waitcnt lgkmcnt(1)
s_mov_b32 m0, s4
s_add_u32 s9, s80, 12288
buffer_load_dwordx4 v234, s[56:59], s9 offen offset:2048 lds
s_add_u32 s8, s80, 18432
buffer_load_dwordx4 v234, s[56:59], s8 offen offset:3072 lds
v_mfma_f32_16x16x32_bf16 v[52:55], v[224:227], v[192:195], v[52:55]
v_mfma_f32_16x16x32_bf16 v[72:75], v[228:231], v[192:195], v[72:75]
ds_read_b128 v[192:195], v242 offset:38912
v_mfma_f32_16x16x32_bf16 v[16:19], v[216:219], v[196:199], v[16:19]
v_mfma_f32_16x16x32_bf16 v[36:39], v[220:223], v[196:199], v[36:39]
v_mfma_f32_16x16x32_bf16 v[56:59], v[224:227], v[196:199], v[56:59]
v_mfma_f32_16x16x32_bf16 v[76:79], v[228:231], v[196:199], v[76:79]
ds_read_b128 v[196:199], v242 offset:39936
v_mfma_f32_16x16x32_bf16 v[0:3], v[200:203], v[160:163], v[0:3]
v_mfma_f32_16x16x32_bf16 v[20:23], v[204:207], v[160:163], v[20:23]
s_waitcnt vmcnt(6)
ds_read_b64_tr_b16 v[216:217], v236 offset:4096
ds_read_b64_tr_b16 v[220:221], v237 offset:4096
ds_read_b64_tr_b16 v[224:225], v238 offset:4096
ds_read_b64_tr_b16 v[228:229], v239 offset:4096
v_mfma_f32_16x16x32_bf16 v[40:43], v[208:211], v[160:163], v[40:43]
v_mfma_f32_16x16x32_bf16 v[60:63], v[212:215], v[160:163], v[60:63]
ds_read_b128 v[160:163], v243 offset:0
v_mfma_f32_16x16x32_bf16 v[4:7], v[200:203], v[164:167], v[4:7]
v_mfma_f32_16x16x32_bf16 v[24:27], v[204:207], v[164:167], v[24:27]
v_mfma_f32_16x16x32_bf16 v[44:47], v[208:211], v[164:167], v[44:47]
s_waitcnt lgkmcnt(1)
s_mov_b32 m0, s5
s_add_u32 s9, s80, 28672
buffer_load_dwordx4 v234, s[56:59], s9 offen lds
s_add_u32 s8, s80, 34816
buffer_load_dwordx4 v234, s[56:59], s8 offen offset:1024 lds
v_mfma_f32_16x16x32_bf16 v[64:67], v[212:215], v[164:167], v[64:67]
ds_read_b128 v[164:167], v243 offset:1024
v_mfma_f32_16x16x32_bf16 v[8:11], v[200:203], v[168:171], v[8:11]
s_waitcnt vmcnt(6)
ds_read_b64_tr_b16 v[218:219], v236 offset:6144
ds_read_b64_tr_b16 v[222:223], v237 offset:6144
ds_read_b64_tr_b16 v[226:227], v238 offset:6144
ds_read_b64_tr_b16 v[230:231], v239 offset:6144
v_mfma_f32_16x16x32_bf16 v[28:31], v[204:207], v[168:171], v[28:31]
v_mfma_f32_16x16x32_bf16 v[48:51], v[208:211], v[168:171], v[48:51]
v_mfma_f32_16x16x32_bf16 v[68:71], v[212:215], v[168:171], v[68:71]
ds_read_b128 v[168:171], v243 offset:2048
v_mfma_f32_16x16x32_bf16 v[12:15], v[200:203], v[172:175], v[12:15]
v_mfma_f32_16x16x32_bf16 v[32:35], v[204:207], v[172:175], v[32:35]
s_waitcnt lgkmcnt(1)
s_mov_b32 m0, s5
s_add_u32 s9, s80, 40960
buffer_load_dwordx4 v234, s[56:59], s9 offen offset:2048 lds
s_add_u32 s8, s80, 47104
buffer_load_dwordx4 v234, s[56:59], s8 offen offset:3072 lds
v_mfma_f32_16x16x32_bf16 v[52:55], v[208:211], v[172:175], v[52:55]
v_mfma_f32_16x16x32_bf16 v[72:75], v[212:215], v[172:175], v[72:75]
ds_read_b128 v[172:175], v243 offset:3072
v_mfma_f32_16x16x32_bf16 v[16:19], v[200:203], v[176:179], v[16:19]
v_mfma_f32_16x16x32_bf16 v[36:39], v[204:207], v[176:179], v[36:39]
v_mfma_f32_16x16x32_bf16 v[56:59], v[208:211], v[176:179], v[56:59]
v_mfma_f32_16x16x32_bf16 v[76:79], v[212:215], v[176:179], v[76:79]
ds_read_b128 v[176:179], v243 offset:4096
v_mfma_f32_16x16x32_bf16 v[0:3], v[216:219], v[180:183], v[0:3]
v_mfma_f32_16x16x32_bf16 v[20:23], v[220:223], v[180:183], v[20:23]
s_waitcnt vmcnt(6)
ds_read_b64_tr_b16 v[200:201], v236 offset:0
ds_read_b64_tr_b16 v[204:205], v237 offset:0
ds_read_b64_tr_b16 v[208:209], v238 offset:0
ds_read_b64_tr_b16 v[212:213], v239 offset:0
v_mfma_f32_16x16x32_bf16 v[40:43], v[224:227], v[180:183], v[40:43]
v_mfma_f32_16x16x32_bf16 v[60:63], v[228:231], v[180:183], v[60:63]
ds_read_b128 v[180:183], v243 offset:5120
v_mfma_f32_16x16x32_bf16 v[4:7], v[216:219], v[184:187], v[4:7]
v_mfma_f32_16x16x32_bf16 v[24:27], v[220:223], v[184:187], v[24:27]
v_mfma_f32_16x16x32_bf16 v[44:47], v[224:227], v[184:187], v[44:47]
s_waitcnt lgkmcnt(1)
s_mov_b32 m0, s4
s_add_u32 s9, s81, 0
buffer_load_dwordx4 v234, s[56:59], s9 offen lds
s_add_u32 s8, s81, 6144
buffer_load_dwordx4 v234, s[56:59], s8 offen offset:1024 lds
v_mfma_f32_16x16x32_bf16 v[64:67], v[228:231], v[184:187], v[64:67]
ds_read_b128 v[184:187], v243 offset:6144
v_mfma_f32_16x16x32_bf16 v[8:11], v[216:219], v[188:191], v[8:11]
s_waitcnt vmcnt(6)
ds_read_b64_tr_b16 v[202:203], v236 offset:2048
ds_read_b64_tr_b16 v[206:207], v237 offset:2048
ds_read_b64_tr_b16 v[210:211], v238 offset:2048
ds_read_b64_tr_b16 v[214:215], v239 offset:2048
v_mfma_f32_16x16x32_bf16 v[28:31], v[220:223], v[188:191], v[28:31]
v_mfma_f32_16x16x32_bf16 v[48:51], v[224:227], v[188:191], v[48:51]
v_mfma_f32_16x16x32_bf16 v[68:71], v[228:231], v[188:191], v[68:71]
ds_read_b128 v[188:191], v243 offset:7168
v_mfma_f32_16x16x32_bf16 v[12:15], v[216:219], v[192:195], v[12:15]
v_mfma_f32_16x16x32_bf16 v[32:35], v[220:223], v[192:195], v[32:35]
s_waitcnt lgkmcnt(1)
s_mov_b32 m0, s4
s_add_u32 s9, s81, 12288
buffer_load_dwordx4 v234, s[56:59], s9 offen offset:2048 lds
s_add_u32 s8, s81, 18432
buffer_load_dwordx4 v234, s[56:59], s8 offen offset:3072 lds
v_mfma_f32_16x16x32_bf16 v[52:55], v[224:227], v[192:195], v[52:55]
v_mfma_f32_16x16x32_bf16 v[72:75], v[228:231], v[192:195], v[72:75]
ds_read_b128 v[192:195], v243 offset:8192
v_mfma_f32_16x16x32_bf16 v[16:19], v[216:219], v[196:199], v[16:19]
v_mfma_f32_16x16x32_bf16 v[36:39], v[220:223], v[196:199], v[36:39]
v_mfma_f32_16x16x32_bf16 v[56:59], v[224:227], v[196:199], v[56:59]
v_mfma_f32_16x16x32_bf16 v[76:79], v[228:231], v[196:199], v[76:79]
ds_read_b128 v[196:199], v243 offset:9216
v_mfma_f32_16x16x32_bf16 v[0:3], v[200:203], v[160:163], v[0:3]
v_mfma_f32_16x16x32_bf16 v[20:23], v[204:207], v[160:163], v[20:23]
s_waitcnt vmcnt(6)
ds_read_b64_tr_b16 v[216:217], v236 offset:4096
ds_read_b64_tr_b16 v[220:221], v237 offset:4096
ds_read_b64_tr_b16 v[224:225], v238 offset:4096
ds_read_b64_tr_b16 v[228:229], v239 offset:4096
v_mfma_f32_16x16x32_bf16 v[40:43], v[208:211], v[160:163], v[40:43]
v_mfma_f32_16x16x32_bf16 v[60:63], v[212:215], v[160:163], v[60:63]
ds_read_b128 v[160:163], v243 offset:10240
v_mfma_f32_16x16x32_bf16 v[4:7], v[200:203], v[164:167], v[4:7]
v_mfma_f32_16x16x32_bf16 v[24:27], v[204:207], v[164:167], v[24:27]
v_mfma_f32_16x16x32_bf16 v[44:47], v[208:211], v[164:167], v[44:47]
s_waitcnt lgkmcnt(1)
s_mov_b32 m0, s5
s_add_u32 s9, s81, 28672
buffer_load_dwordx4 v234, s[56:59], s9 offen lds
s_add_u32 s8, s81, 34816
buffer_load_dwordx4 v234, s[56:59], s8 offen offset:1024 lds
v_mfma_f32_16x16x32_bf16 v[64:67], v[212:215], v[164:167], v[64:67]
ds_read_b128 v[164:167], v243 offset:11264
v_mfma_f32_16x16x32_bf16 v[8:11], v[200:203], v[168:171], v[8:11]
s_waitcnt vmcnt(6)
ds_read_b64_tr_b16 v[218:219], v236 offset:6144
ds_read_b64_tr_b16 v[222:223], v237 offset:6144
ds_read_b64_tr_b16 v[226:227], v238 offset:6144
ds_read_b64_tr_b16 v[230:231], v239 offset:6144
v_mfma_f32_16x16x32_bf16 v[28:31], v[204:207], v[168:171], v[28:31]
v_mfma_f32_16x16x32_bf16 v[48:51], v[208:211], v[168:171], v[48:51]
v_mfma_f32_16x16x32_bf16 v[68:71], v[212:215], v[168:171], v[68:71]
ds_read_b128 v[168:171], v243 offset:12288
v_mfma_f32_16x16x32_bf16 v[12:15], v[200:203], v[172:175], v[12:15]
v_mfma_f32_16x16x32_bf16 v[32:35], v[204:207], v[172:175], v[32:35]
s_waitcnt lgkmcnt(1)
s_mov_b32 m0, s5
s_add_u32 s9, s81, 40960
buffer_load_dwordx4 v234, s[56:59], s9 offen offset:2048 lds
s_add_u32 s8, s81, 47104
buffer_load_dwordx4 v234, s[56:59], s8 offen offset:3072 lds
v_mfma_f32_16x16x32_bf16 v[52:55], v[208:211], v[172:175], v[52:55]
v_mfma_f32_16x16x32_bf16 v[72:75], v[212:215], v[172:175], v[72:75]
ds_read_b128 v[172:175], v243 offset:13312
v_mfma_f32_16x16x32_bf16 v[16:19], v[200:203], v[176:179], v[16:19]
v_mfma_f32_16x16x32_bf16 v[36:39], v[204:207], v[176:179], v[36:39]
v_mfma_f32_16x16x32_bf16 v[56:59], v[208:211], v[176:179], v[56:59]
v_mfma_f32_16x16x32_bf16 v[76:79], v[212:215], v[176:179], v[76:79]
ds_read_b128 v[176:179], v243 offset:14336
v_mfma_f32_16x16x32_bf16 v[0:3], v[216:219], v[180:183], v[0:3]
v_mfma_f32_16x16x32_bf16 v[20:23], v[220:223], v[180:183], v[20:23]
s_waitcnt vmcnt(6)
ds_read_b64_tr_b16 v[200:201], v236 offset:0
ds_read_b64_tr_b16 v[204:205], v237 offset:0
ds_read_b64_tr_b16 v[208:209], v238 offset:0
ds_read_b64_tr_b16 v[212:213], v239 offset:0
v_mfma_f32_16x16x32_bf16 v[40:43], v[224:227], v[180:183], v[40:43]
v_mfma_f32_16x16x32_bf16 v[60:63], v[228:231], v[180:183], v[60:63]
ds_read_b128 v[180:183], v243 offset:15360
v_mfma_f32_16x16x32_bf16 v[4:7], v[216:219], v[184:187], v[4:7]
v_mfma_f32_16x16x32_bf16 v[24:27], v[220:223], v[184:187], v[24:27]
v_mfma_f32_16x16x32_bf16 v[44:47], v[224:227], v[184:187], v[44:47]
s_waitcnt lgkmcnt(1)
s_mov_b32 m0, s4
s_add_u32 s9, s82, 0
buffer_load_dwordx4 v234, s[56:59], s9 offen lds
s_add_u32 s8, s82, 6144
buffer_load_dwordx4 v234, s[56:59], s8 offen offset:1024 lds
v_mfma_f32_16x16x32_bf16 v[64:67], v[228:231], v[184:187], v[64:67]
ds_read_b128 v[184:187], v243 offset:16384
v_mfma_f32_16x16x32_bf16 v[8:11], v[216:219], v[188:191], v[8:11]
s_waitcnt vmcnt(6)
ds_read_b64_tr_b16 v[202:203], v236 offset:2048
ds_read_b64_tr_b16 v[206:207], v237 offset:2048
ds_read_b64_tr_b16 v[210:211], v238 offset:2048
ds_read_b64_tr_b16 v[214:215], v239 offset:2048
v_mfma_f32_16x16x32_bf16 v[28:31], v[220:223], v[188:191], v[28:31]
v_mfma_f32_16x16x32_bf16 v[48:51], v[224:227], v[188:191], v[48:51]
v_mfma_f32_16x16x32_bf16 v[68:71], v[228:231], v[188:191], v[68:71]
ds_read_b128 v[188:191], v243 offset:17408
v_mfma_f32_16x16x32_bf16 v[12:15], v[216:219], v[192:195], v[12:15]
v_mfma_f32_16x16x32_bf16 v[32:35], v[220:223], v[192:195], v[32:35]
s_waitcnt lgkmcnt(1)
s_mov_b32 m0, s4
s_add_u32 s9, s82, 12288
buffer_load_dwordx4 v234, s[56:59], s9 offen offset:2048 lds
s_add_u32 s8, s82, 18432
buffer_load_dwordx4 v234, s[56:59], s8 offen offset:3072 lds
v_mfma_f32_16x16x32_bf16 v[52:55], v[224:227], v[192:195], v[52:55]
v_mfma_f32_16x16x32_bf16 v[72:75], v[228:231], v[192:195], v[72:75]
ds_read_b128 v[192:195], v243 offset:18432
v_mfma_f32_16x16x32_bf16 v[16:19], v[216:219], v[196:199], v[16:19]
v_mfma_f32_16x16x32_bf16 v[36:39], v[220:223], v[196:199], v[36:39]
v_mfma_f32_16x16x32_bf16 v[56:59], v[224:227], v[196:199], v[56:59]
v_mfma_f32_16x16x32_bf16 v[76:79], v[228:231], v[196:199], v[76:79]
ds_read_b128 v[196:199], v243 offset:19456
v_mfma_f32_16x16x32_bf16 v[0:3], v[200:203], v[160:163], v[0:3]
v_mfma_f32_16x16x32_bf16 v[20:23], v[204:207], v[160:163], v[20:23]
s_waitcnt vmcnt(6)
ds_read_b64_tr_b16 v[216:217], v236 offset:4096
ds_read_b64_tr_b16 v[220:221], v237 offset:4096
ds_read_b64_tr_b16 v[224:225], v238 offset:4096
ds_read_b64_tr_b16 v[228:229], v239 offset:4096
v_mfma_f32_16x16x32_bf16 v[40:43], v[208:211], v[160:163], v[40:43]
v_mfma_f32_16x16x32_bf16 v[60:63], v[212:215], v[160:163], v[60:63]
ds_read_b128 v[160:163], v243 offset:20480
v_mfma_f32_16x16x32_bf16 v[4:7], v[200:203], v[164:167], v[4:7]
v_mfma_f32_16x16x32_bf16 v[24:27], v[204:207], v[164:167], v[24:27]
v_mfma_f32_16x16x32_bf16 v[44:47], v[208:211], v[164:167], v[44:47]
s_waitcnt lgkmcnt(1)
s_mov_b32 m0, s5
s_add_u32 s9, s82, 28672
buffer_load_dwordx4 v234, s[56:59], s9 offen lds
s_add_u32 s8, s82, 34816
buffer_load_dwordx4 v234, s[56:59], s8 offen offset:1024 lds
v_mfma_f32_16x16x32_bf16 v[64:67], v[212:215], v[164:167], v[64:67]
ds_read_b128 v[164:167], v243 offset:21504
v_mfma_f32_16x16x32_bf16 v[8:11], v[200:203], v[168:171], v[8:11]
s_waitcnt vmcnt(6)
ds_read_b64_tr_b16 v[218:219], v236 offset:6144
ds_read_b64_tr_b16 v[222:223], v237 offset:6144
ds_read_b64_tr_b16 v[226:227], v238 offset:6144
ds_read_b64_tr_b16 v[230:231], v239 offset:6144
v_mfma_f32_16x16x32_bf16 v[28:31], v[204:207], v[168:171], v[28:31]
v_mfma_f32_16x16x32_bf16 v[48:51], v[208:211], v[168:171], v[48:51]
v_mfma_f32_16x16x32_bf16 v[68:71], v[212:215], v[168:171], v[68:71]
ds_read_b128 v[168:171], v243 offset:22528
v_mfma_f32_16x16x32_bf16 v[12:15], v[200:203], v[172:175], v[12:15]
v_mfma_f32_16x16x32_bf16 v[32:35], v[204:207], v[172:175], v[32:35]
s_waitcnt lgkmcnt(1)
s_mov_b32 m0, s5
s_add_u32 s9, s82, 40960
buffer_load_dwordx4 v234, s[56:59], s9 offen offset:2048 lds
s_add_u32 s8, s82, 47104
buffer_load_dwordx4 v234, s[56:59], s8 offen offset:3072 lds
v_mfma_f32_16x16x32_bf16 v[52:55], v[208:211], v[172:175], v[52:55]
v_mfma_f32_16x16x32_bf16 v[72:75], v[212:215], v[172:175], v[72:75]
ds_read_b128 v[172:175], v243 offset:23552
v_mfma_f32_16x16x32_bf16 v[16:19], v[200:203], v[176:179], v[16:19]
v_mfma_f32_16x16x32_bf16 v[36:39], v[204:207], v[176:179], v[36:39]
v_mfma_f32_16x16x32_bf16 v[56:59], v[208:211], v[176:179], v[56:59]
v_mfma_f32_16x16x32_bf16 v[76:79], v[212:215], v[176:179], v[76:79]
ds_read_b128 v[176:179], v243 offset:24576
v_mfma_f32_16x16x32_bf16 v[0:3], v[216:219], v[180:183], v[0:3]
v_mfma_f32_16x16x32_bf16 v[20:23], v[220:223], v[180:183], v[20:23]
s_waitcnt vmcnt(6)
ds_read_b64_tr_b16 v[200:201], v236 offset:0
ds_read_b64_tr_b16 v[204:205], v237 offset:0
ds_read_b64_tr_b16 v[208:209], v238 offset:0
ds_read_b64_tr_b16 v[212:213], v239 offset:0
v_mfma_f32_16x16x32_bf16 v[40:43], v[224:227], v[180:183], v[40:43]
v_mfma_f32_16x16x32_bf16 v[60:63], v[228:231], v[180:183], v[60:63]
ds_read_b128 v[180:183], v243 offset:25600
v_mfma_f32_16x16x32_bf16 v[4:7], v[216:219], v[184:187], v[4:7]
v_mfma_f32_16x16x32_bf16 v[24:27], v[220:223], v[184:187], v[24:27]
v_mfma_f32_16x16x32_bf16 v[44:47], v[224:227], v[184:187], v[44:47]
s_waitcnt lgkmcnt(1)
s_mov_b32 m0, s4
s_add_u32 s9, s83, 0
buffer_load_dwordx4 v234, s[56:59], s9 offen lds
s_add_u32 s8, s83, 6144
buffer_load_dwordx4 v234, s[56:59], s8 offen offset:1024 lds
v_mfma_f32_16x16x32_bf16 v[64:67], v[228:231], v[184:187], v[64:67]
ds_read_b128 v[184:187], v243 offset:26624
v_mfma_f32_16x16x32_bf16 v[8:11], v[216:219], v[188:191], v[8:11]
s_waitcnt vmcnt(6)
ds_read_b64_tr_b16 v[202:203], v236 offset:2048
ds_read_b64_tr_b16 v[206:207], v237 offset:2048
ds_read_b64_tr_b16 v[210:211], v238 offset:2048
ds_read_b64_tr_b16 v[214:215], v239 offset:2048
v_mfma_f32_16x16x32_bf16 v[28:31], v[220:223], v[188:191], v[28:31]
v_mfma_f32_16x16x32_bf16 v[48:51], v[224:227], v[188:191], v[48:51]
v_mfma_f32_16x16x32_bf16 v[68:71], v[228:231], v[188:191], v[68:71]
ds_read_b128 v[188:191], v243 offset:27648
v_mfma_f32_16x16x32_bf16 v[12:15], v[216:219], v[192:195], v[12:15]
v_mfma_f32_16x16x32_bf16 v[32:35], v[220:223], v[192:195], v[32:35]
s_waitcnt lgkmcnt(1)
s_mov_b32 m0, s4
s_add_u32 s9, s83, 12288
buffer_load_dwordx4 v234, s[56:59], s9 offen offset:2048 lds
s_add_u32 s8, s83, 18432
buffer_load_dwordx4 v234, s[56:59], s8 offen offset:3072 lds
v_mfma_f32_16x16x32_bf16 v[52:55], v[224:227], v[192:195], v[52:55]
v_mfma_f32_16x16x32_bf16 v[72:75], v[228:231], v[192:195], v[72:75]
ds_read_b128 v[192:195], v243 offset:28672
v_mfma_f32_16x16x32_bf16 v[16:19], v[216:219], v[196:199], v[16:19]
v_mfma_f32_16x16x32_bf16 v[36:39], v[220:223], v[196:199], v[36:39]
v_mfma_f32_16x16x32_bf16 v[56:59], v[224:227], v[196:199], v[56:59]
v_mfma_f32_16x16x32_bf16 v[76:79], v[228:231], v[196:199], v[76:79]
ds_read_b128 v[196:199], v243 offset:29696
v_mfma_f32_16x16x32_bf16 v[0:3], v[200:203], v[160:163], v[0:3]
v_mfma_f32_16x16x32_bf16 v[20:23], v[204:207], v[160:163], v[20:23]
s_waitcnt vmcnt(6)
ds_read_b64_tr_b16 v[216:217], v236 offset:4096
ds_read_b64_tr_b16 v[220:221], v237 offset:4096
ds_read_b64_tr_b16 v[224:225], v238 offset:4096
ds_read_b64_tr_b16 v[228:229], v239 offset:4096
v_mfma_f32_16x16x32_bf16 v[40:43], v[208:211], v[160:163], v[40:43]
v_mfma_f32_16x16x32_bf16 v[60:63], v[212:215], v[160:163], v[60:63]
ds_read_b128 v[160:163], v243 offset:30720
v_mfma_f32_16x16x32_bf16 v[4:7], v[200:203], v[164:167], v[4:7]
v_mfma_f32_16x16x32_bf16 v[24:27], v[204:207], v[164:167], v[24:27]
v_mfma_f32_16x16x32_bf16 v[44:47], v[208:211], v[164:167], v[44:47]
s_waitcnt lgkmcnt(1)
s_mov_b32 m0, s5
s_add_u32 s9, s83, 28672
buffer_load_dwordx4 v234, s[56:59], s9 offen lds
s_add_u32 s8, s83, 34816
buffer_load_dwordx4 v234, s[56:59], s8 offen offset:1024 lds
v_mfma_f32_16x16x32_bf16 v[64:67], v[212:215], v[164:167], v[64:67]
ds_read_b128 v[164:167], v243 offset:31744
v_mfma_f32_16x16x32_bf16 v[8:11], v[200:203], v[168:171], v[8:11]
s_waitcnt vmcnt(6)
ds_read_b64_tr_b16 v[218:219], v236 offset:6144
ds_read_b64_tr_b16 v[222:223], v237 offset:6144
ds_read_b64_tr_b16 v[226:227], v238 offset:6144
ds_read_b64_tr_b16 v[230:231], v239 offset:6144
v_mfma_f32_16x16x32_bf16 v[28:31], v[204:207], v[168:171], v[28:31]
v_mfma_f32_16x16x32_bf16 v[48:51], v[208:211], v[168:171], v[48:51]
v_mfma_f32_16x16x32_bf16 v[68:71], v[212:215], v[168:171], v[68:71]
ds_read_b128 v[168:171], v243 offset:32768
v_mfma_f32_16x16x32_bf16 v[12:15], v[200:203], v[172:175], v[12:15]
v_mfma_f32_16x16x32_bf16 v[32:35], v[204:207], v[172:175], v[32:35]
s_waitcnt lgkmcnt(1)
s_mov_b32 m0, s5
s_add_u32 s9, s83, 40960
buffer_load_dwordx4 v234, s[56:59], s9 offen offset:2048 lds
s_add_u32 s8, s83, 47104
buffer_load_dwordx4 v234, s[56:59], s8 offen offset:3072 lds
v_mfma_f32_16x16x32_bf16 v[52:55], v[208:211], v[172:175], v[52:55]
v_mfma_f32_16x16x32_bf16 v[72:75], v[212:215], v[172:175], v[72:75]
ds_read_b128 v[172:175], v243 offset:35840
v_mfma_f32_16x16x32_bf16 v[16:19], v[200:203], v[176:179], v[16:19]
v_mfma_f32_16x16x32_bf16 v[36:39], v[204:207], v[176:179], v[36:39]
v_mfma_f32_16x16x32_bf16 v[56:59], v[208:211], v[176:179], v[56:59]
v_mfma_f32_16x16x32_bf16 v[76:79], v[212:215], v[176:179], v[76:79]
ds_read_b128 v[176:179], v243 offset:36864
v_mfma_f32_16x16x32_bf16 v[0:3], v[216:219], v[180:183], v[0:3]
v_mfma_f32_16x16x32_bf16 v[20:23], v[220:223], v[180:183], v[20:23]
s_waitcnt vmcnt(6)
ds_read_b64_tr_b16 v[200:201], v236 offset:0
ds_read_b64_tr_b16 v[204:205], v237 offset:0
ds_read_b64_tr_b16 v[208:209], v238 offset:0
ds_read_b64_tr_b16 v[212:213], v239 offset:0
v_mfma_f32_16x16x32_bf16 v[40:43], v[224:227], v[180:183], v[40:43]
v_mfma_f32_16x16x32_bf16 v[60:63], v[228:231], v[180:183], v[60:63]
ds_read_b128 v[180:183], v243 offset:37888
v_mfma_f32_16x16x32_bf16 v[4:7], v[216:219], v[184:187], v[4:7]
v_mfma_f32_16x16x32_bf16 v[24:27], v[220:223], v[184:187], v[24:27]
v_mfma_f32_16x16x32_bf16 v[44:47], v[224:227], v[184:187], v[44:47]
v_mfma_f32_16x16x32_bf16 v[64:67], v[228:231], v[184:187], v[64:67]
ds_read_b128 v[184:187], v243 offset:33792
v_mfma_f32_16x16x32_bf16 v[8:11], v[216:219], v[188:191], v[8:11]
s_waitcnt vmcnt(4)
ds_read_b64_tr_b16 v[202:203], v236 offset:2048
ds_read_b64_tr_b16 v[206:207], v237 offset:2048
ds_read_b64_tr_b16 v[210:211], v238 offset:2048
ds_read_b64_tr_b16 v[214:215], v239 offset:2048
v_mfma_f32_16x16x32_bf16 v[28:31], v[220:223], v[188:191], v[28:31]
v_mfma_f32_16x16x32_bf16 v[48:51], v[224:227], v[188:191], v[48:51]
v_mfma_f32_16x16x32_bf16 v[68:71], v[228:231], v[188:191], v[68:71]
ds_read_b128 v[188:191], v243 offset:38912
v_mfma_f32_16x16x32_bf16 v[12:15], v[216:219], v[192:195], v[12:15]
v_mfma_f32_16x16x32_bf16 v[32:35], v[220:223], v[192:195], v[32:35]
v_mfma_f32_16x16x32_bf16 v[52:55], v[224:227], v[192:195], v[52:55]
v_mfma_f32_16x16x32_bf16 v[72:75], v[228:231], v[192:195], v[72:75]
ds_read_b128 v[192:195], v243 offset:34816
v_mfma_f32_16x16x32_bf16 v[16:19], v[216:219], v[196:199], v[16:19]
v_mfma_f32_16x16x32_bf16 v[36:39], v[220:223], v[196:199], v[36:39]
v_mfma_f32_16x16x32_bf16 v[56:59], v[224:227], v[196:199], v[56:59]
v_mfma_f32_16x16x32_bf16 v[76:79], v[228:231], v[196:199], v[76:79]
ds_read_b128 v[196:199], v243 offset:39936
s_waitcnt lgkmcnt(6)
v_mfma_f32_16x16x32_bf16 v[0:3], v[200:203], v[160:163], v[0:3]
s_waitcnt vmcnt(2)
ds_read_b64_tr_b16 v[216:217], v236 offset:4096
ds_read_b64_tr_b16 v[220:221], v237 offset:4096
ds_read_b64_tr_b16 v[224:225], v238 offset:4096
ds_read_b64_tr_b16 v[228:229], v239 offset:4096
s_waitcnt lgkmcnt(9)
v_mfma_f32_16x16x32_bf16 v[20:23], v[204:207], v[160:163], v[20:23]
s_waitcnt vmcnt(0)
ds_read_b64_tr_b16 v[218:219], v236 offset:6144
ds_read_b64_tr_b16 v[222:223], v237 offset:6144
ds_read_b64_tr_b16 v[226:227], v238 offset:6144
ds_read_b64_tr_b16 v[230:231], v239 offset:6144
s_waitcnt lgkmcnt(12)
v_mfma_f32_16x16x32_bf16 v[40:43], v[208:211], v[160:163], v[40:43]
s_waitcnt lgkmcnt(11)
v_mfma_f32_16x16x32_bf16 v[60:63], v[212:215], v[160:163], v[60:63]
v_mfma_f32_16x16x32_bf16 v[4:7], v[200:203], v[164:167], v[4:7]
v_mfma_f32_16x16x32_bf16 v[24:27], v[204:207], v[164:167], v[24:27]
v_mfma_f32_16x16x32_bf16 v[44:47], v[208:211], v[164:167], v[44:47]
v_mfma_f32_16x16x32_bf16 v[64:67], v[212:215], v[164:167], v[64:67]
v_mfma_f32_16x16x32_bf16 v[8:11], v[200:203], v[168:171], v[8:11]
v_mfma_f32_16x16x32_bf16 v[28:31], v[204:207], v[168:171], v[28:31]
v_mfma_f32_16x16x32_bf16 v[48:51], v[208:211], v[168:171], v[48:51]
v_mfma_f32_16x16x32_bf16 v[68:71], v[212:215], v[168:171], v[68:71]
s_waitcnt lgkmcnt(3)
v_mfma_f32_16x16x32_bf16 v[0:3], v[216:219], v[172:175], v[0:3]
s_waitcnt lgkmcnt(2)
v_mfma_f32_16x16x32_bf16 v[20:23], v[220:223], v[172:175], v[20:23]
s_waitcnt lgkmcnt(1)
v_mfma_f32_16x16x32_bf16 v[40:43], v[224:227], v[172:175], v[40:43]
s_waitcnt lgkmcnt(0)
v_mfma_f32_16x16x32_bf16 v[60:63], v[228:231], v[172:175], v[60:63]
v_mfma_f32_16x16x32_bf16 v[4:7], v[216:219], v[176:179], v[4:7]
v_mfma_f32_16x16x32_bf16 v[24:27], v[220:223], v[176:179], v[24:27]
v_mfma_f32_16x16x32_bf16 v[44:47], v[224:227], v[176:179], v[44:47]
v_mfma_f32_16x16x32_bf16 v[64:67], v[228:231], v[176:179], v[64:67]
v_mfma_f32_16x16x32_bf16 v[8:11], v[216:219], v[180:183], v[8:11]
s_nop 2
v_lshlrev_b32 v254, 4, v235
v_cvt_pk_bf16_f32 v0, v0, v1
v_cvt_pk_bf16_f32 v1, v2, v3
v_cvt_pk_bf16_f32 v2, v20, v21
v_cvt_pk_bf16_f32 v3, v22, v23
s_mov_b32 s9, 0
buffer_store_dwordx4 v[0:3], v254, s[60:63], s9 offen sc1
v_cvt_pk_bf16_f32 v40, v40, v41
v_cvt_pk_bf16_f32 v41, v42, v43
v_cvt_pk_bf16_f32 v42, v60, v61
v_cvt_pk_bf16_f32 v43, v62, v63
s_mov_b32 s8, 5120
buffer_store_dwordx4 v[40:43], v254, s[60:63], s8 offen sc1
v_mfma_f32_16x16x32_bf16 v[28:31], v[220:223], v[180:183], v[28:31]
v_mfma_f32_16x16x32_bf16 v[48:51], v[224:227], v[180:183], v[48:51]
v_mfma_f32_16x16x32_bf16 v[68:71], v[228:231], v[180:183], v[68:71]
v_mfma_f32_16x16x32_bf16 v[12:15], v[200:203], v[184:187], v[12:15]
s_nop 2
v_cvt_pk_bf16_f32 v4, v4, v5
v_cvt_pk_bf16_f32 v5, v6, v7
v_cvt_pk_bf16_f32 v6, v24, v25
v_cvt_pk_bf16_f32 v7, v26, v27
s_mov_b32 s9, 1024
buffer_store_dwordx4 v[4:7], v254, s[60:63], s9 offen sc1
v_cvt_pk_bf16_f32 v44, v44, v45
v_cvt_pk_bf16_f32 v45, v46, v47
v_cvt_pk_bf16_f32 v46, v64, v65
v_cvt_pk_bf16_f32 v47, v66, v67
s_mov_b32 s8, 6144
buffer_store_dwordx4 v[44:47], v254, s[60:63], s8 offen sc1
v_mfma_f32_16x16x32_bf16 v[32:35], v[204:207], v[184:187], v[32:35]
v_mfma_f32_16x16x32_bf16 v[52:55], v[208:211], v[184:187], v[52:55]
v_mfma_f32_16x16x32_bf16 v[72:75], v[212:215], v[184:187], v[72:75]
v_mfma_f32_16x16x32_bf16 v[12:15], v[216:219], v[188:191], v[12:15]
s_nop 2
v_cvt_pk_bf16_f32 v8, v8, v9
v_cvt_pk_bf16_f32 v9, v10, v11
v_cvt_pk_bf16_f32 v10, v28, v29
v_cvt_pk_bf16_f32 v11, v30, v31
s_mov_b32 s9, 2048
buffer_store_dwordx4 v[8:11], v254, s[60:63], s9 offen sc1
v_cvt_pk_bf16_f32 v48, v48, v49
v_cvt_pk_bf16_f32 v49, v50, v51
v_cvt_pk_bf16_f32 v50, v68, v69
v_cvt_pk_bf16_f32 v51, v70, v71
s_mov_b32 s8, 7168
buffer_store_dwordx4 v[48:51], v254, s[60:63], s8 offen sc1
v_mfma_f32_16x16x32_bf16 v[32:35], v[220:223], v[188:191], v[32:35]
v_mfma_f32_16x16x32_bf16 v[52:55], v[224:227], v[188:191], v[52:55]
v_mfma_f32_16x16x32_bf16 v[72:75], v[228:231], v[188:191], v[72:75]
v_mfma_f32_16x16x32_bf16 v[16:19], v[200:203], v[192:195], v[16:19]
v_mfma_f32_16x16x32_bf16 v[36:39], v[204:207], v[192:195], v[36:39]
v_mfma_f32_16x16x32_bf16 v[56:59], v[208:211], v[192:195], v[56:59]
v_mfma_f32_16x16x32_bf16 v[76:79], v[212:215], v[192:195], v[76:79]
v_mfma_f32_16x16x32_bf16 v[16:19], v[216:219], v[196:199], v[16:19]
s_nop 2
v_cvt_pk_bf16_f32 v12, v12, v13
v_cvt_pk_bf16_f32 v13, v14, v15
v_cvt_pk_bf16_f32 v14, v32, v33
v_cvt_pk_bf16_f32 v15, v34, v35
s_mov_b32 s9, 3072
buffer_store_dwordx4 v[12:15], v254, s[60:63], s9 offen sc1
v_cvt_pk_bf16_f32 v52, v52, v53
v_cvt_pk_bf16_f32 v53, v54, v55
v_cvt_pk_bf16_f32 v54, v72, v73
v_cvt_pk_bf16_f32 v55, v74, v75
s_mov_b32 s8, 8192
buffer_store_dwordx4 v[52:55], v254, s[60:63], s8 offen sc1
v_mfma_f32_16x16x32_bf16 v[36:39], v[220:223], v[196:199], v[36:39]
v_mfma_f32_16x16x32_bf16 v[56:59], v[224:227], v[196:199], v[56:59]
v_mfma_f32_16x16x32_bf16 v[76:79], v[228:231], v[196:199], v[76:79]
s_nop 7
v_cvt_pk_bf16_f32 v16, v16, v17
v_cvt_pk_bf16_f32 v17, v18, v19
v_cvt_pk_bf16_f32 v18, v36, v37
v_cvt_pk_bf16_f32 v19, v38, v39
s_mov_b32 s9, 4096
buffer_store_dwordx4 v[16:19], v254, s[60:63], s9 offen sc1
v_cvt_pk_bf16_f32 v56, v56, v57
v_cvt_pk_bf16_f32 v57, v58, v59
v_cvt_pk_bf16_f32 v58, v76, v77
v_cvt_pk_bf16_f32 v59, v78, v79
s_mov_b32 s8, 9216
buffer_store_dwordx4 v[56:59], v254, s[60:63], s8 offen sc1
s_add_u32 s10, s98, 0
s_mul_i32 s10, s10, 573440
s_add_u32 s16, s88, s10
s_addc_u32 s17, s89, 0
s_mov_b32 s18, 573440
s_mov_b32 s19, 0x20000
s_cmp_lg_u32 s3, 7
s_cbranch_scc1 L_rAB1p1
s_mov_b32 s10, 0
buffer_load_dwordx4 v[80:83], v113, s[16:19], s10 offen sc1
s_add_u32 s10, s10, 71680
buffer_load_dwordx4 v[84:87], v113, s[16:19], s10 offen sc1
s_add_u32 s10, s10, 71680
buffer_load_dwordx4 v[88:91], v113, s[16:19], s10 offen sc1
s_add_u32 s10, s10, 71680
buffer_load_dwordx4 v[92:95], v113, s[16:19], s10 offen sc1
s_add_u32 s10, s10, 71680
buffer_load_dwordx4 v[96:99], v113, s[16:19], s10 offen sc1
s_add_u32 s10, s10, 71680
buffer_load_dwordx4 v[100:103], v113, s[16:19], s10 offen sc1
s_add_u32 s10, s10, 71680
buffer_load_dwordx4 v[104:107], v113, s[16:19], s10 offen sc1
s_add_u32 s10, s10, 71680
buffer_load_dwordx4 v[108:111], v113, s[16:19], s10 offen sc1
L_rAB1p1:
s_mov_b32 s10, 0
buffer_load_dwordx4 v[120:123], v112, s[16:19], s10 offen sc1
s_add_u32 s10, s10, 71680
buffer_load_dwordx4 v[124:127], v112, s[16:19], s10 offen sc1
s_add_u32 s10, s10, 71680
buffer_load_dwordx4 v[128:131], v112, s[16:19], s10 offen sc1
s_add_u32 s10, s10, 71680
buffer_load_dwordx4 v[132:135], v112, s[16:19], s10 offen sc1
s_add_u32 s10, s10, 71680
buffer_load_dwordx4 v[136:139], v112, s[16:19], s10 offen sc1
s_add_u32 s10, s10, 71680
buffer_load_dwordx4 v[140:143], v112, s[16:19], s10 offen sc1
s_add_u32 s10, s10, 71680
buffer_load_dwordx4 v[144:147], v112, s[16:19], s10 offen sc1
s_add_u32 s10, s10, 71680
buffer_load_dwordx4 v[148:151], v112, s[16:19], s10 offen sc1
s_waitcnt vmcnt(8)
s_waitcnt lgkmcnt(0)
s_barrier
s_cmp_lg_u32 s3, 0
s_cbranch_scc1 L_sigABb
s_mul_i32 s10, s98, 4352
s_add_u32 s10, s10, 41943040
v_mov_b32 v253, s10
v_mov_b32 v254, 1
s_mov_b64 exec, 1
global_atomic_add v253, v254, s[88:89] offset:0 sc1
s_mov_b64 exec, -1
L_sigABb:
s_waitcnt vmcnt(7)
s_cmp_lg_u32 s3, 7
s_cbranch_scc1 L_rAB1p2
v_lshlrev_b32 v160, 16, v80
v_and_b32 v161, 0xffff0000, v80
v_lshlrev_b32 v162, 16, v81
v_and_b32 v163, 0xffff0000, v81
v_lshlrev_b32 v164, 16, v82
v_and_b32 v165, 0xffff0000, v82
v_lshlrev_b32 v166, 16, v83
v_and_b32 v167, 0xffff0000, v83
v_lshlrev_b32 v168, 16, v84
v_and_b32 v169, 0xffff0000, v84
v_lshlrev_b32 v170, 16, v85
v_and_b32 v171, 0xffff0000, v85
v_lshlrev_b32 v172, 16, v86
v_and_b32 v173, 0xffff0000, v86
v_lshlrev_b32 v174, 16, v87
v_and_b32 v175, 0xffff0000, v87
v_pk_add_f32 v[160:161], v[160:161], v[168:169]
v_pk_add_f32 v[162:163], v[162:163], v[170:171]
v_pk_add_f32 v[164:165], v[164:165], v[172:173]
v_pk_add_f32 v[166:167], v[166:167], v[174:175]
v_lshlrev_b32 v168, 16, v88
v_and_b32 v169, 0xffff0000, v88
v_lshlrev_b32 v170, 16, v89
v_and_b32 v171, 0xffff0000, v89
v_lshlrev_b32 v172, 16, v90
v_and_b32 v173, 0xffff0000, v90
v_lshlrev_b32 v174, 16, v91
v_and_b32 v175, 0xffff0000, v91
v_pk_add_f32 v[160:161], v[160:161], v[168:169]
v_pk_add_f32 v[162:163], v[162:163], v[170:171]
v_pk_add_f32 v[164:165], v[164:165], v[172:173]
v_pk_add_f32 v[166:167], v[166:167], v[174:175]
v_lshlrev_b32 v168, 16, v92
v_and_b32 v169, 0xffff0000, v92
v_lshlrev_b32 v170, 16, v93
v_and_b32 v171, 0xffff0000, v93
v_lshlrev_b32 v172, 16, v94
v_and_b32 v173, 0xffff0000, v94
v_lshlrev_b32 v174, 16, v95
v_and_b32 v175, 0xffff0000, v95
v_pk_add_f32 v[160:161], v[160:161], v[168:169]
v_pk_add_f32 v[162:163], v[162:163], v[170:171]
v_pk_add_f32 v[164:165], v[164:165], v[172:173]
v_pk_add_f32 v[166:167], v[166:167], v[174:175]
v_lshlrev_b32 v168, 16, v96
v_and_b32 v169, 0xffff0000, v96
v_lshlrev_b32 v170, 16, v97
v_and_b32 v171, 0xffff0000, v97
v_lshlrev_b32 v172, 16, v98
v_and_b32 v173, 0xffff0000, v98
v_lshlrev_b32 v174, 16, v99
v_and_b32 v175, 0xffff0000, v99
v_pk_add_f32 v[160:161], v[160:161], v[168:169]
v_pk_add_f32 v[162:163], v[162:163], v[170:171]
v_pk_add_f32 v[164:165], v[164:165], v[172:173]
v_pk_add_f32 v[166:167], v[166:167], v[174:175]
v_lshlrev_b32 v168, 16, v100
v_and_b32 v169, 0xffff0000, v100
v_lshlrev_b32 v170, 16, v101
v_and_b32 v171, 0xffff0000, v101
v_lshlrev_b32 v172, 16, v102
v_and_b32 v173, 0xffff0000, v102
v_lshlrev_b32 v174, 16, v103
v_and_b32 v175, 0xffff0000, v103
v_pk_add_f32 v[160:161], v[160:161], v[168:169]
v_pk_add_f32 v[162:163], v[162:163], v[170:171]
v_pk_add_f32 v[164:165], v[164:165], v[172:173]
v_pk_add_f32 v[166:167], v[166:167], v[174:175]
v_lshlrev_b32 v168, 16, v104
v_and_b32 v169, 0xffff0000, v104
v_lshlrev_b32 v170, 16, v105
v_and_b32 v171, 0xffff0000, v105
v_lshlrev_b32 v172, 16, v106
v_and_b32 v173, 0xffff0000, v106
v_lshlrev_b32 v174, 16, v107
v_and_b32 v175, 0xffff0000, v107
v_pk_add_f32 v[160:161], v[160:161], v[168:169]
v_pk_add_f32 v[162:163], v[162:163], v[170:171]
v_pk_add_f32 v[164:165], v[164:165], v[172:173]
v_pk_add_f32 v[166:167], v[166:167], v[174:175]
v_lshlrev_b32 v168, 16, v108
v_and_b32 v169, 0xffff0000, v108
v_lshlrev_b32 v170, 16, v109
v_and_b32 v171, 0xffff0000, v109
v_lshlrev_b32 v172, 16, v110
v_and_b32 v173, 0xffff0000, v110
v_lshlrev_b32 v174, 16, v111
v_and_b32 v175, 0xffff0000, v111
v_pk_add_f32 v[160:161], v[160:161], v[168:169]
v_pk_add_f32 v[162:163], v[162:163], v[170:171]
v_pk_add_f32 v[164:165], v[164:165], v[172:173]
v_pk_add_f32 v[166:167], v[166:167], v[174:175]
v_cvt_pk_bf16_f32 v180, v160, v161
v_cvt_pk_bf16_f32 v181, v162, v163
v_cvt_pk_bf16_f32 v182, v164, v165
v_cvt_pk_bf16_f32 v183, v166, v167
buffer_store_dwordx2 v[180:181], v115, s[20:23], 0 offen offset:0
buffer_store_dwordx2 v[182:183], v115, s[20:23], 0 offen offset:32
L_rAB1p2:
v_lshlrev_b32 v160, 16, v120
v_and_b32 v161, 0xffff0000, v120
v_lshlrev_b32 v162, 16, v121
v_and_b32 v163, 0xffff0000, v121
v_lshlrev_b32 v164, 16, v122
v_and_b32 v165, 0xffff0000, v122
v_lshlrev_b32 v166, 16, v123
v_and_b32 v167, 0xffff0000, v123
s_waitcnt vmcnt(6)
v_lshlrev_b32 v168, 16, v124
v_and_b32 v169, 0xffff0000, v124
v_lshlrev_b32 v170, 16, v125
v_and_b32 v171, 0xffff0000, v125
v_lshlrev_b32 v172, 16, v126
v_and_b32 v173, 0xffff0000, v126
v_lshlrev_b32 v174, 16, v127
v_and_b32 v175, 0xffff0000, v127
v_pk_add_f32 v[160:161], v[160:161], v[168:169]
v_pk_add_f32 v[162:163], v[162:163], v[170:171]
v_pk_add_f32 v[164:165], v[164:165], v[172:173]
v_pk_add_f32 v[166:167], v[166:167], v[174:175]
s_waitcnt vmcnt(5)
v_lshlrev_b32 v168, 16, v128
v_and_b32 v169, 0xffff0000, v128
v_lshlrev_b32 v170, 16, v129
v_and_b32 v171, 0xffff0000, v129
v_lshlrev_b32 v172, 16, v130
v_and_b32 v173, 0xffff0000, v130
v_lshlrev_b32 v174, 16, v131
v_and_b32 v175, 0xffff0000, v131
v_pk_add_f32 v[160:161], v[160:161], v[168:169]
v_pk_add_f32 v[162:163], v[162:163], v[170:171]
v_pk_add_f32 v[164:165], v[164:165], v[172:173]
v_pk_add_f32 v[166:167], v[166:167], v[174:175]
s_waitcnt vmcnt(4)
v_lshlrev_b32 v168, 16, v132
v_and_b32 v169, 0xffff0000, v132
v_lshlrev_b32 v170, 16, v133
v_and_b32 v171, 0xffff0000, v133
v_lshlrev_b32 v172, 16, v134
v_and_b32 v173, 0xffff0000, v134
v_lshlrev_b32 v174, 16, v135
v_and_b32 v175, 0xffff0000, v135
v_pk_add_f32 v[160:161], v[160:161], v[168:169]
v_pk_add_f32 v[162:163], v[162:163], v[170:171]
v_pk_add_f32 v[164:165], v[164:165], v[172:173]
v_pk_add_f32 v[166:167], v[166:167], v[174:175]
s_waitcnt vmcnt(3)
v_lshlrev_b32 v168, 16, v136
v_and_b32 v169, 0xffff0000, v136
v_lshlrev_b32 v170, 16, v137
v_and_b32 v171, 0xffff0000, v137
v_lshlrev_b32 v172, 16, v138
v_and_b32 v173, 0xffff0000, v138
v_lshlrev_b32 v174, 16, v139
v_and_b32 v175, 0xffff0000, v139
v_pk_add_f32 v[160:161], v[160:161], v[168:169]
v_pk_add_f32 v[162:163], v[162:163], v[170:171]
v_pk_add_f32 v[164:165], v[164:165], v[172:173]
v_pk_add_f32 v[166:167], v[166:167], v[174:175]
s_waitcnt vmcnt(2)
v_lshlrev_b32 v168, 16, v140
v_and_b32 v169, 0xffff0000, v140
v_lshlrev_b32 v170, 16, v141
v_and_b32 v171, 0xffff0000, v141
v_lshlrev_b32 v172, 16, v142
v_and_b32 v173, 0xffff0000, v142
v_lshlrev_b32 v174, 16, v143
v_and_b32 v175, 0xffff0000, v143
v_pk_add_f32 v[160:161], v[160:161], v[168:169]
v_pk_add_f32 v[162:163], v[162:163], v[170:171]
v_pk_add_f32 v[164:165], v[164:165], v[172:173]
v_pk_add_f32 v[166:167], v[166:167], v[174:175]
s_waitcnt vmcnt(1)
v_lshlrev_b32 v168, 16, v144
v_and_b32 v169, 0xffff0000, v144
v_lshlrev_b32 v170, 16, v145
v_and_b32 v171, 0xffff0000, v145
v_lshlrev_b32 v172, 16, v146
v_and_b32 v173, 0xffff0000, v146
v_lshlrev_b32 v174, 16, v147
v_and_b32 v175, 0xffff0000, v147
v_pk_add_f32 v[160:161], v[160:161], v[168:169]
v_pk_add_f32 v[162:163], v[162:163], v[170:171]
v_pk_add_f32 v[164:165], v[164:165], v[172:173]
v_pk_add_f32 v[166:167], v[166:167], v[174:175]
s_waitcnt vmcnt(0)
v_lshlrev_b32 v168, 16, v148
v_and_b32 v169, 0xffff0000, v148
v_lshlrev_b32 v170, 16, v149
v_and_b32 v171, 0xffff0000, v149
v_lshlrev_b32 v172, 16, v150
v_and_b32 v173, 0xffff0000, v150
v_lshlrev_b32 v174, 16, v151
v_and_b32 v175, 0xffff0000, v151
v_pk_add_f32 v[160:161], v[160:161], v[168:169]
v_pk_add_f32 v[162:163], v[162:163], v[170:171]
v_pk_add_f32 v[164:165], v[164:165], v[172:173]
v_pk_add_f32 v[166:167], v[166:167], v[174:175]
v_cvt_pk_bf16_f32 v176, v160, v161
v_cvt_pk_bf16_f32 v177, v162, v163
v_cvt_pk_bf16_f32 v178, v164, v165
v_cvt_pk_bf16_f32 v179, v166, v167
buffer_store_dwordx2 v[176:177], v114, s[20:23], 0 offen offset:0
buffer_store_dwordx2 v[178:179], v114, s[20:23], 0 offen offset:32
s_cmp_lg_u32 s3, 0
s_cbranch_scc1 L_rAB2go
s_mul_i32 s10, s98, 4352
s_add_u32 s10, s10, 41943040
v_mov_b32 v116, s10
L_rAB2poll:
s_mov_b64 exec, 1
global_load_dword v117, v116, s[88:89] offset:0 sc1
s_mov_b64 exec, -1
s_waitcnt vmcnt(0)
v_readfirstlane_b32 s10, v117
s_nop 3
s_cmp_ge_u32 s10, 8
s_cbranch_scc1 L_rAB2go
s_sleep 4
s_branch L_rAB2poll
L_rAB2go:
s_barrier
s_add_u32 s10, s98, 32
s_mul_i32 s10, s10, 573440
s_add_u32 s16, s88, s10
s_addc_u32 s17, s89, 0
s_mov_b32 s18, 573440
s_mov_b32 s19, 0x20000
s_cmp_lg_u32 s3, 7
s_cbranch_scc1 L_rAB2p1
s_mov_b32 s10, 0
buffer_load_dwordx4 v[80:83], v113, s[16:19], s10 offen sc1
s_add_u32 s10, s10, 71680
buffer_load_dwordx4 v[84:87], v113, s[16:19], s10 offen sc1
s_add_u32 s10, s10, 71680
buffer_load_dwordx4 v[88:91], v113, s[16:19], s10 offen sc1
s_add_u32 s10, s10, 71680
buffer_load_dwordx4 v[92:95], v113, s[16:19], s10 offen sc1
s_add_u32 s10, s10, 71680
buffer_load_dwordx4 v[96:99], v113, s[16:19], s10 offen sc1
s_add_u32 s10, s10, 71680
buffer_load_dwordx4 v[100:103], v113, s[16:19], s10 offen sc1
s_add_u32 s10, s10, 71680
buffer_load_dwordx4 v[104:107], v113, s[16:19], s10 offen sc1
s_add_u32 s10, s10, 71680
buffer_load_dwordx4 v[108:111], v113, s[16:19], s10 offen sc1
L_rAB2p1:
s_mov_b32 s10, 0
buffer_load_dwordx4 v[120:123], v112, s[16:19], s10 offen sc1
s_add_u32 s10, s10, 71680
buffer_load_dwordx4 v[124:127], v112, s[16:19], s10 offen sc1
s_add_u32 s10, s10, 71680
buffer_load_dwordx4 v[128:131], v112, s[16:19], s10 offen sc1
s_add_u32 s10, s10, 71680
buffer_load_dwordx4 v[132:135], v112, s[16:19], s10 offen sc1
s_add_u32 s10, s10, 71680
buffer_load_dwordx4 v[136:139], v112, s[16:19], s10 offen sc1
s_add_u32 s10, s10, 71680
buffer_load_dwordx4 v[140:143], v112, s[16:19], s10 offen sc1
s_add_u32 s10, s10, 71680
buffer_load_dwordx4 v[144:147], v112, s[16:19], s10 offen sc1
s_add_u32 s10, s10, 71680
buffer_load_dwordx4 v[148:151], v112, s[16:19], s10 offen sc1
s_waitcnt vmcnt(7)
s_cmp_lg_u32 s3, 7
s_cbranch_scc1 L_rAB2p2
v_lshlrev_b32 v160, 16, v80
v_and_b32 v161, 0xffff0000, v80
v_lshlrev_b32 v162, 16, v81
v_and_b32 v163, 0xffff0000, v81
v_lshlrev_b32 v164, 16, v82
v_and_b32 v165, 0xffff0000, v82
v_lshlrev_b32 v166, 16, v83
v_and_b32 v167, 0xffff0000, v83
v_lshlrev_b32 v168, 16, v84
v_and_b32 v169, 0xffff0000, v84
v_lshlrev_b32 v170, 16, v85
v_and_b32 v171, 0xffff0000, v85
v_lshlrev_b32 v172, 16, v86
v_and_b32 v173, 0xffff0000, v86
v_lshlrev_b32 v174, 16, v87
v_and_b32 v175, 0xffff0000, v87
v_pk_add_f32 v[160:161], v[160:161], v[168:169]
v_pk_add_f32 v[162:163], v[162:163], v[170:171]
v_pk_add_f32 v[164:165], v[164:165], v[172:173]
v_pk_add_f32 v[166:167], v[166:167], v[174:175]
v_lshlrev_b32 v168, 16, v88
v_and_b32 v169, 0xffff0000, v88
v_lshlrev_b32 v170, 16, v89
v_and_b32 v171, 0xffff0000, v89
v_lshlrev_b32 v172, 16, v90
v_and_b32 v173, 0xffff0000, v90
v_lshlrev_b32 v174, 16, v91
v_and_b32 v175, 0xffff0000, v91
v_pk_add_f32 v[160:161], v[160:161], v[168:169]
v_pk_add_f32 v[162:163], v[162:163], v[170:171]
v_pk_add_f32 v[164:165], v[164:165], v[172:173]
v_pk_add_f32 v[166:167], v[166:167], v[174:175]
v_lshlrev_b32 v168, 16, v92
v_and_b32 v169, 0xffff0000, v92
v_lshlrev_b32 v170, 16, v93
v_and_b32 v171, 0xffff0000, v93
v_lshlrev_b32 v172, 16, v94
v_and_b32 v173, 0xffff0000, v94
v_lshlrev_b32 v174, 16, v95
v_and_b32 v175, 0xffff0000, v95
v_pk_add_f32 v[160:161], v[160:161], v[168:169]
v_pk_add_f32 v[162:163], v[162:163], v[170:171]
v_pk_add_f32 v[164:165], v[164:165], v[172:173]
v_pk_add_f32 v[166:167], v[166:167], v[174:175]
v_lshlrev_b32 v168, 16, v96
v_and_b32 v169, 0xffff0000, v96
v_lshlrev_b32 v170, 16, v97
v_and_b32 v171, 0xffff0000, v97
v_lshlrev_b32 v172, 16, v98
v_and_b32 v173, 0xffff0000, v98
v_lshlrev_b32 v174, 16, v99
v_and_b32 v175, 0xffff0000, v99
v_pk_add_f32 v[160:161], v[160:161], v[168:169]
v_pk_add_f32 v[162:163], v[162:163], v[170:171]
v_pk_add_f32 v[164:165], v[164:165], v[172:173]
v_pk_add_f32 v[166:167], v[166:167], v[174:175]
v_lshlrev_b32 v168, 16, v100
v_and_b32 v169, 0xffff0000, v100
v_lshlrev_b32 v170, 16, v101
v_and_b32 v171, 0xffff0000, v101
v_lshlrev_b32 v172, 16, v102
v_and_b32 v173, 0xffff0000, v102
v_lshlrev_b32 v174, 16, v103
v_and_b32 v175, 0xffff0000, v103
v_pk_add_f32 v[160:161], v[160:161], v[168:169]
v_pk_add_f32 v[162:163], v[162:163], v[170:171]
v_pk_add_f32 v[164:165], v[164:165], v[172:173]
v_pk_add_f32 v[166:167], v[166:167], v[174:175]
v_lshlrev_b32 v168, 16, v104
v_and_b32 v169, 0xffff0000, v104
v_lshlrev_b32 v170, 16, v105
v_and_b32 v171, 0xffff0000, v105
v_lshlrev_b32 v172, 16, v106
v_and_b32 v173, 0xffff0000, v106
v_lshlrev_b32 v174, 16, v107
v_and_b32 v175, 0xffff0000, v107
v_pk_add_f32 v[160:161], v[160:161], v[168:169]
v_pk_add_f32 v[162:163], v[162:163], v[170:171]
v_pk_add_f32 v[164:165], v[164:165], v[172:173]
v_pk_add_f32 v[166:167], v[166:167], v[174:175]
v_lshlrev_b32 v168, 16, v108
v_and_b32 v169, 0xffff0000, v108
v_lshlrev_b32 v170, 16, v109
v_and_b32 v171, 0xffff0000, v109
v_lshlrev_b32 v172, 16, v110
v_and_b32 v173, 0xffff0000, v110
v_lshlrev_b32 v174, 16, v111
v_and_b32 v175, 0xffff0000, v111
v_pk_add_f32 v[160:161], v[160:161], v[168:169]
v_pk_add_f32 v[162:163], v[162:163], v[170:171]
v_pk_add_f32 v[164:165], v[164:165], v[172:173]
v_pk_add_f32 v[166:167], v[166:167], v[174:175]
v_cvt_pk_bf16_f32 v180, v160, v161
v_cvt_pk_bf16_f32 v181, v162, v163
v_cvt_pk_bf16_f32 v182, v164, v165
v_cvt_pk_bf16_f32 v183, v166, v167
buffer_store_dwordx2 v[180:181], v115, s[20:23], 0 offen offset:896
buffer_store_dwordx2 v[182:183], v115, s[20:23], 0 offen offset:928
L_rAB2p2:
v_lshlrev_b32 v160, 16, v120
v_and_b32 v161, 0xffff0000, v120
v_lshlrev_b32 v162, 16, v121
v_and_b32 v163, 0xffff0000, v121
v_lshlrev_b32 v164, 16, v122
v_and_b32 v165, 0xffff0000, v122
v_lshlrev_b32 v166, 16, v123
v_and_b32 v167, 0xffff0000, v123
s_waitcnt vmcnt(6)
v_lshlrev_b32 v168, 16, v124
v_and_b32 v169, 0xffff0000, v124
v_lshlrev_b32 v170, 16, v125
v_and_b32 v171, 0xffff0000, v125
v_lshlrev_b32 v172, 16, v126
v_and_b32 v173, 0xffff0000, v126
v_lshlrev_b32 v174, 16, v127
v_and_b32 v175, 0xffff0000, v127
v_pk_add_f32 v[160:161], v[160:161], v[168:169]
v_pk_add_f32 v[162:163], v[162:163], v[170:171]
v_pk_add_f32 v[164:165], v[164:165], v[172:173]
v_pk_add_f32 v[166:167], v[166:167], v[174:175]
s_waitcnt vmcnt(5)
v_lshlrev_b32 v168, 16, v128
v_and_b32 v169, 0xffff0000, v128
v_lshlrev_b32 v170, 16, v129
v_and_b32 v171, 0xffff0000, v129
v_lshlrev_b32 v172, 16, v130
v_and_b32 v173, 0xffff0000, v130
v_lshlrev_b32 v174, 16, v131
v_and_b32 v175, 0xffff0000, v131
v_pk_add_f32 v[160:161], v[160:161], v[168:169]
v_pk_add_f32 v[162:163], v[162:163], v[170:171]
v_pk_add_f32 v[164:165], v[164:165], v[172:173]
v_pk_add_f32 v[166:167], v[166:167], v[174:175]
s_waitcnt vmcnt(4)
v_lshlrev_b32 v168, 16, v132
v_and_b32 v169, 0xffff0000, v132
v_lshlrev_b32 v170, 16, v133
v_and_b32 v171, 0xffff0000, v133
v_lshlrev_b32 v172, 16, v134
v_and_b32 v173, 0xffff0000, v134
v_lshlrev_b32 v174, 16, v135
v_and_b32 v175, 0xffff0000, v135
v_pk_add_f32 v[160:161], v[160:161], v[168:169]
v_pk_add_f32 v[162:163], v[162:163], v[170:171]
v_pk_add_f32 v[164:165], v[164:165], v[172:173]
v_pk_add_f32 v[166:167], v[166:167], v[174:175]
s_waitcnt vmcnt(3)
v_lshlrev_b32 v168, 16, v136
v_and_b32 v169, 0xffff0000, v136
v_lshlrev_b32 v170, 16, v137
v_and_b32 v171, 0xffff0000, v137
v_lshlrev_b32 v172, 16, v138
v_and_b32 v173, 0xffff0000, v138
v_lshlrev_b32 v174, 16, v139
v_and_b32 v175, 0xffff0000, v139
v_pk_add_f32 v[160:161], v[160:161], v[168:169]
v_pk_add_f32 v[162:163], v[162:163], v[170:171]
v_pk_add_f32 v[164:165], v[164:165], v[172:173]
v_pk_add_f32 v[166:167], v[166:167], v[174:175]
s_waitcnt vmcnt(2)
v_lshlrev_b32 v168, 16, v140
v_and_b32 v169, 0xffff0000, v140
v_lshlrev_b32 v170, 16, v141
v_and_b32 v171, 0xffff0000, v141
v_lshlrev_b32 v172, 16, v142
v_and_b32 v173, 0xffff0000, v142
v_lshlrev_b32 v174, 16, v143
v_and_b32 v175, 0xffff0000, v143
v_pk_add_f32 v[160:161], v[160:161], v[168:169]
v_pk_add_f32 v[162:163], v[162:163], v[170:171]
v_pk_add_f32 v[164:165], v[164:165], v[172:173]
v_pk_add_f32 v[166:167], v[166:167], v[174:175]
s_waitcnt vmcnt(1)
v_lshlrev_b32 v168, 16, v144
v_and_b32 v169, 0xffff0000, v144
v_lshlrev_b32 v170, 16, v145
v_and_b32 v171, 0xffff0000, v145
v_lshlrev_b32 v172, 16, v146
v_and_b32 v173, 0xffff0000, v146
v_lshlrev_b32 v174, 16, v147
v_and_b32 v175, 0xffff0000, v147
v_pk_add_f32 v[160:161], v[160:161], v[168:169]
v_pk_add_f32 v[162:163], v[162:163], v[170:171]
v_pk_add_f32 v[164:165], v[164:165], v[172:173]
v_pk_add_f32 v[166:167], v[166:167], v[174:175]
s_waitcnt vmcnt(0)
v_lshlrev_b32 v168, 16, v148
v_and_b32 v169, 0xffff0000, v148
v_lshlrev_b32 v170, 16, v149
v_and_b32 v171, 0xffff0000, v149
v_lshlrev_b32 v172, 16, v150
v_and_b32 v173, 0xffff0000, v150
v_lshlrev_b32 v174, 16, v151
v_and_b32 v175, 0xffff0000, v151
v_pk_add_f32 v[160:161], v[160:161], v[168:169]
v_pk_add_f32 v[162:163], v[162:163], v[170:171]
v_pk_add_f32 v[164:165], v[164:165], v[172:173]
v_pk_add_f32 v[166:167], v[166:167], v[174:175]
v_cvt_pk_bf16_f32 v176, v160, v161
v_cvt_pk_bf16_f32 v177, v162, v163
v_cvt_pk_bf16_f32 v178, v164, v165
v_cvt_pk_bf16_f32 v179, v166, v167
buffer_store_dwordx2 v[176:177], v114, s[20:23], 0 offen offset:896
buffer_store_dwordx2 v[178:179], v114, s[20:23], 0 offen offset:928
s_endpgm
.section .rodata,"a"
.p2align 6
.amdhsa_kernel concat_heads__gqa_block_cached__mha_block_cached__near_ridge_kernel
  .amdhsa_next_free_vgpr 256
  .amdhsa_next_free_sgpr 102
  .amdhsa_accum_offset 256
  .amdhsa_group_segment_fixed_size 0
  .amdhsa_kernarg_size 104
  .amdhsa_user_sgpr_count 2
  .amdhsa_user_sgpr_kernarg_segment_ptr 1
  .amdhsa_system_sgpr_workgroup_id_x 1
  .amdhsa_float_denorm_mode_32 3
.end_amdhsa_kernel
```
